```python
import torch

def _softmax(x, axis=-1):
    return torch.softmax(x, dim=axis)
def _gelu(x):
    return torch.nn.functional.gelu(x, approximate="tanh")
def _silu(x):
    return torch.nn.functional.silu(x)
def _sigmoid(x):
    return torch.sigmoid(x)
def _layernorm(x, axis=-1, eps=1e-5):
    m = x.mean(dim=axis, keepdim=True)
    v = x.var(dim=axis, keepdim=True, unbiased=False)
    return (x - m) / torch.sqrt(v + eps)
def _scatter_add(tgt, idx, src, axis=0):
    return tgt.clone().index_add_(axis, idx, src)
def _segment_sum(src, seg, n):
    out = torch.zeros((n,) + src.shape[1:], dtype=src.dtype)
    return out.index_add_(0, seg, src)
def _pad(x, pw):
    flat = tuple(v for pair in reversed(pw) for v in pair)
    return torch.nn.functional.pad(x, flat)

kernel_name = 'recurrent_scan__softmax_full_mha__glu_gated_glu__prompt'

def setup_inputs():

    _w = (lambda a: (lambda t: t.to(torch.bfloat16) if t.is_floating_point() else t)(torch.as_tensor(a)))
    def _A_setup():
        B, S, D = 1, 2048, 576
        return {
            "x": _w((lambda *s: torch.randn(*s, dtype=torch.bfloat16) * 0.05)(B, S, D)),
            "wqkv": _w((lambda *s: torch.randn(*s, dtype=torch.bfloat16) * 0.05)(D, 3 * D)),
            "wo": _w((lambda *s: torch.randn(*s, dtype=torch.bfloat16) * 0.05)(D, D)),
        }
    _A_in = _A_setup()

    def _B_setup():
        B, S, D, F = 1, 2048, 576, 4608
        return {
            "x": _w((lambda *s: torch.randn(*s, dtype=torch.bfloat16) * 0.05)(B, S, D)),
            "w_gate": _w((lambda *s: torch.randn(*s, dtype=torch.bfloat16) * 0.05)(D, F)),
            "w_up": _w((lambda *s: torch.randn(*s, dtype=torch.bfloat16) * 0.05)(D, F)),
            "w_down": _w((lambda *s: torch.randn(*s, dtype=torch.bfloat16) * 0.05)(F, D)),
        }
    _B_in = _B_setup()

    return {
        "A_x": _A_in["x"],
        "A_wqkv": _A_in["wqkv"],
        "A_wo": _A_in["wo"],
        "B_x": _B_in["x"],
        "B_w_gate": _B_in["w_gate"],
        "B_w_up": _B_in["w_up"],
        "B_w_down": _B_in["w_down"],
    }

def reference(A_x, A_wqkv, A_wo, B_x, B_w_gate, B_w_up, B_w_down):
    def _A_ref(x, wqkv, wo):
        B, S, D = x.shape
        H = 32; Dh = D // H
        qkv = (lambda x, *d: x.permute(*d))((x @ wqkv).reshape(B, S, 3, H, Dh), 2, 0, 3, 1, 4)
        q, k, v = qkv[0], qkv[1], qkv[2]
        scale = Dh ** -0.5
        scores = torch.einsum("bhqd,bhkd->bhqk", q, k) * scale
        p = _softmax(scores, axis=-1)
        o = torch.einsum("bhqk,bhkd->bhqd", p, v)
        return (lambda x, *d: x.permute(*d))(o, 0, 2, 1, 3).reshape(B, S, D) @ wo

    def _B_ref(x, w_gate, w_up, w_down):
        g = torch.einsum("bsd,df->bsf", x, w_gate)
        u = torch.einsum("bsd,df->bsf", x, w_up)
        h = _sigmoid(g) * u
        return torch.einsum("bsf,fd->bsd", h, w_down)

    x = A_x
    xn = _layernorm(x, axis=-1)
    s = _A_ref(xn, A_wqkv, A_wo)
    g = _silu(_B_ref(xn, B_w_gate, B_w_up, B_w_down))
    return x + s * g
```

```asm
; @launch grid=(256,1,1) block=(512,1,1) lds=163840
.amdgcn_target "amdgcn-amd-amdhsa--gfx950"
.text
.globl recurrent_scan__softmax_full_mha__glu_gated_glu__prompt_kernel
.p2align 8
.type recurrent_scan__softmax_full_mha__glu_gated_glu__prompt_kernel,@function
recurrent_scan__softmax_full_mha__glu_gated_glu__prompt_kernel:
CODE_BEGIN:
    s_cmp_ge_u32 s2, 256
    s_cbranch_scc1 PK_done
    s_load_dwordx4 s[52:55], s[0:1], 0
    s_load_dwordx4 s[56:59], s[0:1], 32
    s_load_dwordx2 s[16:17], s[0:1], 48
    s_load_dwordx2 s[36:37], s[0:1], 64
    s_load_dwordx2 s[4:5], s[0:1], 72
    v_and_b32 v1, 63, v0
    v_lshrrev_b32 v2, 6, v0
    v_mov_b32 v30, 0x7ff00000
    v_readfirstlane_b32 s20, v2
    s_mov_b32 s6, 268435456
    s_mov_b32 s7, 0x20000
    s_mov_b32 s10, 5308416
    s_mov_b32 s11, 0x20000
    s_mov_b32 s14, 5308416
    s_mov_b32 s15, 0x20000
    s_mov_b32 s18, 5308416
    s_mov_b32 s19, 0x20000
    s_mov_b32 s38, 256
    s_mov_b32 s39, 0x20000
    s_mov_b32 s47, 0x20000
    s_cmp_ge_u32 s20, 4
    s_cbranch_scc1 PH0_ld
    s_lshl_b32 s3, s2, 3
    v_lshrrev_b32 v2, 5, v0
    v_and_b32 v20, 31, v0
    v_add_u32 v3, s3, v2
    v_mul_u32_u24 v3, 1152, v3
    v_mul_u32_u24 v21, 48, v20
    v_cmp_gt_u32 vcc, 24, v20
    v_add_u32 v3, v3, v21
    s_mov_b32 s46, 2359296
    v_cndmask_b32 v3, v30, v3, vcc
    s_waitcnt lgkmcnt(0)
    s_mov_b32 s44, s52
    s_mov_b32 s45, s53
    buffer_load_dwordx4 v[4:7], v3, s[44:47], 0 offen
    buffer_load_dwordx4 v[8:11], v3, s[44:47], 0 offen offset:16
    buffer_load_dwordx4 v[12:15], v3, s[44:47], 0 offen offset:32
    s_mov_b32 s8, s56
    s_mov_b32 s9, s57
    s_mov_b32 s12, s58
    s_mov_b32 s13, s59
    v_lshlrev_b32 v31, 3, v21
    v_lshl_add_u32 v31, v2, 4, v31
    v_add_u32 v31, 147456, v31
    v_lshlrev_b32 v39, 4, v0
    v_add_u32 v39, 147456, v39
    v_lshlrev_b32 v40, 11, v2
    v_bfe_u32 v41, v0, 3, 2
    v_lshl_add_u32 v40, v41, 8, v40
    v_and_b32 v41, 7, v0
    v_lshl_add_u32 v40, v41, 4, v40
    s_lshr_b32 s22, s2, 2
    s_mul_i32 s48, s22, 36864
    s_and_b32 s22, s2, 2
    s_lshl_b32 s22, s22, 9
    s_add_u32 s48, s48, s22
    s_and_b32 s22, s2, 1
    s_lshl_b32 s22, s22, 7
    s_add_u32 s48, s48, s22
    s_add_u32 s49, s48, 16384
    s_add_u32 s63, s48, 32768
    v_lshlrev_b32 v42, 2, v1
    s_lshl_b32 s22, s2, 7
    s_add_u32 s22, s22, 46010368
    v_add_u32 v42, s22, v42
    v_mov_b32 v43, 0
    v_and_b32 v245, 63, v0
    v_lshlrev_b32 v248, 4, v245
    s_and_b32 s23, s2, 7
    s_lshr_b32 s3, s2, 3
    s_and_b32 s24, s3, 3
    s_lshr_b32 s22, s3, 2
    s_lshl_b32 s21, s23, 2
    s_add_u32 s21, s21, s24
    s_mul_i32 s25, s23, 1152
    s_lshl_b32 s3, s24, 5
    s_add_u32 s26, s25, s3
    s_add_u32 s26, s26, 1024
    s_lshl_b32 s3, s24, 8
    s_add_u32 s25, s25, s3
    s_lshl_b32 s27, s20, 10
    s_lshl_b32 s28, s22, 3
    s_add_u32 s28, s28, s20
    s_mul_i32 s31, s28, 36864
    v_lshrrev_b32 v246, 3, v245
    v_and_b32 v247, 7, v245
    v_and_b32 v244, 2, v246
    v_xor_b32 v247, v247, v244
    s_and_b32 s3, s20, 1
    s_lshl_b32 s3, s3, 2
    v_xor_b32 v247, s3, v247
    s_lshl_b32 s3, s20, 3
    v_add_u32 v246, s3, v246
    v_mul_u32_u24 v246, 9216, v246
    v_lshl_add_u32 v249, v247, 4, v246
    v_lshrrev_b32 v244, 4, v245
    v_bfe_u32 v246, v245, 2, 2
    v_lshl_add_u32 v247, v244, 3, v246
    v_lshlrev_b32 v250, 7, v247
    v_lshrrev_b32 v246, 1, v246
    v_lshl_add_u32 v250, v246, 5, v250
    v_and_b32 v244, 1, v244
    v_lshl_add_u32 v250, v244, 6, v250
    v_and_b32 v244, 3, v245
    v_lshl_add_u32 v250, v244, 3, v250
    s_mul_i32 s40, s21, 73728
    s_add_u32 s40, s40, s27
    s_add_u32 s40, s40, 42467328
    s_mul_i32 s41, s21, 36864
    s_add_u32 s41, s41, s27
    s_add_u32 s41, s41, 44826624
    s_mul_i32 s32, s28, 294912
    s_lshl_b32 s3, s26, 5
    s_add_u32 s33, s32, s3
    s_add_u32 s33, s33, 10747904
    s_lshl_b32 s3, s25, 5
    s_add_u32 s32, s32, s3
    s_add_u32 s32, s32, 10747904
    s_lshl_b32 s3, s21, 6
    s_add_u32 s3, s3, s28
    s_lshl_b32 s34, s3, 10
    s_add_u32 s34, s34, 2359296
    s_mul_i32 s35, s3, 3072
    s_add_u32 s35, s35, 4456448
    s_mov_b32 s50, 0xbfb8aa3b
    s_mov_b32 s51, 0x3eae1a93
    s_waitcnt vmcnt(0)
    s_mov_b32 s60, 0x3f803f80
    s_mov_b32 s61, 0x00003f80
    s_mov_b32 s62, 0x3f800000
    v_dot2_f32_bf16 v16, v4, s60, 0
    v_dot2_f32_bf16 v17, v4, v4, 0
    v_dot2_f32_bf16 v18, v5, s60, 0
    v_dot2_f32_bf16 v19, v5, v5, 0
    v_dot2_f32_bf16 v16, v6, s60, v16
    v_dot2_f32_bf16 v17, v6, v6, v17
    v_dot2_f32_bf16 v18, v7, s60, v18
    v_dot2_f32_bf16 v19, v7, v7, v19
    v_dot2_f32_bf16 v16, v8, s60, v16
    v_dot2_f32_bf16 v17, v8, v8, v17
    v_dot2_f32_bf16 v18, v9, s60, v18
    v_dot2_f32_bf16 v19, v9, v9, v19
    v_dot2_f32_bf16 v16, v10, s60, v16
    v_dot2_f32_bf16 v17, v10, v10, v17
    v_dot2_f32_bf16 v18, v11, s60, v18
    v_dot2_f32_bf16 v19, v11, v11, v19
    v_dot2_f32_bf16 v16, v12, s60, v16
    v_dot2_f32_bf16 v17, v12, v12, v17
    v_dot2_f32_bf16 v18, v13, s60, v18
    v_dot2_f32_bf16 v19, v13, v13, v19
    v_dot2_f32_bf16 v16, v14, s60, v16
    v_dot2_f32_bf16 v17, v14, v14, v17
    v_dot2_f32_bf16 v18, v15, s60, v18
    v_dot2_f32_bf16 v19, v15, v15, v19
    s_nop 2
    v_add_f32 v16, v16, v18
    v_add_f32 v17, v17, v19
    s_nop 0
    v_add_f32_dpp v16, v16, v16 quad_perm:[1,0,3,2] row_mask:0xf bank_mask:0xf
    v_add_f32_dpp v17, v17, v17 quad_perm:[1,0,3,2] row_mask:0xf bank_mask:0xf
    s_nop 0
    v_add_f32_dpp v16, v16, v16 quad_perm:[2,3,0,1] row_mask:0xf bank_mask:0xf
    v_add_f32_dpp v17, v17, v17 quad_perm:[2,3,0,1] row_mask:0xf bank_mask:0xf
    s_nop 0
    v_add_f32_dpp v16, v16, v16 row_half_mirror row_mask:0xf bank_mask:0xf
    v_add_f32_dpp v17, v17, v17 row_half_mirror row_mask:0xf bank_mask:0xf
    s_nop 0
    v_add_f32_dpp v16, v16, v16 row_mirror row_mask:0xf bank_mask:0xf
    v_add_f32_dpp v17, v17, v17 row_mirror row_mask:0xf bank_mask:0xf
    v_mov_b32 v18, v16
    v_mov_b32 v19, v17
    s_nop 0
    v_permlane16_swap_b32 v16, v18
    v_permlane16_swap_b32 v17, v19
    v_add_f32 v16, v16, v18
    v_add_f32 v17, v17, v19
    v_mul_f32 v16, 0x3ae38e39, v16
    v_mul_f32 v17, 0x3ae38e39, v17
    v_fma_f32 v17, -v16, v16, v17
    v_max_f32 v17, 0, v17
    v_cvt_pk_bf16_f32 v16, v16, v17
    v_and_b32 v17, 0xffff0000, v16
    v_lshlrev_b32 v16, 16, v16
    v_add_f32 v17, 0x3727c5ac, v17
    v_sub_f32 v16, 0, v16
    v_cvt_pk_bf16_f32 v17, v17, v17
    v_lshlrev_b32 v17, 16, v17
    v_sqrt_f32 v17, v17
    v_dot2_f32_bf16 v44, v4, s61, v16
    v_dot2_f32_bf16 v45, v4, s62, v16
    v_dot2_f32_bf16 v46, v5, s61, v16
    v_dot2_f32_bf16 v47, v5, s62, v16
    v_dot2_f32_bf16 v48, v6, s61, v16
    v_dot2_f32_bf16 v49, v6, s62, v16
    v_dot2_f32_bf16 v50, v7, s61, v16
    v_dot2_f32_bf16 v51, v7, s62, v16
    v_dot2_f32_bf16 v52, v8, s61, v16
    v_dot2_f32_bf16 v53, v8, s62, v16
    v_dot2_f32_bf16 v54, v9, s61, v16
    v_dot2_f32_bf16 v55, v9, s62, v16
    v_dot2_f32_bf16 v56, v10, s61, v16
    v_dot2_f32_bf16 v57, v10, s62, v16
    v_dot2_f32_bf16 v58, v11, s61, v16
    v_dot2_f32_bf16 v59, v11, s62, v16
    v_dot2_f32_bf16 v60, v12, s61, v16
    v_dot2_f32_bf16 v61, v12, s62, v16
    v_dot2_f32_bf16 v62, v13, s61, v16
    v_dot2_f32_bf16 v63, v13, s62, v16
    v_dot2_f32_bf16 v64, v14, s61, v16
    v_dot2_f32_bf16 v65, v14, s62, v16
    v_dot2_f32_bf16 v66, v15, s61, v16
    v_dot2_f32_bf16 v67, v15, s62, v16
    v_cvt_pk_bf16_f32 v17, v17, v17
    v_lshlrev_b32 v17, 16, v17
    v_rcp_f32 v18, v17
    v_cvt_pk_bf16_f32 v4, v44, v45
    v_cvt_pk_bf16_f32 v5, v46, v47
    v_cvt_pk_bf16_f32 v6, v48, v49
    v_cvt_pk_bf16_f32 v7, v50, v51
    v_cvt_pk_bf16_f32 v8, v52, v53
    v_cvt_pk_bf16_f32 v9, v54, v55
    v_cvt_pk_bf16_f32 v10, v56, v57
    v_cvt_pk_bf16_f32 v11, v58, v59
    v_cvt_pk_bf16_f32 v12, v60, v61
    v_cvt_pk_bf16_f32 v13, v62, v63
    v_cvt_pk_bf16_f32 v14, v64, v65
    v_cvt_pk_bf16_f32 v15, v66, v67
    v_mov_b32 v19, v18
    v_lshlrev_b32 v44, 16, v4
    v_and_b32 v45, 0xffff0000, v4
    v_lshlrev_b32 v46, 16, v5
    v_and_b32 v47, 0xffff0000, v5
    v_lshlrev_b32 v48, 16, v6
    v_and_b32 v49, 0xffff0000, v6
    v_lshlrev_b32 v50, 16, v7
    v_and_b32 v51, 0xffff0000, v7
    v_lshlrev_b32 v52, 16, v8
    v_and_b32 v53, 0xffff0000, v8
    v_lshlrev_b32 v54, 16, v9
    v_and_b32 v55, 0xffff0000, v9
    v_lshlrev_b32 v56, 16, v10
    v_and_b32 v57, 0xffff0000, v10
    v_lshlrev_b32 v58, 16, v11
    v_and_b32 v59, 0xffff0000, v11
    v_lshlrev_b32 v60, 16, v12
    v_and_b32 v61, 0xffff0000, v12
    v_lshlrev_b32 v62, 16, v13
    v_and_b32 v63, 0xffff0000, v13
    v_lshlrev_b32 v64, 16, v14
    v_and_b32 v65, 0xffff0000, v14
    v_lshlrev_b32 v66, 16, v15
    v_and_b32 v67, 0xffff0000, v15
    v_pk_mul_f32 v[44:45], v[44:45], v[18:19]
    v_pk_mul_f32 v[46:47], v[46:47], v[18:19]
    v_pk_mul_f32 v[48:49], v[48:49], v[18:19]
    v_pk_mul_f32 v[50:51], v[50:51], v[18:19]
    v_pk_mul_f32 v[52:53], v[52:53], v[18:19]
    v_pk_mul_f32 v[54:55], v[54:55], v[18:19]
    v_pk_mul_f32 v[56:57], v[56:57], v[18:19]
    v_pk_mul_f32 v[58:59], v[58:59], v[18:19]
    v_pk_mul_f32 v[60:61], v[60:61], v[18:19]
    v_pk_mul_f32 v[62:63], v[62:63], v[18:19]
    v_pk_mul_f32 v[64:65], v[64:65], v[18:19]
    v_pk_mul_f32 v[66:67], v[66:67], v[18:19]
    v_cvt_pk_bf16_f32 v4, v44, v45
    v_cvt_pk_bf16_f32 v5, v46, v47
    v_cvt_pk_bf16_f32 v6, v48, v49
    v_cvt_pk_bf16_f32 v7, v50, v51
    v_cvt_pk_bf16_f32 v8, v52, v53
    v_cvt_pk_bf16_f32 v9, v54, v55
    v_cvt_pk_bf16_f32 v10, v56, v57
    v_cvt_pk_bf16_f32 v11, v58, v59
    v_cvt_pk_bf16_f32 v12, v60, v61
    v_cvt_pk_bf16_f32 v13, v62, v63
    v_cvt_pk_bf16_f32 v14, v64, v65
    v_cvt_pk_bf16_f32 v15, v66, v67
    s_mov_b64 exec, vcc
    ds_write_b128 v31, v[4:7]
    ds_write_b128 v31, v[8:11] offset:128
    ds_write_b128 v31, v[12:15] offset:256
    s_mov_b64 exec, -1
    s_waitcnt lgkmcnt(0)
    s_barrier
    ds_read_b128 v[44:47], v39
    ds_read_b128 v[48:51], v39 offset:4096
    s_cmp_lg_u32 s20, 0
    s_cbranch_scc1 PH0_w
    ds_read_b128 v[52:55], v39 offset:8192
    s_mov_b64 exec, 0xffffffff
    buffer_store_dword v43, v42, s[4:7], 0 offen sc1
    s_mov_b64 exec, -1
    s_waitcnt lgkmcnt(0)
    buffer_store_dwordx4 v[52:55], v40, s[4:7], s63 offen sc1
PH0_w:
    s_waitcnt lgkmcnt(0)
    buffer_store_dwordx4 v[44:47], v40, s[4:7], s48 offen sc1
    buffer_store_dwordx4 v[48:51], v40, s[4:7], s49 offen sc1
    s_lshr_b32 s62, s2, 5
    s_lshl_b32 s62, s62, 5
    v_mov_b32 v43, 1
    v_mov_b32 v41, 156672
    s_mov_b64 exec, 1
    s_waitcnt vmcnt(0)
    ds_add_rtn_u32 v40, v41, v43
    s_waitcnt lgkmcnt(0)
    v_cmp_ne_u32 vcc, 3, v40
    s_cbranch_vccnz PH0_a
    buffer_atomic_add v43, off, s[36:39], s62 sc0 sc1
    s_lshl_b32 s62, s62, 7
    s_add_u32 s62, s62, 46010404
    s_waitcnt vmcnt(0)
    v_cmp_ne_u32 vcc, 31, v43
    s_cbranch_vccnz PH0_a
    s_mov_b64 exec, 0xffffffff
    v_lshlrev_b32 v41, 7, v1
    v_mov_b32 v43, 1
    buffer_store_dword v43, v41, s[4:7], s62 offen sc1
PH0_a:
    s_mov_b64 exec, -1
    s_branch PH0_j
PH0_ld:
    v_lshrrev_b32 v32, 3, v1
    v_and_b32 v33, 7, v1
    s_and_b32 s22, s20, 1
    s_mul_i32 s22, s22, 36
    s_lshr_b32 s23, s2, 5
    s_mul_i32 s23, s23, 72
    s_add_u32 s22, s22, s23
    v_add_u32 v28, s22, v1
    v_mul_u32_u24 v28, 9216, v28
    v_cmp_gt_u32 vcc, 36, v1
    s_and_b32 s22, s2, 7
    s_mul_i32 s22, s22, 1152
    s_bfe_u32 s23, s2, 0x20003
    s_lshl_b32 s23, s23, 8
    s_add_u32 s22, s22, s23
    v_add_u32 v28, s22, v28
    v_cndmask_b32 v28, v30, v28, vcc
    s_mov_b32 s42, 5308416
    s_mov_b32 s43, 0x20000
    s_mov_b32 s46, 1990656
    s_cmp_lt_u32 s20, 6
    s_waitcnt lgkmcnt(0)
    s_cselect_b32 s40, s56, s58
    s_cselect_b32 s41, s57, s59
    s_mov_b32 s8, s56
    s_mov_b32 s9, s57
    s_mov_b32 s12, s58
    s_mov_b32 s13, s59
    s_mov_b32 s44, s54
    s_mov_b32 s45, s55
    v_mov_b32 v41, 156672
    v_mov_b32 v43, 0
    ds_write_b32 v41, v43
    v_and_b32 v245, 63, v0
    v_lshlrev_b32 v248, 4, v245
    s_and_b32 s23, s2, 7
    s_lshr_b32 s3, s2, 3
    s_and_b32 s24, s3, 3
    s_lshr_b32 s22, s3, 2
    s_lshl_b32 s21, s23, 2
    s_add_u32 s21, s21, s24
    s_mul_i32 s25, s23, 1152
    s_lshl_b32 s3, s24, 5
    s_add_u32 s26, s25, s3
    s_add_u32 s26, s26, 1024
    s_lshl_b32 s3, s24, 8
    s_add_u32 s25, s25, s3
    s_lshl_b32 s27, s20, 10
    s_lshl_b32 s28, s22, 3
    s_add_u32 s28, s28, s20
    s_mul_i32 s31, s28, 36864
    v_lshrrev_b32 v246, 3, v245
    v_and_b32 v247, 7, v245
    v_and_b32 v244, 2, v246
    v_xor_b32 v247, v247, v244
    s_and_b32 s3, s20, 1
    s_lshl_b32 s3, s3, 2
    v_xor_b32 v247, s3, v247
    s_lshl_b32 s3, s20, 3
    v_add_u32 v246, s3, v246
    v_mul_u32_u24 v246, 9216, v246
    v_lshl_add_u32 v249, v247, 4, v246
    s_and_b32 s48, s20, 3
    v_mul_u32_u24 v34, 13, v1
    v_lshrrev_b32 v34, 8, v34
    v_mul_u32_u24 v35, 20, v34
    v_sub_u32 v35, v1, v35
    v_mul_u32_u24 v36, 1152, v34
    v_lshl_add_u32 v36, v35, 4, v36
    s_mul_i32 s60, s48, 288
    v_add_u32 v36, s60, v36
    v_cmp_gt_u32 vcc, 18, v35
    v_cmp_gt_u32 s[52:53], 3, v34
    s_and_b64 vcc, vcc, s[52:53]
    v_bfe_u32 v37, v1, 4, 1
    v_mul_u32_u24 v37, 2654208, v37
    v_cndmask_b32 v64, v30, v36, vcc
    v_bfe_u32 v38, v1, 3, 1
    v_mul_u32_u24 v38, 1152, v38
    v_lshl_add_u32 v38, v33, 4, v38
    s_mul_i32 s60, s48, 2304
    s_add_u32 s60, s60, 1024
    v_add3_u32 v65, v37, v38, s60
    s_mul_i32 s52, s2, 3456
    s_mul_i32 s53, s2, 9216
    buffer_load_dword v62, v28, s[40:43], 0 offen
    s_add_u32 m0, s27, 114688
    s_add_u32 s60, s52, 0
    buffer_load_dwordx4 v64, s[44:47], s60 offen lds
    s_add_u32 m0, s27, 122880
    s_add_u32 s60, s52, 884736
    buffer_load_dwordx4 v64, s[44:47], s60 offen lds
    s_add_u32 m0, s27, 131072
    s_add_u32 s60, s53, 0
    s_mov_b64 exec, 0xffffffff
    buffer_load_dwordx4 v65, s[8:11], s60 offen lds
    s_not_b64 exec, exec
    buffer_load_dwordx4 v65, s[12:15], s60 offen lds
    s_mov_b64 exec, -1
    s_cmp_ge_u32 s2, 96
    s_cbranch_scc1 PH0_g2
    s_cmp_ge_u32 s2, 64
    s_cbranch_scc1 PH0_m2
    s_add_u32 m0, s27, 139264
    s_add_u32 s60, s52, 1769472
    buffer_load_dwordx4 v64, s[44:47], s60 offen lds
    s_branch PH0_g2
PH0_m2:
    s_add_u32 m0, s27, 139264
    s_add_u32 s60, s53, 1769472
    s_mov_b64 exec, 0xffffffff
    buffer_load_dwordx4 v65, s[8:11], s60 offen lds
    s_not_b64 exec, exec
    buffer_load_dwordx4 v65, s[12:15], s60 offen lds
    s_mov_b64 exec, -1
PH0_g2:
    s_and_b32 s49, s20, 3
    s_getpc_b64 s[96:97]
CT_pc1:
    s_sub_u32 s96, s96, CT_pc1-CODE_BEGIN
    s_subb_u32 s97, s97, 0
    s_mov_b32 s98, CODE_END-CODE_BEGIN
    s_mov_b32 s99, 0x20000
    s_lshr_b32 s62, s2, 3
    s_mul_i32 s62, s62, 4
    s_add_u32 s62, s62, s49
    s_mul_i32 s62, s62, 768
    v_lshlrev_b32 v100, 3, v248
    v_add_u32 v100, s62, v100
    s_mov_b64 exec, 63
    buffer_load_dword v101, v100, s[96:99], 0 offen
    s_mov_b64 exec, -1
    s_and_b32 s62, s2, 2
    s_lshr_b32 s63, s2, 1
    s_and_b32 s63, s63, 4
    s_or_b32 s62, s62, s63
    v_xor_b32 v34, s62, v33
    v_lshrrev_b32 v35, 1, v34
    v_and_b32 v36, 1, v34
    v_mul_u32_u24 v37, 36, v32
    v_cmp_eq_u32 s[54:55], 3, v35
    v_cmp_eq_u32 vcc, 6, v34
    v_sub_u32 v38, 2, v36
    v_lshlrev_b32 v39, 4, v36
    v_cndmask_b32 v38, v35, v38, s[54:55]
    v_cndmask_b32 v39, v39, 32, s[54:55]
    v_mul_u32_u24 v38, 320, v38
    v_add3_u32 v66, v37, v38, v39
    v_add_u32 v40, 32, v37
    v_mov_b32 v41, 960
    v_cndmask_b32 v40, v41, v40, vcc
    v_add_u32 v67, 8, v66
    v_cndmask_b32 v67, v67, v40, s[54:55]
    s_add_u32 s60, s27, 114688
    v_add_u32 v66, s60, v66
    v_add_u32 v67, s60, v67
    v_and_b32 v35, 1, v35
    v_lshlrev_b32 v68, 9, v35
    v_lshrrev_b32 v35, 2, v34
    v_lshl_add_u32 v68, v35, 8, v68
    v_lshl_add_u32 v68, v32, 5, v68
    v_lshl_add_u32 v68, v36, 4, v68
    v_add_u32 v68, s60, v68
    v_lshl_add_u32 v35, s48, 3, v32
    v_mul_u32_u24 v69, 73728, v35
    v_lshl_add_u32 v69, v33, 4, v69
    v_mul_u32_u24 v70, 36864, v35
    v_lshl_add_u32 v70, v33, 4, v70
    s_lshl_b32 s56, s2, 7
    s_add_u32 s57, s56, 44826624
    s_add_u32 s56, s56, 42467328
    s_waitcnt lgkmcnt(0)
    s_barrier
    v_lshrrev_b32 v244, 4, v245
    v_bfe_u32 v246, v245, 2, 2
    v_lshl_add_u32 v247, v244, 3, v246
    v_lshlrev_b32 v250, 7, v247
    v_lshrrev_b32 v246, 1, v246
    v_lshl_add_u32 v250, v246, 5, v250
    v_and_b32 v244, 1, v244
    v_lshl_add_u32 v250, v244, 6, v250
    v_and_b32 v244, 3, v245
    v_lshl_add_u32 v250, v244, 3, v250
    s_mul_i32 s40, s21, 73728
    s_add_u32 s40, s40, s27
    s_add_u32 s40, s40, 42467328
    s_mul_i32 s41, s21, 36864
    s_add_u32 s41, s41, s27
    s_add_u32 s41, s41, 44826624
    s_mul_i32 s32, s28, 294912
    s_lshl_b32 s3, s26, 5
    s_add_u32 s33, s32, s3
    s_add_u32 s33, s33, 10747904
    s_lshl_b32 s3, s25, 5
    s_add_u32 s32, s32, s3
    s_add_u32 s32, s32, 10747904
    s_lshl_b32 s3, s21, 6
    s_add_u32 s3, s3, s28
    s_lshl_b32 s34, s3, 10
    s_add_u32 s34, s34, 2359296
    s_mul_i32 s35, s3, 3072
    s_add_u32 s35, s35, 4456448
    s_mov_b32 s50, 0xbfb8aa3b
    s_mov_b32 s51, 0x3eae1a93
    v_subrev_u32 v29, 294912, v249
    s_sub_u32 s49, s27, 4096
    s_add_u32 m0, s49, 0
    s_add_u32 s30, s25, 0
    buffer_load_dwordx4 v29, s[8:11], s30 offen lds
    s_add_u32 m0, s27, 0
    s_nop 0
    buffer_load_dwordx4 v249, s[8:11], s30 offen lds
    s_add_u32 m0, s49, 8192
    s_add_u32 s30, s25, 589824
    buffer_load_dwordx4 v29, s[8:11], s30 offen lds
    s_add_u32 m0, s27, 8192
    s_nop 0
    buffer_load_dwordx4 v249, s[8:11], s30 offen lds
    s_add_u32 m0, s49, 16384
    s_add_u32 s30, s25, 1179648
    buffer_load_dwordx4 v29, s[8:11], s30 offen lds
    s_add_u32 m0, s27, 16384
    s_nop 0
    buffer_load_dwordx4 v249, s[8:11], s30 offen lds
    s_add_u32 m0, s49, 24576
    s_add_u32 s30, s25, 1769472
    buffer_load_dwordx4 v29, s[8:11], s30 offen lds
    s_add_u32 m0, s27, 24576
    s_nop 0
    buffer_load_dwordx4 v249, s[8:11], s30 offen lds
    s_add_u32 m0, s49, 32768
    s_add_u32 s30, s25, 2359296
    buffer_load_dwordx4 v29, s[8:11], s30 offen lds
    s_add_u32 m0, s27, 32768
    s_nop 0
    buffer_load_dwordx4 v249, s[8:11], s30 offen lds
    s_add_u32 m0, s49, 73728
    s_add_u32 s30, s25, 0
    buffer_load_dwordx4 v29, s[12:15], s30 offen lds
    s_add_u32 m0, s27, 73728
    s_nop 0
    buffer_load_dwordx4 v249, s[12:15], s30 offen lds
    s_add_u32 m0, s49, 81920
    s_add_u32 s30, s25, 589824
    buffer_load_dwordx4 v29, s[12:15], s30 offen lds
    s_add_u32 m0, s27, 81920
    s_nop 0
    buffer_load_dwordx4 v249, s[12:15], s30 offen lds
    s_add_u32 m0, s49, 90112
    s_add_u32 s30, s25, 1179648
    buffer_load_dwordx4 v29, s[12:15], s30 offen lds
    s_add_u32 m0, s27, 90112
    s_nop 0
    buffer_load_dwordx4 v249, s[12:15], s30 offen lds
    s_add_u32 m0, s49, 98304
    s_add_u32 s30, s25, 1769472
    buffer_load_dwordx4 v29, s[12:15], s30 offen lds
    s_add_u32 m0, s27, 98304
    s_nop 0
    buffer_load_dwordx4 v249, s[12:15], s30 offen lds
    s_add_u32 m0, s49, 106496
    s_add_u32 s30, s25, 2359296
    buffer_load_dwordx4 v29, s[12:15], s30 offen lds
    s_add_u32 m0, s27, 106496
    s_nop 0
    buffer_load_dwordx4 v249, s[12:15], s30 offen lds
    s_add_u32 m0, s49, 40960
    s_add_u32 s30, s25, 2949120
    buffer_load_dwordx4 v29, s[8:11], s30 offen lds
    s_add_u32 m0, s27, 40960
    s_nop 0
    buffer_load_dwordx4 v249, s[8:11], s30 offen lds
    s_add_u32 m0, s49, 49152
    s_add_u32 s30, s25, 3538944
    buffer_load_dwordx4 v29, s[8:11], s30 offen lds
    s_add_u32 m0, s27, 49152
    s_nop 0
    buffer_load_dwordx4 v249, s[8:11], s30 offen lds
    s_add_u32 m0, s49, 57344
    s_add_u32 s30, s25, 4128768
    buffer_load_dwordx4 v29, s[8:11], s30 offen lds
    s_add_u32 m0, s27, 57344
    s_nop 0
    buffer_load_dwordx4 v249, s[8:11], s30 offen lds
    s_add_u32 m0, s49, 65536
    s_add_u32 s30, s25, 4718592
    buffer_load_dwordx4 v29, s[8:11], s30 offen lds
    s_add_u32 m0, s27, 65536
    s_nop 0
    buffer_load_dwordx4 v249, s[8:11], s30 offen lds
    s_waitcnt vmcnt(28)
    v_add_u32 v71, 0, v66
    v_add_u32 v72, 0, v67
    ds_read2_b32 v[76:77], v71 offset1:1
    ds_read2_b32 v[78:79], v72 offset1:1
    s_add_u32 s60, s56, 0
    s_waitcnt lgkmcnt(0)
    v_cndmask_b32 v77, v77, 0, s[54:55]
    v_cndmask_b32 v79, v79, 0, s[54:55]
    buffer_store_dwordx4 v[76:79], v69, s[4:7], s60 offen sc1
    v_add_u32 v71, 8192, v66
    v_add_u32 v72, 8192, v67
    ds_read2_b32 v[80:81], v71 offset1:1
    ds_read2_b32 v[82:83], v72 offset1:1
    s_add_u32 s60, s56, 32768
    s_waitcnt lgkmcnt(0)
    v_cndmask_b32 v81, v81, 0, s[54:55]
    v_cndmask_b32 v83, v83, 0, s[54:55]
    buffer_store_dwordx4 v[80:83], v69, s[4:7], s60 offen sc1
    ds_read_b128 v[84:87], v68 offset:16384
    s_add_u32 s60, s57, 0
    s_waitcnt lgkmcnt(0)
    buffer_store_dwordx4 v[84:87], v70, s[4:7], s60 offen sc1
    s_cmp_ge_u32 s2, 96
    s_cbranch_scc1 PH0_g3
    s_cmp_ge_u32 s2, 64
    s_cbranch_scc1 PH0_m3
    v_add_u32 v71, 24576, v66
    v_add_u32 v72, 24576, v67
    ds_read2_b32 v[88:89], v71 offset1:1
    ds_read2_b32 v[90:91], v72 offset1:1
    s_add_u32 s60, s56, 65536
    s_waitcnt lgkmcnt(0)
    v_cndmask_b32 v89, v89, 0, s[54:55]
    v_cndmask_b32 v91, v91, 0, s[54:55]
    buffer_store_dwordx4 v[88:91], v69, s[4:7], s60 offen sc1
    s_branch PH0_g3
PH0_m3:
    ds_read_b128 v[88:91], v68 offset:24576
    s_add_u32 s60, s57, 24576
    s_waitcnt lgkmcnt(0)
    buffer_store_dwordx4 v[88:91], v70, s[4:7], s60 offen sc1
PH0_g3:
    s_add_u32 m0, s49, 114688
    s_add_u32 s30, s25, 2949120
    buffer_load_dwordx4 v29, s[12:15], s30 offen lds
    s_add_u32 m0, s27, 114688
    s_nop 0
    buffer_load_dwordx4 v249, s[12:15], s30 offen lds
    s_add_u32 m0, s49, 122880
    s_add_u32 s30, s25, 3538944
    buffer_load_dwordx4 v29, s[12:15], s30 offen lds
    s_add_u32 m0, s27, 122880
    s_nop 0
    buffer_load_dwordx4 v249, s[12:15], s30 offen lds
    s_add_u32 m0, s49, 131072
    s_add_u32 s30, s25, 4128768
    buffer_load_dwordx4 v29, s[12:15], s30 offen lds
    s_add_u32 m0, s27, 131072
    s_nop 0
    buffer_load_dwordx4 v249, s[12:15], s30 offen lds
    s_add_u32 m0, s49, 139264
    s_add_u32 s30, s25, 4718592
    buffer_load_dwordx4 v29, s[12:15], s30 offen lds
    s_add_u32 m0, s27, 139264
    s_nop 0
    buffer_load_dwordx4 v249, s[12:15], s30 offen lds
PH0_j:
    s_add_u32 s61, s32, 4096
    s_cmp_lg_u32 s20, 0
    s_cbranch_scc1 POLLA_ok
    s_lshl_b32 s62, s2, 7
    s_add_u32 s62, s62, 46010404
    v_mov_b32 v42, s62
    v_mov_b32 v43, 0
    v_cmp_gt_u32 vcc, 1, v43
    s_cbranch_vccz POLLA_ok
    s_mov_b32 s63, 1048576
POLLA_spin:
    s_sleep 1
    buffer_load_dword v43, v42, s[4:7], 0 offen sc1
    s_waitcnt vmcnt(0)
    v_cmp_gt_u32 vcc, 1, v43
    s_sub_u32 s63, s63, 1
    s_cbranch_scc1 POLLA_ok
    s_cbranch_vccnz POLLA_spin
POLLA_ok:
    s_waitcnt vmcnt(0)
    s_barrier
    s_add_u32 s60, s31, 0
    buffer_load_dwordx4 v[0:3], v248, s[4:7], s60 offen offset:0 sc1
    buffer_load_dwordx4 v[4:7], v248, s[4:7], s60 offen offset:1024 sc1
    buffer_load_dwordx4 v[8:11], v248, s[4:7], s60 offen offset:2048 sc1
    buffer_load_dwordx4 v[12:15], v248, s[4:7], s60 offen offset:3072 sc1
    v_add_u32 v244, 73728, v250
    v_xor_b32 v245, 32, v244
    v_xor_b32 v246, 64, v244
    v_xor_b32 v247, 96, v244
    v_add_u32 v240, 0, v250
    v_xor_b32 v241, 32, v240
    v_xor_b32 v242, 64, v240
    v_xor_b32 v243, 96, v240
    ds_read_b64_tr_b16 v[224:225], v240 offset:0
    ds_read_b64_tr_b16 v[226:227], v240 offset:512
    ds_read_b64_tr_b16 v[228:229], v241 offset:0
    ds_read_b64_tr_b16 v[230:231], v241 offset:512
    ds_read_b64_tr_b16 v[232:233], v242 offset:0
    ds_read_b64_tr_b16 v[234:235], v242 offset:512
    s_setprio 3
    s_waitcnt vmcnt(3) lgkmcnt(4)
    v_mfma_f32_16x16x32_bf16 v[144:147], v[224:227], v[0:3], 0
    ds_read_b64_tr_b16 v[236:237], v243 offset:0
    ds_read_b64_tr_b16 v[238:239], v243 offset:512
    s_waitcnt vmcnt(2)
    v_mfma_f32_16x16x32_bf16 v[148:151], v[224:227], v[4:7], 0
    s_waitcnt lgkmcnt(4)
    s_add_u32 s60, s31, 4096
    buffer_load_dwordx4 v[16:19], v248, s[4:7], s60 offen offset:0 sc1
    v_mfma_f32_16x16x32_bf16 v[152:155], v[228:231], v[0:3], 0
    v_mfma_f32_16x16x32_bf16 v[156:159], v[228:231], v[4:7], 0
    ds_read_b64_tr_b16 v[224:225], v244 offset:0
    ds_read_b64_tr_b16 v[226:227], v244 offset:512
    s_waitcnt lgkmcnt(4)
    v_mfma_f32_16x16x32_bf16 v[160:163], v[232:235], v[0:3], 0
    ds_read_b64_tr_b16 v[228:229], v245 offset:0
    v_mfma_f32_16x16x32_bf16 v[164:167], v[232:235], v[4:7], 0
    ds_read_b64_tr_b16 v[230:231], v245 offset:512
    s_waitcnt lgkmcnt(4)
    v_mfma_f32_16x16x32_bf16 v[168:171], v[236:239], v[0:3], 0
    ds_read_b64_tr_b16 v[232:233], v246 offset:0
    ds_read_b64_tr_b16 v[234:235], v246 offset:512
    v_mfma_f32_16x16x32_bf16 v[172:175], v[236:239], v[4:7], 0
    s_waitcnt lgkmcnt(4)
    buffer_load_dwordx4 v[20:23], v248, s[4:7], s60 offen offset:1024 sc1
    v_mfma_f32_16x16x32_bf16 v[176:179], v[224:227], v[0:3], 0
    ds_read_b64_tr_b16 v[236:237], v247 offset:0
    v_mfma_f32_16x16x32_bf16 v[180:183], v[224:227], v[4:7], 0
    ds_read_b64_tr_b16 v[238:239], v247 offset:512
    s_waitcnt lgkmcnt(4)
    v_mfma_f32_16x16x32_bf16 v[184:187], v[228:231], v[0:3], 0
    ds_read_b64_tr_b16 v[224:225], v240 offset:4096
    ds_read_b64_tr_b16 v[226:227], v240 offset:4608
    v_mfma_f32_16x16x32_bf16 v[188:191], v[228:231], v[4:7], 0
    s_waitcnt lgkmcnt(4)
    buffer_load_dwordx4 v[24:27], v248, s[4:7], s60 offen offset:2048 sc1
    v_mfma_f32_16x16x32_bf16 v[192:195], v[232:235], v[0:3], 0
    ds_read_b64_tr_b16 v[228:229], v241 offset:4096
    v_mfma_f32_16x16x32_bf16 v[196:199], v[232:235], v[4:7], 0
    ds_read_b64_tr_b16 v[230:231], v241 offset:4608
    s_waitcnt lgkmcnt(4)
    v_mfma_f32_16x16x32_bf16 v[200:203], v[236:239], v[0:3], 0
    ds_read_b64_tr_b16 v[232:233], v242 offset:4096
    v_mfma_f32_16x16x32_bf16 v[204:207], v[236:239], v[4:7], 0
    ds_read_b64_tr_b16 v[234:235], v242 offset:4608
    s_waitcnt vmcnt(3) lgkmcnt(4)
    v_mfma_f32_16x16x32_bf16 v[144:147], v[224:227], v[8:11], v[144:147]
    ds_read_b64_tr_b16 v[236:237], v243 offset:4096
    ds_read_b64_tr_b16 v[238:239], v243 offset:4608
    v_mfma_f32_16x16x32_bf16 v[148:151], v[224:227], v[12:15], v[148:151]
    s_waitcnt lgkmcnt(4)
    buffer_load_dwordx4 v[28:31], v248, s[4:7], s60 offen offset:3072 sc1
    v_mfma_f32_16x16x32_bf16 v[152:155], v[228:231], v[8:11], v[152:155]
    ds_read_b64_tr_b16 v[224:225], v244 offset:4096
    v_mfma_f32_16x16x32_bf16 v[156:159], v[228:231], v[12:15], v[156:159]
    ds_read_b64_tr_b16 v[226:227], v244 offset:4608
    s_waitcnt lgkmcnt(4)
    v_mfma_f32_16x16x32_bf16 v[160:163], v[232:235], v[8:11], v[160:163]
    ds_read_b64_tr_b16 v[228:229], v245 offset:4096
    ds_read_b64_tr_b16 v[230:231], v245 offset:4608
    v_mfma_f32_16x16x32_bf16 v[164:167], v[232:235], v[12:15], v[164:167]
    s_waitcnt lgkmcnt(4)
    s_add_u32 s60, s31, 8192
    buffer_load_dwordx4 v[32:35], v248, s[4:7], s60 offen offset:0 sc1
    v_mfma_f32_16x16x32_bf16 v[168:171], v[236:239], v[8:11], v[168:171]
    ds_read_b64_tr_b16 v[232:233], v246 offset:4096
    v_mfma_f32_16x16x32_bf16 v[172:175], v[236:239], v[12:15], v[172:175]
    ds_read_b64_tr_b16 v[234:235], v246 offset:4608
    s_waitcnt lgkmcnt(4)
    v_mfma_f32_16x16x32_bf16 v[176:179], v[224:227], v[8:11], v[176:179]
    ds_read_b64_tr_b16 v[236:237], v247 offset:4096
    v_mfma_f32_16x16x32_bf16 v[180:183], v[224:227], v[12:15], v[180:183]
    ds_read_b64_tr_b16 v[238:239], v247 offset:4608
    s_waitcnt lgkmcnt(4)
    v_mfma_f32_16x16x32_bf16 v[184:187], v[228:231], v[8:11], v[184:187]
    ds_read_b64_tr_b16 v[224:225], v240 offset:8192
    ds_read_b64_tr_b16 v[226:227], v240 offset:8704
    v_mfma_f32_16x16x32_bf16 v[188:191], v[228:231], v[12:15], v[188:191]
    s_waitcnt lgkmcnt(4)
    buffer_load_dwordx4 v[36:39], v248, s[4:7], s60 offen offset:1024 sc1
    v_mfma_f32_16x16x32_bf16 v[192:195], v[232:235], v[8:11], v[192:195]
    ds_read_b64_tr_b16 v[228:229], v241 offset:8192
    v_mfma_f32_16x16x32_bf16 v[196:199], v[232:235], v[12:15], v[196:199]
    ds_read_b64_tr_b16 v[230:231], v241 offset:8704
    s_waitcnt lgkmcnt(4)
    v_mfma_f32_16x16x32_bf16 v[200:203], v[236:239], v[8:11], v[200:203]
    ds_read_b64_tr_b16 v[232:233], v242 offset:8192
    ds_read_b64_tr_b16 v[234:235], v242 offset:8704
    v_mfma_f32_16x16x32_bf16 v[204:207], v[236:239], v[12:15], v[204:207]
    s_waitcnt vmcnt(4) lgkmcnt(4)
    buffer_load_dwordx4 v[40:43], v248, s[4:7], s60 offen offset:2048 sc1
    v_mfma_f32_16x16x32_bf16 v[144:147], v[224:227], v[16:19], v[144:147]
    ds_read_b64_tr_b16 v[236:237], v243 offset:8192
    v_mfma_f32_16x16x32_bf16 v[148:151], v[224:227], v[20:23], v[148:151]
    ds_read_b64_tr_b16 v[238:239], v243 offset:8704
    s_waitcnt lgkmcnt(4)
    v_mfma_f32_16x16x32_bf16 v[152:155], v[228:231], v[16:19], v[152:155]
    ds_read_b64_tr_b16 v[224:225], v244 offset:8192
    v_mfma_f32_16x16x32_bf16 v[156:159], v[228:231], v[20:23], v[156:159]
    ds_read_b64_tr_b16 v[226:227], v244 offset:8704
    s_waitcnt lgkmcnt(4)
    v_mfma_f32_16x16x32_bf16 v[160:163], v[232:235], v[16:19], v[160:163]
    ds_read_b64_tr_b16 v[228:229], v245 offset:8192
    ds_read_b64_tr_b16 v[230:231], v245 offset:8704
    v_mfma_f32_16x16x32_bf16 v[164:167], v[232:235], v[20:23], v[164:167]
    s_waitcnt lgkmcnt(4)
    buffer_load_dwordx4 v[44:47], v248, s[4:7], s60 offen offset:3072 sc1
    v_mfma_f32_16x16x32_bf16 v[168:171], v[236:239], v[16:19], v[168:171]
    ds_read_b64_tr_b16 v[232:233], v246 offset:8192
    v_mfma_f32_16x16x32_bf16 v[172:175], v[236:239], v[20:23], v[172:175]
    ds_read_b64_tr_b16 v[234:235], v246 offset:8704
    s_waitcnt lgkmcnt(4)
    s_cmp_lg_u32 s20, 7
    s_cbranch_scc1 PH1_b
    v_mov_b32 v220, 1
    s_lshl_b32 s62, s22, 5
    s_mov_b64 exec, 1
    buffer_atomic_add v220, off, s[36:39], s62 offset:16 sc1
    s_mov_b64 exec, -1
PH1_b:
    s_setprio 2
    v_mfma_f32_16x16x32_bf16 v[176:179], v[224:227], v[16:19], v[176:179]
    ds_read_b64_tr_b16 v[236:237], v247 offset:8192
    ds_read_b64_tr_b16 v[238:239], v247 offset:8704
    v_mfma_f32_16x16x32_bf16 v[180:183], v[224:227], v[20:23], v[180:183]
    s_waitcnt lgkmcnt(4)
    s_add_u32 s60, s31, 12288
    buffer_load_dwordx4 v[48:51], v248, s[4:7], s60 offen offset:0 sc1
    v_mfma_f32_16x16x32_bf16 v[184:187], v[228:231], v[16:19], v[184:187]
    ds_read_b64_tr_b16 v[224:225], v240 offset:12288
    v_mfma_f32_16x16x32_bf16 v[188:191], v[228:231], v[20:23], v[188:191]
    ds_read_b64_tr_b16 v[226:227], v240 offset:12800
    s_waitcnt lgkmcnt(4)
    v_mfma_f32_16x16x32_bf16 v[192:195], v[232:235], v[16:19], v[192:195]
    ds_read_b64_tr_b16 v[228:229], v241 offset:12288
    v_mfma_f32_16x16x32_bf16 v[196:199], v[232:235], v[20:23], v[196:199]
    ds_read_b64_tr_b16 v[230:231], v241 offset:12800
    s_waitcnt lgkmcnt(4)
    v_mfma_f32_16x16x32_bf16 v[200:203], v[236:239], v[16:19], v[200:203]
    ds_read_b64_tr_b16 v[232:233], v242 offset:12288
    ds_read_b64_tr_b16 v[234:235], v242 offset:12800
    v_mfma_f32_16x16x32_bf16 v[204:207], v[236:239], v[20:23], v[204:207]
    s_waitcnt vmcnt(5) lgkmcnt(4)
    buffer_load_dwordx4 v[52:55], v248, s[4:7], s60 offen offset:1024 sc1
    v_mfma_f32_16x16x32_bf16 v[144:147], v[224:227], v[24:27], v[144:147]
    ds_read_b64_tr_b16 v[236:237], v243 offset:12288
    v_mfma_f32_16x16x32_bf16 v[148:151], v[224:227], v[28:31], v[148:151]
    ds_read_b64_tr_b16 v[238:239], v243 offset:12800
    s_waitcnt lgkmcnt(4)
    v_mfma_f32_16x16x32_bf16 v[152:155], v[228:231], v[24:27], v[152:155]
    ds_read_b64_tr_b16 v[224:225], v244 offset:12288
    ds_read_b64_tr_b16 v[226:227], v244 offset:12800
    v_mfma_f32_16x16x32_bf16 v[156:159], v[228:231], v[28:31], v[156:159]
    s_waitcnt lgkmcnt(4)
    buffer_load_dwordx4 v[56:59], v248, s[4:7], s60 offen offset:2048 sc1
    v_mfma_f32_16x16x32_bf16 v[160:163], v[232:235], v[24:27], v[160:163]
    ds_read_b64_tr_b16 v[228:229], v245 offset:12288
    v_mfma_f32_16x16x32_bf16 v[164:167], v[232:235], v[28:31], v[164:167]
    ds_read_b64_tr_b16 v[230:231], v245 offset:12800
    s_waitcnt lgkmcnt(4)
    v_mfma_f32_16x16x32_bf16 v[168:171], v[236:239], v[24:27], v[168:171]
    ds_read_b64_tr_b16 v[232:233], v246 offset:12288
    v_mfma_f32_16x16x32_bf16 v[172:175], v[236:239], v[28:31], v[172:175]
    ds_read_b64_tr_b16 v[234:235], v246 offset:12800
    s_waitcnt lgkmcnt(4)
    v_mfma_f32_16x16x32_bf16 v[176:179], v[224:227], v[24:27], v[176:179]
    ds_read_b64_tr_b16 v[236:237], v247 offset:12288
    ds_read_b64_tr_b16 v[238:239], v247 offset:12800
    v_mfma_f32_16x16x32_bf16 v[180:183], v[224:227], v[28:31], v[180:183]
    s_waitcnt lgkmcnt(4)
    buffer_load_dwordx4 v[60:63], v248, s[4:7], s60 offen offset:3072 sc1
    v_mfma_f32_16x16x32_bf16 v[184:187], v[228:231], v[24:27], v[184:187]
    ds_read_b64_tr_b16 v[224:225], v240 offset:16384
    v_mfma_f32_16x16x32_bf16 v[188:191], v[228:231], v[28:31], v[188:191]
    ds_read_b64_tr_b16 v[226:227], v240 offset:16896
    s_waitcnt lgkmcnt(4)
    v_mfma_f32_16x16x32_bf16 v[192:195], v[232:235], v[24:27], v[192:195]
    ds_read_b64_tr_b16 v[228:229], v241 offset:16384
    ds_read_b64_tr_b16 v[230:231], v241 offset:16896
    v_mfma_f32_16x16x32_bf16 v[196:199], v[232:235], v[28:31], v[196:199]
    s_waitcnt lgkmcnt(4)
    s_add_u32 s60, s31, 16384
    buffer_load_dwordx4 v[64:67], v248, s[4:7], s60 offen offset:0 sc1
    v_mfma_f32_16x16x32_bf16 v[200:203], v[236:239], v[24:27], v[200:203]
    ds_read_b64_tr_b16 v[232:233], v242 offset:16384
    v_mfma_f32_16x16x32_bf16 v[204:207], v[236:239], v[28:31], v[204:207]
    ds_read_b64_tr_b16 v[234:235], v242 offset:16896
    s_waitcnt vmcnt(7) lgkmcnt(4)
    v_mfma_f32_16x16x32_bf16 v[144:147], v[224:227], v[32:35], v[144:147]
    ds_read_b64_tr_b16 v[236:237], v243 offset:16384
    v_mfma_f32_16x16x32_bf16 v[148:151], v[224:227], v[36:39], v[148:151]
    ds_read_b64_tr_b16 v[238:239], v243 offset:16896
    s_waitcnt lgkmcnt(4)
    v_mfma_f32_16x16x32_bf16 v[152:155], v[228:231], v[32:35], v[152:155]
    ds_read_b64_tr_b16 v[224:225], v244 offset:16384
    ds_read_b64_tr_b16 v[226:227], v244 offset:16896
    v_mfma_f32_16x16x32_bf16 v[156:159], v[228:231], v[36:39], v[156:159]
    s_waitcnt lgkmcnt(4)
    buffer_load_dwordx4 v[68:71], v248, s[4:7], s60 offen offset:1024 sc1
    v_mfma_f32_16x16x32_bf16 v[160:163], v[232:235], v[32:35], v[160:163]
    ds_read_b64_tr_b16 v[228:229], v245 offset:16384
    v_mfma_f32_16x16x32_bf16 v[164:167], v[232:235], v[36:39], v[164:167]
    ds_read_b64_tr_b16 v[230:231], v245 offset:16896
    s_waitcnt lgkmcnt(4)
    v_mfma_f32_16x16x32_bf16 v[168:171], v[236:239], v[32:35], v[168:171]
    ds_read_b64_tr_b16 v[232:233], v246 offset:16384
    ds_read_b64_tr_b16 v[234:235], v246 offset:16896
    v_mfma_f32_16x16x32_bf16 v[172:175], v[236:239], v[36:39], v[172:175]
    s_waitcnt lgkmcnt(4)
    buffer_load_dwordx4 v[72:75], v248, s[4:7], s60 offen offset:2048 sc1
    v_mfma_f32_16x16x32_bf16 v[176:179], v[224:227], v[32:35], v[176:179]
    ds_read_b64_tr_b16 v[236:237], v247 offset:16384
    v_mfma_f32_16x16x32_bf16 v[180:183], v[224:227], v[36:39], v[180:183]
    ds_read_b64_tr_b16 v[238:239], v247 offset:16896
    s_waitcnt lgkmcnt(4)
    v_mfma_f32_16x16x32_bf16 v[184:187], v[228:231], v[32:35], v[184:187]
    ds_read_b64_tr_b16 v[224:225], v240 offset:20480
    v_mfma_f32_16x16x32_bf16 v[188:191], v[228:231], v[36:39], v[188:191]
    ds_read_b64_tr_b16 v[226:227], v240 offset:20992
    s_waitcnt lgkmcnt(4)
    v_mfma_f32_16x16x32_bf16 v[192:195], v[232:235], v[32:35], v[192:195]
    ds_read_b64_tr_b16 v[228:229], v241 offset:20480
    ds_read_b64_tr_b16 v[230:231], v241 offset:20992
    v_mfma_f32_16x16x32_bf16 v[196:199], v[232:235], v[36:39], v[196:199]
    s_waitcnt lgkmcnt(4)
    buffer_load_dwordx4 v[76:79], v248, s[4:7], s60 offen offset:3072 sc1
    v_mfma_f32_16x16x32_bf16 v[200:203], v[236:239], v[32:35], v[200:203]
    ds_read_b64_tr_b16 v[232:233], v242 offset:20480
    v_mfma_f32_16x16x32_bf16 v[204:207], v[236:239], v[36:39], v[204:207]
    ds_read_b64_tr_b16 v[234:235], v242 offset:20992
    s_waitcnt vmcnt(8) lgkmcnt(4)
    v_mfma_f32_16x16x32_bf16 v[144:147], v[224:227], v[40:43], v[144:147]
    ds_read_b64_tr_b16 v[236:237], v243 offset:20480
    ds_read_b64_tr_b16 v[238:239], v243 offset:20992
    v_mfma_f32_16x16x32_bf16 v[148:151], v[224:227], v[44:47], v[148:151]
    s_waitcnt lgkmcnt(4)
    s_add_u32 s60, s31, 20480
    buffer_load_dwordx4 v[80:83], v248, s[4:7], s60 offen offset:0 sc1
    v_mfma_f32_16x16x32_bf16 v[152:155], v[228:231], v[40:43], v[152:155]
    ds_read_b64_tr_b16 v[224:225], v244 offset:20480
    v_mfma_f32_16x16x32_bf16 v[156:159], v[228:231], v[44:47], v[156:159]
    ds_read_b64_tr_b16 v[226:227], v244 offset:20992
    s_waitcnt lgkmcnt(4)
    v_mfma_f32_16x16x32_bf16 v[160:163], v[232:235], v[40:43], v[160:163]
    ds_read_b64_tr_b16 v[228:229], v245 offset:20480
    v_mfma_f32_16x16x32_bf16 v[164:167], v[232:235], v[44:47], v[164:167]
    ds_read_b64_tr_b16 v[230:231], v245 offset:20992
    s_waitcnt lgkmcnt(4)
    v_mfma_f32_16x16x32_bf16 v[168:171], v[236:239], v[40:43], v[168:171]
    ds_read_b64_tr_b16 v[232:233], v246 offset:20480
    ds_read_b64_tr_b16 v[234:235], v246 offset:20992
    v_mfma_f32_16x16x32_bf16 v[172:175], v[236:239], v[44:47], v[172:175]
    s_waitcnt lgkmcnt(4)
    buffer_load_dwordx4 v[84:87], v248, s[4:7], s60 offen offset:1024 sc1
    v_mfma_f32_16x16x32_bf16 v[176:179], v[224:227], v[40:43], v[176:179]
    ds_read_b64_tr_b16 v[236:237], v247 offset:20480
    v_mfma_f32_16x16x32_bf16 v[180:183], v[224:227], v[44:47], v[180:183]
    ds_read_b64_tr_b16 v[238:239], v247 offset:20992
    s_waitcnt lgkmcnt(4)
    v_mfma_f32_16x16x32_bf16 v[184:187], v[228:231], v[40:43], v[184:187]
    ds_read_b64_tr_b16 v[224:225], v240 offset:24576
    ds_read_b64_tr_b16 v[226:227], v240 offset:25088
    v_mfma_f32_16x16x32_bf16 v[188:191], v[228:231], v[44:47], v[188:191]
    s_waitcnt lgkmcnt(4)
    buffer_load_dwordx4 v[88:91], v248, s[4:7], s60 offen offset:2048 sc1
    v_mfma_f32_16x16x32_bf16 v[192:195], v[232:235], v[40:43], v[192:195]
    ds_read_b64_tr_b16 v[228:229], v241 offset:24576
    v_mfma_f32_16x16x32_bf16 v[196:199], v[232:235], v[44:47], v[196:199]
    ds_read_b64_tr_b16 v[230:231], v241 offset:25088
    s_waitcnt lgkmcnt(4)
    v_mfma_f32_16x16x32_bf16 v[200:203], v[236:239], v[40:43], v[200:203]
    ds_read_b64_tr_b16 v[232:233], v242 offset:24576
    v_mfma_f32_16x16x32_bf16 v[204:207], v[236:239], v[44:47], v[204:207]
    ds_read_b64_tr_b16 v[234:235], v242 offset:25088
    s_waitcnt vmcnt(9) lgkmcnt(4)
    v_mfma_f32_16x16x32_bf16 v[144:147], v[224:227], v[48:51], v[144:147]
    ds_read_b64_tr_b16 v[236:237], v243 offset:24576
    ds_read_b64_tr_b16 v[238:239], v243 offset:25088
    v_mfma_f32_16x16x32_bf16 v[148:151], v[224:227], v[52:55], v[148:151]
    s_waitcnt lgkmcnt(4)
    buffer_load_dwordx4 v[92:95], v248, s[4:7], s60 offen offset:3072 sc1
    v_mfma_f32_16x16x32_bf16 v[152:155], v[228:231], v[48:51], v[152:155]
    ds_read_b64_tr_b16 v[224:225], v244 offset:24576
    v_mfma_f32_16x16x32_bf16 v[156:159], v[228:231], v[52:55], v[156:159]
    ds_read_b64_tr_b16 v[226:227], v244 offset:25088
    s_waitcnt lgkmcnt(4)
    s_setprio 1
    v_mfma_f32_16x16x32_bf16 v[160:163], v[232:235], v[48:51], v[160:163]
    ds_read_b64_tr_b16 v[228:229], v245 offset:24576
    ds_read_b64_tr_b16 v[230:231], v245 offset:25088
    v_mfma_f32_16x16x32_bf16 v[164:167], v[232:235], v[52:55], v[164:167]
    s_waitcnt lgkmcnt(4)
    s_add_u32 s60, s31, 24576
    buffer_load_dwordx4 v[96:99], v248, s[4:7], s60 offen offset:0 sc1
    v_mfma_f32_16x16x32_bf16 v[168:171], v[236:239], v[48:51], v[168:171]
    ds_read_b64_tr_b16 v[232:233], v246 offset:24576
    v_mfma_f32_16x16x32_bf16 v[172:175], v[236:239], v[52:55], v[172:175]
    ds_read_b64_tr_b16 v[234:235], v246 offset:25088
    s_waitcnt lgkmcnt(4)
    v_mfma_f32_16x16x32_bf16 v[176:179], v[224:227], v[48:51], v[176:179]
    ds_read_b64_tr_b16 v[236:237], v247 offset:24576
    v_mfma_f32_16x16x32_bf16 v[180:183], v[224:227], v[52:55], v[180:183]
    ds_read_b64_tr_b16 v[238:239], v247 offset:25088
    s_waitcnt lgkmcnt(4)
    v_mfma_f32_16x16x32_bf16 v[184:187], v[228:231], v[48:51], v[184:187]
    ds_read_b64_tr_b16 v[224:225], v240 offset:28672
    ds_read_b64_tr_b16 v[226:227], v240 offset:29184
    v_mfma_f32_16x16x32_bf16 v[188:191], v[228:231], v[52:55], v[188:191]
    s_waitcnt lgkmcnt(4)
    buffer_load_dwordx4 v[100:103], v248, s[4:7], s60 offen offset:1024 sc1
    v_mfma_f32_16x16x32_bf16 v[192:195], v[232:235], v[48:51], v[192:195]
    ds_read_b64_tr_b16 v[228:229], v241 offset:28672
    v_mfma_f32_16x16x32_bf16 v[196:199], v[232:235], v[52:55], v[196:199]
    ds_read_b64_tr_b16 v[230:231], v241 offset:29184
    s_waitcnt lgkmcnt(4)
    v_mfma_f32_16x16x32_bf16 v[200:203], v[236:239], v[48:51], v[200:203]
    ds_read_b64_tr_b16 v[232:233], v242 offset:28672
    ds_read_b64_tr_b16 v[234:235], v242 offset:29184
    v_mfma_f32_16x16x32_bf16 v[204:207], v[236:239], v[52:55], v[204:207]
    s_waitcnt vmcnt(10) lgkmcnt(4)
    buffer_load_dwordx4 v[104:107], v248, s[4:7], s60 offen offset:2048 sc1
    v_mfma_f32_16x16x32_bf16 v[144:147], v[224:227], v[56:59], v[144:147]
    ds_read_b64_tr_b16 v[236:237], v243 offset:28672
    v_mfma_f32_16x16x32_bf16 v[148:151], v[224:227], v[60:63], v[148:151]
    ds_read_b64_tr_b16 v[238:239], v243 offset:29184
    s_waitcnt lgkmcnt(4)
    v_mfma_f32_16x16x32_bf16 v[152:155], v[228:231], v[56:59], v[152:155]
    ds_read_b64_tr_b16 v[224:225], v244 offset:28672
    v_mfma_f32_16x16x32_bf16 v[156:159], v[228:231], v[60:63], v[156:159]
    ds_read_b64_tr_b16 v[226:227], v244 offset:29184
    s_waitcnt lgkmcnt(4)
    v_mfma_f32_16x16x32_bf16 v[160:163], v[232:235], v[56:59], v[160:163]
    ds_read_b64_tr_b16 v[228:229], v245 offset:28672
    ds_read_b64_tr_b16 v[230:231], v245 offset:29184
    v_mfma_f32_16x16x32_bf16 v[164:167], v[232:235], v[60:63], v[164:167]
    s_waitcnt lgkmcnt(4)
    buffer_load_dwordx4 v[108:111], v248, s[4:7], s60 offen offset:3072 sc1
    v_mfma_f32_16x16x32_bf16 v[168:171], v[236:239], v[56:59], v[168:171]
    ds_read_b64_tr_b16 v[232:233], v246 offset:28672
    v_mfma_f32_16x16x32_bf16 v[172:175], v[236:239], v[60:63], v[172:175]
    ds_read_b64_tr_b16 v[234:235], v246 offset:29184
    s_waitcnt lgkmcnt(4)
    v_mfma_f32_16x16x32_bf16 v[176:179], v[224:227], v[56:59], v[176:179]
    ds_read_b64_tr_b16 v[236:237], v247 offset:28672
    ds_read_b64_tr_b16 v[238:239], v247 offset:29184
    v_mfma_f32_16x16x32_bf16 v[180:183], v[224:227], v[60:63], v[180:183]
    s_waitcnt lgkmcnt(4)
    s_add_u32 s60, s31, 28672
    buffer_load_dwordx4 v[112:115], v248, s[4:7], s60 offen offset:0 sc1
    v_mfma_f32_16x16x32_bf16 v[184:187], v[228:231], v[56:59], v[184:187]
    ds_read_b64_tr_b16 v[224:225], v240 offset:32768
    v_mfma_f32_16x16x32_bf16 v[188:191], v[228:231], v[60:63], v[188:191]
    ds_read_b64_tr_b16 v[226:227], v240 offset:33280
    s_waitcnt lgkmcnt(4)
    v_mfma_f32_16x16x32_bf16 v[192:195], v[232:235], v[56:59], v[192:195]
    ds_read_b64_tr_b16 v[228:229], v241 offset:32768
    v_mfma_f32_16x16x32_bf16 v[196:199], v[232:235], v[60:63], v[196:199]
    ds_read_b64_tr_b16 v[230:231], v241 offset:33280
    s_waitcnt lgkmcnt(4)
    v_mfma_f32_16x16x32_bf16 v[200:203], v[236:239], v[56:59], v[200:203]
    ds_read_b64_tr_b16 v[232:233], v242 offset:32768
    ds_read_b64_tr_b16 v[234:235], v242 offset:33280
    v_mfma_f32_16x16x32_bf16 v[204:207], v[236:239], v[60:63], v[204:207]
    s_waitcnt vmcnt(11) lgkmcnt(4)
    buffer_load_dwordx4 v[116:119], v248, s[4:7], s60 offen offset:1024 sc1
    v_mfma_f32_16x16x32_bf16 v[144:147], v[224:227], v[64:67], v[144:147]
    ds_read_b64_tr_b16 v[236:237], v243 offset:32768
    v_mfma_f32_16x16x32_bf16 v[148:151], v[224:227], v[68:71], v[148:151]
    ds_read_b64_tr_b16 v[238:239], v243 offset:33280
    s_waitcnt lgkmcnt(4)
    v_mfma_f32_16x16x32_bf16 v[152:155], v[228:231], v[64:67], v[152:155]
    ds_read_b64_tr_b16 v[224:225], v244 offset:32768
    ds_read_b64_tr_b16 v[226:227], v244 offset:33280
    v_mfma_f32_16x16x32_bf16 v[156:159], v[228:231], v[68:71], v[156:159]
    s_waitcnt lgkmcnt(4)
    buffer_load_dwordx4 v[120:123], v248, s[4:7], s60 offen offset:2048 sc1
    v_mfma_f32_16x16x32_bf16 v[160:163], v[232:235], v[64:67], v[160:163]
    ds_read_b64_tr_b16 v[228:229], v245 offset:32768
    v_mfma_f32_16x16x32_bf16 v[164:167], v[232:235], v[68:71], v[164:167]
    ds_read_b64_tr_b16 v[230:231], v245 offset:33280
    s_waitcnt lgkmcnt(4)
    v_mfma_f32_16x16x32_bf16 v[168:171], v[236:239], v[64:67], v[168:171]
    ds_read_b64_tr_b16 v[232:233], v246 offset:32768
    v_mfma_f32_16x16x32_bf16 v[172:175], v[236:239], v[68:71], v[172:175]
    ds_read_b64_tr_b16 v[234:235], v246 offset:33280
    s_waitcnt lgkmcnt(4)
    v_mfma_f32_16x16x32_bf16 v[176:179], v[224:227], v[64:67], v[176:179]
    ds_read_b64_tr_b16 v[236:237], v247 offset:32768
    ds_read_b64_tr_b16 v[238:239], v247 offset:33280
    v_mfma_f32_16x16x32_bf16 v[180:183], v[224:227], v[68:71], v[180:183]
    s_waitcnt lgkmcnt(4)
    buffer_load_dwordx4 v[124:127], v248, s[4:7], s60 offen offset:3072 sc1
    v_mfma_f32_16x16x32_bf16 v[184:187], v[228:231], v[64:67], v[184:187]
    ds_read_b64_tr_b16 v[224:225], v240 offset:36864
    v_mfma_f32_16x16x32_bf16 v[188:191], v[228:231], v[68:71], v[188:191]
    ds_read_b64_tr_b16 v[226:227], v240 offset:37376
    s_waitcnt lgkmcnt(4)
    v_mfma_f32_16x16x32_bf16 v[192:195], v[232:235], v[64:67], v[192:195]
    ds_read_b64_tr_b16 v[228:229], v241 offset:36864
    ds_read_b64_tr_b16 v[230:231], v241 offset:37376
    v_mfma_f32_16x16x32_bf16 v[196:199], v[232:235], v[68:71], v[196:199]
    s_waitcnt lgkmcnt(4)
    s_add_u32 s60, s31, 32768
    buffer_load_dwordx4 v[128:131], v248, s[4:7], s60 offen offset:0 sc1
    v_mfma_f32_16x16x32_bf16 v[200:203], v[236:239], v[64:67], v[200:203]
    ds_read_b64_tr_b16 v[232:233], v242 offset:36864
    ds_read_b64_tr_b16 v[234:235], v242 offset:37376
    v_mfma_f32_16x16x32_bf16 v[204:207], v[236:239], v[68:71], v[204:207]
    s_waitcnt vmcnt(13) lgkmcnt(4)
    s_lshl_b32 s62, s21, 10
    s_add_u32 s62, s62, s31
    s_add_u32 s62, s62, 29622272
    s_lshl_b32 s63, s21, 7
    s_add_u32 s63, s63, s31
    s_add_u32 s63, s63, 29655040
    v_mov_b32 v220, -1
    v_mov_b32 v221, -1
    v_mov_b32 v222, -1
    v_mov_b32 v223, -1
    buffer_store_dwordx4 v[220:223], v248, s[4:7], s62 offen sc1
    s_mov_b64 exec, 0xff
    buffer_store_dwordx4 v[220:223], v248, s[4:7], s63 offen sc1
    s_mov_b64 exec, -1
    v_mfma_f32_16x16x32_bf16 v[144:147], v[224:227], v[72:75], v[144:147]
    ds_read_b64_tr_b16 v[236:237], v243 offset:36864
    v_mfma_f32_16x16x32_bf16 v[148:151], v[224:227], v[76:79], v[148:151]
    ds_read_b64_tr_b16 v[238:239], v243 offset:37376
    s_waitcnt lgkmcnt(4)
    v_mfma_f32_16x16x32_bf16 v[152:155], v[228:231], v[72:75], v[152:155]
    ds_read_b64_tr_b16 v[224:225], v244 offset:36864
    ds_read_b64_tr_b16 v[226:227], v244 offset:37376
    v_mfma_f32_16x16x32_bf16 v[156:159], v[228:231], v[76:79], v[156:159]
    s_waitcnt lgkmcnt(4)
    buffer_load_dwordx4 v[132:135], v248, s[4:7], s60 offen offset:1024 sc1
    v_mfma_f32_16x16x32_bf16 v[160:163], v[232:235], v[72:75], v[160:163]
    ds_read_b64_tr_b16 v[228:229], v245 offset:36864
    v_mfma_f32_16x16x32_bf16 v[164:167], v[232:235], v[76:79], v[164:167]
    ds_read_b64_tr_b16 v[230:231], v245 offset:37376
    s_waitcnt lgkmcnt(4)
    v_mfma_f32_16x16x32_bf16 v[168:171], v[236:239], v[72:75], v[168:171]
    ds_read_b64_tr_b16 v[232:233], v246 offset:36864
    ds_read_b64_tr_b16 v[234:235], v246 offset:37376
    v_mfma_f32_16x16x32_bf16 v[172:175], v[236:239], v[76:79], v[172:175]
    s_waitcnt lgkmcnt(4)
    buffer_load_dwordx4 v[136:139], v248, s[4:7], s60 offen offset:2048 sc1
    v_mfma_f32_16x16x32_bf16 v[176:179], v[224:227], v[72:75], v[176:179]
    ds_read_b64_tr_b16 v[236:237], v247 offset:36864
    v_mfma_f32_16x16x32_bf16 v[180:183], v[224:227], v[76:79], v[180:183]
    ds_read_b64_tr_b16 v[238:239], v247 offset:37376
    s_waitcnt lgkmcnt(4)
    v_mfma_f32_16x16x32_bf16 v[184:187], v[228:231], v[72:75], v[184:187]
    v_mfma_f32_16x16x32_bf16 v[188:191], v[228:231], v[76:79], v[188:191]
    v_add_u32 v240, 40960, v250
    v_xor_b32 v241, 32, v240
    v_xor_b32 v242, 64, v240
    v_xor_b32 v243, 96, v240
    ds_read_b64_tr_b16 v[224:225], v240 offset:0
    ds_read_b64_tr_b16 v[226:227], v240 offset:512
    s_waitcnt lgkmcnt(4)
    v_mfma_f32_16x16x32_bf16 v[192:195], v[232:235], v[72:75], v[192:195]
    ds_read_b64_tr_b16 v[228:229], v241 offset:0
    ds_read_b64_tr_b16 v[230:231], v241 offset:512
    v_mfma_f32_16x16x32_bf16 v[196:199], v[232:235], v[76:79], v[196:199]
    s_waitcnt lgkmcnt(4)
    buffer_load_dwordx4 v[140:143], v248, s[4:7], s60 offen offset:3072 sc1
    v_mfma_f32_16x16x32_bf16 v[200:203], v[236:239], v[72:75], v[200:203]
    ds_read_b64_tr_b16 v[232:233], v242 offset:0
    v_mfma_f32_16x16x32_bf16 v[204:207], v[236:239], v[76:79], v[204:207]
    ds_read_b64_tr_b16 v[234:235], v242 offset:512
    s_waitcnt vmcnt(16) lgkmcnt(4)
    s_setprio 0
    v_mfma_f32_16x16x32_bf16 v[144:147], v[224:227], v[80:83], v[144:147]
    ds_read_b64_tr_b16 v[236:237], v243 offset:0
    v_mfma_f32_16x16x32_bf16 v[148:151], v[224:227], v[84:87], v[148:151]
    ds_read_b64_tr_b16 v[238:239], v243 offset:512
    s_waitcnt lgkmcnt(4)
    v_mfma_f32_16x16x32_bf16 v[152:155], v[228:231], v[80:83], v[152:155]
    ds_read_b64_tr_b16 v[224:225], v240 offset:4096
    v_mfma_f32_16x16x32_bf16 v[156:159], v[228:231], v[84:87], v[156:159]
    ds_read_b64_tr_b16 v[226:227], v240 offset:4608
    s_waitcnt lgkmcnt(4)
    v_mfma_f32_16x16x32_bf16 v[160:163], v[232:235], v[80:83], v[160:163]
    ds_read_b64_tr_b16 v[228:229], v241 offset:4096
    v_mfma_f32_16x16x32_bf16 v[164:167], v[232:235], v[84:87], v[164:167]
    ds_read_b64_tr_b16 v[230:231], v241 offset:4608
    s_waitcnt lgkmcnt(4)
    v_mfma_f32_16x16x32_bf16 v[168:171], v[236:239], v[80:83], v[168:171]
    ds_read_b64_tr_b16 v[232:233], v242 offset:4096
    v_mfma_f32_16x16x32_bf16 v[172:175], v[236:239], v[84:87], v[172:175]
    ds_read_b64_tr_b16 v[234:235], v242 offset:4608
    s_waitcnt vmcnt(14) lgkmcnt(4)
    v_mfma_f32_16x16x32_bf16 v[144:147], v[224:227], v[88:91], v[144:147]
    ds_read_b64_tr_b16 v[236:237], v243 offset:4096
    ds_read_b64_tr_b16 v[238:239], v243 offset:4608
    v_mfma_f32_16x16x32_bf16 v[148:151], v[224:227], v[92:95], v[148:151]
    s_waitcnt lgkmcnt(4)
    s_mul_i32 s62, s28, 82944
    s_add_u32 s62, s62, s25
    v_mul_u32_u24 v251, 576, v248
    s_mov_b64 exec, 0x1ff
    buffer_load_dword v252, v251, s[8:11], s62 offen offset:128
    s_mov_b64 exec, -1
    v_mfma_f32_16x16x32_bf16 v[152:155], v[228:231], v[88:91], v[152:155]
    ds_read_b64_tr_b16 v[224:225], v240 offset:8192
    v_mfma_f32_16x16x32_bf16 v[156:159], v[228:231], v[92:95], v[156:159]
    ds_read_b64_tr_b16 v[226:227], v240 offset:8704
    s_waitcnt lgkmcnt(4)
    v_mfma_f32_16x16x32_bf16 v[160:163], v[232:235], v[88:91], v[160:163]
    ds_read_b64_tr_b16 v[228:229], v241 offset:8192
    v_mfma_f32_16x16x32_bf16 v[164:167], v[232:235], v[92:95], v[164:167]
    ds_read_b64_tr_b16 v[230:231], v241 offset:8704
    s_waitcnt lgkmcnt(4)
    v_mfma_f32_16x16x32_bf16 v[168:171], v[236:239], v[88:91], v[168:171]
    ds_read_b64_tr_b16 v[232:233], v242 offset:8192
    v_mfma_f32_16x16x32_bf16 v[172:175], v[236:239], v[92:95], v[172:175]
    ds_read_b64_tr_b16 v[234:235], v242 offset:8704
    s_waitcnt vmcnt(13) lgkmcnt(4)
    v_mfma_f32_16x16x32_bf16 v[144:147], v[224:227], v[96:99], v[144:147]
    ds_read_b64_tr_b16 v[236:237], v243 offset:8192
    v_mfma_f32_16x16x32_bf16 v[148:151], v[224:227], v[100:103], v[148:151]
    ds_read_b64_tr_b16 v[238:239], v243 offset:8704
    s_waitcnt lgkmcnt(4)
    v_mfma_f32_16x16x32_bf16 v[152:155], v[228:231], v[96:99], v[152:155]
    ds_read_b64_tr_b16 v[224:225], v240 offset:12288
    v_mfma_f32_16x16x32_bf16 v[156:159], v[228:231], v[100:103], v[156:159]
    ds_read_b64_tr_b16 v[226:227], v240 offset:12800
    s_waitcnt lgkmcnt(4)
    v_mfma_f32_16x16x32_bf16 v[160:163], v[232:235], v[96:99], v[160:163]
    ds_read_b64_tr_b16 v[228:229], v241 offset:12288
    v_mfma_f32_16x16x32_bf16 v[164:167], v[232:235], v[100:103], v[164:167]
    ds_read_b64_tr_b16 v[230:231], v241 offset:12800
    s_waitcnt lgkmcnt(4)
    v_mfma_f32_16x16x32_bf16 v[168:171], v[236:239], v[96:99], v[168:171]
    ds_read_b64_tr_b16 v[232:233], v242 offset:12288
    v_mfma_f32_16x16x32_bf16 v[172:175], v[236:239], v[100:103], v[172:175]
    ds_read_b64_tr_b16 v[234:235], v242 offset:12800
    s_waitcnt vmcnt(11) lgkmcnt(4)
    v_mfma_f32_16x16x32_bf16 v[144:147], v[224:227], v[104:107], v[144:147]
    ds_read_b64_tr_b16 v[236:237], v243 offset:12288
    v_mfma_f32_16x16x32_bf16 v[148:151], v[224:227], v[108:111], v[148:151]
    ds_read_b64_tr_b16 v[238:239], v243 offset:12800
    s_waitcnt lgkmcnt(4)
    v_mfma_f32_16x16x32_bf16 v[152:155], v[228:231], v[104:107], v[152:155]
    ds_read_b64_tr_b16 v[224:225], v240 offset:16384
    v_mfma_f32_16x16x32_bf16 v[156:159], v[228:231], v[108:111], v[156:159]
    ds_read_b64_tr_b16 v[226:227], v240 offset:16896
    s_waitcnt lgkmcnt(4)
    v_mfma_f32_16x16x32_bf16 v[160:163], v[232:235], v[104:107], v[160:163]
    ds_read_b64_tr_b16 v[228:229], v241 offset:16384
    v_mfma_f32_16x16x32_bf16 v[164:167], v[232:235], v[108:111], v[164:167]
    ds_read_b64_tr_b16 v[230:231], v241 offset:16896
    s_waitcnt lgkmcnt(4)
    v_mfma_f32_16x16x32_bf16 v[168:171], v[236:239], v[104:107], v[168:171]
    ds_read_b64_tr_b16 v[232:233], v242 offset:16384
    v_mfma_f32_16x16x32_bf16 v[172:175], v[236:239], v[108:111], v[172:175]
    ds_read_b64_tr_b16 v[234:235], v242 offset:16896
    s_waitcnt vmcnt(9) lgkmcnt(4)
    v_mfma_f32_16x16x32_bf16 v[144:147], v[224:227], v[112:115], v[144:147]
    ds_read_b64_tr_b16 v[236:237], v243 offset:16384
    v_mfma_f32_16x16x32_bf16 v[148:151], v[224:227], v[116:119], v[148:151]
    ds_read_b64_tr_b16 v[238:239], v243 offset:16896
    s_waitcnt lgkmcnt(4)
    v_mfma_f32_16x16x32_bf16 v[152:155], v[228:231], v[112:115], v[152:155]
    ds_read_b64_tr_b16 v[224:225], v240 offset:20480
    v_mfma_f32_16x16x32_bf16 v[156:159], v[228:231], v[116:119], v[156:159]
    ds_read_b64_tr_b16 v[226:227], v240 offset:20992
    s_waitcnt lgkmcnt(4)
    v_mfma_f32_16x16x32_bf16 v[160:163], v[232:235], v[112:115], v[160:163]
    ds_read_b64_tr_b16 v[228:229], v241 offset:20480
    ds_read_b64_tr_b16 v[230:231], v241 offset:20992
    v_mfma_f32_16x16x32_bf16 v[164:167], v[232:235], v[116:119], v[164:167]
    s_waitcnt lgkmcnt(4)
    s_mul_i32 s62, s28, 82944
    s_add_u32 s62, s62, s25
    v_mul_u32_u24 v251, 576, v248
    s_mov_b64 exec, 0x1ff
    buffer_load_dword v252, v251, s[12:15], s62 offen offset:128
    s_mov_b64 exec, -1
    v_mfma_f32_16x16x32_bf16 v[168:171], v[236:239], v[112:115], v[168:171]
    ds_read_b64_tr_b16 v[232:233], v242 offset:20480
    v_mfma_f32_16x16x32_bf16 v[172:175], v[236:239], v[116:119], v[172:175]
    ds_read_b64_tr_b16 v[234:235], v242 offset:20992
    s_waitcnt vmcnt(8) lgkmcnt(4)
    v_mfma_f32_16x16x32_bf16 v[144:147], v[224:227], v[120:123], v[144:147]
    ds_read_b64_tr_b16 v[236:237], v243 offset:20480
    v_mfma_f32_16x16x32_bf16 v[148:151], v[224:227], v[124:127], v[148:151]
    ds_read_b64_tr_b16 v[238:239], v243 offset:20992
    s_waitcnt lgkmcnt(4)
    v_mfma_f32_16x16x32_bf16 v[152:155], v[228:231], v[120:123], v[152:155]
    ds_read_b64_tr_b16 v[224:225], v240 offset:24576
    v_mfma_f32_16x16x32_bf16 v[156:159], v[228:231], v[124:127], v[156:159]
    ds_read_b64_tr_b16 v[226:227], v240 offset:25088
    s_waitcnt lgkmcnt(4)
    v_mfma_f32_16x16x32_bf16 v[160:163], v[232:235], v[120:123], v[160:163]
    ds_read_b64_tr_b16 v[228:229], v241 offset:24576
    v_mfma_f32_16x16x32_bf16 v[164:167], v[232:235], v[124:127], v[164:167]
    ds_read_b64_tr_b16 v[230:231], v241 offset:25088
    s_waitcnt lgkmcnt(4)
    v_mfma_f32_16x16x32_bf16 v[168:171], v[236:239], v[120:123], v[168:171]
    ds_read_b64_tr_b16 v[232:233], v242 offset:24576
    v_mfma_f32_16x16x32_bf16 v[172:175], v[236:239], v[124:127], v[172:175]
    ds_read_b64_tr_b16 v[234:235], v242 offset:25088
    s_waitcnt vmcnt(4) lgkmcnt(4)
    v_mfma_f32_16x16x32_bf16 v[144:147], v[224:227], v[128:131], v[144:147]
    ds_read_b64_tr_b16 v[236:237], v243 offset:24576
    v_mfma_f32_16x16x32_bf16 v[148:151], v[224:227], v[132:135], v[148:151]
    ds_read_b64_tr_b16 v[238:239], v243 offset:25088
    s_waitcnt lgkmcnt(4)
    v_mfma_f32_16x16x32_bf16 v[152:155], v[228:231], v[128:131], v[152:155]
    ds_read_b64_tr_b16 v[224:225], v240 offset:28672
    v_mfma_f32_16x16x32_bf16 v[156:159], v[228:231], v[132:135], v[156:159]
    ds_read_b64_tr_b16 v[226:227], v240 offset:29184
    s_waitcnt lgkmcnt(4)
    v_mfma_f32_16x16x32_bf16 v[160:163], v[232:235], v[128:131], v[160:163]
    ds_read_b64_tr_b16 v[228:229], v241 offset:28672
    v_mfma_f32_16x16x32_bf16 v[164:167], v[232:235], v[132:135], v[164:167]
    ds_read_b64_tr_b16 v[230:231], v241 offset:29184
    s_waitcnt lgkmcnt(4)
    v_mfma_f32_16x16x32_bf16 v[168:171], v[236:239], v[128:131], v[168:171]
    ds_read_b64_tr_b16 v[232:233], v242 offset:28672
    v_mfma_f32_16x16x32_bf16 v[172:175], v[236:239], v[132:135], v[172:175]
    ds_read_b64_tr_b16 v[234:235], v242 offset:29184
    s_waitcnt vmcnt(2) lgkmcnt(4)
    v_mfma_f32_16x16x32_bf16 v[144:147], v[224:227], v[136:139], v[144:147]
    ds_read_b64_tr_b16 v[236:237], v243 offset:28672
    v_mfma_f32_16x16x32_bf16 v[148:151], v[224:227], v[140:143], v[148:151]
    ds_read_b64_tr_b16 v[238:239], v243 offset:29184
    s_waitcnt lgkmcnt(4)
    v_mfma_f32_16x16x32_bf16 v[152:155], v[228:231], v[136:139], v[152:155]
    v_mfma_f32_16x16x32_bf16 v[156:159], v[228:231], v[140:143], v[156:159]
    s_cmp_lg_u32 s20, 0
    s_cbranch_scc1 POLLB_ok
    v_and_b32 v222, 0xf0, v248
    buffer_load_dword v223, v222, s[36:39], 0 offen sc1
    s_waitcnt vmcnt(0)
    v_cmp_gt_u32 vcc, 32, v223
    s_cbranch_vccz POLLB_ok
    s_mov_b32 s63, 1048576
POLLB_spin:
    s_sleep 24
    buffer_load_dword v223, v222, s[36:39], 0 offen sc1
    s_waitcnt vmcnt(0)
    v_cmp_gt_u32 vcc, 32, v223
    s_sub_u32 s63, s63, 1
    s_cbranch_scc1 POLLB_ok
    s_cbranch_vccnz POLLB_spin
POLLB_ok:
    s_waitcnt lgkmcnt(0)
    s_barrier
    v_add_u32 v240, 114688, v250
    v_xor_b32 v241, 32, v240
    v_xor_b32 v242, 64, v240
    v_xor_b32 v243, 96, v240
    ds_read_b64_tr_b16 v[224:225], v240 offset:0
    ds_read_b64_tr_b16 v[226:227], v240 offset:512
    s_setprio 3
    v_mfma_f32_16x16x32_bf16 v[160:163], v[232:235], v[136:139], v[160:163]
    ds_read_b64_tr_b16 v[228:229], v241 offset:0
    ds_read_b64_tr_b16 v[230:231], v241 offset:512
    v_mfma_f32_16x16x32_bf16 v[164:167], v[232:235], v[140:143], v[164:167]
    s_add_u32 m0, s27, 0
    s_add_u32 s30, s41, 0
    buffer_load_dwordx4 v248, s[4:7], s30 offen sc1 lds
    v_mfma_f32_16x16x32_bf16 v[168:171], v[236:239], v[136:139], v[168:171]
    ds_read_b64_tr_b16 v[232:233], v242 offset:0
    v_mfma_f32_16x16x32_bf16 v[172:175], v[236:239], v[140:143], v[172:175]
    ds_read_b64_tr_b16 v[234:235], v242 offset:512
    s_waitcnt lgkmcnt(4)
    v_mfma_f32_16x16x32_bf16 v[176:179], v[224:227], v[80:83], v[176:179]
    ds_read_b64_tr_b16 v[236:237], v243 offset:0
    v_mfma_f32_16x16x32_bf16 v[180:183], v[224:227], v[84:87], v[180:183]
    ds_read_b64_tr_b16 v[238:239], v243 offset:512
    s_waitcnt lgkmcnt(4)
    v_mfma_f32_16x16x32_bf16 v[184:187], v[228:231], v[80:83], v[184:187]
    ds_read_b64_tr_b16 v[224:225], v240 offset:4096
    ds_read_b64_tr_b16 v[226:227], v240 offset:4608
    v_mfma_f32_16x16x32_bf16 v[188:191], v[228:231], v[84:87], v[188:191]
    s_waitcnt lgkmcnt(4)
    s_add_u32 m0, s27, 8192
    s_add_u32 s30, s41, 8192
    buffer_load_dwordx4 v248, s[4:7], s30 offen sc1 lds
    v_mfma_f32_16x16x32_bf16 v[192:195], v[232:235], v[80:83], v[192:195]
    ds_read_b64_tr_b16 v[228:229], v241 offset:4096
    ds_read_b64_tr_b16 v[230:231], v241 offset:4608
    v_mfma_f32_16x16x32_bf16 v[196:199], v[232:235], v[84:87], v[196:199]
    s_waitcnt lgkmcnt(4)
    v_mul_f32 v144, s50, v144
    v_mul_f32 v145, s50, v145
    v_mfma_f32_16x16x32_bf16 v[200:203], v[236:239], v[80:83], v[200:203]
    ds_read_b64_tr_b16 v[232:233], v242 offset:4096
    ds_read_b64_tr_b16 v[234:235], v242 offset:4608
    v_mfma_f32_16x16x32_bf16 v[204:207], v[236:239], v[84:87], v[204:207]
    s_waitcnt lgkmcnt(4)
    v_mul_f32 v146, s50, v146
    v_mul_f32 v147, s50, v147
    v_mfma_f32_16x16x32_bf16 v[176:179], v[224:227], v[88:91], v[176:179]
    ds_read_b64_tr_b16 v[236:237], v243 offset:4096
    ds_read_b64_tr_b16 v[238:239], v243 offset:4608
    v_mfma_f32_16x16x32_bf16 v[180:183], v[224:227], v[92:95], v[180:183]
    s_waitcnt lgkmcnt(4)
    s_add_u32 m0, s27, 16384
    s_add_u32 s30, s41, 16384
    buffer_load_dwordx4 v248, s[4:7], s30 offen sc1 lds
    s_setprio 2
    v_mfma_f32_16x16x32_bf16 v[184:187], v[228:231], v[88:91], v[184:187]
    ds_read_b64_tr_b16 v[224:225], v240 offset:8192
    ds_read_b64_tr_b16 v[226:227], v240 offset:8704
    v_mfma_f32_16x16x32_bf16 v[188:191], v[228:231], v[92:95], v[188:191]
    s_waitcnt lgkmcnt(4)
    v_exp_f32 v144, v144
    v_exp_f32 v145, v145
    v_mfma_f32_16x16x32_bf16 v[192:195], v[232:235], v[88:91], v[192:195]
    ds_read_b64_tr_b16 v[228:229], v241 offset:8192
    ds_read_b64_tr_b16 v[230:231], v241 offset:8704
    v_mfma_f32_16x16x32_bf16 v[196:199], v[232:235], v[92:95], v[196:199]
    s_waitcnt lgkmcnt(4)
    v_exp_f32 v146, v146
    v_mfma_f32_16x16x32_bf16 v[200:203], v[236:239], v[88:91], v[200:203]
    ds_read_b64_tr_b16 v[232:233], v242 offset:8192
    ds_read_b64_tr_b16 v[234:235], v242 offset:8704
    v_mfma_f32_16x16x32_bf16 v[204:207], v[236:239], v[92:95], v[204:207]
    s_waitcnt lgkmcnt(4)
    s_add_u32 m0, s27, 24576
    s_add_u32 s30, s41, 24576
    buffer_load_dwordx4 v248, s[4:7], s30 offen sc1 lds
    v_mfma_f32_16x16x32_bf16 v[176:179], v[224:227], v[96:99], v[176:179]
    ds_read_b64_tr_b16 v[236:237], v243 offset:8192
    ds_read_b64_tr_b16 v[238:239], v243 offset:8704
    v_mfma_f32_16x16x32_bf16 v[180:183], v[224:227], v[100:103], v[180:183]
    s_waitcnt lgkmcnt(4)
    v_exp_f32 v147, v147
    v_add_f32 v144, 1.0, v144
    v_add_f32 v145, 1.0, v145
    v_mfma_f32_16x16x32_bf16 v[184:187], v[228:231], v[96:99], v[184:187]
    ds_read_b64_tr_b16 v[224:225], v240 offset:12288
    ds_read_b64_tr_b16 v[226:227], v240 offset:12800
    v_mfma_f32_16x16x32_bf16 v[188:191], v[228:231], v[100:103], v[188:191]
    s_waitcnt lgkmcnt(4)
    v_add_f32 v146, 1.0, v146
    v_add_f32 v147, 1.0, v147
    v_mfma_f32_16x16x32_bf16 v[192:195], v[232:235], v[96:99], v[192:195]
    ds_read_b64_tr_b16 v[228:229], v241 offset:12288
    ds_read_b64_tr_b16 v[230:231], v241 offset:12800
    v_mfma_f32_16x16x32_bf16 v[196:199], v[232:235], v[100:103], v[196:199]
    s_waitcnt lgkmcnt(4)
    s_add_u32 m0, s27, 32768
    s_add_u32 s30, s41, 32768
    buffer_load_dwordx4 v248, s[4:7], s30 offen sc1 lds
    v_mfma_f32_16x16x32_bf16 v[200:203], v[236:239], v[96:99], v[200:203]
    ds_read_b64_tr_b16 v[232:233], v242 offset:12288
    ds_read_b64_tr_b16 v[234:235], v242 offset:12800
    v_mfma_f32_16x16x32_bf16 v[204:207], v[236:239], v[100:103], v[204:207]
    s_waitcnt lgkmcnt(4)
    v_rcp_f32 v144, v144
    v_rcp_f32 v145, v145
    v_mfma_f32_16x16x32_bf16 v[176:179], v[224:227], v[104:107], v[176:179]
    ds_read_b64_tr_b16 v[236:237], v243 offset:12288
    ds_read_b64_tr_b16 v[238:239], v243 offset:12800
    v_mfma_f32_16x16x32_bf16 v[180:183], v[224:227], v[108:111], v[180:183]
    s_waitcnt lgkmcnt(4)
    v_rcp_f32 v146, v146
    v_rcp_f32 v147, v147
    s_setprio 1
    v_mfma_f32_16x16x32_bf16 v[184:187], v[228:231], v[104:107], v[184:187]
    ds_read_b64_tr_b16 v[224:225], v240 offset:16384
    ds_read_b64_tr_b16 v[226:227], v240 offset:16896
    v_mfma_f32_16x16x32_bf16 v[188:191], v[228:231], v[108:111], v[188:191]
    s_waitcnt lgkmcnt(4)
    s_add_u32 m0, s27, 73728
    s_add_u32 s30, s40, 0
    buffer_load_dwordx4 v248, s[4:7], s30 offen sc1 lds
    v_mfma_f32_16x16x32_bf16 v[192:195], v[232:235], v[104:107], v[192:195]
    ds_read_b64_tr_b16 v[228:229], v241 offset:16384
    ds_read_b64_tr_b16 v[230:231], v241 offset:16896
    v_mfma_f32_16x16x32_bf16 v[196:199], v[232:235], v[108:111], v[196:199]
    s_waitcnt lgkmcnt(4)
    v_mul_f32 v148, s50, v148
    v_mul_f32 v149, s50, v149
    v_mul_f32 v150, s50, v150
    v_mul_f32 v151, s50, v151
    v_mfma_f32_16x16x32_bf16 v[200:203], v[236:239], v[104:107], v[200:203]
    ds_read_b64_tr_b16 v[232:233], v242 offset:16384
    ds_read_b64_tr_b16 v[234:235], v242 offset:16896
    v_mfma_f32_16x16x32_bf16 v[204:207], v[236:239], v[108:111], v[204:207]
    s_waitcnt lgkmcnt(4)
    v_exp_f32 v148, v148
    v_mfma_f32_16x16x32_bf16 v[176:179], v[224:227], v[112:115], v[176:179]
    ds_read_b64_tr_b16 v[236:237], v243 offset:16384
    ds_read_b64_tr_b16 v[238:239], v243 offset:16896
    v_mfma_f32_16x16x32_bf16 v[180:183], v[224:227], v[116:119], v[180:183]
    s_waitcnt lgkmcnt(4)
    s_add_u32 m0, s27, 81920
    s_add_u32 s30, s40, 8192
    buffer_load_dwordx4 v248, s[4:7], s30 offen sc1 lds
    v_mfma_f32_16x16x32_bf16 v[184:187], v[228:231], v[112:115], v[184:187]
    ds_read_b64_tr_b16 v[224:225], v240 offset:20480
    ds_read_b64_tr_b16 v[226:227], v240 offset:20992
    v_mfma_f32_16x16x32_bf16 v[188:191], v[228:231], v[116:119], v[188:191]
    s_waitcnt lgkmcnt(4)
    v_exp_f32 v149, v149
    v_exp_f32 v150, v150
    v_mfma_f32_16x16x32_bf16 v[192:195], v[232:235], v[112:115], v[192:195]
    ds_read_b64_tr_b16 v[228:229], v241 offset:20480
    ds_read_b64_tr_b16 v[230:231], v241 offset:20992
    v_mfma_f32_16x16x32_bf16 v[196:199], v[232:235], v[116:119], v[196:199]
    s_waitcnt lgkmcnt(4)
    v_exp_f32 v151, v151
    v_mfma_f32_16x16x32_bf16 v[200:203], v[236:239], v[112:115], v[200:203]
    ds_read_b64_tr_b16 v[232:233], v242 offset:20480
    ds_read_b64_tr_b16 v[234:235], v242 offset:20992
    v_mfma_f32_16x16x32_bf16 v[204:207], v[236:239], v[116:119], v[204:207]
    s_waitcnt lgkmcnt(4)
    s_add_u32 m0, s27, 90112
    s_add_u32 s30, s40, 16384
    buffer_load_dwordx4 v248, s[4:7], s30 offen sc1 lds
    v_mfma_f32_16x16x32_bf16 v[176:179], v[224:227], v[120:123], v[176:179]
    ds_read_b64_tr_b16 v[236:237], v243 offset:20480
    ds_read_b64_tr_b16 v[238:239], v243 offset:20992
    v_mfma_f32_16x16x32_bf16 v[180:183], v[224:227], v[124:127], v[180:183]
    s_waitcnt lgkmcnt(4)
    v_add_f32 v148, 1.0, v148
    v_add_f32 v149, 1.0, v149
    v_add_f32 v150, 1.0, v150
    v_add_f32 v151, 1.0, v151
    s_setprio 0
    v_mfma_f32_16x16x32_bf16 v[184:187], v[228:231], v[120:123], v[184:187]
    ds_read_b64_tr_b16 v[224:225], v240 offset:24576
    ds_read_b64_tr_b16 v[226:227], v240 offset:25088
    v_mfma_f32_16x16x32_bf16 v[188:191], v[228:231], v[124:127], v[188:191]
    s_waitcnt lgkmcnt(4)
    v_rcp_f32 v148, v148
    v_mfma_f32_16x16x32_bf16 v[192:195], v[232:235], v[120:123], v[192:195]
    ds_read_b64_tr_b16 v[228:229], v241 offset:24576
    ds_read_b64_tr_b16 v[230:231], v241 offset:25088
    v_mfma_f32_16x16x32_bf16 v[196:199], v[232:235], v[124:127], v[196:199]
    s_waitcnt lgkmcnt(4)
    s_add_u32 m0, s27, 98304
    s_add_u32 s30, s40, 24576
    buffer_load_dwordx4 v248, s[4:7], s30 offen sc1 lds
    v_mfma_f32_16x16x32_bf16 v[200:203], v[236:239], v[120:123], v[200:203]
    ds_read_b64_tr_b16 v[232:233], v242 offset:24576
    ds_read_b64_tr_b16 v[234:235], v242 offset:25088
    v_mfma_f32_16x16x32_bf16 v[204:207], v[236:239], v[124:127], v[204:207]
    s_waitcnt lgkmcnt(4)
    v_rcp_f32 v149, v149
    v_rcp_f32 v150, v150
    v_mfma_f32_16x16x32_bf16 v[176:179], v[224:227], v[128:131], v[176:179]
    ds_read_b64_tr_b16 v[236:237], v243 offset:24576
    ds_read_b64_tr_b16 v[238:239], v243 offset:25088
    v_mfma_f32_16x16x32_bf16 v[180:183], v[224:227], v[132:135], v[180:183]
    s_waitcnt lgkmcnt(4)
    v_rcp_f32 v151, v151
    v_mul_f32 v152, s50, v152
    v_mul_f32 v153, s50, v153
    v_mfma_f32_16x16x32_bf16 v[184:187], v[228:231], v[128:131], v[184:187]
    ds_read_b64_tr_b16 v[224:225], v240 offset:28672
    ds_read_b64_tr_b16 v[226:227], v240 offset:29184
    v_mfma_f32_16x16x32_bf16 v[188:191], v[228:231], v[132:135], v[188:191]
    s_waitcnt lgkmcnt(4)
    s_add_u32 m0, s27, 106496
    s_add_u32 s30, s40, 32768
    buffer_load_dwordx4 v248, s[4:7], s30 offen sc1 lds
    v_mfma_f32_16x16x32_bf16 v[192:195], v[232:235], v[128:131], v[192:195]
    ds_read_b64_tr_b16 v[228:229], v241 offset:28672
    ds_read_b64_tr_b16 v[230:231], v241 offset:29184
    v_mfma_f32_16x16x32_bf16 v[196:199], v[232:235], v[132:135], v[196:199]
    s_waitcnt lgkmcnt(4)
    v_mul_f32 v154, s50, v154
    v_mul_f32 v155, s50, v155
    v_exp_f32 v152, v152
    v_mfma_f32_16x16x32_bf16 v[200:203], v[236:239], v[128:131], v[200:203]
    ds_read_b64_tr_b16 v[232:233], v242 offset:28672
    ds_read_b64_tr_b16 v[234:235], v242 offset:29184
    v_mfma_f32_16x16x32_bf16 v[204:207], v[236:239], v[132:135], v[204:207]
    s_waitcnt lgkmcnt(4)
    v_exp_f32 v153, v153
    v_mfma_f32_16x16x32_bf16 v[176:179], v[224:227], v[136:139], v[176:179]
    ds_read_b64_tr_b16 v[236:237], v243 offset:28672
    ds_read_b64_tr_b16 v[238:239], v243 offset:29184
    v_mfma_f32_16x16x32_bf16 v[180:183], v[224:227], v[140:143], v[180:183]
    s_waitcnt lgkmcnt(4)
    s_add_u32 m0, s27, 40960
    s_add_u32 s30, s40, 40960
    buffer_load_dwordx4 v248, s[4:7], s30 offen sc1 lds
    v_mfma_f32_16x16x32_bf16 v[184:187], v[228:231], v[136:139], v[184:187]
    v_mfma_f32_16x16x32_bf16 v[188:191], v[228:231], v[140:143], v[188:191]
    s_waitcnt vmcnt(6) lgkmcnt(0)
    s_barrier
    s_cmp_lg_u32 s20, 7
    s_cbranch_scc1 PH1_c
    v_mov_b32 v253, 1
    s_lshl_b32 s62, s22, 5
    s_mov_b64 exec, 1
    buffer_atomic_add v253, off, s[36:39], s62 offset:8 sc1
    s_mov_b64 exec, -1
PH1_c:
    v_add_u32 v240, 0, v250
    v_xor_b32 v241, 32, v240
    v_xor_b32 v242, 64, v240
    v_xor_b32 v243, 96, v240
    ds_read_b64_tr_b16 v[224:225], v240 offset:0
    ds_read_b64_tr_b16 v[226:227], v240 offset:512
    v_exp_f32 v154, v154
    v_exp_f32 v155, v155
    s_setprio 3
    v_mfma_f32_16x16x32_bf16 v[192:195], v[232:235], v[136:139], v[192:195]
    ds_read_b64_tr_b16 v[228:229], v241 offset:0
    ds_read_b64_tr_b16 v[230:231], v241 offset:512
    v_mfma_f32_16x16x32_bf16 v[196:199], v[232:235], v[140:143], v[196:199]
    v_add_f32 v152, 1.0, v152
    v_add_f32 v153, 1.0, v153
    v_mfma_f32_16x16x32_bf16 v[200:203], v[236:239], v[136:139], v[200:203]
    ds_read_b64_tr_b16 v[232:233], v242 offset:0
    ds_read_b64_tr_b16 v[234:235], v242 offset:512
    v_mfma_f32_16x16x32_bf16 v[204:207], v[236:239], v[140:143], v[204:207]
    s_waitcnt lgkmcnt(4)
    s_add_u32 m0, s27, 49152
    s_add_u32 s30, s40, 49152
    buffer_load_dwordx4 v248, s[4:7], s30 offen sc1 lds
    v_mfma_f32_16x16x32_bf16 v[208:211], v[224:227], v[0:3], 0
    ds_read_b64_tr_b16 v[236:237], v243 offset:0
    ds_read_b64_tr_b16 v[238:239], v243 offset:512
    v_mfma_f32_16x16x32_bf16 v[212:215], v[224:227], v[4:7], 0
    s_waitcnt lgkmcnt(4)
    v_add_f32 v154, 1.0, v154
    v_add_f32 v155, 1.0, v155
    v_mfma_f32_16x16x32_bf16 v[216:219], v[228:231], v[0:3], 0
    ds_read_b64_tr_b16 v[224:225], v240 offset:4096
    v_mfma_f32_16x16x32_bf16 v[220:223], v[228:231], v[4:7], 0
    ds_read_b64_tr_b16 v[226:227], v240 offset:4608
    s_waitcnt lgkmcnt(4)
    v_mfma_f32_16x16x32_bf16 v[208:211], v[232:235], v[72:75], v[208:211]
    ds_read_b64_tr_b16 v[228:229], v241 offset:4096
    ds_read_b64_tr_b16 v[230:231], v241 offset:4608
    v_mfma_f32_16x16x32_bf16 v[212:215], v[232:235], v[76:79], v[212:215]
    s_waitcnt lgkmcnt(4)
    s_add_u32 m0, s27, 57344
    s_add_u32 s30, s40, 57344
    buffer_load_dwordx4 v248, s[4:7], s30 offen sc1 lds
    v_mfma_f32_16x16x32_bf16 v[216:219], v[236:239], v[72:75], v[216:219]
    ds_read_b64_tr_b16 v[232:233], v242 offset:4096
    ds_read_b64_tr_b16 v[234:235], v242 offset:4608
    v_mfma_f32_16x16x32_bf16 v[220:223], v[236:239], v[76:79], v[220:223]
    s_waitcnt lgkmcnt(4)
    v_mul_f32 v176, v176, v144
    v_mul_f32 v177, v177, v145
    v_mul_f32 v178, v178, v146
    v_mul_f32 v179, v179, v147
    v_mfma_f32_16x16x32_bf16 v[208:211], v[224:227], v[8:11], v[208:211]
    ds_read_b64_tr_b16 v[236:237], v243 offset:4096
    ds_read_b64_tr_b16 v[238:239], v243 offset:4608
    v_mfma_f32_16x16x32_bf16 v[212:215], v[224:227], v[12:15], v[212:215]
    s_waitcnt lgkmcnt(4)
    v_mul_f32 v180, v180, v148
    v_mul_f32 v181, v181, v149
    v_mfma_f32_16x16x32_bf16 v[216:219], v[228:231], v[8:11], v[216:219]
    ds_read_b64_tr_b16 v[224:225], v240 offset:8192
    ds_read_b64_tr_b16 v[226:227], v240 offset:8704
    v_mfma_f32_16x16x32_bf16 v[220:223], v[228:231], v[12:15], v[220:223]
    s_waitcnt lgkmcnt(4)
    s_add_u32 m0, s27, 65536
    s_add_u32 s30, s40, 65536
    buffer_load_dwordx4 v248, s[4:7], s30 offen sc1 lds
    s_setprio 2
    v_mfma_f32_16x16x32_bf16 v[208:211], v[232:235], v[80:83], v[208:211]
    ds_read_b64_tr_b16 v[228:229], v241 offset:8192
    ds_read_b64_tr_b16 v[230:231], v241 offset:8704
    v_mfma_f32_16x16x32_bf16 v[212:215], v[232:235], v[84:87], v[212:215]
    s_waitcnt lgkmcnt(4)
    s_lshr_b32 s62, s2, 3
    s_lshl_b32 s62, s62, 3
    s_add_u32 s62, s62, s20
    s_mul_i32 s62, s62, 5248
    s_lshr_b32 s63, s23, 1
    s_mul_i32 s63, s63, 1327104
    s_add_u32 s62, s62, s63
    v_lshlrev_b32 v251, 3, v248
    s_mov_b32 s29, s62
    s_mov_b64 exec, 0x7f
    buffer_load_dword v252, v251, s[16:19], s29 offen offset:0
    s_mov_b64 exec, -1
    v_mfma_f32_16x16x32_bf16 v[216:219], v[236:239], v[80:83], v[216:219]
    ds_read_b64_tr_b16 v[232:233], v242 offset:8192
    ds_read_b64_tr_b16 v[234:235], v242 offset:8704
    v_mfma_f32_16x16x32_bf16 v[220:223], v[236:239], v[84:87], v[220:223]
    s_waitcnt lgkmcnt(4)
    v_mul_f32 v182, v182, v150
    v_mul_f32 v183, v183, v151
    v_cvt_pk_bf16_f32 v244, v176, v177
    v_cvt_pk_bf16_f32 v245, v178, v179
    v_mfma_f32_16x16x32_bf16 v[208:211], v[224:227], v[16:19], v[208:211]
    ds_read_b64_tr_b16 v[236:237], v243 offset:8192
    ds_read_b64_tr_b16 v[238:239], v243 offset:8704
    v_mfma_f32_16x16x32_bf16 v[212:215], v[224:227], v[20:23], v[212:215]
    s_waitcnt lgkmcnt(4)
    s_add_u32 m0, s27, 114688
    s_add_u32 s30, s25, 128
    buffer_load_dwordx4 v249, s[8:11], s30 offen lds
    v_mfma_f32_16x16x32_bf16 v[216:219], v[228:231], v[16:19], v[216:219]
    ds_read_b64_tr_b16 v[224:225], v240 offset:12288
    ds_read_b64_tr_b16 v[226:227], v240 offset:12800
    v_mfma_f32_16x16x32_bf16 v[220:223], v[228:231], v[20:23], v[220:223]
    s_waitcnt lgkmcnt(4)
    v_cvt_pk_bf16_f32 v246, v180, v181
    v_cvt_pk_bf16_f32 v247, v182, v183
    s_nop 1
    v_permlane16_swap_b32 v244, v246
    v_permlane16_swap_b32 v245, v247
    v_mfma_f32_16x16x32_bf16 v[208:211], v[232:235], v[88:91], v[208:211]
    ds_read_b64_tr_b16 v[228:229], v241 offset:12288
    ds_read_b64_tr_b16 v[230:231], v241 offset:12800
    v_mfma_f32_16x16x32_bf16 v[212:215], v[232:235], v[92:95], v[212:215]
    s_waitcnt lgkmcnt(4)
    buffer_store_dwordx4 v[244:247], v248, s[4:7], s32 offen offset:0 sc1
    v_mfma_f32_16x16x32_bf16 v[216:219], v[236:239], v[88:91], v[216:219]
    ds_read_b64_tr_b16 v[232:233], v242 offset:12288
    ds_read_b64_tr_b16 v[234:235], v242 offset:12800
    v_mfma_f32_16x16x32_bf16 v[220:223], v[236:239], v[92:95], v[220:223]
    s_waitcnt lgkmcnt(4)
    v_rcp_f32 v152, v152
    v_rcp_f32 v153, v153
    v_mfma_f32_16x16x32_bf16 v[208:211], v[224:227], v[24:27], v[208:211]
    ds_read_b64_tr_b16 v[236:237], v243 offset:12288
    ds_read_b64_tr_b16 v[238:239], v243 offset:12800
    v_mfma_f32_16x16x32_bf16 v[212:215], v[224:227], v[28:31], v[212:215]
    s_waitcnt lgkmcnt(4)
    v_rcp_f32 v154, v154
    v_rcp_f32 v155, v155
    v_mfma_f32_16x16x32_bf16 v[216:219], v[228:231], v[24:27], v[216:219]
    ds_read_b64_tr_b16 v[224:225], v240 offset:16384
    ds_read_b64_tr_b16 v[226:227], v240 offset:16896
    v_mfma_f32_16x16x32_bf16 v[220:223], v[228:231], v[28:31], v[220:223]
    s_waitcnt lgkmcnt(4)
    v_mul_f32 v156, s50, v156
    v_mul_f32 v157, s50, v157
    v_mfma_f32_16x16x32_bf16 v[208:211], v[232:235], v[96:99], v[208:211]
    ds_read_b64_tr_b16 v[228:229], v241 offset:16384
    ds_read_b64_tr_b16 v[230:231], v241 offset:16896
    v_mfma_f32_16x16x32_bf16 v[212:215], v[232:235], v[100:103], v[212:215]
    s_waitcnt lgkmcnt(4)
    v_mul_f32 v158, s50, v158
    v_mul_f32 v159, s50, v159
    s_setprio 1
    v_mfma_f32_16x16x32_bf16 v[216:219], v[236:239], v[96:99], v[216:219]
    ds_read_b64_tr_b16 v[232:233], v242 offset:16384
    ds_read_b64_tr_b16 v[234:235], v242 offset:16896
    v_mfma_f32_16x16x32_bf16 v[220:223], v[236:239], v[100:103], v[220:223]
    s_waitcnt lgkmcnt(4)
    s_add_u32 m0, s27, 122880
    s_add_u32 s30, s25, 589952
    buffer_load_dwordx4 v249, s[8:11], s30 offen lds
    v_mfma_f32_16x16x32_bf16 v[208:211], v[224:227], v[32:35], v[208:211]
    ds_read_b64_tr_b16 v[236:237], v243 offset:16384
    ds_read_b64_tr_b16 v[238:239], v243 offset:16896
    v_mfma_f32_16x16x32_bf16 v[212:215], v[224:227], v[36:39], v[212:215]
    s_waitcnt lgkmcnt(4)
    v_exp_f32 v156, v156
    v_exp_f32 v157, v157
    v_mfma_f32_16x16x32_bf16 v[216:219], v[228:231], v[32:35], v[216:219]
    ds_read_b64_tr_b16 v[224:225], v240 offset:20480
    ds_read_b64_tr_b16 v[226:227], v240 offset:20992
    v_mfma_f32_16x16x32_bf16 v[220:223], v[228:231], v[36:39], v[220:223]
    s_waitcnt lgkmcnt(4)
    v_exp_f32 v158, v158
    v_mfma_f32_16x16x32_bf16 v[208:211], v[232:235], v[104:107], v[208:211]
    ds_read_b64_tr_b16 v[228:229], v241 offset:20480
    ds_read_b64_tr_b16 v[230:231], v241 offset:20992
    v_mfma_f32_16x16x32_bf16 v[212:215], v[232:235], v[108:111], v[212:215]
    s_waitcnt lgkmcnt(4)
    v_exp_f32 v159, v159
    v_mfma_f32_16x16x32_bf16 v[216:219], v[236:239], v[104:107], v[216:219]
    ds_read_b64_tr_b16 v[232:233], v242 offset:20480
    ds_read_b64_tr_b16 v[234:235], v242 offset:20992
    v_mfma_f32_16x16x32_bf16 v[220:223], v[236:239], v[108:111], v[220:223]
    s_waitcnt lgkmcnt(4)
    v_add_f32 v156, 1.0, v156
    v_add_f32 v157, 1.0, v157
    v_mfma_f32_16x16x32_bf16 v[208:211], v[224:227], v[40:43], v[208:211]
    ds_read_b64_tr_b16 v[236:237], v243 offset:20480
    ds_read_b64_tr_b16 v[238:239], v243 offset:20992
    v_mfma_f32_16x16x32_bf16 v[212:215], v[224:227], v[44:47], v[212:215]
    s_waitcnt lgkmcnt(4)
    s_mov_b64 exec, 0x7f
    buffer_load_dword v252, v251, s[16:19], s29 offen offset:896
    s_mov_b64 exec, -1
    v_mfma_f32_16x16x32_bf16 v[216:219], v[228:231], v[40:43], v[216:219]
    ds_read_b64_tr_b16 v[224:225], v240 offset:24576
    ds_read_b64_tr_b16 v[226:227], v240 offset:25088
    v_mfma_f32_16x16x32_bf16 v[220:223], v[228:231], v[44:47], v[220:223]
    s_waitcnt lgkmcnt(4)
    v_add_f32 v158, 1.0, v158
    v_add_f32 v159, 1.0, v159
    v_rcp_f32 v156, v156
    v_mfma_f32_16x16x32_bf16 v[208:211], v[232:235], v[112:115], v[208:211]
    ds_read_b64_tr_b16 v[228:229], v241 offset:24576
    ds_read_b64_tr_b16 v[230:231], v241 offset:25088
    v_mfma_f32_16x16x32_bf16 v[212:215], v[232:235], v[116:119], v[212:215]
    s_waitcnt lgkmcnt(4)
    s_add_u32 m0, s27, 131072
    s_add_u32 s30, s25, 1179776
    buffer_load_dwordx4 v249, s[8:11], s30 offen lds
    v_mfma_f32_16x16x32_bf16 v[216:219], v[236:239], v[112:115], v[216:219]
    ds_read_b64_tr_b16 v[232:233], v242 offset:24576
    ds_read_b64_tr_b16 v[234:235], v242 offset:25088
    v_mfma_f32_16x16x32_bf16 v[220:223], v[236:239], v[116:119], v[220:223]
    s_waitcnt lgkmcnt(4)
    v_rcp_f32 v157, v157
    v_rcp_f32 v158, v158
    s_setprio 0
    v_mfma_f32_16x16x32_bf16 v[208:211], v[224:227], v[48:51], v[208:211]
    ds_read_b64_tr_b16 v[236:237], v243 offset:24576
    ds_read_b64_tr_b16 v[238:239], v243 offset:25088
    v_mfma_f32_16x16x32_bf16 v[212:215], v[224:227], v[52:55], v[212:215]
    s_waitcnt lgkmcnt(4)
    v_rcp_f32 v159, v159
    v_mul_f32 v184, v184, v152
    v_mul_f32 v185, v185, v153
    v_mfma_f32_16x16x32_bf16 v[216:219], v[228:231], v[48:51], v[216:219]
    ds_read_b64_tr_b16 v[224:225], v240 offset:28672
    ds_read_b64_tr_b16 v[226:227], v240 offset:29184
    v_mfma_f32_16x16x32_bf16 v[220:223], v[228:231], v[52:55], v[220:223]
    s_waitcnt lgkmcnt(4)
    v_mul_f32 v186, v186, v154
    v_mul_f32 v187, v187, v155
    v_mfma_f32_16x16x32_bf16 v[208:211], v[232:235], v[120:123], v[208:211]
    ds_read_b64_tr_b16 v[228:229], v241 offset:28672
    ds_read_b64_tr_b16 v[230:231], v241 offset:29184
    v_mfma_f32_16x16x32_bf16 v[212:215], v[232:235], v[124:127], v[212:215]
    s_waitcnt lgkmcnt(4)
    v_mul_f32 v188, v188, v156
    v_mul_f32 v189, v189, v157
    v_mfma_f32_16x16x32_bf16 v[216:219], v[236:239], v[120:123], v[216:219]
    ds_read_b64_tr_b16 v[232:233], v242 offset:28672
    ds_read_b64_tr_b16 v[234:235], v242 offset:29184
    v_mfma_f32_16x16x32_bf16 v[220:223], v[236:239], v[124:127], v[220:223]
    s_waitcnt lgkmcnt(4)
    v_mul_f32 v190, v190, v158
    v_mul_f32 v191, v191, v159
    v_mfma_f32_16x16x32_bf16 v[208:211], v[224:227], v[56:59], v[208:211]
    ds_read_b64_tr_b16 v[236:237], v243 offset:28672
    ds_read_b64_tr_b16 v[238:239], v243 offset:29184
    v_mfma_f32_16x16x32_bf16 v[212:215], v[224:227], v[60:63], v[212:215]
    s_waitcnt lgkmcnt(4)
    v_cvt_pk_bf16_f32 v244, v184, v185
    v_cvt_pk_bf16_f32 v245, v186, v187
    v_mfma_f32_16x16x32_bf16 v[216:219], v[228:231], v[56:59], v[216:219]
    ds_read_b64_tr_b16 v[224:225], v240 offset:32768
    ds_read_b64_tr_b16 v[226:227], v240 offset:33280
    v_mfma_f32_16x16x32_bf16 v[220:223], v[228:231], v[60:63], v[220:223]
    s_waitcnt lgkmcnt(4)
    s_add_u32 m0, s27, 139264
    s_add_u32 s30, s25, 1769600
    buffer_load_dwordx4 v249, s[8:11], s30 offen lds
    v_mfma_f32_16x16x32_bf16 v[208:211], v[232:235], v[128:131], v[208:211]
    ds_read_b64_tr_b16 v[228:229], v241 offset:32768
    ds_read_b64_tr_b16 v[230:231], v241 offset:33280
    v_mfma_f32_16x16x32_bf16 v[212:215], v[232:235], v[132:135], v[212:215]
    s_waitcnt lgkmcnt(4)
    v_cvt_pk_bf16_f32 v246, v188, v189
    v_cvt_pk_bf16_f32 v247, v190, v191
    s_nop 1
    v_permlane16_swap_b32 v244, v246
    v_permlane16_swap_b32 v245, v247
    v_mfma_f32_16x16x32_bf16 v[216:219], v[236:239], v[128:131], v[216:219]
    ds_read_b64_tr_b16 v[232:233], v242 offset:32768
    ds_read_b64_tr_b16 v[234:235], v242 offset:33280
    v_mfma_f32_16x16x32_bf16 v[220:223], v[236:239], v[132:135], v[220:223]
    s_waitcnt lgkmcnt(4)
    buffer_store_dwordx4 v[244:247], v248, s[4:7], s32 offen offset:1024 sc1
    v_mfma_f32_16x16x32_bf16 v[208:211], v[224:227], v[64:67], v[208:211]
    ds_read_b64_tr_b16 v[236:237], v243 offset:32768
    ds_read_b64_tr_b16 v[238:239], v243 offset:33280
    v_mfma_f32_16x16x32_bf16 v[212:215], v[224:227], v[68:71], v[212:215]
    s_waitcnt lgkmcnt(4)
    v_mul_f32 v160, s50, v160
    v_mul_f32 v161, s50, v161
    v_mul_f32 v162, s50, v162
    v_mul_f32 v163, s50, v163
    v_mfma_f32_16x16x32_bf16 v[216:219], v[228:231], v[64:67], v[216:219]
    v_mfma_f32_16x16x32_bf16 v[220:223], v[228:231], v[68:71], v[220:223]
    s_waitcnt vmcnt(8) lgkmcnt(0)
    s_barrier
    v_add_u32 v240, 73728, v250
    v_xor_b32 v241, 32, v240
    v_xor_b32 v242, 64, v240
    v_xor_b32 v243, 96, v240
    ds_read_b64_tr_b16 v[224:225], v240 offset:0
    ds_read_b64_tr_b16 v[226:227], v240 offset:512
    v_exp_f32 v160, v160
    s_setprio 3
    v_mfma_f32_16x16x32_bf16 v[208:211], v[232:235], v[136:139], v[208:211]
    ds_read_b64_tr_b16 v[228:229], v241 offset:0
    ds_read_b64_tr_b16 v[230:231], v241 offset:512
    v_mfma_f32_16x16x32_bf16 v[212:215], v[232:235], v[140:143], v[212:215]
    s_mov_b64 exec, 0x7f
    buffer_load_dword v252, v251, s[16:19], s29 offen offset:1792
    s_mov_b64 exec, -1
    v_mfma_f32_16x16x32_bf16 v[216:219], v[236:239], v[136:139], v[216:219]
    ds_read_b64_tr_b16 v[232:233], v242 offset:0
    ds_read_b64_tr_b16 v[234:235], v242 offset:512
    v_mfma_f32_16x16x32_bf16 v[220:223], v[236:239], v[140:143], v[220:223]
    s_waitcnt lgkmcnt(4)
    v_exp_f32 v161, v161
    v_exp_f32 v162, v162
    v_mfma_f32_16x16x32_bf16 v[144:147], v[224:227], v[0:3], 0
    ds_read_b64_tr_b16 v[236:237], v243 offset:0
    ds_read_b64_tr_b16 v[238:239], v243 offset:512
    v_mfma_f32_16x16x32_bf16 v[148:151], v[224:227], v[4:7], 0
    s_waitcnt lgkmcnt(4)
    s_add_u32 m0, s27, 0
    s_add_u32 s30, s25, 2359424
    buffer_load_dwordx4 v249, s[8:11], s30 offen lds
    v_mfma_f32_16x16x32_bf16 v[152:155], v[228:231], v[0:3], 0
    ds_read_b64_tr_b16 v[224:225], v240 offset:4096
    ds_read_b64_tr_b16 v[226:227], v240 offset:4608
    v_mfma_f32_16x16x32_bf16 v[156:159], v[228:231], v[4:7], 0
    s_waitcnt lgkmcnt(4)
    v_exp_f32 v163, v163
    v_add_f32 v160, 1.0, v160
    v_add_f32 v161, 1.0, v161
    v_mfma_f32_16x16x32_bf16 v[176:179], v[0:3], v[232:235], 0
    ds_read_b64_tr_b16 v[228:229], v241 offset:4096
    ds_read_b64_tr_b16 v[230:231], v241 offset:4608
    v_mfma_f32_16x16x32_bf16 v[180:183], v[4:7], v[232:235], 0
    s_waitcnt lgkmcnt(4)
    v_add_f32 v162, 1.0, v162
    v_add_f32 v163, 1.0, v163
    v_rcp_f32 v160, v160
    v_mfma_f32_16x16x32_bf16 v[184:187], v[0:3], v[236:239], 0
    ds_read_b64_tr_b16 v[232:233], v242 offset:4096
    ds_read_b64_tr_b16 v[234:235], v242 offset:4608
    v_mfma_f32_16x16x32_bf16 v[188:191], v[4:7], v[236:239], 0
    s_waitcnt lgkmcnt(4)
    v_rcp_f32 v161, v161
    v_mfma_f32_16x16x32_bf16 v[144:147], v[224:227], v[8:11], v[144:147]
    ds_read_b64_tr_b16 v[236:237], v243 offset:4096
    ds_read_b64_tr_b16 v[238:239], v243 offset:4608
    v_mfma_f32_16x16x32_bf16 v[148:151], v[224:227], v[12:15], v[148:151]
    s_waitcnt lgkmcnt(4)
    v_rcp_f32 v162, v162
    v_mfma_f32_16x16x32_bf16 v[152:155], v[228:231], v[8:11], v[152:155]
    ds_read_b64_tr_b16 v[224:225], v240 offset:8192
    ds_read_b64_tr_b16 v[226:227], v240 offset:8704
    v_mfma_f32_16x16x32_bf16 v[156:159], v[228:231], v[12:15], v[156:159]
    s_waitcnt lgkmcnt(4)
    v_rcp_f32 v163, v163
    v_mfma_f32_16x16x32_bf16 v[176:179], v[8:11], v[232:235], v[176:179]
    ds_read_b64_tr_b16 v[228:229], v241 offset:8192
    ds_read_b64_tr_b16 v[230:231], v241 offset:8704
    v_mfma_f32_16x16x32_bf16 v[180:183], v[12:15], v[232:235], v[180:183]
    s_waitcnt lgkmcnt(4)
    v_mul_f32 v164, s50, v164
    v_mul_f32 v165, s50, v165
    v_mfma_f32_16x16x32_bf16 v[184:187], v[8:11], v[236:239], v[184:187]
    ds_read_b64_tr_b16 v[232:233], v242 offset:8192
    ds_read_b64_tr_b16 v[234:235], v242 offset:8704
    v_mfma_f32_16x16x32_bf16 v[188:191], v[12:15], v[236:239], v[188:191]
    s_waitcnt lgkmcnt(4)
    s_add_u32 m0, s27, 8192
    s_add_u32 s30, s25, 2949248
    buffer_load_dwordx4 v249, s[8:11], s30 offen lds
    v_mfma_f32_16x16x32_bf16 v[144:147], v[224:227], v[16:19], v[144:147]
    ds_read_b64_tr_b16 v[236:237], v243 offset:8192
    ds_read_b64_tr_b16 v[238:239], v243 offset:8704
    v_mfma_f32_16x16x32_bf16 v[148:151], v[224:227], v[20:23], v[148:151]
    s_waitcnt lgkmcnt(4)
    v_mul_f32 v166, s50, v166
    v_mul_f32 v167, s50, v167
    v_exp_f32 v164, v164
    v_mfma_f32_16x16x32_bf16 v[152:155], v[228:231], v[16:19], v[152:155]
    ds_read_b64_tr_b16 v[224:225], v240 offset:12288
    ds_read_b64_tr_b16 v[226:227], v240 offset:12800
    v_mfma_f32_16x16x32_bf16 v[156:159], v[228:231], v[20:23], v[156:159]
    s_waitcnt lgkmcnt(4)
    v_exp_f32 v165, v165
    v_mfma_f32_16x16x32_bf16 v[176:179], v[16:19], v[232:235], v[176:179]
    ds_read_b64_tr_b16 v[228:229], v241 offset:12288
    ds_read_b64_tr_b16 v[230:231], v241 offset:12800
    v_mfma_f32_16x16x32_bf16 v[180:183], v[20:23], v[232:235], v[180:183]
    s_waitcnt lgkmcnt(4)
    v_exp_f32 v166, v166
    v_mfma_f32_16x16x32_bf16 v[184:187], v[16:19], v[236:239], v[184:187]
    ds_read_b64_tr_b16 v[232:233], v242 offset:12288
    ds_read_b64_tr_b16 v[234:235], v242 offset:12800
    v_mfma_f32_16x16x32_bf16 v[188:191], v[20:23], v[236:239], v[188:191]
    s_waitcnt lgkmcnt(4)
    v_exp_f32 v167, v167
    v_mfma_f32_16x16x32_bf16 v[144:147], v[224:227], v[24:27], v[144:147]
    ds_read_b64_tr_b16 v[236:237], v243 offset:12288
    ds_read_b64_tr_b16 v[238:239], v243 offset:12800
    v_mfma_f32_16x16x32_bf16 v[148:151], v[224:227], v[28:31], v[148:151]
    s_waitcnt lgkmcnt(4)
    s_mov_b64 exec, 0x7f
    buffer_load_dword v252, v251, s[16:19], s29 offen offset:2688
    s_mov_b64 exec, -1
    v_mfma_f32_16x16x32_bf16 v[152:155], v[228:231], v[24:27], v[152:155]
    ds_read_b64_tr_b16 v[224:225], v240 offset:16384
    ds_read_b64_tr_b16 v[226:227], v240 offset:16896
    v_mfma_f32_16x16x32_bf16 v[156:159], v[228:231], v[28:31], v[156:159]
    s_waitcnt lgkmcnt(4)
    v_add_f32 v164, 1.0, v164
    v_add_f32 v165, 1.0, v165
    v_add_f32 v166, 1.0, v166
    v_add_f32 v167, 1.0, v167
    v_mfma_f32_16x16x32_bf16 v[176:179], v[24:27], v[232:235], v[176:179]
    ds_read_b64_tr_b16 v[228:229], v241 offset:16384
    ds_read_b64_tr_b16 v[230:231], v241 offset:16896
    v_mfma_f32_16x16x32_bf16 v[180:183], v[28:31], v[232:235], v[180:183]
    s_waitcnt lgkmcnt(4)
    s_add_u32 m0, s27, 16384
    s_add_u32 s30, s25, 3539072
    buffer_load_dwordx4 v249, s[8:11], s30 offen lds
    s_setprio 2
    v_mfma_f32_16x16x32_bf16 v[184:187], v[24:27], v[236:239], v[184:187]
    ds_read_b64_tr_b16 v[232:233], v242 offset:16384
    ds_read_b64_tr_b16 v[234:235], v242 offset:16896
    v_mfma_f32_16x16x32_bf16 v[188:191], v[28:31], v[236:239], v[188:191]
    s_waitcnt lgkmcnt(4)
    v_rcp_f32 v164, v164
    v_rcp_f32 v165, v165
    v_mfma_f32_16x16x32_bf16 v[144:147], v[224:227], v[32:35], v[144:147]
    ds_read_b64_tr_b16 v[236:237], v243 offset:16384
    ds_read_b64_tr_b16 v[238:239], v243 offset:16896
    v_mfma_f32_16x16x32_bf16 v[148:151], v[224:227], v[36:39], v[148:151]
    s_waitcnt lgkmcnt(4)
    v_rcp_f32 v166, v166
    v_rcp_f32 v167, v167
    v_mfma_f32_16x16x32_bf16 v[152:155], v[228:231], v[32:35], v[152:155]
    ds_read_b64_tr_b16 v[224:225], v240 offset:20480
    ds_read_b64_tr_b16 v[226:227], v240 offset:20992
    v_mfma_f32_16x16x32_bf16 v[156:159], v[228:231], v[36:39], v[156:159]
    s_waitcnt lgkmcnt(4)
    v_mul_f32 v192, v192, v160
    v_mul_f32 v193, v193, v161
    v_mfma_f32_16x16x32_bf16 v[176:179], v[32:35], v[232:235], v[176:179]
    ds_read_b64_tr_b16 v[228:229], v241 offset:20480
    ds_read_b64_tr_b16 v[230:231], v241 offset:20992
    v_mfma_f32_16x16x32_bf16 v[180:183], v[36:39], v[232:235], v[180:183]
    s_waitcnt lgkmcnt(4)
    v_mul_f32 v194, v194, v162
    v_mul_f32 v195, v195, v163
    v_mfma_f32_16x16x32_bf16 v[184:187], v[32:35], v[236:239], v[184:187]
    ds_read_b64_tr_b16 v[232:233], v242 offset:20480
    ds_read_b64_tr_b16 v[234:235], v242 offset:20992
    v_mfma_f32_16x16x32_bf16 v[188:191], v[36:39], v[236:239], v[188:191]
    s_waitcnt lgkmcnt(4)
    v_mul_f32 v196, v196, v164
    v_mul_f32 v197, v197, v165
    v_mfma_f32_16x16x32_bf16 v[144:147], v[224:227], v[40:43], v[144:147]
    ds_read_b64_tr_b16 v[236:237], v243 offset:20480
    ds_read_b64_tr_b16 v[238:239], v243 offset:20992
    v_mfma_f32_16x16x32_bf16 v[148:151], v[224:227], v[44:47], v[148:151]
    s_waitcnt lgkmcnt(4)
    v_mul_f32 v198, v198, v166
    v_mul_f32 v199, v199, v167
    v_mfma_f32_16x16x32_bf16 v[152:155], v[228:231], v[40:43], v[152:155]
    ds_read_b64_tr_b16 v[224:225], v240 offset:24576
    ds_read_b64_tr_b16 v[226:227], v240 offset:25088
    v_mfma_f32_16x16x32_bf16 v[156:159], v[228:231], v[44:47], v[156:159]
    s_waitcnt lgkmcnt(4)
    s_add_u32 m0, s27, 24576
    s_add_u32 s30, s25, 4128896
    buffer_load_dwordx4 v249, s[8:11], s30 offen lds
    v_mfma_f32_16x16x32_bf16 v[176:179], v[40:43], v[232:235], v[176:179]
    ds_read_b64_tr_b16 v[228:229], v241 offset:24576
    ds_read_b64_tr_b16 v[230:231], v241 offset:25088
    v_mfma_f32_16x16x32_bf16 v[180:183], v[44:47], v[232:235], v[180:183]
    s_waitcnt lgkmcnt(4)
    v_cvt_pk_bf16_f32 v244, v192, v193
    v_cvt_pk_bf16_f32 v245, v194, v195
    v_cvt_pk_bf16_f32 v246, v196, v197
    v_cvt_pk_bf16_f32 v247, v198, v199
    v_mfma_f32_16x16x32_bf16 v[184:187], v[40:43], v[236:239], v[184:187]
    ds_read_b64_tr_b16 v[232:233], v242 offset:24576
    ds_read_b64_tr_b16 v[234:235], v242 offset:25088
    v_mfma_f32_16x16x32_bf16 v[188:191], v[44:47], v[236:239], v[188:191]
    s_waitcnt lgkmcnt(4)
    s_nop 1
    v_permlane16_swap_b32 v244, v246
    v_permlane16_swap_b32 v245, v247
    v_mfma_f32_16x16x32_bf16 v[144:147], v[224:227], v[48:51], v[144:147]
    ds_read_b64_tr_b16 v[236:237], v243 offset:24576
    ds_read_b64_tr_b16 v[238:239], v243 offset:25088
    v_mfma_f32_16x16x32_bf16 v[148:151], v[224:227], v[52:55], v[148:151]
    s_waitcnt lgkmcnt(4)
    buffer_store_dwordx4 v[244:247], v248, s[4:7], s32 offen offset:2048 sc1
    v_mfma_f32_16x16x32_bf16 v[152:155], v[228:231], v[48:51], v[152:155]
    ds_read_b64_tr_b16 v[224:225], v240 offset:28672
    ds_read_b64_tr_b16 v[226:227], v240 offset:29184
    v_mfma_f32_16x16x32_bf16 v[156:159], v[228:231], v[52:55], v[156:159]
    s_waitcnt lgkmcnt(4)
    v_mul_f32 v168, s50, v168
    v_mul_f32 v169, s50, v169
    v_mul_f32 v170, s50, v170
    v_mul_f32 v171, s50, v171
    v_mfma_f32_16x16x32_bf16 v[176:179], v[48:51], v[232:235], v[176:179]
    ds_read_b64_tr_b16 v[228:229], v241 offset:28672
    ds_read_b64_tr_b16 v[230:231], v241 offset:29184
    v_mfma_f32_16x16x32_bf16 v[180:183], v[52:55], v[232:235], v[180:183]
    s_waitcnt lgkmcnt(4)
    s_add_u32 s29, s29, 3584
    s_mov_b64 exec, 0x7f
    buffer_load_dword v252, v251, s[16:19], s29 offen offset:0
    s_mov_b64 exec, -1
    v_mfma_f32_16x16x32_bf16 v[184:187], v[48:51], v[236:239], v[184:187]
    ds_read_b64_tr_b16 v[232:233], v242 offset:28672
    ds_read_b64_tr_b16 v[234:235], v242 offset:29184
    v_mfma_f32_16x16x32_bf16 v[188:191], v[52:55], v[236:239], v[188:191]
    s_waitcnt lgkmcnt(4)
    v_exp_f32 v168, v168
    v_exp_f32 v169, v169
    v_mfma_f32_16x16x32_bf16 v[144:147], v[224:227], v[56:59], v[144:147]
    ds_read_b64_tr_b16 v[236:237], v243 offset:28672
    ds_read_b64_tr_b16 v[238:239], v243 offset:29184
    v_mfma_f32_16x16x32_bf16 v[148:151], v[224:227], v[60:63], v[148:151]
    s_waitcnt lgkmcnt(4)
    s_add_u32 m0, s27, 32768
    s_add_u32 s30, s25, 4718720
    buffer_load_dwordx4 v249, s[8:11], s30 offen lds
    v_mfma_f32_16x16x32_bf16 v[152:155], v[228:231], v[56:59], v[152:155]
    ds_read_b64_tr_b16 v[224:225], v240 offset:32768
    ds_read_b64_tr_b16 v[226:227], v240 offset:33280
    v_mfma_f32_16x16x32_bf16 v[156:159], v[228:231], v[60:63], v[156:159]
    s_waitcnt lgkmcnt(4)
    v_exp_f32 v170, v170
    v_exp_f32 v171, v171
    v_mfma_f32_16x16x32_bf16 v[176:179], v[56:59], v[232:235], v[176:179]
    ds_read_b64_tr_b16 v[228:229], v241 offset:32768
    ds_read_b64_tr_b16 v[230:231], v241 offset:33280
    v_mfma_f32_16x16x32_bf16 v[180:183], v[60:63], v[232:235], v[180:183]
    s_waitcnt lgkmcnt(4)
    v_add_f32 v168, 1.0, v168
    v_add_f32 v169, 1.0, v169
    v_add_f32 v170, 1.0, v170
    v_add_f32 v171, 1.0, v171
    v_mfma_f32_16x16x32_bf16 v[184:187], v[56:59], v[236:239], v[184:187]
    ds_read_b64_tr_b16 v[232:233], v242 offset:32768
    ds_read_b64_tr_b16 v[234:235], v242 offset:33280
    v_mfma_f32_16x16x32_bf16 v[188:191], v[60:63], v[236:239], v[188:191]
    s_waitcnt lgkmcnt(4)
    v_rcp_f32 v168, v168
    v_mfma_f32_16x16x32_bf16 v[144:147], v[224:227], v[64:67], v[144:147]
    ds_read_b64_tr_b16 v[236:237], v243 offset:32768
    ds_read_b64_tr_b16 v[238:239], v243 offset:33280
    v_mfma_f32_16x16x32_bf16 v[148:151], v[224:227], v[68:71], v[148:151]
    s_waitcnt lgkmcnt(4)
    v_rcp_f32 v169, v169
    s_setprio 1
    v_mfma_f32_16x16x32_bf16 v[152:155], v[228:231], v[64:67], v[152:155]
    ds_read_b64_tr_b16 v[224:225], v240 offset:36864
    ds_read_b64_tr_b16 v[226:227], v240 offset:37376
    v_mfma_f32_16x16x32_bf16 v[156:159], v[228:231], v[68:71], v[156:159]
    s_waitcnt lgkmcnt(4)
    v_rcp_f32 v170, v170
    v_mfma_f32_16x16x32_bf16 v[176:179], v[64:67], v[232:235], v[176:179]
    ds_read_b64_tr_b16 v[228:229], v241 offset:36864
    ds_read_b64_tr_b16 v[230:231], v241 offset:37376
    v_mfma_f32_16x16x32_bf16 v[180:183], v[68:71], v[232:235], v[180:183]
    s_waitcnt lgkmcnt(4)
    v_rcp_f32 v171, v171
    v_mfma_f32_16x16x32_bf16 v[184:187], v[64:67], v[236:239], v[184:187]
    ds_read_b64_tr_b16 v[232:233], v242 offset:36864
    ds_read_b64_tr_b16 v[234:235], v242 offset:37376
    v_mfma_f32_16x16x32_bf16 v[188:191], v[68:71], v[236:239], v[188:191]
    s_waitcnt lgkmcnt(4)
    v_mul_f32 v172, s50, v172
    v_mul_f32 v173, s50, v173
    v_mfma_f32_16x16x32_bf16 v[144:147], v[224:227], v[72:75], v[144:147]
    ds_read_b64_tr_b16 v[236:237], v243 offset:36864
    ds_read_b64_tr_b16 v[238:239], v243 offset:37376
    v_mfma_f32_16x16x32_bf16 v[148:151], v[224:227], v[76:79], v[148:151]
    s_waitcnt lgkmcnt(4)
    v_mul_f32 v174, s50, v174
    v_mul_f32 v175, s50, v175
    v_mfma_f32_16x16x32_bf16 v[152:155], v[228:231], v[72:75], v[152:155]
    v_mfma_f32_16x16x32_bf16 v[156:159], v[228:231], v[76:79], v[156:159]
    v_add_u32 v240, 40960, v250
    v_xor_b32 v241, 32, v240
    v_xor_b32 v242, 64, v240
    v_xor_b32 v243, 96, v240
    ds_read_b64_tr_b16 v[224:225], v240 offset:0
    ds_read_b64_tr_b16 v[226:227], v240 offset:512
    s_waitcnt lgkmcnt(4)
    v_exp_f32 v172, v172
    v_mfma_f32_16x16x32_bf16 v[176:179], v[72:75], v[232:235], v[176:179]
    ds_read_b64_tr_b16 v[228:229], v241 offset:0
    ds_read_b64_tr_b16 v[230:231], v241 offset:512
    v_mfma_f32_16x16x32_bf16 v[180:183], v[76:79], v[232:235], v[180:183]
    s_waitcnt lgkmcnt(4)
    v_exp_f32 v173, v173
    v_mfma_f32_16x16x32_bf16 v[184:187], v[72:75], v[236:239], v[184:187]
    ds_read_b64_tr_b16 v[232:233], v242 offset:0
    ds_read_b64_tr_b16 v[234:235], v242 offset:512
    v_mfma_f32_16x16x32_bf16 v[188:191], v[76:79], v[236:239], v[188:191]
    s_waitcnt lgkmcnt(4)
    v_exp_f32 v174, v174
    v_mfma_f32_16x16x32_bf16 v[144:147], v[224:227], v[80:83], v[144:147]
    ds_read_b64_tr_b16 v[236:237], v243 offset:0
    ds_read_b64_tr_b16 v[238:239], v243 offset:512
    v_mfma_f32_16x16x32_bf16 v[148:151], v[224:227], v[84:87], v[148:151]
    s_waitcnt lgkmcnt(4)
    s_mov_b64 exec, 0x7f
    buffer_load_dword v252, v251, s[16:19], s29 offen offset:896
    s_mov_b64 exec, -1
    v_mfma_f32_16x16x32_bf16 v[152:155], v[228:231], v[80:83], v[152:155]
    ds_read_b64_tr_b16 v[224:225], v240 offset:4096
    ds_read_b64_tr_b16 v[226:227], v240 offset:4608
    v_mfma_f32_16x16x32_bf16 v[156:159], v[228:231], v[84:87], v[156:159]
    s_waitcnt lgkmcnt(4)
    v_exp_f32 v175, v175
    v_add_f32 v172, 1.0, v172
    v_add_f32 v173, 1.0, v173
    v_mfma_f32_16x16x32_bf16 v[176:179], v[80:83], v[232:235], v[176:179]
    ds_read_b64_tr_b16 v[228:229], v241 offset:4096
    ds_read_b64_tr_b16 v[230:231], v241 offset:4608
    v_mfma_f32_16x16x32_bf16 v[180:183], v[84:87], v[232:235], v[180:183]
    s_waitcnt lgkmcnt(4)
    v_add_f32 v174, 1.0, v174
    v_add_f32 v175, 1.0, v175
    v_rcp_f32 v172, v172
    v_mfma_f32_16x16x32_bf16 v[184:187], v[80:83], v[236:239], v[184:187]
    ds_read_b64_tr_b16 v[232:233], v242 offset:4096
    ds_read_b64_tr_b16 v[234:235], v242 offset:4608
    v_mfma_f32_16x16x32_bf16 v[188:191], v[84:87], v[236:239], v[188:191]
    s_waitcnt lgkmcnt(4)
    v_rcp_f32 v173, v173
    v_mfma_f32_16x16x32_bf16 v[144:147], v[224:227], v[88:91], v[144:147]
    ds_read_b64_tr_b16 v[236:237], v243 offset:4096
    ds_read_b64_tr_b16 v[238:239], v243 offset:4608
    v_mfma_f32_16x16x32_bf16 v[148:151], v[224:227], v[92:95], v[148:151]
    s_waitcnt lgkmcnt(4)
    v_rcp_f32 v174, v174
    v_mfma_f32_16x16x32_bf16 v[152:155], v[228:231], v[88:91], v[152:155]
    ds_read_b64_tr_b16 v[224:225], v240 offset:8192
    ds_read_b64_tr_b16 v[226:227], v240 offset:8704
    v_mfma_f32_16x16x32_bf16 v[156:159], v[228:231], v[92:95], v[156:159]
    s_waitcnt lgkmcnt(4)
    v_rcp_f32 v175, v175
    v_mfma_f32_16x16x32_bf16 v[176:179], v[88:91], v[232:235], v[176:179]
    ds_read_b64_tr_b16 v[228:229], v241 offset:8192
    ds_read_b64_tr_b16 v[230:231], v241 offset:8704
    v_mfma_f32_16x16x32_bf16 v[180:183], v[92:95], v[232:235], v[180:183]
    s_waitcnt lgkmcnt(4)
    v_mul_f32 v200, v200, v168
    v_mul_f32 v201, v201, v169
    v_mfma_f32_16x16x32_bf16 v[184:187], v[88:91], v[236:239], v[184:187]
    ds_read_b64_tr_b16 v[232:233], v242 offset:8192
    ds_read_b64_tr_b16 v[234:235], v242 offset:8704
    v_mfma_f32_16x16x32_bf16 v[188:191], v[92:95], v[236:239], v[188:191]
    s_waitcnt lgkmcnt(4)
    v_mul_f32 v202, v202, v170
    v_mul_f32 v203, v203, v171
    v_mfma_f32_16x16x32_bf16 v[144:147], v[224:227], v[96:99], v[144:147]
    ds_read_b64_tr_b16 v[236:237], v243 offset:8192
    ds_read_b64_tr_b16 v[238:239], v243 offset:8704
    v_mfma_f32_16x16x32_bf16 v[148:151], v[224:227], v[100:103], v[148:151]
    s_waitcnt lgkmcnt(4)
    v_mul_f32 v204, v204, v172
    v_mul_f32 v205, v205, v173
    v_mfma_f32_16x16x32_bf16 v[152:155], v[228:231], v[96:99], v[152:155]
    ds_read_b64_tr_b16 v[224:225], v240 offset:12288
    ds_read_b64_tr_b16 v[226:227], v240 offset:12800
    v_mfma_f32_16x16x32_bf16 v[156:159], v[228:231], v[100:103], v[156:159]
    s_waitcnt lgkmcnt(4)
    v_mul_f32 v206, v206, v174
    v_mul_f32 v207, v207, v175
    v_mfma_f32_16x16x32_bf16 v[176:179], v[96:99], v[232:235], v[176:179]
    ds_read_b64_tr_b16 v[228:229], v241 offset:12288
    ds_read_b64_tr_b16 v[230:231], v241 offset:12800
    v_mfma_f32_16x16x32_bf16 v[180:183], v[100:103], v[232:235], v[180:183]
    s_waitcnt lgkmcnt(4)
    v_cvt_pk_bf16_f32 v244, v200, v201
    v_cvt_pk_bf16_f32 v245, v202, v203
    s_setprio 0
    v_mfma_f32_16x16x32_bf16 v[184:187], v[96:99], v[236:239], v[184:187]
    ds_read_b64_tr_b16 v[232:233], v242 offset:12288
    ds_read_b64_tr_b16 v[234:235], v242 offset:12800
    v_mfma_f32_16x16x32_bf16 v[188:191], v[100:103], v[236:239], v[188:191]
    s_waitcnt lgkmcnt(4)
    v_cvt_pk_bf16_f32 v246, v204, v205
    v_cvt_pk_bf16_f32 v247, v206, v207
    v_mfma_f32_16x16x32_bf16 v[144:147], v[224:227], v[104:107], v[144:147]
    ds_read_b64_tr_b16 v[236:237], v243 offset:12288
    ds_read_b64_tr_b16 v[238:239], v243 offset:12800
    v_mfma_f32_16x16x32_bf16 v[148:151], v[224:227], v[108:111], v[148:151]
    s_waitcnt lgkmcnt(4)
    s_nop 1
    v_permlane16_swap_b32 v244, v246
    v_permlane16_swap_b32 v245, v247
    v_mfma_f32_16x16x32_bf16 v[152:155], v[228:231], v[104:107], v[152:155]
    ds_read_b64_tr_b16 v[224:225], v240 offset:16384
    ds_read_b64_tr_b16 v[226:227], v240 offset:16896
    v_mfma_f32_16x16x32_bf16 v[156:159], v[228:231], v[108:111], v[156:159]
    s_waitcnt lgkmcnt(4)
    buffer_store_dwordx4 v[244:247], v248, s[4:7], s32 offen offset:3072 sc1
    v_mfma_f32_16x16x32_bf16 v[176:179], v[104:107], v[232:235], v[176:179]
    ds_read_b64_tr_b16 v[228:229], v241 offset:16384
    ds_read_b64_tr_b16 v[230:231], v241 offset:16896
    v_mfma_f32_16x16x32_bf16 v[180:183], v[108:111], v[232:235], v[180:183]
    s_waitcnt lgkmcnt(4)
    v_mul_f32 v208, s50, v208
    v_mul_f32 v209, s50, v209
    v_mul_f32 v210, s50, v210
    v_mul_f32 v211, s50, v211
    v_mfma_f32_16x16x32_bf16 v[184:187], v[104:107], v[236:239], v[184:187]
    ds_read_b64_tr_b16 v[232:233], v242 offset:16384
    ds_read_b64_tr_b16 v[234:235], v242 offset:16896
    v_mfma_f32_16x16x32_bf16 v[188:191], v[108:111], v[236:239], v[188:191]
    s_waitcnt lgkmcnt(4)
    v_exp_f32 v208, v208
    v_exp_f32 v209, v209
    v_mfma_f32_16x16x32_bf16 v[144:147], v[224:227], v[112:115], v[144:147]
    ds_read_b64_tr_b16 v[236:237], v243 offset:16384
    ds_read_b64_tr_b16 v[238:239], v243 offset:16896
    v_mfma_f32_16x16x32_bf16 v[148:151], v[224:227], v[116:119], v[148:151]
    s_waitcnt lgkmcnt(4)
    v_exp_f32 v210, v210
    v_mfma_f32_16x16x32_bf16 v[152:155], v[228:231], v[112:115], v[152:155]
    ds_read_b64_tr_b16 v[224:225], v240 offset:20480
    ds_read_b64_tr_b16 v[226:227], v240 offset:20992
    v_mfma_f32_16x16x32_bf16 v[156:159], v[228:231], v[116:119], v[156:159]
    s_waitcnt lgkmcnt(4)
    v_exp_f32 v211, v211
    v_mfma_f32_16x16x32_bf16 v[176:179], v[112:115], v[232:235], v[176:179]
    ds_read_b64_tr_b16 v[228:229], v241 offset:20480
    ds_read_b64_tr_b16 v[230:231], v241 offset:20992
    v_mfma_f32_16x16x32_bf16 v[180:183], v[116:119], v[232:235], v[180:183]
    s_waitcnt lgkmcnt(4)
    v_add_f32 v208, 1.0, v208
    v_add_f32 v209, 1.0, v209
    v_mfma_f32_16x16x32_bf16 v[184:187], v[112:115], v[236:239], v[184:187]
    ds_read_b64_tr_b16 v[232:233], v242 offset:20480
    ds_read_b64_tr_b16 v[234:235], v242 offset:20992
    v_mfma_f32_16x16x32_bf16 v[188:191], v[116:119], v[236:239], v[188:191]
    s_waitcnt lgkmcnt(4)
    v_add_f32 v210, 1.0, v210
    v_add_f32 v211, 1.0, v211
    v_mfma_f32_16x16x32_bf16 v[144:147], v[224:227], v[120:123], v[144:147]
    ds_read_b64_tr_b16 v[236:237], v243 offset:20480
    ds_read_b64_tr_b16 v[238:239], v243 offset:20992
    v_mfma_f32_16x16x32_bf16 v[148:151], v[224:227], v[124:127], v[148:151]
    s_waitcnt lgkmcnt(4)
    v_rcp_f32 v208, v208
    v_mfma_f32_16x16x32_bf16 v[152:155], v[228:231], v[120:123], v[152:155]
    ds_read_b64_tr_b16 v[224:225], v240 offset:24576
    ds_read_b64_tr_b16 v[226:227], v240 offset:25088
    v_mfma_f32_16x16x32_bf16 v[156:159], v[228:231], v[124:127], v[156:159]
    s_waitcnt lgkmcnt(4)
    v_rcp_f32 v209, v209
    v_mfma_f32_16x16x32_bf16 v[176:179], v[120:123], v[232:235], v[176:179]
    ds_read_b64_tr_b16 v[228:229], v241 offset:24576
    ds_read_b64_tr_b16 v[230:231], v241 offset:25088
    v_mfma_f32_16x16x32_bf16 v[180:183], v[124:127], v[232:235], v[180:183]
    s_waitcnt lgkmcnt(4)
    v_rcp_f32 v210, v210
    v_mfma_f32_16x16x32_bf16 v[184:187], v[120:123], v[236:239], v[184:187]
    ds_read_b64_tr_b16 v[232:233], v242 offset:24576
    ds_read_b64_tr_b16 v[234:235], v242 offset:25088
    v_mfma_f32_16x16x32_bf16 v[188:191], v[124:127], v[236:239], v[188:191]
    s_waitcnt lgkmcnt(4)
    v_rcp_f32 v211, v211
    v_mfma_f32_16x16x32_bf16 v[144:147], v[224:227], v[128:131], v[144:147]
    ds_read_b64_tr_b16 v[236:237], v243 offset:24576
    ds_read_b64_tr_b16 v[238:239], v243 offset:25088
    v_mfma_f32_16x16x32_bf16 v[148:151], v[224:227], v[132:135], v[148:151]
    s_waitcnt lgkmcnt(4)
    v_mul_f32 v212, s50, v212
    v_mul_f32 v213, s50, v213
    v_mfma_f32_16x16x32_bf16 v[152:155], v[228:231], v[128:131], v[152:155]
    ds_read_b64_tr_b16 v[224:225], v240 offset:28672
    ds_read_b64_tr_b16 v[226:227], v240 offset:29184
    v_mfma_f32_16x16x32_bf16 v[156:159], v[228:231], v[132:135], v[156:159]
    s_waitcnt lgkmcnt(4)
    v_mul_f32 v214, s50, v214
    v_mul_f32 v215, s50, v215
    v_exp_f32 v212, v212
    v_mfma_f32_16x16x32_bf16 v[176:179], v[128:131], v[232:235], v[176:179]
    ds_read_b64_tr_b16 v[228:229], v241 offset:28672
    ds_read_b64_tr_b16 v[230:231], v241 offset:29184
    v_mfma_f32_16x16x32_bf16 v[180:183], v[132:135], v[232:235], v[180:183]
    s_waitcnt lgkmcnt(4)
    v_exp_f32 v213, v213
    v_mfma_f32_16x16x32_bf16 v[184:187], v[128:131], v[236:239], v[184:187]
    ds_read_b64_tr_b16 v[232:233], v242 offset:28672
    ds_read_b64_tr_b16 v[234:235], v242 offset:29184
    v_mfma_f32_16x16x32_bf16 v[188:191], v[132:135], v[236:239], v[188:191]
    s_waitcnt lgkmcnt(4)
    v_exp_f32 v214, v214
    v_mfma_f32_16x16x32_bf16 v[144:147], v[224:227], v[136:139], v[144:147]
    ds_read_b64_tr_b16 v[236:237], v243 offset:28672
    ds_read_b64_tr_b16 v[238:239], v243 offset:29184
    v_mfma_f32_16x16x32_bf16 v[148:151], v[224:227], v[140:143], v[148:151]
    s_waitcnt lgkmcnt(4)
    v_exp_f32 v215, v215
    v_mfma_f32_16x16x32_bf16 v[152:155], v[228:231], v[136:139], v[152:155]
    v_mfma_f32_16x16x32_bf16 v[156:159], v[228:231], v[140:143], v[156:159]
    s_waitcnt vmcnt(1) lgkmcnt(0)
    s_barrier
    v_add_u32 v240, 114688, v250
    v_xor_b32 v241, 32, v240
    v_xor_b32 v242, 64, v240
    v_xor_b32 v243, 96, v240
    ds_read_b64_tr_b16 v[224:225], v240 offset:0
    ds_read_b64_tr_b16 v[226:227], v240 offset:512
    v_add_f32 v212, 1.0, v212
    v_add_f32 v213, 1.0, v213
    s_setprio 3
    v_mfma_f32_16x16x32_bf16 v[176:179], v[136:139], v[232:235], v[176:179]
    ds_read_b64_tr_b16 v[228:229], v241 offset:0
    ds_read_b64_tr_b16 v[230:231], v241 offset:512
    v_mfma_f32_16x16x32_bf16 v[180:183], v[140:143], v[232:235], v[180:183]
    s_add_u32 m0, s27, 40960
    s_add_u32 s30, s25, 128
    buffer_load_dwordx4 v249, s[12:15], s30 offen lds
    v_mfma_f32_16x16x32_bf16 v[184:187], v[136:139], v[236:239], v[184:187]
    ds_read_b64_tr_b16 v[232:233], v242 offset:0
    ds_read_b64_tr_b16 v[234:235], v242 offset:512
    v_mfma_f32_16x16x32_bf16 v[188:191], v[140:143], v[236:239], v[188:191]
    s_waitcnt lgkmcnt(4)
    v_add_f32 v214, 1.0, v214
    v_add_f32 v215, 1.0, v215
    v_rcp_f32 v212, v212
    v_mfma_f32_16x16x32_bf16 v[160:163], v[224:227], v[0:3], 0
    ds_read_b64_tr_b16 v[236:237], v243 offset:0
    ds_read_b64_tr_b16 v[238:239], v243 offset:512
    v_mfma_f32_16x16x32_bf16 v[164:167], v[224:227], v[4:7], 0
    s_waitcnt lgkmcnt(4)
    v_rcp_f32 v213, v213
    v_mfma_f32_16x16x32_bf16 v[168:171], v[228:231], v[0:3], 0
    ds_read_b64_tr_b16 v[224:225], v240 offset:4096
    ds_read_b64_tr_b16 v[226:227], v240 offset:4608
    v_mfma_f32_16x16x32_bf16 v[172:175], v[228:231], v[4:7], 0
    s_waitcnt lgkmcnt(4)
    v_rcp_f32 v214, v214
    v_mfma_f32_16x16x32_bf16 v[192:195], v[232:235], v[0:3], 0
    ds_read_b64_tr_b16 v[228:229], v241 offset:4096
    ds_read_b64_tr_b16 v[230:231], v241 offset:4608
    v_mfma_f32_16x16x32_bf16 v[196:199], v[232:235], v[4:7], 0
    s_waitcnt lgkmcnt(4)
    v_rcp_f32 v215, v215
    v_mfma_f32_16x16x32_bf16 v[200:203], v[236:239], v[0:3], 0
    ds_read_b64_tr_b16 v[232:233], v242 offset:4096
    ds_read_b64_tr_b16 v[234:235], v242 offset:4608
    v_mfma_f32_16x16x32_bf16 v[204:207], v[236:239], v[4:7], 0
    s_waitcnt lgkmcnt(4)
    v_mul_f32 v216, v216, v208
    v_mul_f32 v217, v217, v209
    v_mfma_f32_16x16x32_bf16 v[160:163], v[224:227], v[8:11], v[160:163]
    ds_read_b64_tr_b16 v[236:237], v243 offset:4096
    ds_read_b64_tr_b16 v[238:239], v243 offset:4608
    v_mfma_f32_16x16x32_bf16 v[164:167], v[224:227], v[12:15], v[164:167]
    s_waitcnt lgkmcnt(4)
    s_add_u32 m0, s27, 49152
    s_add_u32 s30, s25, 589952
    buffer_load_dwordx4 v249, s[12:15], s30 offen lds
    v_mfma_f32_16x16x32_bf16 v[168:171], v[228:231], v[8:11], v[168:171]
    ds_read_b64_tr_b16 v[224:225], v240 offset:8192
    ds_read_b64_tr_b16 v[226:227], v240 offset:8704
    v_mfma_f32_16x16x32_bf16 v[172:175], v[228:231], v[12:15], v[172:175]
    s_waitcnt lgkmcnt(4)
    v_mul_f32 v218, v218, v210
    v_mul_f32 v219, v219, v211
    v_mul_f32 v220, v220, v212
    v_mul_f32 v221, v221, v213
    v_mfma_f32_16x16x32_bf16 v[192:195], v[232:235], v[8:11], v[192:195]
    ds_read_b64_tr_b16 v[228:229], v241 offset:8192
    ds_read_b64_tr_b16 v[230:231], v241 offset:8704
    v_mfma_f32_16x16x32_bf16 v[196:199], v[232:235], v[12:15], v[196:199]
    s_waitcnt lgkmcnt(4)
    v_mul_f32 v222, v222, v214
    v_mul_f32 v223, v223, v215
    v_mfma_f32_16x16x32_bf16 v[200:203], v[236:239], v[8:11], v[200:203]
    ds_read_b64_tr_b16 v[232:233], v242 offset:8192
    ds_read_b64_tr_b16 v[234:235], v242 offset:8704
    v_mfma_f32_16x16x32_bf16 v[204:207], v[236:239], v[12:15], v[204:207]
    s_waitcnt lgkmcnt(4)
    v_cvt_pk_bf16_f32 v244, v216, v217
    v_cvt_pk_bf16_f32 v245, v218, v219
    v_mfma_f32_16x16x32_bf16 v[160:163], v[224:227], v[16:19], v[160:163]
    ds_read_b64_tr_b16 v[236:237], v243 offset:8192
    ds_read_b64_tr_b16 v[238:239], v243 offset:8704
    v_mfma_f32_16x16x32_bf16 v[164:167], v[224:227], v[20:23], v[164:167]
    s_waitcnt lgkmcnt(4)
    v_cvt_pk_bf16_f32 v246, v220, v221
    v_cvt_pk_bf16_f32 v247, v222, v223
    v_mfma_f32_16x16x32_bf16 v[168:171], v[228:231], v[16:19], v[168:171]
    ds_read_b64_tr_b16 v[224:225], v240 offset:12288
    ds_read_b64_tr_b16 v[226:227], v240 offset:12800
    v_mfma_f32_16x16x32_bf16 v[172:175], v[228:231], v[20:23], v[172:175]
    s_waitcnt lgkmcnt(4)
    s_nop 1
    v_permlane16_swap_b32 v244, v246
    v_permlane16_swap_b32 v245, v247
    v_mfma_f32_16x16x32_bf16 v[192:195], v[232:235], v[16:19], v[192:195]
    ds_read_b64_tr_b16 v[228:229], v241 offset:12288
    ds_read_b64_tr_b16 v[230:231], v241 offset:12800
    v_mfma_f32_16x16x32_bf16 v[196:199], v[232:235], v[20:23], v[196:199]
    s_waitcnt lgkmcnt(4)
    buffer_store_dwordx4 v[244:247], v248, s[4:7], s33 offen offset:0 sc1
    v_mfma_f32_16x16x32_bf16 v[200:203], v[236:239], v[16:19], v[200:203]
    ds_read_b64_tr_b16 v[232:233], v242 offset:12288
    ds_read_b64_tr_b16 v[234:235], v242 offset:12800
    v_mfma_f32_16x16x32_bf16 v[204:207], v[236:239], v[20:23], v[204:207]
    s_waitcnt lgkmcnt(4)
    s_add_u32 m0, s27, 57344
    s_add_u32 s30, s25, 1179776
    buffer_load_dwordx4 v249, s[12:15], s30 offen lds
    v_mfma_f32_16x16x32_bf16 v[160:163], v[224:227], v[24:27], v[160:163]
    ds_read_b64_tr_b16 v[236:237], v243 offset:12288
    ds_read_b64_tr_b16 v[238:239], v243 offset:12800
    v_mfma_f32_16x16x32_bf16 v[164:167], v[224:227], v[28:31], v[164:167]
    s_waitcnt lgkmcnt(4)
    v_and_b32 v252, 624, v248
    v_and_b32 v244, 0x80, v248
    v_lshl_add_u32 v252, v244, 1, v252
    v_and_b32 v244, 0x100, v248
    v_mfma_f32_16x16x32_bf16 v[168:171], v[228:231], v[24:27], v[168:171]
    ds_read_b64_tr_b16 v[224:225], v240 offset:16384
    ds_read_b64_tr_b16 v[226:227], v240 offset:16896
    v_mfma_f32_16x16x32_bf16 v[172:175], v[228:231], v[28:31], v[172:175]
    s_waitcnt lgkmcnt(4)
    v_lshrrev_b32 v244, 1, v244
    v_add_u32 v252, v252, v244
    v_mfma_f32_16x16x32_bf16 v[192:195], v[232:235], v[24:27], v[192:195]
    ds_read_b64_tr_b16 v[228:229], v241 offset:16384
    ds_read_b64_tr_b16 v[230:231], v241 offset:16896
    v_mfma_f32_16x16x32_bf16 v[196:199], v[232:235], v[28:31], v[196:199]
    s_waitcnt lgkmcnt(4)
    v_and_b32 v253, 0xf0, v248
    v_and_b32 v244, 0x300, v248
    s_setprio 2
    v_mfma_f32_16x16x32_bf16 v[200:203], v[236:239], v[24:27], v[200:203]
    ds_read_b64_tr_b16 v[232:233], v242 offset:16384
    ds_read_b64_tr_b16 v[234:235], v242 offset:16896
    v_mfma_f32_16x16x32_bf16 v[204:207], v[236:239], v[28:31], v[204:207]
    s_waitcnt lgkmcnt(4)
    v_lshl_add_u32 v253, v244, 1, v253
    v_cvt_pk_bf16_f32 v212, v152, v153
    v_mfma_f32_16x16x32_bf16 v[160:163], v[224:227], v[32:35], v[160:163]
    ds_read_b64_tr_b16 v[236:237], v243 offset:16384
    ds_read_b64_tr_b16 v[238:239], v243 offset:16896
    v_mfma_f32_16x16x32_bf16 v[164:167], v[224:227], v[36:39], v[164:167]
    s_waitcnt lgkmcnt(4)
    v_cvt_pk_bf16_f32 v213, v154, v155
    v_cvt_pk_bf16_f32 v214, v156, v157
    v_mfma_f32_16x16x32_bf16 v[168:171], v[228:231], v[32:35], v[168:171]
    ds_read_b64_tr_b16 v[224:225], v240 offset:20480
    ds_read_b64_tr_b16 v[226:227], v240 offset:20992
    v_mfma_f32_16x16x32_bf16 v[172:175], v[228:231], v[36:39], v[172:175]
    s_waitcnt lgkmcnt(4)
    s_add_u32 m0, s27, 65536
    s_add_u32 s30, s25, 1769600
    buffer_load_dwordx4 v249, s[12:15], s30 offen lds
    v_mfma_f32_16x16x32_bf16 v[192:195], v[232:235], v[32:35], v[192:195]
    ds_read_b64_tr_b16 v[228:229], v241 offset:20480
    ds_read_b64_tr_b16 v[230:231], v241 offset:20992
    v_mfma_f32_16x16x32_bf16 v[196:199], v[232:235], v[36:39], v[196:199]
    s_waitcnt lgkmcnt(4)
    v_cvt_pk_bf16_f32 v215, v158, v159
    v_cvt_pk_bf16_f32 v216, v176, v177
    v_cvt_pk_bf16_f32 v217, v178, v179
    v_cvt_pk_bf16_f32 v218, v180, v181
    v_mfma_f32_16x16x32_bf16 v[200:203], v[236:239], v[32:35], v[200:203]
    ds_read_b64_tr_b16 v[232:233], v242 offset:20480
    ds_read_b64_tr_b16 v[234:235], v242 offset:20992
    v_mfma_f32_16x16x32_bf16 v[204:207], v[236:239], v[36:39], v[204:207]
    s_waitcnt lgkmcnt(4)
    v_cvt_pk_bf16_f32 v219, v182, v183
    v_mfma_f32_16x16x32_bf16 v[160:163], v[224:227], v[40:43], v[160:163]
    ds_read_b64_tr_b16 v[236:237], v243 offset:20480
    ds_read_b64_tr_b16 v[238:239], v243 offset:20992
    v_mfma_f32_16x16x32_bf16 v[164:167], v[224:227], v[44:47], v[164:167]
    s_waitcnt lgkmcnt(4)
    buffer_store_dwordx4 v[216:219], v253, s[4:7], s35 offen offset:1024 sc1
    v_mfma_f32_16x16x32_bf16 v[168:171], v[228:231], v[40:43], v[168:171]
    ds_read_b64_tr_b16 v[224:225], v240 offset:24576
    ds_read_b64_tr_b16 v[226:227], v240 offset:25088
    v_mfma_f32_16x16x32_bf16 v[172:175], v[228:231], v[44:47], v[172:175]
    s_waitcnt lgkmcnt(4)
    v_lshrrev_b32 v244, 3, v244
    v_add_u32 v244, v244, v248
    v_and_b32 v244, 0x70, v244
    v_and_b32 v245, 0xf8f, v253
    v_mfma_f32_16x16x32_bf16 v[192:195], v[232:235], v[40:43], v[192:195]
    ds_read_b64_tr_b16 v[228:229], v241 offset:24576
    ds_read_b64_tr_b16 v[230:231], v241 offset:25088
    v_mfma_f32_16x16x32_bf16 v[196:199], v[232:235], v[44:47], v[196:199]
    s_waitcnt lgkmcnt(4)
    v_or_b32 v245, v245, v244
    v_and_b32 v246, 0x80, v248
    v_mfma_f32_16x16x32_bf16 v[200:203], v[236:239], v[40:43], v[200:203]
    ds_read_b64_tr_b16 v[232:233], v242 offset:24576
    ds_read_b64_tr_b16 v[234:235], v242 offset:25088
    v_mfma_f32_16x16x32_bf16 v[204:207], v[236:239], v[44:47], v[204:207]
    s_waitcnt lgkmcnt(4)
    s_add_u32 m0, s27, 73728
    s_add_u32 s30, s25, 2359424
    buffer_load_dwordx4 v249, s[12:15], s30 offen lds
    v_mfma_f32_16x16x32_bf16 v[160:163], v[224:227], v[48:51], v[160:163]
    ds_read_b64_tr_b16 v[236:237], v243 offset:24576
    ds_read_b64_tr_b16 v[238:239], v243 offset:25088
    v_mfma_f32_16x16x32_bf16 v[164:167], v[224:227], v[52:55], v[164:167]
    s_waitcnt lgkmcnt(4)
    v_cmp_eq_u32 vcc, 0, v246
    v_and_b32 v246, 0xf0, v248
    v_mov_b32 v255, 0
    v_cndmask_b32 v251, v245, v253, vcc
    v_mfma_f32_16x16x32_bf16 v[168:171], v[228:231], v[48:51], v[168:171]
    ds_read_b64_tr_b16 v[224:225], v240 offset:28672
    ds_read_b64_tr_b16 v[226:227], v240 offset:29184
    v_mfma_f32_16x16x32_bf16 v[172:175], v[228:231], v[52:55], v[172:175]
    s_waitcnt lgkmcnt(4)
    v_and_b32 v245, 0xb0, v246
    v_cmp_eq_u32 vcc, 0x20, v245
    v_mfma_f32_16x16x32_bf16 v[192:195], v[232:235], v[48:51], v[192:195]
    ds_read_b64_tr_b16 v[228:229], v241 offset:28672
    ds_read_b64_tr_b16 v[230:231], v241 offset:29184
    v_mfma_f32_16x16x32_bf16 v[196:199], v[232:235], v[52:55], v[196:199]
    s_waitcnt lgkmcnt(4)
    v_and_b32 v245, 0x60, v246
    v_mov_b32 v254, 0
    v_mfma_f32_16x16x32_bf16 v[200:203], v[236:239], v[48:51], v[200:203]
    ds_read_b64_tr_b16 v[232:233], v242 offset:28672
    ds_read_b64_tr_b16 v[234:235], v242 offset:29184
    v_mfma_f32_16x16x32_bf16 v[204:207], v[236:239], v[52:55], v[204:207]
    s_waitcnt lgkmcnt(4)
    v_cndmask_b32 v255, v255, 1.0, vcc
    v_cmp_eq_u32 vcc, 0, v245
    v_mfma_f32_16x16x32_bf16 v[160:163], v[224:227], v[56:59], v[160:163]
    ds_read_b64_tr_b16 v[236:237], v243 offset:28672
    ds_read_b64_tr_b16 v[238:239], v243 offset:29184
    v_mfma_f32_16x16x32_bf16 v[164:167], v[224:227], v[60:63], v[164:167]
    s_waitcnt lgkmcnt(4)
    v_and_b32 v245, 0xe0, v246
    v_mov_b32 v247, s51
    v_mfma_f32_16x16x32_bf16 v[168:171], v[228:231], v[56:59], v[168:171]
    v_mfma_f32_16x16x32_bf16 v[172:175], v[228:231], v[60:63], v[172:175]
    v_add_u32 v240, 0, v250
    v_xor_b32 v241, 32, v240
    v_xor_b32 v242, 64, v240
    v_xor_b32 v243, 96, v240
    ds_read_b64_tr_b16 v[224:225], v240 offset:0
    ds_read_b64_tr_b16 v[226:227], v240 offset:512
    s_waitcnt lgkmcnt(4)
    v_cndmask_b32 v254, v254, 1.0, vcc
    v_cmp_eq_u32 vcc, 0x40, v245
    v_mfma_f32_16x16x32_bf16 v[192:195], v[232:235], v[56:59], v[192:195]
    ds_read_b64_tr_b16 v[228:229], v241 offset:0
    ds_read_b64_tr_b16 v[230:231], v241 offset:512
    v_mfma_f32_16x16x32_bf16 v[196:199], v[232:235], v[60:63], v[196:199]
    s_waitcnt lgkmcnt(4)
    s_add_u32 m0, s27, 81920
    s_add_u32 s30, s25, 2949248
    buffer_load_dwordx4 v249, s[12:15], s30 offen lds
    v_mfma_f32_16x16x32_bf16 v[200:203], v[236:239], v[56:59], v[200:203]
    ds_read_b64_tr_b16 v[232:233], v242 offset:0
    ds_read_b64_tr_b16 v[234:235], v242 offset:512
    v_mfma_f32_16x16x32_bf16 v[204:207], v[236:239], v[60:63], v[204:207]
    s_waitcnt lgkmcnt(4)
    s_nop 1
    v_cndmask_b32 v254, v254, v247, vcc
    v_permlane16_swap_b32 v212, v214
    v_permlane16_swap_b32 v213, v215
    v_mfma_f32_16x16x32_bf16 v[160:163], v[224:227], v[64:67], v[160:163]
    ds_read_b64_tr_b16 v[236:237], v243 offset:0
    ds_read_b64_tr_b16 v[238:239], v243 offset:512
    v_mfma_f32_16x16x32_bf16 v[164:167], v[224:227], v[68:71], v[164:167]
    s_waitcnt lgkmcnt(4)
    buffer_store_dwordx4 v[212:215], v252, s[4:7], s35 offen offset:0 sc1
    s_setprio 1
    v_mfma_f32_16x16x32_bf16 v[168:171], v[228:231], v[64:67], v[168:171]
    ds_read_b64_tr_b16 v[224:225], v240 offset:4096
    ds_read_b64_tr_b16 v[226:227], v240 offset:4608
    v_mfma_f32_16x16x32_bf16 v[172:175], v[228:231], v[68:71], v[172:175]
    s_waitcnt lgkmcnt(4)
    v_fma_f32 v184, v184, v254, v255
    v_fma_f32 v185, v185, v254, v255
    v_fma_f32 v186, v186, v254, v255
    v_fma_f32 v187, v187, v254, v255
    v_mfma_f32_16x16x32_bf16 v[192:195], v[232:235], v[64:67], v[192:195]
    ds_read_b64_tr_b16 v[228:229], v241 offset:4096
    ds_read_b64_tr_b16 v[230:231], v241 offset:4608
    v_mfma_f32_16x16x32_bf16 v[196:199], v[232:235], v[68:71], v[196:199]
    s_waitcnt lgkmcnt(4)
    v_fma_f32 v188, v188, v254, v255
    v_fma_f32 v189, v189, v254, v255
    v_mfma_f32_16x16x32_bf16 v[200:203], v[236:239], v[64:67], v[200:203]
    ds_read_b64_tr_b16 v[232:233], v242 offset:4096
    ds_read_b64_tr_b16 v[234:235], v242 offset:4608
    v_mfma_f32_16x16x32_bf16 v[204:207], v[236:239], v[68:71], v[204:207]
    s_waitcnt lgkmcnt(4)
    v_fma_f32 v190, v190, v254, v255
    v_fma_f32 v191, v191, v254, v255
    v_mfma_f32_16x16x32_bf16 v[160:163], v[224:227], v[72:75], v[160:163]
    ds_read_b64_tr_b16 v[236:237], v243 offset:4096
    ds_read_b64_tr_b16 v[238:239], v243 offset:4608
    v_mfma_f32_16x16x32_bf16 v[164:167], v[224:227], v[76:79], v[164:167]
    s_waitcnt lgkmcnt(4)
    s_add_u32 m0, s27, 90112
    s_add_u32 s30, s25, 3539072
    buffer_load_dwordx4 v249, s[12:15], s30 offen lds
    v_mfma_f32_16x16x32_bf16 v[168:171], v[228:231], v[72:75], v[168:171]
    ds_read_b64_tr_b16 v[224:225], v240 offset:8192
    ds_read_b64_tr_b16 v[226:227], v240 offset:8704
    v_mfma_f32_16x16x32_bf16 v[172:175], v[228:231], v[76:79], v[172:175]
    s_waitcnt lgkmcnt(4)
    v_cvt_pk_bf16_f32 v220, v184, v185
    v_cvt_pk_bf16_f32 v221, v186, v187
    v_cvt_pk_bf16_f32 v222, v188, v189
    v_cvt_pk_bf16_f32 v223, v190, v191
    v_mfma_f32_16x16x32_bf16 v[192:195], v[232:235], v[72:75], v[192:195]
    ds_read_b64_tr_b16 v[228:229], v241 offset:8192
    ds_read_b64_tr_b16 v[230:231], v241 offset:8704
    v_mfma_f32_16x16x32_bf16 v[196:199], v[232:235], v[76:79], v[196:199]
    s_waitcnt lgkmcnt(4)
    v_mul_f32 v144, s51, v144
    v_mul_f32 v145, s51, v145
    v_mfma_f32_16x16x32_bf16 v[200:203], v[236:239], v[72:75], v[200:203]
    ds_read_b64_tr_b16 v[232:233], v242 offset:8192
    ds_read_b64_tr_b16 v[234:235], v242 offset:8704
    v_mfma_f32_16x16x32_bf16 v[204:207], v[236:239], v[76:79], v[204:207]
    s_waitcnt lgkmcnt(4)
    v_mul_f32 v146, s51, v146
    v_mul_f32 v147, s51, v147
    v_mfma_f32_16x16x32_bf16 v[160:163], v[224:227], v[80:83], v[160:163]
    ds_read_b64_tr_b16 v[236:237], v243 offset:8192
    ds_read_b64_tr_b16 v[238:239], v243 offset:8704
    v_mfma_f32_16x16x32_bf16 v[164:167], v[224:227], v[84:87], v[164:167]
    s_waitcnt lgkmcnt(4)
    v_mul_f32 v148, s51, v148
    v_mul_f32 v149, s51, v149
    v_mfma_f32_16x16x32_bf16 v[168:171], v[228:231], v[80:83], v[168:171]
    ds_read_b64_tr_b16 v[224:225], v240 offset:12288
    ds_read_b64_tr_b16 v[226:227], v240 offset:12800
    v_mfma_f32_16x16x32_bf16 v[172:175], v[228:231], v[84:87], v[172:175]
    s_waitcnt lgkmcnt(4)
    v_mul_f32 v150, s51, v150
    v_mul_f32 v151, s51, v151
    v_mfma_f32_16x16x32_bf16 v[192:195], v[232:235], v[80:83], v[192:195]
    ds_read_b64_tr_b16 v[228:229], v241 offset:12288
    ds_read_b64_tr_b16 v[230:231], v241 offset:12800
    v_mfma_f32_16x16x32_bf16 v[196:199], v[232:235], v[84:87], v[196:199]
    s_waitcnt lgkmcnt(4)
    buffer_store_dwordx4 v[220:223], v251, s[4:7], s35 offen offset:1280 sc1
    v_mfma_f32_16x16x32_bf16 v[200:203], v[236:239], v[80:83], v[200:203]
    ds_read_b64_tr_b16 v[232:233], v242 offset:12288
    ds_read_b64_tr_b16 v[234:235], v242 offset:12800
    v_mfma_f32_16x16x32_bf16 v[204:207], v[236:239], v[84:87], v[204:207]
    s_waitcnt lgkmcnt(4)
    s_add_u32 m0, s27, 98304
    s_add_u32 s30, s25, 4128896
    buffer_load_dwordx4 v249, s[12:15], s30 offen lds
    v_mfma_f32_16x16x32_bf16 v[160:163], v[224:227], v[88:91], v[160:163]
    ds_read_b64_tr_b16 v[236:237], v243 offset:12288
    ds_read_b64_tr_b16 v[238:239], v243 offset:12800
    v_mfma_f32_16x16x32_bf16 v[164:167], v[224:227], v[92:95], v[164:167]
    s_waitcnt lgkmcnt(4)
    v_cvt_pk_bf16_f32 v208, v144, v145
    v_cvt_pk_bf16_f32 v209, v146, v147
    v_cvt_pk_bf16_f32 v210, v148, v149
    v_cvt_pk_bf16_f32 v211, v150, v151
    v_mfma_f32_16x16x32_bf16 v[168:171], v[228:231], v[88:91], v[168:171]
    ds_read_b64_tr_b16 v[224:225], v240 offset:16384
    v_mfma_f32_16x16x32_bf16 v[172:175], v[228:231], v[92:95], v[172:175]
    ds_read_b64_tr_b16 v[226:227], v240 offset:16896
    s_waitcnt lgkmcnt(4)
    v_mfma_f32_16x16x32_bf16 v[192:195], v[232:235], v[88:91], v[192:195]
    ds_read_b64_tr_b16 v[228:229], v241 offset:16384
    v_mfma_f32_16x16x32_bf16 v[196:199], v[232:235], v[92:95], v[196:199]
    ds_read_b64_tr_b16 v[230:231], v241 offset:16896
    s_waitcnt lgkmcnt(4)
    v_mfma_f32_16x16x32_bf16 v[200:203], v[236:239], v[88:91], v[200:203]
    ds_read_b64_tr_b16 v[232:233], v242 offset:16384
    v_mfma_f32_16x16x32_bf16 v[204:207], v[236:239], v[92:95], v[204:207]
    ds_read_b64_tr_b16 v[234:235], v242 offset:16896
    s_waitcnt lgkmcnt(4)
    v_mfma_f32_16x16x32_bf16 v[160:163], v[224:227], v[96:99], v[160:163]
    ds_read_b64_tr_b16 v[236:237], v243 offset:16384
    v_mfma_f32_16x16x32_bf16 v[164:167], v[224:227], v[100:103], v[164:167]
    ds_read_b64_tr_b16 v[238:239], v243 offset:16896
    s_waitcnt lgkmcnt(4)
    v_mfma_f32_16x16x32_bf16 v[168:171], v[228:231], v[96:99], v[168:171]
    ds_read_b64_tr_b16 v[224:225], v240 offset:20480
    ds_read_b64_tr_b16 v[226:227], v240 offset:20992
    v_mfma_f32_16x16x32_bf16 v[172:175], v[228:231], v[100:103], v[172:175]
    s_waitcnt lgkmcnt(4)
    s_add_u32 m0, s27, 106496
    s_add_u32 s30, s25, 4718720
    buffer_load_dwordx4 v249, s[12:15], s30 offen lds
    v_mfma_f32_16x16x32_bf16 v[192:195], v[232:235], v[96:99], v[192:195]
    ds_read_b64_tr_b16 v[228:229], v241 offset:20480
    v_mfma_f32_16x16x32_bf16 v[196:199], v[232:235], v[100:103], v[196:199]
    ds_read_b64_tr_b16 v[230:231], v241 offset:20992
    s_waitcnt lgkmcnt(4)
    s_setprio 0
    v_mfma_f32_16x16x32_bf16 v[200:203], v[236:239], v[96:99], v[200:203]
    ds_read_b64_tr_b16 v[232:233], v242 offset:20480
    v_mfma_f32_16x16x32_bf16 v[204:207], v[236:239], v[100:103], v[204:207]
    ds_read_b64_tr_b16 v[234:235], v242 offset:20992
    s_waitcnt lgkmcnt(4)
    v_mfma_f32_16x16x32_bf16 v[160:163], v[224:227], v[104:107], v[160:163]
    ds_read_b64_tr_b16 v[236:237], v243 offset:20480
    v_mfma_f32_16x16x32_bf16 v[164:167], v[224:227], v[108:111], v[164:167]
    ds_read_b64_tr_b16 v[238:239], v243 offset:20992
    s_waitcnt lgkmcnt(4)
    v_mfma_f32_16x16x32_bf16 v[168:171], v[228:231], v[104:107], v[168:171]
    ds_read_b64_tr_b16 v[224:225], v240 offset:24576
    ds_read_b64_tr_b16 v[226:227], v240 offset:25088
    v_mfma_f32_16x16x32_bf16 v[172:175], v[228:231], v[108:111], v[172:175]
    s_waitcnt lgkmcnt(4)
    v_permlane16_swap_b32 v208, v210
    v_permlane16_swap_b32 v209, v211
    v_mfma_f32_16x16x32_bf16 v[192:195], v[232:235], v[104:107], v[192:195]
    ds_read_b64_tr_b16 v[228:229], v241 offset:24576
    ds_read_b64_tr_b16 v[230:231], v241 offset:25088
    v_mfma_f32_16x16x32_bf16 v[196:199], v[232:235], v[108:111], v[196:199]
    s_waitcnt lgkmcnt(4)
    buffer_store_dwordx4 v[208:211], v248, s[4:7], s34 offen offset:0 sc1
    v_mfma_f32_16x16x32_bf16 v[200:203], v[236:239], v[104:107], v[200:203]
    ds_read_b64_tr_b16 v[232:233], v242 offset:24576
    ds_read_b64_tr_b16 v[234:235], v242 offset:25088
    v_mfma_f32_16x16x32_bf16 v[204:207], v[236:239], v[108:111], v[204:207]
    s_waitcnt lgkmcnt(4)
    s_getpc_b64 s[96:97]
CT_pc2:
    s_sub_u32 s96, s96, CT_pc2-CODE_BEGIN
    s_subb_u32 s97, s97, 0
    s_mov_b32 s98, CODE_END-CODE_BEGIN
    s_mov_b32 s99, 0x20000
    s_lshr_b32 s62, s2, 3
    s_mul_i32 s62, s62, 8
    s_add_u32 s62, s62, s20
    s_mul_i32 s62, s62, 384
    v_lshlrev_b32 v249, 3, v248
    v_add_u32 v249, s62, v249
    s_mov_b64 exec, 7
    buffer_load_dword v249, v249, s[96:99], 0 offen
    s_mov_b64 exec, -1
    v_mfma_f32_16x16x32_bf16 v[160:163], v[224:227], v[112:115], v[160:163]
    ds_read_b64_tr_b16 v[236:237], v243 offset:24576
    ds_read_b64_tr_b16 v[238:239], v243 offset:25088
    v_mfma_f32_16x16x32_bf16 v[164:167], v[224:227], v[116:119], v[164:167]
    s_waitcnt lgkmcnt(4)
    s_cmp_lg_u32 s20, 0
    s_cbranch_scc1 POLLC_pre
    v_and_b32 v246, 0x70, v248
    v_lshlrev_b32 v246, 1, v246
    v_add_u32 v246, 8, v246
    buffer_load_dword v247, v246, s[36:39], 0 offen sc1
POLLC_pre:
    v_mfma_f32_16x16x32_bf16 v[168:171], v[228:231], v[112:115], v[168:171]
    ds_read_b64_tr_b16 v[224:225], v240 offset:28672
    v_mfma_f32_16x16x32_bf16 v[172:175], v[228:231], v[116:119], v[172:175]
    ds_read_b64_tr_b16 v[226:227], v240 offset:29184
    s_waitcnt lgkmcnt(4)
    v_mfma_f32_16x16x32_bf16 v[192:195], v[232:235], v[112:115], v[192:195]
    ds_read_b64_tr_b16 v[228:229], v241 offset:28672
    v_mfma_f32_16x16x32_bf16 v[196:199], v[232:235], v[116:119], v[196:199]
    ds_read_b64_tr_b16 v[230:231], v241 offset:29184
    s_waitcnt lgkmcnt(4)
    v_mfma_f32_16x16x32_bf16 v[200:203], v[236:239], v[112:115], v[200:203]
    ds_read_b64_tr_b16 v[232:233], v242 offset:28672
    v_mfma_f32_16x16x32_bf16 v[204:207], v[236:239], v[116:119], v[204:207]
    ds_read_b64_tr_b16 v[234:235], v242 offset:29184
    s_waitcnt lgkmcnt(4)
    v_mfma_f32_16x16x32_bf16 v[160:163], v[224:227], v[120:123], v[160:163]
    ds_read_b64_tr_b16 v[236:237], v243 offset:28672
    v_mfma_f32_16x16x32_bf16 v[164:167], v[224:227], v[124:127], v[164:167]
    ds_read_b64_tr_b16 v[238:239], v243 offset:29184
    s_waitcnt lgkmcnt(4)
    v_mfma_f32_16x16x32_bf16 v[168:171], v[228:231], v[120:123], v[168:171]
    ds_read_b64_tr_b16 v[224:225], v240 offset:32768
    v_mfma_f32_16x16x32_bf16 v[172:175], v[228:231], v[124:127], v[172:175]
    ds_read_b64_tr_b16 v[226:227], v240 offset:33280
    s_waitcnt lgkmcnt(4)
    v_mfma_f32_16x16x32_bf16 v[192:195], v[232:235], v[120:123], v[192:195]
    ds_read_b64_tr_b16 v[228:229], v241 offset:32768
    v_mfma_f32_16x16x32_bf16 v[196:199], v[232:235], v[124:127], v[196:199]
    ds_read_b64_tr_b16 v[230:231], v241 offset:33280
    s_waitcnt lgkmcnt(4)
    v_mfma_f32_16x16x32_bf16 v[200:203], v[236:239], v[120:123], v[200:203]
    ds_read_b64_tr_b16 v[232:233], v242 offset:32768
    v_mfma_f32_16x16x32_bf16 v[204:207], v[236:239], v[124:127], v[204:207]
    ds_read_b64_tr_b16 v[234:235], v242 offset:33280
    s_waitcnt lgkmcnt(4)
    v_mfma_f32_16x16x32_bf16 v[160:163], v[224:227], v[128:131], v[160:163]
    ds_read_b64_tr_b16 v[236:237], v243 offset:32768
    v_mfma_f32_16x16x32_bf16 v[164:167], v[224:227], v[132:135], v[164:167]
    ds_read_b64_tr_b16 v[238:239], v243 offset:33280
    s_waitcnt lgkmcnt(4)
    v_mfma_f32_16x16x32_bf16 v[168:171], v[228:231], v[128:131], v[168:171]
    ds_read_b64_tr_b16 v[224:225], v240 offset:36864
    v_mfma_f32_16x16x32_bf16 v[172:175], v[228:231], v[132:135], v[172:175]
    ds_read_b64_tr_b16 v[226:227], v240 offset:37376
    s_waitcnt lgkmcnt(4)
    v_mfma_f32_16x16x32_bf16 v[192:195], v[232:235], v[128:131], v[192:195]
    ds_read_b64_tr_b16 v[228:229], v241 offset:36864
    v_mfma_f32_16x16x32_bf16 v[196:199], v[232:235], v[132:135], v[196:199]
    ds_read_b64_tr_b16 v[230:231], v241 offset:37376
    s_waitcnt lgkmcnt(4)
    v_mfma_f32_16x16x32_bf16 v[200:203], v[236:239], v[128:131], v[200:203]
    ds_read_b64_tr_b16 v[232:233], v242 offset:36864
    v_mfma_f32_16x16x32_bf16 v[204:207], v[236:239], v[132:135], v[204:207]
    ds_read_b64_tr_b16 v[234:235], v242 offset:37376
    s_waitcnt lgkmcnt(4)
    v_mfma_f32_16x16x32_bf16 v[160:163], v[224:227], v[136:139], v[160:163]
    ds_read_b64_tr_b16 v[236:237], v243 offset:36864
    v_mfma_f32_16x16x32_bf16 v[164:167], v[224:227], v[140:143], v[164:167]
    ds_read_b64_tr_b16 v[238:239], v243 offset:37376
    s_waitcnt lgkmcnt(4)
    v_mfma_f32_16x16x32_bf16 v[168:171], v[228:231], v[136:139], v[168:171]
    v_mfma_f32_16x16x32_bf16 v[172:175], v[228:231], v[140:143], v[172:175]
    s_waitcnt vmcnt(0)
    s_cmp_lg_u32 s20, 0
    s_cbranch_scc1 POLLC_ok
    v_cmp_gt_u32 vcc, 32, v247
    s_cbranch_vccz POLLC_ok
    s_mov_b32 s63, 1048576
POLLC_spin:
    s_sleep 24
    buffer_load_dword v247, v246, s[36:39], 0 offen sc1
    s_waitcnt vmcnt(0)
    v_cmp_gt_u32 vcc, 32, v247
    s_sub_u32 s63, s63, 1
    s_cbranch_scc1 POLLC_ok
    s_cbranch_vccnz POLLC_spin
POLLC_ok:
    s_waitcnt lgkmcnt(0)
    s_barrier
    s_cmp_lg_u32 s20, 0
    s_cbranch_scc1 PH1_pub
    s_lshl_b32 s62, s2, 7
    s_add_u32 s62, s62, 46010368
    v_mov_b32 v244, 1
    s_mov_b64 exec, 1
    buffer_store_dword v244, off, s[4:7], s62 sc1
    s_mov_b64 exec, -1
PH1_pub:
    v_add_u32 v240, 40960, v250
    v_xor_b32 v241, 32, v240
    v_xor_b32 v242, 64, v240
    v_xor_b32 v243, 96, v240
    ds_read_b64_tr_b16 v[224:225], v240 offset:0
    ds_read_b64_tr_b16 v[226:227], v240 offset:512
    s_setprio 3
    v_mfma_f32_16x16x32_bf16 v[192:195], v[232:235], v[136:139], v[192:195]
    ds_read_b64_tr_b16 v[228:229], v241 offset:0
    ds_read_b64_tr_b16 v[230:231], v241 offset:512
    v_mfma_f32_16x16x32_bf16 v[196:199], v[232:235], v[140:143], v[196:199]
    s_mul_i32 s54, s20, 3072
    s_add_u32 m0, s54, 114688
    s_nop 0
    buffer_load_dwordx4 v248, s[4:7], s35 offen offset:0 sc1 lds
    v_mfma_f32_16x16x32_bf16 v[200:203], v[236:239], v[136:139], v[200:203]
    ds_read_b64_tr_b16 v[232:233], v242 offset:0
    v_mfma_f32_16x16x32_bf16 v[204:207], v[236:239], v[140:143], v[204:207]
    ds_read_b64_tr_b16 v[234:235], v242 offset:512
    s_waitcnt lgkmcnt(4)
    v_mfma_f32_16x16x32_bf16 v[144:147], v[224:227], v[0:3], 0
    ds_read_b64_tr_b16 v[236:237], v243 offset:0
    v_mfma_f32_16x16x32_bf16 v[148:151], v[224:227], v[4:7], 0
    ds_read_b64_tr_b16 v[238:239], v243 offset:512
    s_waitcnt lgkmcnt(4)
    v_mfma_f32_16x16x32_bf16 v[152:155], v[228:231], v[0:3], 0
    ds_read_b64_tr_b16 v[224:225], v240 offset:4096
    ds_read_b64_tr_b16 v[226:227], v240 offset:4608
    v_mfma_f32_16x16x32_bf16 v[156:159], v[228:231], v[4:7], 0
    s_waitcnt lgkmcnt(4)
    buffer_load_dwordx4 v248, s[4:7], s35 offen offset:1024 sc1 lds
    v_mfma_f32_16x16x32_bf16 v[176:179], v[232:235], v[0:3], 0
    ds_read_b64_tr_b16 v[228:229], v241 offset:4096
    ds_read_b64_tr_b16 v[230:231], v241 offset:4608
    v_mfma_f32_16x16x32_bf16 v[180:183], v[232:235], v[4:7], 0
    s_waitcnt lgkmcnt(4)
    s_mov_b32 exec_lo, 0xffcfffff
    buffer_load_dwordx4 v248, s[4:7], s35 offen offset:2048 sc1 lds
    s_mov_b32 exec_lo, -1
    v_mfma_f32_16x16x32_bf16 v[184:187], v[236:239], v[0:3], 0
    ds_read_b64_tr_b16 v[232:233], v242 offset:4096
    ds_read_b64_tr_b16 v[234:235], v242 offset:4608
    v_mfma_f32_16x16x32_bf16 v[188:191], v[236:239], v[4:7], 0
    s_waitcnt lgkmcnt(4)
    v_bfe_u32 v210, v248, 4, 3
    v_lshlrev_b32 v210, 2, v210
    v_add_u32 v210, 117056, v210
    v_mov_b32 v211, 0
    s_mov_b64 exec, 0xff
    ds_write_b32 v210, v211
    s_mov_b64 exec, -1
    v_mfma_f32_16x16x32_bf16 v[144:147], v[224:227], v[8:11], v[144:147]
    ds_read_b64_tr_b16 v[236:237], v243 offset:4096
    ds_read_b64_tr_b16 v[238:239], v243 offset:4608
    v_mfma_f32_16x16x32_bf16 v[148:151], v[224:227], v[12:15], v[148:151]
    s_waitcnt lgkmcnt(5)
    s_and_b32 s36, s20, 3
    s_lshr_b32 s38, s23, 1
    s_and_b32 s55, s24, 1
    s_lshl_b32 s56, s38, 1
    s_add_u32 s57, s56, s55
    s_xor_b32 s58, s57, 1
    s_lshr_b32 s59, s24, 1
    s_mul_i32 s59, s59, 576
    s_mul_i32 s55, s55, 320
    s_add_u32 s55, s55, s59
    s_setprio 2
    v_mfma_f32_16x16x32_bf16 v[152:155], v[228:231], v[8:11], v[152:155]
    ds_read_b64_tr_b16 v[224:225], v240 offset:8192
    ds_read_b64_tr_b16 v[226:227], v240 offset:8704
    v_mfma_f32_16x16x32_bf16 v[156:159], v[228:231], v[12:15], v[156:159]
    s_waitcnt lgkmcnt(5)
    s_mul_i32 s39, s57, 663552
    s_add_u32 s45, s39, s59
    s_add_u32 s45, s45, 256
    s_add_u32 s39, s39, s55
    s_mul_i32 s42, s58, 663552
    s_add_u32 s42, s42, s55
    s_lshl_b32 s46, s36, 12
    s_lshl_b32 s47, s36, 10
    s_lshl_b32 s55, s36, 4
    s_lshl_b32 s40, s22, 1
    v_mfma_f32_16x16x32_bf16 v[176:179], v[232:235], v[8:11], v[176:179]
    ds_read_b64_tr_b16 v[228:229], v241 offset:8192
    ds_read_b64_tr_b16 v[230:231], v241 offset:8704
    v_mfma_f32_16x16x32_bf16 v[180:183], v[232:235], v[12:15], v[180:183]
    s_waitcnt lgkmcnt(4)
    s_cmp_ge_u32 s24, 2
    s_cselect_b32 s8, 4, 0
    s_cselect_b32 s13, 5, 1
    s_cselect_b32 s9, 6, 2
    s_cselect_b32 s14, 7, 3
    s_cselect_b32 s10, 8, 4
    s_cselect_b32 s15, 1, 5
    s_cselect_b32 s11, 0, 6
    s_cselect_b32 s25, 3, 7
    s_cselect_b32 s12, 2, 8
    s_cmp_ge_u32 s20, 4
    s_cselect_b32 s59, s9, s8
    s_cselect_b32 s56, 20480, 0
    s_mul_i32 s59, s59, 73728
    v_mfma_f32_16x16x32_bf16 v[184:187], v[236:239], v[8:11], v[184:187]
    ds_read_b64_tr_b16 v[232:233], v242 offset:8192
    ds_read_b64_tr_b16 v[234:235], v242 offset:8704
    v_mfma_f32_16x16x32_bf16 v[188:191], v[236:239], v[12:15], v[188:191]
    s_waitcnt lgkmcnt(4)
    v_lshrrev_b32 v210, 8, v248
    v_bfe_u32 v211, v248, 4, 4
    v_lshlrev_b32 v209, 2, v210
    v_xor_b32 v211, v211, v209
    v_add_u32 v210, s55, v210
    v_mul_u32_u24 v210, 1152, v210
    v_lshl_add_u32 v251, v211, 4, v210
    v_add_u32 v252, 3584, v251
    v_add_u32 v253, 7168, v251
    v_add_u32 v254, 10752, v251
    v_mfma_f32_16x16x32_bf16 v[144:147], v[224:227], v[16:19], v[144:147]
    ds_read_b64_tr_b16 v[236:237], v243 offset:8192
    ds_read_b64_tr_b16 v[238:239], v243 offset:8704
    v_mfma_f32_16x16x32_bf16 v[148:151], v[224:227], v[20:23], v[148:151]
    s_waitcnt lgkmcnt(4)
    v_lshrrev_b32 v210, 6, v248
    v_add_u32 v210, s55, v210
    v_mul_u32_u24 v210, 1152, v210
    v_and_b32 v211, 0x30, v248
    v_add_u32 v255, v211, v210
    v_mfma_f32_16x16x32_bf16 v[152:155], v[228:231], v[16:19], v[152:155]
    ds_read_b64_tr_b16 v[224:225], v240 offset:12288
    ds_read_b64_tr_b16 v[226:227], v240 offset:12800
    v_mfma_f32_16x16x32_bf16 v[156:159], v[228:231], v[20:23], v[156:159]
    s_waitcnt lgkmcnt(4)
    s_add_u32 m0, s46, s56
    s_add_u32 s48, s39, s59
    buffer_load_dwordx4 v251, s[16:19], s48 offen offset:0 lds
    v_mfma_f32_16x16x32_bf16 v[176:179], v[232:235], v[16:19], v[176:179]
    ds_read_b64_tr_b16 v[228:229], v241 offset:12288
    ds_read_b64_tr_b16 v[230:231], v241 offset:12800
    v_mfma_f32_16x16x32_bf16 v[180:183], v[232:235], v[20:23], v[180:183]
    s_waitcnt lgkmcnt(4)
    buffer_load_dwordx4 v252, s[16:19], s48 offen offset:1024 lds
    v_mfma_f32_16x16x32_bf16 v[184:187], v[236:239], v[16:19], v[184:187]
    ds_read_b64_tr_b16 v[232:233], v242 offset:12288
    ds_read_b64_tr_b16 v[234:235], v242 offset:12800
    v_mfma_f32_16x16x32_bf16 v[188:191], v[236:239], v[20:23], v[188:191]
    s_waitcnt lgkmcnt(4)
    buffer_load_dwordx4 v253, s[16:19], s48 offen offset:2048 lds
    v_mfma_f32_16x16x32_bf16 v[144:147], v[224:227], v[24:27], v[144:147]
    ds_read_b64_tr_b16 v[236:237], v243 offset:12288
    ds_read_b64_tr_b16 v[238:239], v243 offset:12800
    v_mfma_f32_16x16x32_bf16 v[148:151], v[224:227], v[28:31], v[148:151]
    s_waitcnt lgkmcnt(4)
    buffer_load_dwordx4 v254, s[16:19], s48 offen offset:3072 lds
    s_setprio 1
    v_mfma_f32_16x16x32_bf16 v[152:155], v[228:231], v[24:27], v[152:155]
    ds_read_b64_tr_b16 v[224:225], v240 offset:16384
    ds_read_b64_tr_b16 v[226:227], v240 offset:16896
    v_mfma_f32_16x16x32_bf16 v[156:159], v[228:231], v[28:31], v[156:159]
    s_waitcnt lgkmcnt(4)
    s_add_u32 s56, s56, 16384
    s_add_u32 m0, s47, s56
    s_add_u32 s48, s45, s59
    buffer_load_dwordx4 v255, s[16:19], s48 offen lds
    v_mfma_f32_16x16x32_bf16 v[176:179], v[232:235], v[24:27], v[176:179]
    ds_read_b64_tr_b16 v[228:229], v241 offset:16384
    ds_read_b64_tr_b16 v[230:231], v241 offset:16896
    v_mfma_f32_16x16x32_bf16 v[180:183], v[232:235], v[28:31], v[180:183]
    s_waitcnt lgkmcnt(4)
    v_mul_f32 v160, s50, v160
    v_mul_f32 v161, s50, v161
    v_mul_f32 v162, s50, v162
    v_mul_f32 v163, s50, v163
    v_mfma_f32_16x16x32_bf16 v[184:187], v[236:239], v[24:27], v[184:187]
    ds_read_b64_tr_b16 v[232:233], v242 offset:16384
    ds_read_b64_tr_b16 v[234:235], v242 offset:16896
    v_mfma_f32_16x16x32_bf16 v[188:191], v[236:239], v[28:31], v[188:191]
    s_waitcnt lgkmcnt(4)
    v_exp_f32 v160, v160
    v_exp_f32 v161, v161
    v_mfma_f32_16x16x32_bf16 v[144:147], v[224:227], v[32:35], v[144:147]
    ds_read_b64_tr_b16 v[236:237], v243 offset:16384
    ds_read_b64_tr_b16 v[238:239], v243 offset:16896
    v_mfma_f32_16x16x32_bf16 v[148:151], v[224:227], v[36:39], v[148:151]
    s_waitcnt lgkmcnt(4)
    v_exp_f32 v162, v162
    v_exp_f32 v163, v163
    v_mfma_f32_16x16x32_bf16 v[152:155], v[228:231], v[32:35], v[152:155]
    ds_read_b64_tr_b16 v[224:225], v240 offset:20480
    ds_read_b64_tr_b16 v[226:227], v240 offset:20992
    v_mfma_f32_16x16x32_bf16 v[156:159], v[228:231], v[36:39], v[156:159]
    s_waitcnt lgkmcnt(4)
    v_add_f32 v160, 1.0, v160
    v_add_f32 v161, 1.0, v161
    v_add_f32 v162, 1.0, v162
    v_add_f32 v163, 1.0, v163
    v_mfma_f32_16x16x32_bf16 v[176:179], v[232:235], v[32:35], v[176:179]
    ds_read_b64_tr_b16 v[228:229], v241 offset:20480
    ds_read_b64_tr_b16 v[230:231], v241 offset:20992
    v_mfma_f32_16x16x32_bf16 v[180:183], v[232:235], v[36:39], v[180:183]
    s_waitcnt lgkmcnt(4)
    v_rcp_f32 v160, v160
    v_mfma_f32_16x16x32_bf16 v[184:187], v[236:239], v[32:35], v[184:187]
    ds_read_b64_tr_b16 v[232:233], v242 offset:20480
    ds_read_b64_tr_b16 v[234:235], v242 offset:20992
    v_mfma_f32_16x16x32_bf16 v[188:191], v[236:239], v[36:39], v[188:191]
    s_waitcnt lgkmcnt(4)
    v_rcp_f32 v161, v161
    v_rcp_f32 v162, v162
    v_mfma_f32_16x16x32_bf16 v[144:147], v[224:227], v[40:43], v[144:147]
    ds_read_b64_tr_b16 v[236:237], v243 offset:20480
    ds_read_b64_tr_b16 v[238:239], v243 offset:20992
    v_mfma_f32_16x16x32_bf16 v[148:151], v[224:227], v[44:47], v[148:151]
    s_waitcnt lgkmcnt(4)
    v_rcp_f32 v163, v163
    v_mul_f32 v164, s50, v164
    v_mul_f32 v165, s50, v165
    s_setprio 0
    v_mfma_f32_16x16x32_bf16 v[152:155], v[228:231], v[40:43], v[152:155]
    ds_read_b64_tr_b16 v[224:225], v240 offset:24576
    ds_read_b64_tr_b16 v[226:227], v240 offset:25088
    v_mfma_f32_16x16x32_bf16 v[156:159], v[228:231], v[44:47], v[156:159]
    s_waitcnt lgkmcnt(4)
    v_mul_f32 v166, s50, v166
    v_mul_f32 v167, s50, v167
    v_mfma_f32_16x16x32_bf16 v[176:179], v[232:235], v[40:43], v[176:179]
    ds_read_b64_tr_b16 v[228:229], v241 offset:24576
    ds_read_b64_tr_b16 v[230:231], v241 offset:25088
    v_mfma_f32_16x16x32_bf16 v[180:183], v[232:235], v[44:47], v[180:183]
    s_waitcnt lgkmcnt(4)
    v_exp_f32 v164, v164
    v_exp_f32 v165, v165
    v_mfma_f32_16x16x32_bf16 v[184:187], v[236:239], v[40:43], v[184:187]
    ds_read_b64_tr_b16 v[232:233], v242 offset:24576
    ds_read_b64_tr_b16 v[234:235], v242 offset:25088
    v_mfma_f32_16x16x32_bf16 v[188:191], v[236:239], v[44:47], v[188:191]
    s_waitcnt lgkmcnt(4)
    v_exp_f32 v166, v166
    v_exp_f32 v167, v167
    v_mfma_f32_16x16x32_bf16 v[144:147], v[224:227], v[48:51], v[144:147]
    ds_read_b64_tr_b16 v[236:237], v243 offset:24576
    ds_read_b64_tr_b16 v[238:239], v243 offset:25088
    v_mfma_f32_16x16x32_bf16 v[148:151], v[224:227], v[52:55], v[148:151]
    s_waitcnt lgkmcnt(4)
    v_add_f32 v164, 1.0, v164
    v_add_f32 v165, 1.0, v165
    v_mfma_f32_16x16x32_bf16 v[152:155], v[228:231], v[48:51], v[152:155]
    ds_read_b64_tr_b16 v[224:225], v240 offset:28672
    ds_read_b64_tr_b16 v[226:227], v240 offset:29184
    v_mfma_f32_16x16x32_bf16 v[156:159], v[228:231], v[52:55], v[156:159]
    s_waitcnt lgkmcnt(4)
    v_add_f32 v166, 1.0, v166
    v_add_f32 v167, 1.0, v167
    v_rcp_f32 v164, v164
    v_mfma_f32_16x16x32_bf16 v[176:179], v[232:235], v[48:51], v[176:179]
    ds_read_b64_tr_b16 v[228:229], v241 offset:28672
    ds_read_b64_tr_b16 v[230:231], v241 offset:29184
    v_mfma_f32_16x16x32_bf16 v[180:183], v[232:235], v[52:55], v[180:183]
    s_waitcnt lgkmcnt(4)
    v_rcp_f32 v165, v165
    v_rcp_f32 v166, v166
    v_mfma_f32_16x16x32_bf16 v[184:187], v[236:239], v[48:51], v[184:187]
    ds_read_b64_tr_b16 v[232:233], v242 offset:28672
    ds_read_b64_tr_b16 v[234:235], v242 offset:29184
    v_mfma_f32_16x16x32_bf16 v[188:191], v[236:239], v[52:55], v[188:191]
    s_waitcnt lgkmcnt(4)
    v_rcp_f32 v167, v167
    v_mul_f32 v168, s50, v168
    v_mul_f32 v169, s50, v169
    v_mfma_f32_16x16x32_bf16 v[144:147], v[224:227], v[56:59], v[144:147]
    ds_read_b64_tr_b16 v[236:237], v243 offset:28672
    ds_read_b64_tr_b16 v[238:239], v243 offset:29184
    v_mfma_f32_16x16x32_bf16 v[148:151], v[224:227], v[60:63], v[148:151]
    s_waitcnt lgkmcnt(4)
    v_mul_f32 v170, s50, v170
    v_mul_f32 v171, s50, v171
    v_mfma_f32_16x16x32_bf16 v[152:155], v[228:231], v[56:59], v[152:155]
    v_mfma_f32_16x16x32_bf16 v[156:159], v[228:231], v[60:63], v[156:159]
    s_waitcnt vmcnt(0) lgkmcnt(0)
    s_barrier
    v_add_u32 v240, 73728, v250
    v_xor_b32 v241, 32, v240
    v_xor_b32 v242, 64, v240
    v_xor_b32 v243, 96, v240
    ds_read_b64_tr_b16 v[224:225], v240 offset:0
    ds_read_b64_tr_b16 v[226:227], v240 offset:512
    v_exp_f32 v168, v168
    v_exp_f32 v169, v169
    s_setprio 3
    v_mfma_f32_16x16x32_bf16 v[176:179], v[232:235], v[56:59], v[176:179]
    ds_read_b64_tr_b16 v[228:229], v241 offset:0
    ds_read_b64_tr_b16 v[230:231], v241 offset:512
    v_mfma_f32_16x16x32_bf16 v[180:183], v[232:235], v[60:63], v[180:183]
    v_exp_f32 v170, v170
    v_exp_f32 v171, v171
    v_mfma_f32_16x16x32_bf16 v[184:187], v[236:239], v[56:59], v[184:187]
    ds_read_b64_tr_b16 v[232:233], v242 offset:0
    ds_read_b64_tr_b16 v[234:235], v242 offset:512
    v_mfma_f32_16x16x32_bf16 v[188:191], v[236:239], v[60:63], v[188:191]
    s_waitcnt lgkmcnt(4)
    v_add_f32 v168, 1.0, v168
    v_add_f32 v169, 1.0, v169
    s_cmp_ge_u32 s20, 4
    s_cbranch_scc1 PH_role1
    v_mfma_f32_16x16x32_bf16 v[144:147], v[224:227], v[64:67], v[144:147]
    ds_read_b64_tr_b16 v[236:237], v243 offset:0
    ds_read_b64_tr_b16 v[238:239], v243 offset:512
    v_mfma_f32_16x16x32_bf16 v[148:151], v[224:227], v[68:71], v[148:151]
    s_waitcnt lgkmcnt(4)
    s_lshl_b32 s36, s22, 3
    s_lshl_b32 s38, s20, 1
    s_add_u32 s36, s36, s38
    v_mfma_f32_16x16x32_bf16 v[152:155], v[228:231], v[64:67], v[152:155]
    ds_read_b64_tr_b16 v[224:225], v240 offset:4096
    ds_read_b64_tr_b16 v[226:227], v240 offset:4608
    v_mfma_f32_16x16x32_bf16 v[156:159], v[228:231], v[68:71], v[156:159]
    s_waitcnt lgkmcnt(4)
    v_add_f32 v170, 1.0, v170
    v_add_f32 v171, 1.0, v171
    v_rcp_f32 v168, v168
    v_mfma_f32_16x16x32_bf16 v[176:179], v[232:235], v[64:67], v[176:179]
    ds_read_b64_tr_b16 v[228:229], v241 offset:4096
    ds_read_b64_tr_b16 v[230:231], v241 offset:4608
    v_mfma_f32_16x16x32_bf16 v[180:183], v[232:235], v[68:71], v[180:183]
    s_waitcnt lgkmcnt(4)
    s_mul_i32 s37, s21, 196608
    s_add_u32 s37, s37, 4354048
    s_lshl_b32 s38, s21, 6
    v_mfma_f32_16x16x32_bf16 v[184:187], v[236:239], v[64:67], v[184:187]
    ds_read_b64_tr_b16 v[232:233], v242 offset:4096
    ds_read_b64_tr_b16 v[234:235], v242 offset:4608
    v_mfma_f32_16x16x32_bf16 v[188:191], v[236:239], v[68:71], v[188:191]
    s_waitcnt lgkmcnt(4)
    v_rcp_f32 v169, v169
    v_rcp_f32 v170, v170
    v_mfma_f32_16x16x32_bf16 v[144:147], v[224:227], v[72:75], v[144:147]
    ds_read_b64_tr_b16 v[236:237], v243 offset:4096
    ds_read_b64_tr_b16 v[238:239], v243 offset:4608
    v_mfma_f32_16x16x32_bf16 v[148:151], v[224:227], v[76:79], v[148:151]
    s_waitcnt lgkmcnt(4)
    s_add_u32 s38, s38, s36
    s_lshl_b32 s39, s38, 10
    s_add_u32 s39, s39, 2359296
    v_mfma_f32_16x16x32_bf16 v[152:155], v[228:231], v[72:75], v[152:155]
    ds_read_b64_tr_b16 v[224:225], v240 offset:8192
    ds_read_b64_tr_b16 v[226:227], v240 offset:8704
    v_mfma_f32_16x16x32_bf16 v[156:159], v[228:231], v[76:79], v[156:159]
    s_waitcnt lgkmcnt(4)
    v_rcp_f32 v171, v171
    v_mul_f32 v172, s50, v172
    v_mul_f32 v173, s50, v173
    v_mfma_f32_16x16x32_bf16 v[176:179], v[232:235], v[72:75], v[176:179]
    ds_read_b64_tr_b16 v[228:229], v241 offset:8192
    ds_read_b64_tr_b16 v[230:231], v241 offset:8704
    v_mfma_f32_16x16x32_bf16 v[180:183], v[232:235], v[76:79], v[180:183]
    s_waitcnt lgkmcnt(4)
    s_mul_i32 s38, s38, 3072
    s_add_u32 s38, s38, 4456448
    v_bfe_u32 v251, v248, 9, 1
    v_mfma_f32_16x16x32_bf16 v[184:187], v[236:239], v[72:75], v[184:187]
    ds_read_b64_tr_b16 v[232:233], v242 offset:8192
    ds_read_b64_tr_b16 v[234:235], v242 offset:8704
    v_mfma_f32_16x16x32_bf16 v[188:191], v[236:239], v[76:79], v[188:191]
    s_waitcnt lgkmcnt(4)
    v_mul_f32 v174, s50, v174
    v_mul_f32 v175, s50, v175
    v_exp_f32 v172, v172
    s_setprio 2
    v_mfma_f32_16x16x32_bf16 v[144:147], v[224:227], v[80:83], v[144:147]
    ds_read_b64_tr_b16 v[236:237], v243 offset:8192
    ds_read_b64_tr_b16 v[238:239], v243 offset:8704
    v_mfma_f32_16x16x32_bf16 v[148:151], v[224:227], v[84:87], v[148:151]
    s_waitcnt lgkmcnt(4)
    v_bfe_u32 v252, v248, 8, 1
    v_bfe_u32 v253, v248, 6, 1
    v_bfe_u32 v254, v248, 7, 1
    v_mfma_f32_16x16x32_bf16 v[152:155], v[228:231], v[80:83], v[152:155]
    ds_read_b64_tr_b16 v[224:225], v240 offset:12288
    ds_read_b64_tr_b16 v[226:227], v240 offset:12800
    v_mfma_f32_16x16x32_bf16 v[156:159], v[228:231], v[84:87], v[156:159]
    s_waitcnt lgkmcnt(4)
    v_exp_f32 v173, v173
    v_exp_f32 v174, v174
    v_mfma_f32_16x16x32_bf16 v[176:179], v[232:235], v[80:83], v[176:179]
    ds_read_b64_tr_b16 v[228:229], v241 offset:12288
    ds_read_b64_tr_b16 v[230:231], v241 offset:12800
    v_mfma_f32_16x16x32_bf16 v[180:183], v[232:235], v[84:87], v[180:183]
    s_waitcnt lgkmcnt(4)
    v_bfe_u32 v255, v248, 4, 2
    v_lshlrev_b32 v255, 1, v255
    v_lshl_add_u32 v255, v253, 9, v255
    v_mfma_f32_16x16x32_bf16 v[184:187], v[236:239], v[80:83], v[184:187]
    ds_read_b64_tr_b16 v[232:233], v242 offset:12288
    ds_read_b64_tr_b16 v[234:235], v242 offset:12800
    v_mfma_f32_16x16x32_bf16 v[188:191], v[236:239], v[84:87], v[188:191]
    s_waitcnt lgkmcnt(4)
    v_exp_f32 v175, v175
    v_add_f32 v172, 1.0, v172
    v_add_f32 v173, 1.0, v173
    v_mfma_f32_16x16x32_bf16 v[144:147], v[224:227], v[88:91], v[144:147]
    ds_read_b64_tr_b16 v[236:237], v243 offset:12288
    ds_read_b64_tr_b16 v[238:239], v243 offset:12800
    v_mfma_f32_16x16x32_bf16 v[148:151], v[224:227], v[92:95], v[148:151]
    s_waitcnt lgkmcnt(4)
    v_lshl_add_u32 v255, v251, 4, v255
    v_lshl_add_u32 v223, v252, 3, v255
    v_lshl_add_u32 v223, v254, 10, v223
    v_mfma_f32_16x16x32_bf16 v[152:155], v[228:231], v[88:91], v[152:155]
    ds_read_b64_tr_b16 v[224:225], v240 offset:16384
    ds_read_b64_tr_b16 v[226:227], v240 offset:16896
    v_mfma_f32_16x16x32_bf16 v[156:159], v[228:231], v[92:95], v[156:159]
    s_waitcnt lgkmcnt(4)
    v_add_f32 v174, 1.0, v174
    v_add_f32 v175, 1.0, v175
    v_rcp_f32 v172, v172
    v_mfma_f32_16x16x32_bf16 v[176:179], v[232:235], v[88:91], v[176:179]
    ds_read_b64_tr_b16 v[228:229], v241 offset:16384
    ds_read_b64_tr_b16 v[230:231], v241 offset:16896
    v_mfma_f32_16x16x32_bf16 v[180:183], v[232:235], v[92:95], v[180:183]
    s_waitcnt lgkmcnt(4)
    v_add_u32 v223, 1344, v223
    v_mfma_f32_16x16x32_bf16 v[184:187], v[236:239], v[88:91], v[184:187]
    ds_read_b64_tr_b16 v[232:233], v242 offset:16384
    ds_read_b64_tr_b16 v[234:235], v242 offset:16896
    v_mfma_f32_16x16x32_bf16 v[188:191], v[236:239], v[92:95], v[188:191]
    s_waitcnt lgkmcnt(4)
    v_rcp_f32 v173, v173
    v_rcp_f32 v174, v174
    v_mfma_f32_16x16x32_bf16 v[144:147], v[224:227], v[96:99], v[144:147]
    ds_read_b64_tr_b16 v[236:237], v243 offset:16384
    ds_read_b64_tr_b16 v[238:239], v243 offset:16896
    v_mfma_f32_16x16x32_bf16 v[148:151], v[224:227], v[100:103], v[148:151]
    s_waitcnt lgkmcnt(4)
    buffer_load_dwordx4 v[208:211], v248, s[4:7], s39 offen sc1
    buffer_load_ushort v216, v223, s[4:7], s38 offen sc1
    buffer_load_dwordx4 v[212:215], v248, s[4:7], s39 offen offset:1024 sc1
    buffer_load_ushort v218, v223, s[4:7], s38 offen offset:3072 sc1
    v_mfma_f32_16x16x32_bf16 v[152:155], v[228:231], v[96:99], v[152:155]
    ds_read_b64_tr_b16 v[224:225], v240 offset:20480
    ds_read_b64_tr_b16 v[226:227], v240 offset:20992
    v_mfma_f32_16x16x32_bf16 v[156:159], v[228:231], v[100:103], v[156:159]
    s_waitcnt lgkmcnt(4)
    v_rcp_f32 v175, v175
    v_mul_f32 v192, s50, v192
    v_mul_f32 v193, s50, v193
    v_mfma_f32_16x16x32_bf16 v[176:179], v[232:235], v[96:99], v[176:179]
    ds_read_b64_tr_b16 v[228:229], v241 offset:20480
    ds_read_b64_tr_b16 v[230:231], v241 offset:20992
    v_mfma_f32_16x16x32_bf16 v[180:183], v[232:235], v[100:103], v[180:183]
    s_waitcnt lgkmcnt(4)
    v_lshl_add_u32 v222, v254, 3, v255
    v_lshl_add_u32 v222, v252, 10, v222
    s_setprio 1
    v_mfma_f32_16x16x32_bf16 v[184:187], v[236:239], v[96:99], v[184:187]
    ds_read_b64_tr_b16 v[232:233], v242 offset:20480
    ds_read_b64_tr_b16 v[234:235], v242 offset:20992
    v_mfma_f32_16x16x32_bf16 v[188:191], v[236:239], v[100:103], v[188:191]
    s_waitcnt lgkmcnt(4)
    v_mul_f32 v194, s50, v194
    v_mul_f32 v195, s50, v195
    v_exp_f32 v192, v192
    v_mfma_f32_16x16x32_bf16 v[144:147], v[224:227], v[104:107], v[144:147]
    ds_read_b64_tr_b16 v[236:237], v243 offset:20480
    ds_read_b64_tr_b16 v[238:239], v243 offset:20992
    v_mfma_f32_16x16x32_bf16 v[148:151], v[224:227], v[108:111], v[148:151]
    s_waitcnt lgkmcnt(4)
    v_lshl_add_u32 v222, v253, 5, v222
    v_lshl_add_u32 v222, v252, 6, v222
    v_mfma_f32_16x16x32_bf16 v[152:155], v[228:231], v[104:107], v[152:155]
    ds_read_b64_tr_b16 v[224:225], v240 offset:24576
    ds_read_b64_tr_b16 v[226:227], v240 offset:25088
    v_mfma_f32_16x16x32_bf16 v[156:159], v[228:231], v[108:111], v[156:159]
    s_waitcnt lgkmcnt(4)
    v_exp_f32 v193, v193
    v_exp_f32 v194, v194
    v_mfma_f32_16x16x32_bf16 v[176:179], v[232:235], v[104:107], v[176:179]
    ds_read_b64_tr_b16 v[228:229], v241 offset:24576
    ds_read_b64_tr_b16 v[230:231], v241 offset:25088
    v_mfma_f32_16x16x32_bf16 v[180:183], v[232:235], v[108:111], v[180:183]
    s_waitcnt lgkmcnt(4)
    v_add_u32 v222, 103808, v222
    v_bfe_u32 v252, v248, 4, 5
    v_mfma_f32_16x16x32_bf16 v[184:187], v[236:239], v[104:107], v[184:187]
    ds_read_b64_tr_b16 v[232:233], v242 offset:24576
    ds_read_b64_tr_b16 v[234:235], v242 offset:25088
    v_mfma_f32_16x16x32_bf16 v[188:191], v[236:239], v[108:111], v[188:191]
    s_waitcnt lgkmcnt(4)
    v_exp_f32 v195, v195
    v_add_f32 v192, 1.0, v192
    v_add_f32 v193, 1.0, v193
    v_mfma_f32_16x16x32_bf16 v[144:147], v[224:227], v[112:115], v[144:147]
    ds_read_b64_tr_b16 v[236:237], v243 offset:24576
    ds_read_b64_tr_b16 v[238:239], v243 offset:25088
    v_mfma_f32_16x16x32_bf16 v[148:151], v[224:227], v[116:119], v[148:151]
    s_waitcnt lgkmcnt(4)
    v_cmp_eq_u32 vcc, 22, v252
    v_min_u32 v253, 19, v252
    v_mfma_f32_16x16x32_bf16 v[152:155], v[228:231], v[112:115], v[152:155]
    ds_read_b64_tr_b16 v[224:225], v240 offset:28672
    ds_read_b64_tr_b16 v[226:227], v240 offset:29184
    v_mfma_f32_16x16x32_bf16 v[156:159], v[228:231], v[116:119], v[156:159]
    s_waitcnt lgkmcnt(4)
    v_add_f32 v194, 1.0, v194
    v_add_f32 v195, 1.0, v195
    v_rcp_f32 v192, v192
    v_mfma_f32_16x16x32_bf16 v[176:179], v[232:235], v[112:115], v[176:179]
    ds_read_b64_tr_b16 v[228:229], v241 offset:28672
    ds_read_b64_tr_b16 v[230:231], v241 offset:29184
    v_mfma_f32_16x16x32_bf16 v[180:183], v[232:235], v[116:119], v[180:183]
    s_waitcnt lgkmcnt(4)
    v_add_u32 v220, 102400, v248
    v_cndmask_b32 v252, v253, v252, vcc
    v_mfma_f32_16x16x32_bf16 v[184:187], v[236:239], v[112:115], v[184:187]
    ds_read_b64_tr_b16 v[232:233], v242 offset:28672
    ds_read_b64_tr_b16 v[234:235], v242 offset:29184
    v_mfma_f32_16x16x32_bf16 v[188:191], v[236:239], v[116:119], v[188:191]
    s_waitcnt lgkmcnt(4)
    v_rcp_f32 v193, v193
    v_rcp_f32 v194, v194
    v_mfma_f32_16x16x32_bf16 v[144:147], v[224:227], v[120:123], v[144:147]
    ds_read_b64_tr_b16 v[236:237], v243 offset:28672
    ds_read_b64_tr_b16 v[238:239], v243 offset:29184
    v_mfma_f32_16x16x32_bf16 v[148:151], v[224:227], v[124:127], v[148:151]
    s_waitcnt lgkmcnt(4)
    v_lshlrev_b32 v252, 4, v252
    v_lshl_add_u32 v221, v251, 9, v252
    v_mfma_f32_16x16x32_bf16 v[152:155], v[228:231], v[120:123], v[152:155]
    ds_read_b64_tr_b16 v[224:225], v240 offset:32768
    ds_read_b64_tr_b16 v[226:227], v240 offset:33280
    v_mfma_f32_16x16x32_bf16 v[156:159], v[228:231], v[124:127], v[156:159]
    s_waitcnt lgkmcnt(4)
    v_rcp_f32 v195, v195
    v_mul_f32 v196, s50, v196
    v_mul_f32 v197, s50, v197
    s_setprio 0
    v_mfma_f32_16x16x32_bf16 v[176:179], v[232:235], v[120:123], v[176:179]
    ds_read_b64_tr_b16 v[228:229], v241 offset:32768
    ds_read_b64_tr_b16 v[230:231], v241 offset:33280
    v_mfma_f32_16x16x32_bf16 v[180:183], v[232:235], v[124:127], v[180:183]
    s_waitcnt lgkmcnt(4)
    v_add_u32 v221, 102400, v221
    v_mov_b32 v217, 0
    v_mfma_f32_16x16x32_bf16 v[184:187], v[236:239], v[120:123], v[184:187]
    ds_read_b64_tr_b16 v[232:233], v242 offset:32768
    ds_read_b64_tr_b16 v[234:235], v242 offset:33280
    v_mfma_f32_16x16x32_bf16 v[188:191], v[236:239], v[124:127], v[188:191]
    s_waitcnt lgkmcnt(4)
    v_mul_f32 v198, s50, v198
    v_mul_f32 v199, s50, v199
    v_exp_f32 v196, v196
    v_mfma_f32_16x16x32_bf16 v[144:147], v[224:227], v[128:131], v[144:147]
    ds_read_b64_tr_b16 v[236:237], v243 offset:32768
    ds_read_b64_tr_b16 v[238:239], v243 offset:33280
    v_mfma_f32_16x16x32_bf16 v[148:151], v[224:227], v[132:135], v[148:151]
    s_waitcnt lgkmcnt(4)
    v_mov_b32 v219, 0
    v_mfma_f32_16x16x32_bf16 v[152:155], v[228:231], v[128:131], v[152:155]
    ds_read_b64_tr_b16 v[224:225], v240 offset:36864
    ds_read_b64_tr_b16 v[226:227], v240 offset:37376
    v_mfma_f32_16x16x32_bf16 v[156:159], v[228:231], v[132:135], v[156:159]
    s_waitcnt lgkmcnt(4)
    v_exp_f32 v197, v197
    v_exp_f32 v198, v198
    v_mfma_f32_16x16x32_bf16 v[176:179], v[232:235], v[128:131], v[176:179]
    ds_read_b64_tr_b16 v[228:229], v241 offset:36864
    ds_read_b64_tr_b16 v[230:231], v241 offset:37376
    v_mfma_f32_16x16x32_bf16 v[180:183], v[232:235], v[132:135], v[180:183]
    s_waitcnt lgkmcnt(4)
    v_exp_f32 v199, v199
    v_add_f32 v196, 1.0, v196
    v_add_f32 v197, 1.0, v197
    v_mfma_f32_16x16x32_bf16 v[184:187], v[236:239], v[128:131], v[184:187]
    ds_read_b64_tr_b16 v[232:233], v242 offset:36864
    ds_read_b64_tr_b16 v[234:235], v242 offset:37376
    v_mfma_f32_16x16x32_bf16 v[188:191], v[236:239], v[132:135], v[188:191]
    s_waitcnt lgkmcnt(4)
    v_add_f32 v198, 1.0, v198
    v_add_f32 v199, 1.0, v199
    v_rcp_f32 v196, v196
    v_mfma_f32_16x16x32_bf16 v[144:147], v[224:227], v[136:139], v[144:147]
    ds_read_b64_tr_b16 v[236:237], v243 offset:36864
    ds_read_b64_tr_b16 v[238:239], v243 offset:37376
    v_mfma_f32_16x16x32_bf16 v[148:151], v[224:227], v[140:143], v[148:151]
    s_waitcnt lgkmcnt(4)
    v_rcp_f32 v197, v197
    v_rcp_f32 v198, v198
    v_mfma_f32_16x16x32_bf16 v[152:155], v[228:231], v[136:139], v[152:155]
    v_mfma_f32_16x16x32_bf16 v[156:159], v[228:231], v[140:143], v[156:159]
    s_waitcnt lgkmcnt(2)
    v_rcp_f32 v199, v199
    v_mfma_f32_16x16x32_bf16 v[176:179], v[232:235], v[136:139], v[176:179]
    v_mfma_f32_16x16x32_bf16 v[180:183], v[232:235], v[140:143], v[180:183]
    s_waitcnt lgkmcnt(0)
    v_mul_f32 v200, s50, v200
    v_mul_f32 v201, s50, v201
    v_mul_f32 v202, s50, v202
    v_mul_f32 v203, s50, v203
    v_mfma_f32_16x16x32_bf16 v[184:187], v[236:239], v[136:139], v[184:187]
    v_mfma_f32_16x16x32_bf16 v[188:191], v[236:239], v[140:143], v[188:191]
    v_exp_f32 v200, v200
    v_exp_f32 v201, v201
    v_exp_f32 v202, v202
    v_exp_f32 v203, v203
    v_add_f32 v200, 1.0, v200
    v_add_f32 v201, 1.0, v201
    v_add_f32 v202, 1.0, v202
    v_add_f32 v203, 1.0, v203
    v_rcp_f32 v200, v200
    v_rcp_f32 v201, v201
    v_rcp_f32 v202, v202
    v_rcp_f32 v203, v203
    v_mul_f32 v204, s50, v204
    v_mul_f32 v205, s50, v205
    v_mul_f32 v206, s50, v206
    v_mul_f32 v207, s50, v207
    v_exp_f32 v204, v204
    v_exp_f32 v205, v205
    v_exp_f32 v206, v206
    v_exp_f32 v207, v207
    v_add_f32 v204, 1.0, v204
    v_add_f32 v205, 1.0, v205
    v_add_f32 v206, 1.0, v206
    v_add_f32 v207, 1.0, v207
    v_rcp_f32 v204, v204
    v_rcp_f32 v205, v205
    v_rcp_f32 v206, v206
    v_rcp_f32 v207, v207
    s_setprio 0
    s_nop 7
    v_mul_f32 v144, v144, v160
    v_mul_f32 v145, v145, v161
    v_mul_f32 v146, v146, v162
    v_mul_f32 v147, v147, v163
    v_mul_f32 v148, v148, v164
    v_mul_f32 v149, v149, v165
    v_mul_f32 v150, v150, v166
    v_mul_f32 v151, v151, v167
    v_mul_f32 v152, v152, v168
    v_mul_f32 v153, v153, v169
    v_mul_f32 v154, v154, v170
    v_mul_f32 v155, v155, v171
    v_mul_f32 v156, v156, v172
    v_mul_f32 v157, v157, v173
    v_mul_f32 v158, v158, v174
    v_mul_f32 v159, v159, v175
    v_mul_f32 v192, v176, v192
    v_mul_f32 v193, v177, v193
    v_mul_f32 v194, v178, v194
    v_mul_f32 v195, v179, v195
    v_mul_f32 v196, v180, v196
    v_mul_f32 v197, v181, v197
    v_mul_f32 v198, v182, v198
    v_mul_f32 v199, v183, v199
    v_mul_f32 v200, v184, v200
    v_mul_f32 v201, v185, v201
    v_mul_f32 v202, v186, v202
    v_mul_f32 v203, v187, v203
    v_mul_f32 v204, v188, v204
    v_mul_f32 v205, v189, v205
    v_mul_f32 v206, v190, v206
    v_mul_f32 v207, v191, v207
    v_cvt_pk_bf16_f32 v176, v144, v145
    v_cvt_pk_bf16_f32 v177, v146, v147
    v_cvt_pk_bf16_f32 v178, v148, v149
    v_cvt_pk_bf16_f32 v179, v150, v151
    v_cvt_pk_bf16_f32 v180, v152, v153
    v_cvt_pk_bf16_f32 v181, v154, v155
    v_cvt_pk_bf16_f32 v182, v156, v157
    v_cvt_pk_bf16_f32 v183, v158, v159
    v_cvt_pk_bf16_f32 v184, v192, v193
    v_cvt_pk_bf16_f32 v185, v194, v195
    v_cvt_pk_bf16_f32 v186, v196, v197
    v_cvt_pk_bf16_f32 v187, v198, v199
    v_cvt_pk_bf16_f32 v188, v200, v201
    v_cvt_pk_bf16_f32 v189, v202, v203
    v_cvt_pk_bf16_f32 v190, v204, v205
    v_cvt_pk_bf16_f32 v191, v206, v207
    v_permlane16_swap_b32 v176, v178
    v_permlane16_swap_b32 v177, v179
    v_permlane16_swap_b32 v180, v182
    v_permlane16_swap_b32 v181, v183
    v_permlane16_swap_b32 v184, v186
    v_permlane16_swap_b32 v185, v187
    v_permlane16_swap_b32 v188, v190
    v_permlane16_swap_b32 v189, v191
    v_mov_b32 v113, 0
    v_mov_b32 v115, 0
    v_bfe_u32 v134, v248, 4, 2
    v_lshlrev_b32 v134, 2, v134
    v_add_u32 v134, 117056, v134
    s_lshl_b32 s42, s20, 2
    s_add_u32 s42, s42, 117056
    v_mov_b32 v135, s42
    v_mov_b32 v136, 1
    s_waitcnt vmcnt(0)
    ds_read_b128 v[88:91], v220 offset:12288
    ds_read_u16 v112, v222 offset:12288
    ds_read_b128 v[92:95], v220 offset:15360
    ds_read_u16 v114, v222 offset:15360
    ds_read_b128 v[104:107], v221 offset:13312
    s_waitcnt lgkmcnt(3)
    v_mfma_f32_32x32x8bf16_1k v[8:23], v[112:113], v[216:217], 0
    v_mfma_f32_32x32x16_bf16 v[8:23], v[88:91], v[208:211], v[8:23]
    s_nop 7
    s_nop 3
    v_mfma_f32_32x32x8bf16_1k v[24:39], v[112:113], v[218:219], 0
    v_exp_f32 v8, v8
    v_exp_f32 v9, v9
    v_exp_f32 v10, v10
    v_exp_f32 v11, v11
    ds_read_b128 v[96:99], v221 offset:14336
    v_exp_f32 v12, v12
    v_exp_f32 v13, v13
    v_exp_f32 v14, v14
    v_exp_f32 v15, v15
    v_cvt_pk_bf16_f32 v72, v8, v9
    v_cvt_pk_bf16_f32 v73, v10, v11
    v_cvt_pk_bf16_f32 v74, v12, v13
    v_cvt_pk_bf16_f32 v75, v14, v15
    v_mfma_f32_32x32x16_bf16 v[24:39], v[88:91], v[212:215], v[24:39]
    v_exp_f32 v16, v16
    v_exp_f32 v17, v17
    v_exp_f32 v18, v18
    v_exp_f32 v19, v19
    s_waitcnt lgkmcnt(0)
    v_exp_f32 v20, v20
    v_exp_f32 v21, v21
    v_exp_f32 v22, v22
    v_exp_f32 v23, v23
    v_cvt_pk_bf16_f32 v76, v16, v17
    v_cvt_pk_bf16_f32 v77, v18, v19
    v_cvt_pk_bf16_f32 v78, v20, v21
    v_cvt_pk_bf16_f32 v79, v22, v23
    v_mfma_f32_32x32x8bf16_1k v[8:23], v[114:115], v[216:217], 0
    v_exp_f32 v24, v24
    v_exp_f32 v25, v25
    v_exp_f32 v26, v26
    v_exp_f32 v27, v27
    v_mfma_f32_32x32x16_bf16 v[40:55], v[104:107], v[72:75], 0
    buffer_store_dwordx4 v[176:179], v248, s[4:7], s61 offen offset:0 sc1
    ds_read_b128 v[88:91], v220 offset:18432
    v_exp_f32 v28, v28
    v_exp_f32 v29, v29
    v_exp_f32 v30, v30
    v_exp_f32 v31, v31
    v_cvt_pk_bf16_f32 v80, v24, v25
    v_cvt_pk_bf16_f32 v81, v26, v27
    v_cvt_pk_bf16_f32 v82, v28, v29
    v_cvt_pk_bf16_f32 v83, v30, v31
    v_mfma_f32_32x32x16_bf16 v[8:23], v[92:95], v[208:211], v[8:23]
    ds_read_u16 v112, v222 offset:18432
    v_exp_f32 v32, v32
    v_exp_f32 v33, v33
    v_exp_f32 v34, v34
    v_exp_f32 v35, v35
    v_mfma_f32_32x32x16_bf16 v[40:55], v[96:99], v[76:79], v[40:55]
    ds_read_b128 v[108:111], v221 offset:16384
    v_exp_f32 v36, v36
    v_exp_f32 v37, v37
    v_exp_f32 v38, v38
    v_exp_f32 v39, v39
    v_cvt_pk_bf16_f32 v84, v32, v33
    v_cvt_pk_bf16_f32 v85, v34, v35
    v_cvt_pk_bf16_f32 v86, v36, v37
    v_cvt_pk_bf16_f32 v87, v38, v39
    v_mfma_f32_32x32x8bf16_1k v[24:39], v[114:115], v[218:219], 0
    v_exp_f32 v8, v8
    v_exp_f32 v9, v9
    v_exp_f32 v10, v10
    v_exp_f32 v11, v11
    v_mfma_f32_32x32x16_bf16 v[56:71], v[104:107], v[80:83], 0
    ds_read_b128 v[100:103], v221 offset:17408
    v_exp_f32 v12, v12
    v_exp_f32 v13, v13
    v_exp_f32 v14, v14
    v_exp_f32 v15, v15
    v_cvt_pk_bf16_f32 v72, v8, v9
    v_cvt_pk_bf16_f32 v73, v10, v11
    v_cvt_pk_bf16_f32 v74, v12, v13
    v_cvt_pk_bf16_f32 v75, v14, v15
    v_mfma_f32_32x32x16_bf16 v[24:39], v[92:95], v[212:215], v[24:39]
    v_exp_f32 v16, v16
    v_exp_f32 v17, v17
    v_exp_f32 v18, v18
    v_exp_f32 v19, v19
    v_mfma_f32_32x32x16_bf16 v[56:71], v[96:99], v[84:87], v[56:71]
    s_waitcnt lgkmcnt(0)
    v_exp_f32 v20, v20
    v_exp_f32 v21, v21
    v_exp_f32 v22, v22
    v_exp_f32 v23, v23
    v_cvt_pk_bf16_f32 v76, v16, v17
    v_cvt_pk_bf16_f32 v77, v18, v19
    v_cvt_pk_bf16_f32 v78, v20, v21
    v_cvt_pk_bf16_f32 v79, v22, v23
    v_mfma_f32_32x32x8bf16_1k v[8:23], v[112:113], v[216:217], 0
    v_exp_f32 v24, v24
    v_exp_f32 v25, v25
    v_exp_f32 v26, v26
    v_exp_f32 v27, v27
    v_mfma_f32_32x32x16_bf16 v[40:55], v[108:111], v[72:75], v[40:55]
    ds_read_b128 v[92:95], v220 offset:21504
    v_exp_f32 v28, v28
    v_exp_f32 v29, v29
    v_exp_f32 v30, v30
    v_exp_f32 v31, v31
    v_cvt_pk_bf16_f32 v80, v24, v25
    v_cvt_pk_bf16_f32 v81, v26, v27
    v_cvt_pk_bf16_f32 v82, v28, v29
    v_cvt_pk_bf16_f32 v83, v30, v31
    v_mfma_f32_32x32x16_bf16 v[8:23], v[88:91], v[208:211], v[8:23]
    ds_read_u16 v114, v222 offset:21504
    v_exp_f32 v32, v32
    v_exp_f32 v33, v33
    v_exp_f32 v34, v34
    v_exp_f32 v35, v35
    v_mfma_f32_32x32x16_bf16 v[40:55], v[100:103], v[76:79], v[40:55]
    ds_read_b128 v[104:107], v221 offset:19456
    v_exp_f32 v36, v36
    v_exp_f32 v37, v37
    v_exp_f32 v38, v38
    v_exp_f32 v39, v39
    v_cvt_pk_bf16_f32 v84, v32, v33
    v_cvt_pk_bf16_f32 v85, v34, v35
    v_cvt_pk_bf16_f32 v86, v36, v37
    v_cvt_pk_bf16_f32 v87, v38, v39
    v_mfma_f32_32x32x8bf16_1k v[24:39], v[112:113], v[218:219], 0
    v_exp_f32 v8, v8
    v_exp_f32 v9, v9
    v_exp_f32 v10, v10
    v_exp_f32 v11, v11
    v_mfma_f32_32x32x16_bf16 v[56:71], v[108:111], v[80:83], v[56:71]
    ds_read_b128 v[96:99], v221 offset:20480
    v_exp_f32 v12, v12
    v_exp_f32 v13, v13
    v_exp_f32 v14, v14
    v_exp_f32 v15, v15
    v_cvt_pk_bf16_f32 v72, v8, v9
    v_cvt_pk_bf16_f32 v73, v10, v11
    v_cvt_pk_bf16_f32 v74, v12, v13
    v_cvt_pk_bf16_f32 v75, v14, v15
    v_mfma_f32_32x32x16_bf16 v[24:39], v[88:91], v[212:215], v[24:39]
    v_exp_f32 v16, v16
    v_exp_f32 v17, v17
    v_exp_f32 v18, v18
    v_exp_f32 v19, v19
    v_mfma_f32_32x32x16_bf16 v[56:71], v[100:103], v[84:87], v[56:71]
    s_waitcnt lgkmcnt(0)
    v_exp_f32 v20, v20
    v_exp_f32 v21, v21
    v_exp_f32 v22, v22
    v_exp_f32 v23, v23
    v_cvt_pk_bf16_f32 v76, v16, v17
    v_cvt_pk_bf16_f32 v77, v18, v19
    v_cvt_pk_bf16_f32 v78, v20, v21
    v_cvt_pk_bf16_f32 v79, v22, v23
    v_mfma_f32_32x32x8bf16_1k v[8:23], v[114:115], v[216:217], 0
    v_exp_f32 v24, v24
    v_exp_f32 v25, v25
    v_exp_f32 v26, v26
    v_exp_f32 v27, v27
    v_mfma_f32_32x32x16_bf16 v[40:55], v[104:107], v[72:75], v[40:55]
    ds_read_b128 v[88:91], v220 offset:24576
    v_exp_f32 v28, v28
    v_exp_f32 v29, v29
    v_exp_f32 v30, v30
    v_exp_f32 v31, v31
    v_cvt_pk_bf16_f32 v80, v24, v25
    v_cvt_pk_bf16_f32 v81, v26, v27
    v_cvt_pk_bf16_f32 v82, v28, v29
    v_cvt_pk_bf16_f32 v83, v30, v31
    v_mfma_f32_32x32x16_bf16 v[8:23], v[92:95], v[208:211], v[8:23]
    ds_read_u16 v112, v222 offset:24576
    v_exp_f32 v32, v32
    v_exp_f32 v33, v33
    v_exp_f32 v34, v34
    v_exp_f32 v35, v35
    v_mfma_f32_32x32x16_bf16 v[40:55], v[96:99], v[76:79], v[40:55]
    ds_read_b128 v[108:111], v221 offset:22528
    v_exp_f32 v36, v36
    v_exp_f32 v37, v37
    v_exp_f32 v38, v38
    v_exp_f32 v39, v39
    v_cvt_pk_bf16_f32 v84, v32, v33
    v_cvt_pk_bf16_f32 v85, v34, v35
    v_cvt_pk_bf16_f32 v86, v36, v37
    v_cvt_pk_bf16_f32 v87, v38, v39
    v_mfma_f32_32x32x8bf16_1k v[24:39], v[114:115], v[218:219], 0
    v_exp_f32 v8, v8
    v_exp_f32 v9, v9
    v_exp_f32 v10, v10
    v_exp_f32 v11, v11
    v_mfma_f32_32x32x16_bf16 v[56:71], v[104:107], v[80:83], v[56:71]
    ds_read_b128 v[100:103], v221 offset:23552
    v_exp_f32 v12, v12
    v_exp_f32 v13, v13
    v_exp_f32 v14, v14
    v_exp_f32 v15, v15
    v_cvt_pk_bf16_f32 v72, v8, v9
    v_cvt_pk_bf16_f32 v73, v10, v11
    v_cvt_pk_bf16_f32 v74, v12, v13
    v_cvt_pk_bf16_f32 v75, v14, v15
    v_mfma_f32_32x32x16_bf16 v[24:39], v[92:95], v[212:215], v[24:39]
    v_exp_f32 v16, v16
    v_exp_f32 v17, v17
    v_exp_f32 v18, v18
    v_exp_f32 v19, v19
    v_mfma_f32_32x32x16_bf16 v[56:71], v[96:99], v[84:87], v[56:71]
    s_waitcnt lgkmcnt(0)
    v_exp_f32 v20, v20
    v_exp_f32 v21, v21
    v_exp_f32 v22, v22
    v_exp_f32 v23, v23
    v_cvt_pk_bf16_f32 v76, v16, v17
    v_cvt_pk_bf16_f32 v77, v18, v19
    v_cvt_pk_bf16_f32 v78, v20, v21
    v_cvt_pk_bf16_f32 v79, v22, v23
    v_mfma_f32_32x32x8bf16_1k v[8:23], v[112:113], v[216:217], 0
    v_exp_f32 v24, v24
    v_exp_f32 v25, v25
    v_exp_f32 v26, v26
    v_exp_f32 v27, v27
    v_mfma_f32_32x32x16_bf16 v[40:55], v[108:111], v[72:75], v[40:55]
    buffer_store_dwordx4 v[180:183], v248, s[4:7], s61 offen offset:1024 sc1
    s_mov_b64 exec, 1
    ds_add_u32 v135, v136
    s_mov_b64 exec, -1
    ds_read_b128 v[92:95], v220 offset:27648
    v_exp_f32 v28, v28
    v_exp_f32 v29, v29
    v_exp_f32 v30, v30
    v_exp_f32 v31, v31
    v_cvt_pk_bf16_f32 v80, v24, v25
    v_cvt_pk_bf16_f32 v81, v26, v27
    v_cvt_pk_bf16_f32 v82, v28, v29
    v_cvt_pk_bf16_f32 v83, v30, v31
    v_mfma_f32_32x32x16_bf16 v[8:23], v[88:91], v[208:211], v[8:23]
    ds_read_u16 v114, v222 offset:27648
    v_exp_f32 v32, v32
    v_exp_f32 v33, v33
    v_exp_f32 v34, v34
    v_exp_f32 v35, v35
    v_mfma_f32_32x32x16_bf16 v[40:55], v[100:103], v[76:79], v[40:55]
    ds_read_b128 v[104:107], v221 offset:25600
    v_exp_f32 v36, v36
    v_exp_f32 v37, v37
    v_exp_f32 v38, v38
    v_exp_f32 v39, v39
    v_cvt_pk_bf16_f32 v84, v32, v33
    v_cvt_pk_bf16_f32 v85, v34, v35
    v_cvt_pk_bf16_f32 v86, v36, v37
    v_cvt_pk_bf16_f32 v87, v38, v39
    v_mfma_f32_32x32x8bf16_1k v[24:39], v[112:113], v[218:219], 0
    v_exp_f32 v8, v8
    v_exp_f32 v9, v9
    v_exp_f32 v10, v10
    v_exp_f32 v11, v11
    v_mfma_f32_32x32x16_bf16 v[56:71], v[108:111], v[80:83], v[56:71]
    ds_read_b128 v[96:99], v221 offset:26624
    v_exp_f32 v12, v12
    v_exp_f32 v13, v13
    v_exp_f32 v14, v14
    v_exp_f32 v15, v15
    v_cvt_pk_bf16_f32 v72, v8, v9
    v_cvt_pk_bf16_f32 v73, v10, v11
    v_cvt_pk_bf16_f32 v74, v12, v13
    v_cvt_pk_bf16_f32 v75, v14, v15
    v_mfma_f32_32x32x16_bf16 v[24:39], v[88:91], v[212:215], v[24:39]
    v_exp_f32 v16, v16
    v_exp_f32 v17, v17
    v_exp_f32 v18, v18
    v_exp_f32 v19, v19
    v_mfma_f32_32x32x16_bf16 v[56:71], v[100:103], v[84:87], v[56:71]
    s_waitcnt lgkmcnt(0)
    v_exp_f32 v20, v20
    v_exp_f32 v21, v21
    v_exp_f32 v22, v22
    v_exp_f32 v23, v23
    v_cvt_pk_bf16_f32 v76, v16, v17
    v_cvt_pk_bf16_f32 v77, v18, v19
    v_cvt_pk_bf16_f32 v78, v20, v21
    v_cvt_pk_bf16_f32 v79, v22, v23
    v_mfma_f32_32x32x8bf16_1k v[8:23], v[114:115], v[216:217], 0
    v_exp_f32 v24, v24
    v_exp_f32 v25, v25
    v_exp_f32 v26, v26
    v_exp_f32 v27, v27
    v_mfma_f32_32x32x16_bf16 v[40:55], v[104:107], v[72:75], v[40:55]
    ds_read_b128 v[88:91], v220 offset:30720
    v_exp_f32 v28, v28
    v_exp_f32 v29, v29
    v_exp_f32 v30, v30
    v_exp_f32 v31, v31
    v_cvt_pk_bf16_f32 v80, v24, v25
    v_cvt_pk_bf16_f32 v81, v26, v27
    v_cvt_pk_bf16_f32 v82, v28, v29
    v_cvt_pk_bf16_f32 v83, v30, v31
    v_mfma_f32_32x32x16_bf16 v[8:23], v[92:95], v[208:211], v[8:23]
    ds_read_u16 v112, v222 offset:30720
    v_exp_f32 v32, v32
    v_exp_f32 v33, v33
    v_exp_f32 v34, v34
    v_exp_f32 v35, v35
    v_mfma_f32_32x32x16_bf16 v[40:55], v[96:99], v[76:79], v[40:55]
    ds_read_b128 v[108:111], v221 offset:28672
    v_exp_f32 v36, v36
    v_exp_f32 v37, v37
    v_exp_f32 v38, v38
    v_exp_f32 v39, v39
    v_cvt_pk_bf16_f32 v84, v32, v33
    v_cvt_pk_bf16_f32 v85, v34, v35
    v_cvt_pk_bf16_f32 v86, v36, v37
    v_cvt_pk_bf16_f32 v87, v38, v39
    v_mfma_f32_32x32x8bf16_1k v[24:39], v[114:115], v[218:219], 0
    v_exp_f32 v8, v8
    v_exp_f32 v9, v9
    v_exp_f32 v10, v10
    v_exp_f32 v11, v11
    v_mfma_f32_32x32x16_bf16 v[56:71], v[104:107], v[80:83], v[56:71]
    ds_read_b128 v[100:103], v221 offset:29696
    v_exp_f32 v12, v12
    v_exp_f32 v13, v13
    v_exp_f32 v14, v14
    v_exp_f32 v15, v15
    v_cvt_pk_bf16_f32 v72, v8, v9
    v_cvt_pk_bf16_f32 v73, v10, v11
    v_cvt_pk_bf16_f32 v74, v12, v13
    v_cvt_pk_bf16_f32 v75, v14, v15
    v_mfma_f32_32x32x16_bf16 v[24:39], v[92:95], v[212:215], v[24:39]
    v_exp_f32 v16, v16
    v_exp_f32 v17, v17
    v_exp_f32 v18, v18
    v_exp_f32 v19, v19
    v_mfma_f32_32x32x16_bf16 v[56:71], v[96:99], v[84:87], v[56:71]
    s_waitcnt lgkmcnt(0)
    v_exp_f32 v20, v20
    v_exp_f32 v21, v21
    v_exp_f32 v22, v22
    v_exp_f32 v23, v23
    v_cvt_pk_bf16_f32 v76, v16, v17
    v_cvt_pk_bf16_f32 v77, v18, v19
    v_cvt_pk_bf16_f32 v78, v20, v21
    v_cvt_pk_bf16_f32 v79, v22, v23
    v_mfma_f32_32x32x8bf16_1k v[8:23], v[112:113], v[216:217], 0
    v_exp_f32 v24, v24
    v_exp_f32 v25, v25
    v_exp_f32 v26, v26
    v_exp_f32 v27, v27
    v_mfma_f32_32x32x16_bf16 v[40:55], v[108:111], v[72:75], v[40:55]
    ds_read_b128 v[92:95], v220 offset:33792
    v_exp_f32 v28, v28
    v_exp_f32 v29, v29
    v_exp_f32 v30, v30
    v_exp_f32 v31, v31
    v_cvt_pk_bf16_f32 v80, v24, v25
    v_cvt_pk_bf16_f32 v81, v26, v27
    v_cvt_pk_bf16_f32 v82, v28, v29
    v_cvt_pk_bf16_f32 v83, v30, v31
    v_mfma_f32_32x32x16_bf16 v[8:23], v[88:91], v[208:211], v[8:23]
    ds_read_u16 v114, v222 offset:33792
    v_exp_f32 v32, v32
    v_exp_f32 v33, v33
    v_exp_f32 v34, v34
    v_exp_f32 v35, v35
    v_mfma_f32_32x32x16_bf16 v[40:55], v[100:103], v[76:79], v[40:55]
    ds_read_b128 v[104:107], v221 offset:31744
    v_exp_f32 v36, v36
    v_exp_f32 v37, v37
    v_exp_f32 v38, v38
    v_exp_f32 v39, v39
    v_cvt_pk_bf16_f32 v84, v32, v33
    v_cvt_pk_bf16_f32 v85, v34, v35
    v_cvt_pk_bf16_f32 v86, v36, v37
    v_cvt_pk_bf16_f32 v87, v38, v39
    v_mfma_f32_32x32x8bf16_1k v[24:39], v[112:113], v[218:219], 0
    v_exp_f32 v8, v8
    v_exp_f32 v9, v9
    v_exp_f32 v10, v10
    v_exp_f32 v11, v11
    v_mfma_f32_32x32x16_bf16 v[56:71], v[108:111], v[80:83], v[56:71]
    ds_read_b128 v[96:99], v221 offset:32768
    v_exp_f32 v12, v12
    v_exp_f32 v13, v13
    v_exp_f32 v14, v14
    v_exp_f32 v15, v15
    v_cvt_pk_bf16_f32 v72, v8, v9
    v_cvt_pk_bf16_f32 v73, v10, v11
    v_cvt_pk_bf16_f32 v74, v12, v13
    v_cvt_pk_bf16_f32 v75, v14, v15
    v_mfma_f32_32x32x16_bf16 v[24:39], v[88:91], v[212:215], v[24:39]
    ds_read2_b32 v[132:133], v134 offset1:4
    v_exp_f32 v16, v16
    v_exp_f32 v17, v17
    v_exp_f32 v18, v18
    v_exp_f32 v19, v19
    v_mfma_f32_32x32x16_bf16 v[56:71], v[100:103], v[84:87], v[56:71]
    s_waitcnt lgkmcnt(0)
    v_exp_f32 v20, v20
    v_exp_f32 v21, v21
    v_exp_f32 v22, v22
    v_exp_f32 v23, v23
    v_cvt_pk_bf16_f32 v76, v16, v17
    v_cvt_pk_bf16_f32 v77, v18, v19
    v_cvt_pk_bf16_f32 v78, v20, v21
    v_cvt_pk_bf16_f32 v79, v22, v23
    v_mfma_f32_32x32x8bf16_1k v[8:23], v[114:115], v[216:217], 0
    v_exp_f32 v24, v24
    v_exp_f32 v25, v25
    v_exp_f32 v26, v26
    v_exp_f32 v27, v27
    v_mfma_f32_32x32x16_bf16 v[40:55], v[104:107], v[72:75], v[40:55]
    buffer_store_dwordx4 v[184:187], v248, s[4:7], s61 offen offset:2048 sc1
    v_cmp_gt_u32 vcc, 1, v133
    s_cbranch_vccz ATT_c8_ok
ATT_c8_spin:
    ds_read2_b32 v[132:133], v134 offset1:4
    s_waitcnt lgkmcnt(0)
    v_cmp_gt_u32 vcc, 1, v133
    s_cbranch_vccnz ATT_c8_spin
ATT_c8_ok:
    ds_read_b128 v[88:91], v220 offset:36864
    v_exp_f32 v28, v28
    v_exp_f32 v29, v29
    v_exp_f32 v30, v30
    v_exp_f32 v31, v31
    v_cvt_pk_bf16_f32 v80, v24, v25
    v_cvt_pk_bf16_f32 v81, v26, v27
    v_cvt_pk_bf16_f32 v82, v28, v29
    v_cvt_pk_bf16_f32 v83, v30, v31
    v_mfma_f32_32x32x16_bf16 v[8:23], v[92:95], v[208:211], v[8:23]
    ds_read_u16 v112, v222 offset:36864
    v_exp_f32 v32, v32
    v_exp_f32 v33, v33
    v_exp_f32 v34, v34
    v_exp_f32 v35, v35
    v_mfma_f32_32x32x16_bf16 v[40:55], v[96:99], v[76:79], v[40:55]
    ds_read_b128 v[108:111], v221 offset:34816
    v_exp_f32 v36, v36
    v_exp_f32 v37, v37
    v_exp_f32 v38, v38
    v_exp_f32 v39, v39
    v_cvt_pk_bf16_f32 v84, v32, v33
    v_cvt_pk_bf16_f32 v85, v34, v35
    v_cvt_pk_bf16_f32 v86, v36, v37
    v_cvt_pk_bf16_f32 v87, v38, v39
    v_mfma_f32_32x32x8bf16_1k v[24:39], v[114:115], v[218:219], 0
    v_exp_f32 v8, v8
    v_exp_f32 v9, v9
    v_exp_f32 v10, v10
    v_exp_f32 v11, v11
    v_mfma_f32_32x32x16_bf16 v[56:71], v[104:107], v[80:83], v[56:71]
    ds_read_b128 v[100:103], v221 offset:35840
    v_exp_f32 v12, v12
    v_exp_f32 v13, v13
    v_exp_f32 v14, v14
    v_exp_f32 v15, v15
    v_cvt_pk_bf16_f32 v72, v8, v9
    v_cvt_pk_bf16_f32 v73, v10, v11
    v_cvt_pk_bf16_f32 v74, v12, v13
    v_cvt_pk_bf16_f32 v75, v14, v15
    v_mfma_f32_32x32x16_bf16 v[24:39], v[92:95], v[212:215], v[24:39]
    v_exp_f32 v16, v16
    v_exp_f32 v17, v17
    v_exp_f32 v18, v18
    v_exp_f32 v19, v19
    v_mfma_f32_32x32x16_bf16 v[56:71], v[96:99], v[84:87], v[56:71]
    s_waitcnt lgkmcnt(0)
    v_exp_f32 v20, v20
    v_exp_f32 v21, v21
    v_exp_f32 v22, v22
    v_exp_f32 v23, v23
    v_cvt_pk_bf16_f32 v76, v16, v17
    v_cvt_pk_bf16_f32 v77, v18, v19
    v_cvt_pk_bf16_f32 v78, v20, v21
    v_cvt_pk_bf16_f32 v79, v22, v23
    v_mfma_f32_32x32x8bf16_1k v[8:23], v[112:113], v[216:217], 0
    v_exp_f32 v24, v24
    v_exp_f32 v25, v25
    v_exp_f32 v26, v26
    v_exp_f32 v27, v27
    v_mfma_f32_32x32x16_bf16 v[40:55], v[108:111], v[72:75], v[40:55]
    s_mov_b64 exec, 1
    ds_add_u32 v135, v136
    s_mov_b64 exec, -1
    ds_read_b128 v[92:95], v220 offset:39936
    v_exp_f32 v28, v28
    v_exp_f32 v29, v29
    v_exp_f32 v30, v30
    v_exp_f32 v31, v31
    v_cvt_pk_bf16_f32 v80, v24, v25
    v_cvt_pk_bf16_f32 v81, v26, v27
    v_cvt_pk_bf16_f32 v82, v28, v29
    v_cvt_pk_bf16_f32 v83, v30, v31
    v_mfma_f32_32x32x16_bf16 v[8:23], v[88:91], v[208:211], v[8:23]
    ds_read_u16 v114, v222 offset:39936
    v_exp_f32 v32, v32
    v_exp_f32 v33, v33
    v_exp_f32 v34, v34
    v_exp_f32 v35, v35
    v_mfma_f32_32x32x16_bf16 v[40:55], v[100:103], v[76:79], v[40:55]
    ds_read_b128 v[104:107], v221 offset:37888
    v_exp_f32 v36, v36
    v_exp_f32 v37, v37
    v_exp_f32 v38, v38
    v_exp_f32 v39, v39
    v_cvt_pk_bf16_f32 v84, v32, v33
    v_cvt_pk_bf16_f32 v85, v34, v35
    v_cvt_pk_bf16_f32 v86, v36, v37
    v_cvt_pk_bf16_f32 v87, v38, v39
    v_mfma_f32_32x32x8bf16_1k v[24:39], v[112:113], v[218:219], 0
    v_exp_f32 v8, v8
    v_exp_f32 v9, v9
    v_exp_f32 v10, v10
    v_exp_f32 v11, v11
    v_mfma_f32_32x32x16_bf16 v[56:71], v[108:111], v[80:83], v[56:71]
    ds_read_b128 v[96:99], v221 offset:38912
    v_exp_f32 v12, v12
    v_exp_f32 v13, v13
    v_exp_f32 v14, v14
    v_exp_f32 v15, v15
    v_cvt_pk_bf16_f32 v72, v8, v9
    v_cvt_pk_bf16_f32 v73, v10, v11
    v_cvt_pk_bf16_f32 v74, v12, v13
    v_cvt_pk_bf16_f32 v75, v14, v15
    v_mfma_f32_32x32x16_bf16 v[24:39], v[88:91], v[212:215], v[24:39]
    v_exp_f32 v16, v16
    v_exp_f32 v17, v17
    v_exp_f32 v18, v18
    v_exp_f32 v19, v19
    v_mfma_f32_32x32x16_bf16 v[56:71], v[100:103], v[84:87], v[56:71]
    s_waitcnt lgkmcnt(0)
    v_exp_f32 v20, v20
    v_exp_f32 v21, v21
    v_exp_f32 v22, v22
    v_exp_f32 v23, v23
    v_cvt_pk_bf16_f32 v76, v16, v17
    v_cvt_pk_bf16_f32 v77, v18, v19
    v_cvt_pk_bf16_f32 v78, v20, v21
    v_cvt_pk_bf16_f32 v79, v22, v23
    v_mfma_f32_32x32x8bf16_1k v[8:23], v[114:115], v[216:217], 0
    v_exp_f32 v24, v24
    v_exp_f32 v25, v25
    v_exp_f32 v26, v26
    v_exp_f32 v27, v27
    v_mfma_f32_32x32x16_bf16 v[40:55], v[104:107], v[72:75], v[40:55]
    ds_read_b128 v[88:91], v220 offset:43008
    v_exp_f32 v28, v28
    v_exp_f32 v29, v29
    v_exp_f32 v30, v30
    v_exp_f32 v31, v31
    v_cvt_pk_bf16_f32 v80, v24, v25
    v_cvt_pk_bf16_f32 v81, v26, v27
    v_cvt_pk_bf16_f32 v82, v28, v29
    v_cvt_pk_bf16_f32 v83, v30, v31
    v_mfma_f32_32x32x16_bf16 v[8:23], v[92:95], v[208:211], v[8:23]
    ds_read_u16 v112, v222 offset:43008
    v_exp_f32 v32, v32
    v_exp_f32 v33, v33
    v_exp_f32 v34, v34
    v_exp_f32 v35, v35
    v_mfma_f32_32x32x16_bf16 v[40:55], v[96:99], v[76:79], v[40:55]
    ds_read_b128 v[108:111], v221 offset:40960
    v_exp_f32 v36, v36
    v_exp_f32 v37, v37
    v_exp_f32 v38, v38
    v_exp_f32 v39, v39
    v_cvt_pk_bf16_f32 v84, v32, v33
    v_cvt_pk_bf16_f32 v85, v34, v35
    v_cvt_pk_bf16_f32 v86, v36, v37
    v_cvt_pk_bf16_f32 v87, v38, v39
    v_mfma_f32_32x32x8bf16_1k v[24:39], v[114:115], v[218:219], 0
    v_exp_f32 v8, v8
    v_exp_f32 v9, v9
    v_exp_f32 v10, v10
    v_exp_f32 v11, v11
    v_mfma_f32_32x32x16_bf16 v[56:71], v[104:107], v[80:83], v[56:71]
    ds_read_b128 v[100:103], v221 offset:41984
    v_exp_f32 v12, v12
    v_exp_f32 v13, v13
    v_exp_f32 v14, v14
    v_exp_f32 v15, v15
    v_cvt_pk_bf16_f32 v72, v8, v9
    v_cvt_pk_bf16_f32 v73, v10, v11
    v_cvt_pk_bf16_f32 v74, v12, v13
    v_cvt_pk_bf16_f32 v75, v14, v15
    v_mfma_f32_32x32x16_bf16 v[24:39], v[92:95], v[212:215], v[24:39]
    v_exp_f32 v16, v16
    v_exp_f32 v17, v17
    v_exp_f32 v18, v18
    v_exp_f32 v19, v19
    v_mfma_f32_32x32x16_bf16 v[56:71], v[96:99], v[84:87], v[56:71]
    s_waitcnt lgkmcnt(0)
    v_exp_f32 v20, v20
    v_exp_f32 v21, v21
    v_exp_f32 v22, v22
    v_exp_f32 v23, v23
    v_cvt_pk_bf16_f32 v76, v16, v17
    v_cvt_pk_bf16_f32 v77, v18, v19
    v_cvt_pk_bf16_f32 v78, v20, v21
    v_cvt_pk_bf16_f32 v79, v22, v23
    v_mfma_f32_32x32x8bf16_1k v[8:23], v[112:113], v[216:217], 0
    v_exp_f32 v24, v24
    v_exp_f32 v25, v25
    v_exp_f32 v26, v26
    v_exp_f32 v27, v27
    v_mfma_f32_32x32x16_bf16 v[40:55], v[108:111], v[72:75], v[40:55]
    buffer_store_dwordx4 v[188:191], v248, s[4:7], s61 offen offset:3072 sc1
    ds_read_b128 v[92:95], v220 offset:46080
    v_exp_f32 v28, v28
    v_exp_f32 v29, v29
    v_exp_f32 v30, v30
    v_exp_f32 v31, v31
    v_cvt_pk_bf16_f32 v80, v24, v25
    v_cvt_pk_bf16_f32 v81, v26, v27
    v_cvt_pk_bf16_f32 v82, v28, v29
    v_cvt_pk_bf16_f32 v83, v30, v31
    v_mfma_f32_32x32x16_bf16 v[8:23], v[88:91], v[208:211], v[8:23]
    ds_read_u16 v114, v222 offset:46080
    v_exp_f32 v32, v32
    v_exp_f32 v33, v33
    v_exp_f32 v34, v34
    v_exp_f32 v35, v35
    v_mfma_f32_32x32x16_bf16 v[40:55], v[100:103], v[76:79], v[40:55]
    ds_read_b128 v[104:107], v221 offset:44032
    v_exp_f32 v36, v36
    v_exp_f32 v37, v37
    v_exp_f32 v38, v38
    v_exp_f32 v39, v39
    v_cvt_pk_bf16_f32 v84, v32, v33
    v_cvt_pk_bf16_f32 v85, v34, v35
    v_cvt_pk_bf16_f32 v86, v36, v37
    v_cvt_pk_bf16_f32 v87, v38, v39
    v_mfma_f32_32x32x8bf16_1k v[24:39], v[112:113], v[218:219], 0
    v_exp_f32 v8, v8
    v_exp_f32 v9, v9
    v_exp_f32 v10, v10
    v_exp_f32 v11, v11
    v_mfma_f32_32x32x16_bf16 v[56:71], v[108:111], v[80:83], v[56:71]
    ds_read_b128 v[96:99], v221 offset:45056
    v_exp_f32 v12, v12
    v_exp_f32 v13, v13
    v_exp_f32 v14, v14
    v_exp_f32 v15, v15
    v_cvt_pk_bf16_f32 v72, v8, v9
    v_cvt_pk_bf16_f32 v73, v10, v11
    v_cvt_pk_bf16_f32 v74, v12, v13
    v_cvt_pk_bf16_f32 v75, v14, v15
    v_mfma_f32_32x32x16_bf16 v[24:39], v[88:91], v[212:215], v[24:39]
    ds_read2_b32 v[132:133], v134 offset1:4
    v_exp_f32 v16, v16
    v_exp_f32 v17, v17
    v_exp_f32 v18, v18
    v_exp_f32 v19, v19
    v_mfma_f32_32x32x16_bf16 v[56:71], v[100:103], v[84:87], v[56:71]
    s_waitcnt lgkmcnt(0)
    v_exp_f32 v20, v20
    v_exp_f32 v21, v21
    v_exp_f32 v22, v22
    v_exp_f32 v23, v23
    v_cvt_pk_bf16_f32 v76, v16, v17
    v_cvt_pk_bf16_f32 v77, v18, v19
    v_cvt_pk_bf16_f32 v78, v20, v21
    v_cvt_pk_bf16_f32 v79, v22, v23
    v_mfma_f32_32x32x8bf16_1k v[8:23], v[114:115], v[216:217], 0
    v_exp_f32 v24, v24
    v_exp_f32 v25, v25
    v_exp_f32 v26, v26
    v_exp_f32 v27, v27
    v_mfma_f32_32x32x16_bf16 v[40:55], v[104:107], v[72:75], v[40:55]
    v_cmp_gt_u32 vcc, 1, v133
    s_cbranch_vccz ATT_c12_ok
ATT_c12_spin:
    ds_read2_b32 v[132:133], v134 offset1:4
    s_waitcnt lgkmcnt(0)
    v_cmp_gt_u32 vcc, 1, v133
    s_cbranch_vccnz ATT_c12_spin
ATT_c12_ok:
    ds_read_b128 v[88:91], v220 offset:49152
    v_exp_f32 v28, v28
    v_exp_f32 v29, v29
    v_exp_f32 v30, v30
    v_exp_f32 v31, v31
    v_cvt_pk_bf16_f32 v80, v24, v25
    v_cvt_pk_bf16_f32 v81, v26, v27
    v_cvt_pk_bf16_f32 v82, v28, v29
    v_cvt_pk_bf16_f32 v83, v30, v31
    v_mfma_f32_32x32x16_bf16 v[8:23], v[92:95], v[208:211], v[8:23]
    ds_read_u16 v112, v222 offset:49152
    v_exp_f32 v32, v32
    v_exp_f32 v33, v33
    v_exp_f32 v34, v34
    v_exp_f32 v35, v35
    v_mfma_f32_32x32x16_bf16 v[40:55], v[96:99], v[76:79], v[40:55]
    ds_read_b128 v[108:111], v221 offset:47104
    v_exp_f32 v36, v36
    v_exp_f32 v37, v37
    v_exp_f32 v38, v38
    v_exp_f32 v39, v39
    v_cvt_pk_bf16_f32 v84, v32, v33
    v_cvt_pk_bf16_f32 v85, v34, v35
    v_cvt_pk_bf16_f32 v86, v36, v37
    v_cvt_pk_bf16_f32 v87, v38, v39
    v_mfma_f32_32x32x8bf16_1k v[24:39], v[114:115], v[218:219], 0
    v_exp_f32 v8, v8
    v_exp_f32 v9, v9
    v_exp_f32 v10, v10
    v_exp_f32 v11, v11
    v_mfma_f32_32x32x16_bf16 v[56:71], v[104:107], v[80:83], v[56:71]
    ds_read_b128 v[100:103], v221 offset:48128
    v_exp_f32 v12, v12
    v_exp_f32 v13, v13
    v_exp_f32 v14, v14
    v_exp_f32 v15, v15
    v_cvt_pk_bf16_f32 v72, v8, v9
    v_cvt_pk_bf16_f32 v73, v10, v11
    v_cvt_pk_bf16_f32 v74, v12, v13
    v_cvt_pk_bf16_f32 v75, v14, v15
    v_mfma_f32_32x32x16_bf16 v[24:39], v[92:95], v[212:215], v[24:39]
    v_exp_f32 v16, v16
    v_exp_f32 v17, v17
    v_exp_f32 v18, v18
    v_exp_f32 v19, v19
    v_mfma_f32_32x32x16_bf16 v[56:71], v[96:99], v[84:87], v[56:71]
    s_waitcnt lgkmcnt(0)
    v_exp_f32 v20, v20
    v_exp_f32 v21, v21
    v_exp_f32 v22, v22
    v_exp_f32 v23, v23
    v_cvt_pk_bf16_f32 v76, v16, v17
    v_cvt_pk_bf16_f32 v77, v18, v19
    v_cvt_pk_bf16_f32 v78, v20, v21
    v_cvt_pk_bf16_f32 v79, v22, v23
    v_mfma_f32_32x32x8bf16_1k v[8:23], v[112:113], v[216:217], 0
    v_exp_f32 v24, v24
    v_exp_f32 v25, v25
    v_exp_f32 v26, v26
    v_exp_f32 v27, v27
    v_mfma_f32_32x32x16_bf16 v[40:55], v[108:111], v[72:75], v[40:55]
    s_mov_b64 exec, 1
    ds_add_u32 v135, v136
    s_mov_b64 exec, -1
    ds_read_b128 v[92:95], v220 offset:52224
    v_exp_f32 v28, v28
    v_exp_f32 v29, v29
    v_exp_f32 v30, v30
    v_exp_f32 v31, v31
    v_cvt_pk_bf16_f32 v80, v24, v25
    v_cvt_pk_bf16_f32 v81, v26, v27
    v_cvt_pk_bf16_f32 v82, v28, v29
    v_cvt_pk_bf16_f32 v83, v30, v31
    v_mfma_f32_32x32x16_bf16 v[8:23], v[88:91], v[208:211], v[8:23]
    ds_read_u16 v114, v222 offset:52224
    v_exp_f32 v32, v32
    v_exp_f32 v33, v33
    v_exp_f32 v34, v34
    v_exp_f32 v35, v35
    v_mfma_f32_32x32x16_bf16 v[40:55], v[100:103], v[76:79], v[40:55]
    ds_read_b128 v[104:107], v221 offset:50176
    v_exp_f32 v36, v36
    v_exp_f32 v37, v37
    v_exp_f32 v38, v38
    v_exp_f32 v39, v39
    v_cvt_pk_bf16_f32 v84, v32, v33
    v_cvt_pk_bf16_f32 v85, v34, v35
    v_cvt_pk_bf16_f32 v86, v36, v37
    v_cvt_pk_bf16_f32 v87, v38, v39
    v_mfma_f32_32x32x8bf16_1k v[24:39], v[112:113], v[218:219], 0
    v_exp_f32 v8, v8
    v_exp_f32 v9, v9
    v_exp_f32 v10, v10
    v_exp_f32 v11, v11
    v_mfma_f32_32x32x16_bf16 v[56:71], v[108:111], v[80:83], v[56:71]
    ds_read_b128 v[96:99], v221 offset:51200
    v_exp_f32 v12, v12
    v_exp_f32 v13, v13
    v_exp_f32 v14, v14
    v_exp_f32 v15, v15
    v_cvt_pk_bf16_f32 v72, v8, v9
    v_cvt_pk_bf16_f32 v73, v10, v11
    v_cvt_pk_bf16_f32 v74, v12, v13
    v_cvt_pk_bf16_f32 v75, v14, v15
    v_mfma_f32_32x32x16_bf16 v[24:39], v[88:91], v[212:215], v[24:39]
    v_exp_f32 v16, v16
    v_exp_f32 v17, v17
    v_exp_f32 v18, v18
    v_exp_f32 v19, v19
    v_mfma_f32_32x32x16_bf16 v[56:71], v[100:103], v[84:87], v[56:71]
    s_waitcnt lgkmcnt(0)
    v_exp_f32 v20, v20
    v_exp_f32 v21, v21
    v_exp_f32 v22, v22
    v_exp_f32 v23, v23
    v_cvt_pk_bf16_f32 v76, v16, v17
    v_cvt_pk_bf16_f32 v77, v18, v19
    v_cvt_pk_bf16_f32 v78, v20, v21
    v_cvt_pk_bf16_f32 v79, v22, v23
    v_mfma_f32_32x32x8bf16_1k v[8:23], v[114:115], v[216:217], 0
    v_exp_f32 v24, v24
    v_exp_f32 v25, v25
    v_exp_f32 v26, v26
    v_exp_f32 v27, v27
    v_mfma_f32_32x32x16_bf16 v[40:55], v[104:107], v[72:75], v[40:55]
    ds_read_b128 v[88:91], v220 offset:55296
    v_exp_f32 v28, v28
    v_exp_f32 v29, v29
    v_exp_f32 v30, v30
    v_exp_f32 v31, v31
    v_cvt_pk_bf16_f32 v80, v24, v25
    v_cvt_pk_bf16_f32 v81, v26, v27
    v_cvt_pk_bf16_f32 v82, v28, v29
    v_cvt_pk_bf16_f32 v83, v30, v31
    v_mfma_f32_32x32x16_bf16 v[8:23], v[92:95], v[208:211], v[8:23]
    ds_read_u16 v112, v222 offset:55296
    v_exp_f32 v32, v32
    v_exp_f32 v33, v33
    v_exp_f32 v34, v34
    v_exp_f32 v35, v35
    v_mfma_f32_32x32x16_bf16 v[40:55], v[96:99], v[76:79], v[40:55]
    ds_read_b128 v[108:111], v221 offset:53248
    v_exp_f32 v36, v36
    v_exp_f32 v37, v37
    v_exp_f32 v38, v38
    v_exp_f32 v39, v39
    v_cvt_pk_bf16_f32 v84, v32, v33
    v_cvt_pk_bf16_f32 v85, v34, v35
    v_cvt_pk_bf16_f32 v86, v36, v37
    v_cvt_pk_bf16_f32 v87, v38, v39
    v_mfma_f32_32x32x8bf16_1k v[24:39], v[114:115], v[218:219], 0
    v_exp_f32 v8, v8
    v_exp_f32 v9, v9
    v_exp_f32 v10, v10
    v_exp_f32 v11, v11
    v_mfma_f32_32x32x16_bf16 v[56:71], v[104:107], v[80:83], v[56:71]
    ds_read_b128 v[100:103], v221 offset:54272
    v_exp_f32 v12, v12
    v_exp_f32 v13, v13
    v_exp_f32 v14, v14
    v_exp_f32 v15, v15
    v_cvt_pk_bf16_f32 v72, v8, v9
    v_cvt_pk_bf16_f32 v73, v10, v11
    v_cvt_pk_bf16_f32 v74, v12, v13
    v_cvt_pk_bf16_f32 v75, v14, v15
    v_mfma_f32_32x32x16_bf16 v[24:39], v[92:95], v[212:215], v[24:39]
    v_exp_f32 v16, v16
    v_exp_f32 v17, v17
    v_exp_f32 v18, v18
    v_exp_f32 v19, v19
    v_mfma_f32_32x32x16_bf16 v[56:71], v[96:99], v[84:87], v[56:71]
    s_waitcnt lgkmcnt(0)
    v_exp_f32 v20, v20
    v_exp_f32 v21, v21
    v_exp_f32 v22, v22
    v_exp_f32 v23, v23
    v_cvt_pk_bf16_f32 v76, v16, v17
    v_cvt_pk_bf16_f32 v77, v18, v19
    v_cvt_pk_bf16_f32 v78, v20, v21
    v_cvt_pk_bf16_f32 v79, v22, v23
    v_mfma_f32_32x32x8bf16_1k v[8:23], v[112:113], v[216:217], 0
    v_exp_f32 v24, v24
    v_exp_f32 v25, v25
    v_exp_f32 v26, v26
    v_exp_f32 v27, v27
    v_mfma_f32_32x32x16_bf16 v[40:55], v[108:111], v[72:75], v[40:55]
    ds_read_b128 v[92:95], v220 offset:58368
    v_exp_f32 v28, v28
    v_exp_f32 v29, v29
    v_exp_f32 v30, v30
    v_exp_f32 v31, v31
    v_cvt_pk_bf16_f32 v80, v24, v25
    v_cvt_pk_bf16_f32 v81, v26, v27
    v_cvt_pk_bf16_f32 v82, v28, v29
    v_cvt_pk_bf16_f32 v83, v30, v31
    v_mfma_f32_32x32x16_bf16 v[8:23], v[88:91], v[208:211], v[8:23]
    ds_read_u16 v114, v222 offset:58368
    v_exp_f32 v32, v32
    v_exp_f32 v33, v33
    v_exp_f32 v34, v34
    v_exp_f32 v35, v35
    v_mfma_f32_32x32x16_bf16 v[40:55], v[100:103], v[76:79], v[40:55]
    ds_read_b128 v[104:107], v221 offset:56320
    v_exp_f32 v36, v36
    v_exp_f32 v37, v37
    v_exp_f32 v38, v38
    v_exp_f32 v39, v39
    v_cvt_pk_bf16_f32 v84, v32, v33
    v_cvt_pk_bf16_f32 v85, v34, v35
    v_cvt_pk_bf16_f32 v86, v36, v37
    v_cvt_pk_bf16_f32 v87, v38, v39
    v_mfma_f32_32x32x8bf16_1k v[24:39], v[112:113], v[218:219], 0
    v_exp_f32 v8, v8
    v_exp_f32 v9, v9
    v_exp_f32 v10, v10
    v_exp_f32 v11, v11
    v_mfma_f32_32x32x16_bf16 v[56:71], v[108:111], v[80:83], v[56:71]
    ds_read_b128 v[96:99], v221 offset:57344
    v_exp_f32 v12, v12
    v_exp_f32 v13, v13
    v_exp_f32 v14, v14
    v_exp_f32 v15, v15
    v_cvt_pk_bf16_f32 v72, v8, v9
    v_cvt_pk_bf16_f32 v73, v10, v11
    v_cvt_pk_bf16_f32 v74, v12, v13
    v_cvt_pk_bf16_f32 v75, v14, v15
    v_mfma_f32_32x32x16_bf16 v[24:39], v[88:91], v[212:215], v[24:39]
    ds_read2_b32 v[132:133], v134 offset1:4
    v_exp_f32 v16, v16
    v_exp_f32 v17, v17
    v_exp_f32 v18, v18
    v_exp_f32 v19, v19
    v_mfma_f32_32x32x16_bf16 v[56:71], v[100:103], v[84:87], v[56:71]
    s_waitcnt lgkmcnt(0)
    v_exp_f32 v20, v20
    v_exp_f32 v21, v21
    v_exp_f32 v22, v22
    v_exp_f32 v23, v23
    v_cvt_pk_bf16_f32 v76, v16, v17
    v_cvt_pk_bf16_f32 v77, v18, v19
    v_cvt_pk_bf16_f32 v78, v20, v21
    v_cvt_pk_bf16_f32 v79, v22, v23
    v_mfma_f32_32x32x8bf16_1k v[8:23], v[114:115], v[216:217], 0
    v_exp_f32 v24, v24
    v_exp_f32 v25, v25
    v_exp_f32 v26, v26
    v_exp_f32 v27, v27
    v_mfma_f32_32x32x16_bf16 v[40:55], v[104:107], v[72:75], v[40:55]
    v_cmp_gt_u32 vcc, 3, v133
    s_cbranch_vccz ATT_c16_ok
ATT_c16_spin:
    ds_read2_b32 v[132:133], v134 offset1:4
    s_waitcnt lgkmcnt(0)
    v_cmp_gt_u32 vcc, 3, v133
    s_cbranch_vccnz ATT_c16_spin
ATT_c16_ok:
    ds_read_b128 v[88:91], v220 offset:0
    v_exp_f32 v28, v28
    v_exp_f32 v29, v29
    v_exp_f32 v30, v30
    v_exp_f32 v31, v31
    v_cvt_pk_bf16_f32 v80, v24, v25
    v_cvt_pk_bf16_f32 v81, v26, v27
    v_cvt_pk_bf16_f32 v82, v28, v29
    v_cvt_pk_bf16_f32 v83, v30, v31
    v_mfma_f32_32x32x16_bf16 v[8:23], v[92:95], v[208:211], v[8:23]
    ds_read_u16 v112, v222 offset:0
    v_exp_f32 v32, v32
    v_exp_f32 v33, v33
    v_exp_f32 v34, v34
    v_exp_f32 v35, v35
    v_mfma_f32_32x32x16_bf16 v[40:55], v[96:99], v[76:79], v[40:55]
    ds_read_b128 v[108:111], v221 offset:59392
    v_exp_f32 v36, v36
    v_exp_f32 v37, v37
    v_exp_f32 v38, v38
    v_exp_f32 v39, v39
    v_cvt_pk_bf16_f32 v84, v32, v33
    v_cvt_pk_bf16_f32 v85, v34, v35
    v_cvt_pk_bf16_f32 v86, v36, v37
    v_cvt_pk_bf16_f32 v87, v38, v39
    v_mfma_f32_32x32x8bf16_1k v[24:39], v[114:115], v[218:219], 0
    v_exp_f32 v8, v8
    v_exp_f32 v9, v9
    v_exp_f32 v10, v10
    v_exp_f32 v11, v11
    v_mfma_f32_32x32x16_bf16 v[56:71], v[104:107], v[80:83], v[56:71]
    ds_read_b128 v[100:103], v221 offset:60416
    v_exp_f32 v12, v12
    v_exp_f32 v13, v13
    v_exp_f32 v14, v14
    v_exp_f32 v15, v15
    v_cvt_pk_bf16_f32 v72, v8, v9
    v_cvt_pk_bf16_f32 v73, v10, v11
    v_cvt_pk_bf16_f32 v74, v12, v13
    v_cvt_pk_bf16_f32 v75, v14, v15
    v_mfma_f32_32x32x16_bf16 v[24:39], v[92:95], v[212:215], v[24:39]
    v_exp_f32 v16, v16
    v_exp_f32 v17, v17
    v_exp_f32 v18, v18
    v_exp_f32 v19, v19
    v_mfma_f32_32x32x16_bf16 v[56:71], v[96:99], v[84:87], v[56:71]
    s_waitcnt lgkmcnt(0)
    v_exp_f32 v20, v20
    v_exp_f32 v21, v21
    v_exp_f32 v22, v22
    v_exp_f32 v23, v23
    v_cvt_pk_bf16_f32 v76, v16, v17
    v_cvt_pk_bf16_f32 v77, v18, v19
    v_cvt_pk_bf16_f32 v78, v20, v21
    v_cvt_pk_bf16_f32 v79, v22, v23
    v_mfma_f32_32x32x8bf16_1k v[8:23], v[112:113], v[216:217], 0
    v_exp_f32 v24, v24
    v_exp_f32 v25, v25
    v_exp_f32 v26, v26
    v_exp_f32 v27, v27
    v_mfma_f32_32x32x16_bf16 v[40:55], v[108:111], v[72:75], v[40:55]
    s_waitcnt vmcnt(0)
    s_mov_b64 exec, 1
    ds_add_u32 v135, v136
    s_mov_b64 exec, -1
    ds_read_b128 v[92:95], v220 offset:3072
    v_exp_f32 v28, v28
    v_exp_f32 v29, v29
    v_exp_f32 v30, v30
    v_exp_f32 v31, v31
    v_cvt_pk_bf16_f32 v80, v24, v25
    v_cvt_pk_bf16_f32 v81, v26, v27
    v_cvt_pk_bf16_f32 v82, v28, v29
    v_cvt_pk_bf16_f32 v83, v30, v31
    v_mfma_f32_32x32x16_bf16 v[8:23], v[88:91], v[208:211], v[8:23]
    ds_read_u16 v114, v222 offset:3072
    v_exp_f32 v32, v32
    v_exp_f32 v33, v33
    v_exp_f32 v34, v34
    v_exp_f32 v35, v35
    v_mfma_f32_32x32x16_bf16 v[40:55], v[100:103], v[76:79], v[40:55]
    ds_read_b128 v[104:107], v221 offset:1024
    v_exp_f32 v36, v36
    v_exp_f32 v37, v37
    v_exp_f32 v38, v38
    v_exp_f32 v39, v39
    v_cvt_pk_bf16_f32 v84, v32, v33
    v_cvt_pk_bf16_f32 v85, v34, v35
    v_cvt_pk_bf16_f32 v86, v36, v37
    v_cvt_pk_bf16_f32 v87, v38, v39
    v_mfma_f32_32x32x8bf16_1k v[24:39], v[112:113], v[218:219], 0
    v_exp_f32 v8, v8
    v_exp_f32 v9, v9
    v_exp_f32 v10, v10
    v_exp_f32 v11, v11
    v_mfma_f32_32x32x16_bf16 v[56:71], v[108:111], v[80:83], v[56:71]
    ds_read_b128 v[96:99], v221 offset:2048
    v_exp_f32 v12, v12
    v_exp_f32 v13, v13
    v_exp_f32 v14, v14
    v_exp_f32 v15, v15
    v_cvt_pk_bf16_f32 v72, v8, v9
    v_cvt_pk_bf16_f32 v73, v10, v11
    v_cvt_pk_bf16_f32 v74, v12, v13
    v_cvt_pk_bf16_f32 v75, v14, v15
    v_mfma_f32_32x32x16_bf16 v[24:39], v[88:91], v[212:215], v[24:39]
    v_exp_f32 v16, v16
    v_exp_f32 v17, v17
    v_exp_f32 v18, v18
    v_exp_f32 v19, v19
    v_mfma_f32_32x32x16_bf16 v[56:71], v[100:103], v[84:87], v[56:71]
    s_waitcnt lgkmcnt(0)
    v_exp_f32 v20, v20
    v_exp_f32 v21, v21
    v_exp_f32 v22, v22
    v_exp_f32 v23, v23
    v_cvt_pk_bf16_f32 v76, v16, v17
    v_cvt_pk_bf16_f32 v77, v18, v19
    v_cvt_pk_bf16_f32 v78, v20, v21
    v_cvt_pk_bf16_f32 v79, v22, v23
    v_mfma_f32_32x32x8bf16_1k v[8:23], v[114:115], v[216:217], 0
    v_exp_f32 v24, v24
    v_exp_f32 v25, v25
    v_exp_f32 v26, v26
    v_exp_f32 v27, v27
    v_mfma_f32_32x32x16_bf16 v[40:55], v[104:107], v[72:75], v[40:55]
    ds_read_b128 v[88:91], v220 offset:6144
    v_exp_f32 v28, v28
    v_exp_f32 v29, v29
    v_exp_f32 v30, v30
    v_exp_f32 v31, v31
    v_cvt_pk_bf16_f32 v80, v24, v25
    v_cvt_pk_bf16_f32 v81, v26, v27
    v_cvt_pk_bf16_f32 v82, v28, v29
    v_cvt_pk_bf16_f32 v83, v30, v31
    v_mfma_f32_32x32x16_bf16 v[8:23], v[92:95], v[208:211], v[8:23]
    ds_read_u16 v112, v222 offset:6144
    v_exp_f32 v32, v32
    v_exp_f32 v33, v33
    v_exp_f32 v34, v34
    v_exp_f32 v35, v35
    v_mfma_f32_32x32x16_bf16 v[40:55], v[96:99], v[76:79], v[40:55]
    ds_read_b128 v[108:111], v221 offset:4096
    v_exp_f32 v36, v36
    v_exp_f32 v37, v37
    v_exp_f32 v38, v38
    v_exp_f32 v39, v39
    v_cvt_pk_bf16_f32 v84, v32, v33
    v_cvt_pk_bf16_f32 v85, v34, v35
    v_cvt_pk_bf16_f32 v86, v36, v37
    v_cvt_pk_bf16_f32 v87, v38, v39
    v_mfma_f32_32x32x8bf16_1k v[24:39], v[114:115], v[218:219], 0
    v_exp_f32 v8, v8
    v_exp_f32 v9, v9
    v_exp_f32 v10, v10
    v_exp_f32 v11, v11
    v_mfma_f32_32x32x16_bf16 v[56:71], v[104:107], v[80:83], v[56:71]
    ds_read_b128 v[100:103], v221 offset:5120
    v_exp_f32 v12, v12
    v_exp_f32 v13, v13
    v_exp_f32 v14, v14
    v_exp_f32 v15, v15
    v_cvt_pk_bf16_f32 v72, v8, v9
    v_cvt_pk_bf16_f32 v73, v10, v11
    v_cvt_pk_bf16_f32 v74, v12, v13
    v_cvt_pk_bf16_f32 v75, v14, v15
    v_mfma_f32_32x32x16_bf16 v[24:39], v[92:95], v[212:215], v[24:39]
    v_exp_f32 v16, v16
    v_exp_f32 v17, v17
    v_exp_f32 v18, v18
    v_exp_f32 v19, v19
    v_mfma_f32_32x32x16_bf16 v[56:71], v[96:99], v[84:87], v[56:71]
    s_waitcnt lgkmcnt(0)
    v_exp_f32 v20, v20
    v_exp_f32 v21, v21
    v_exp_f32 v22, v22
    v_exp_f32 v23, v23
    v_cvt_pk_bf16_f32 v76, v16, v17
    v_cvt_pk_bf16_f32 v77, v18, v19
    v_cvt_pk_bf16_f32 v78, v20, v21
    v_cvt_pk_bf16_f32 v79, v22, v23
    v_mfma_f32_32x32x8bf16_1k v[8:23], v[112:113], v[216:217], 0
    v_exp_f32 v24, v24
    v_exp_f32 v25, v25
    v_exp_f32 v26, v26
    v_exp_f32 v27, v27
    v_mfma_f32_32x32x16_bf16 v[40:55], v[108:111], v[72:75], v[40:55]
    ds_read_b128 v[92:95], v220 offset:9216
    v_exp_f32 v28, v28
    v_exp_f32 v29, v29
    v_exp_f32 v30, v30
    v_exp_f32 v31, v31
    v_cvt_pk_bf16_f32 v80, v24, v25
    v_cvt_pk_bf16_f32 v81, v26, v27
    v_cvt_pk_bf16_f32 v82, v28, v29
    v_cvt_pk_bf16_f32 v83, v30, v31
    v_mfma_f32_32x32x16_bf16 v[8:23], v[88:91], v[208:211], v[8:23]
    ds_read_u16 v114, v222 offset:9216
    v_exp_f32 v32, v32
    v_exp_f32 v33, v33
    v_exp_f32 v34, v34
    v_exp_f32 v35, v35
    v_mfma_f32_32x32x16_bf16 v[40:55], v[100:103], v[76:79], v[40:55]
    ds_read_b128 v[104:107], v221 offset:7168
    v_exp_f32 v36, v36
    v_exp_f32 v37, v37
    v_exp_f32 v38, v38
    v_exp_f32 v39, v39
    v_cvt_pk_bf16_f32 v84, v32, v33
    v_cvt_pk_bf16_f32 v85, v34, v35
    v_cvt_pk_bf16_f32 v86, v36, v37
    v_cvt_pk_bf16_f32 v87, v38, v39
    v_mfma_f32_32x32x8bf16_1k v[24:39], v[112:113], v[218:219], 0
    v_exp_f32 v8, v8
    v_exp_f32 v9, v9
    v_exp_f32 v10, v10
    v_exp_f32 v11, v11
    v_mfma_f32_32x32x16_bf16 v[56:71], v[108:111], v[80:83], v[56:71]
    ds_read_b128 v[96:99], v221 offset:8192
    v_exp_f32 v12, v12
    v_exp_f32 v13, v13
    v_exp_f32 v14, v14
    v_exp_f32 v15, v15
    v_cvt_pk_bf16_f32 v72, v8, v9
    v_cvt_pk_bf16_f32 v73, v10, v11
    v_cvt_pk_bf16_f32 v74, v12, v13
    v_cvt_pk_bf16_f32 v75, v14, v15
    v_mfma_f32_32x32x16_bf16 v[24:39], v[88:91], v[212:215], v[24:39]
    ds_read2_b32 v[132:133], v134 offset1:4
    v_exp_f32 v16, v16
    v_exp_f32 v17, v17
    v_exp_f32 v18, v18
    v_exp_f32 v19, v19
    v_mfma_f32_32x32x16_bf16 v[56:71], v[100:103], v[84:87], v[56:71]
    s_waitcnt lgkmcnt(0)
    v_exp_f32 v20, v20
    v_exp_f32 v21, v21
    v_exp_f32 v22, v22
    v_exp_f32 v23, v23
    v_cvt_pk_bf16_f32 v76, v16, v17
    v_cvt_pk_bf16_f32 v77, v18, v19
    v_cvt_pk_bf16_f32 v78, v20, v21
    v_cvt_pk_bf16_f32 v79, v22, v23
    v_mfma_f32_32x32x8bf16_1k v[8:23], v[114:115], v[216:217], 0
    v_exp_f32 v24, v24
    v_exp_f32 v25, v25
    v_exp_f32 v26, v26
    v_exp_f32 v27, v27
    v_mfma_f32_32x32x16_bf16 v[40:55], v[104:107], v[72:75], v[40:55]
    v_cmp_gt_u32 vcc, 5, v133
    s_cbranch_vccz ATT_c20_ok
ATT_c20_spin:
    ds_read2_b32 v[132:133], v134 offset1:4
    s_waitcnt lgkmcnt(0)
    v_cmp_gt_u32 vcc, 5, v133
    s_cbranch_vccnz ATT_c20_spin
ATT_c20_ok:
    ds_read_b128 v[88:91], v220 offset:12288
    v_exp_f32 v28, v28
    v_exp_f32 v29, v29
    v_exp_f32 v30, v30
    v_exp_f32 v31, v31
    v_cvt_pk_bf16_f32 v80, v24, v25
    v_cvt_pk_bf16_f32 v81, v26, v27
    v_cvt_pk_bf16_f32 v82, v28, v29
    v_cvt_pk_bf16_f32 v83, v30, v31
    v_mfma_f32_32x32x16_bf16 v[8:23], v[92:95], v[208:211], v[8:23]
    ds_read_u16 v112, v222 offset:12288
    v_exp_f32 v32, v32
    v_exp_f32 v33, v33
    v_exp_f32 v34, v34
    v_exp_f32 v35, v35
    v_mfma_f32_32x32x16_bf16 v[40:55], v[96:99], v[76:79], v[40:55]
    ds_read_b128 v[108:111], v221 offset:10240
    v_exp_f32 v36, v36
    v_exp_f32 v37, v37
    v_exp_f32 v38, v38
    v_exp_f32 v39, v39
    v_cvt_pk_bf16_f32 v84, v32, v33
    v_cvt_pk_bf16_f32 v85, v34, v35
    v_cvt_pk_bf16_f32 v86, v36, v37
    v_cvt_pk_bf16_f32 v87, v38, v39
    v_mfma_f32_32x32x8bf16_1k v[24:39], v[114:115], v[218:219], 0
    v_exp_f32 v8, v8
    v_exp_f32 v9, v9
    v_exp_f32 v10, v10
    v_exp_f32 v11, v11
    v_mfma_f32_32x32x16_bf16 v[56:71], v[104:107], v[80:83], v[56:71]
    ds_read_b128 v[100:103], v221 offset:11264
    v_exp_f32 v12, v12
    v_exp_f32 v13, v13
    v_exp_f32 v14, v14
    v_exp_f32 v15, v15
    v_cvt_pk_bf16_f32 v72, v8, v9
    v_cvt_pk_bf16_f32 v73, v10, v11
    v_cvt_pk_bf16_f32 v74, v12, v13
    v_cvt_pk_bf16_f32 v75, v14, v15
    v_mfma_f32_32x32x16_bf16 v[24:39], v[92:95], v[212:215], v[24:39]
    v_exp_f32 v16, v16
    v_exp_f32 v17, v17
    v_exp_f32 v18, v18
    v_exp_f32 v19, v19
    v_mfma_f32_32x32x16_bf16 v[56:71], v[96:99], v[84:87], v[56:71]
    s_waitcnt lgkmcnt(0)
    v_exp_f32 v20, v20
    v_exp_f32 v21, v21
    v_exp_f32 v22, v22
    v_exp_f32 v23, v23
    v_cvt_pk_bf16_f32 v76, v16, v17
    v_cvt_pk_bf16_f32 v77, v18, v19
    v_cvt_pk_bf16_f32 v78, v20, v21
    v_cvt_pk_bf16_f32 v79, v22, v23
    v_mfma_f32_32x32x8bf16_1k v[8:23], v[112:113], v[216:217], 0
    v_exp_f32 v24, v24
    v_exp_f32 v25, v25
    v_exp_f32 v26, v26
    v_exp_f32 v27, v27
    v_mfma_f32_32x32x16_bf16 v[40:55], v[108:111], v[72:75], v[40:55]
    s_mov_b64 exec, 1
    ds_add_u32 v135, v136
    s_mov_b64 exec, -1
    ds_read_b128 v[92:95], v220 offset:15360
    v_exp_f32 v28, v28
    v_exp_f32 v29, v29
    v_exp_f32 v30, v30
    v_exp_f32 v31, v31
    v_cvt_pk_bf16_f32 v80, v24, v25
    v_cvt_pk_bf16_f32 v81, v26, v27
    v_cvt_pk_bf16_f32 v82, v28, v29
    v_cvt_pk_bf16_f32 v83, v30, v31
    v_mfma_f32_32x32x16_bf16 v[8:23], v[88:91], v[208:211], v[8:23]
    ds_read_u16 v114, v222 offset:15360
    v_exp_f32 v32, v32
    v_exp_f32 v33, v33
    v_exp_f32 v34, v34
    v_exp_f32 v35, v35
    v_mfma_f32_32x32x16_bf16 v[40:55], v[100:103], v[76:79], v[40:55]
    ds_read_b128 v[104:107], v221 offset:13312
    v_exp_f32 v36, v36
    v_exp_f32 v37, v37
    v_exp_f32 v38, v38
    v_exp_f32 v39, v39
    v_cvt_pk_bf16_f32 v84, v32, v33
    v_cvt_pk_bf16_f32 v85, v34, v35
    v_cvt_pk_bf16_f32 v86, v36, v37
    v_cvt_pk_bf16_f32 v87, v38, v39
    v_mfma_f32_32x32x8bf16_1k v[24:39], v[112:113], v[218:219], 0
    v_exp_f32 v8, v8
    v_exp_f32 v9, v9
    v_exp_f32 v10, v10
    v_exp_f32 v11, v11
    v_mfma_f32_32x32x16_bf16 v[56:71], v[108:111], v[80:83], v[56:71]
    ds_read_b128 v[96:99], v221 offset:14336
    v_exp_f32 v12, v12
    v_exp_f32 v13, v13
    v_exp_f32 v14, v14
    v_exp_f32 v15, v15
    v_cvt_pk_bf16_f32 v72, v8, v9
    v_cvt_pk_bf16_f32 v73, v10, v11
    v_cvt_pk_bf16_f32 v74, v12, v13
    v_cvt_pk_bf16_f32 v75, v14, v15
    v_mfma_f32_32x32x16_bf16 v[24:39], v[88:91], v[212:215], v[24:39]
    v_exp_f32 v16, v16
    v_exp_f32 v17, v17
    v_exp_f32 v18, v18
    v_exp_f32 v19, v19
    v_mfma_f32_32x32x16_bf16 v[56:71], v[100:103], v[84:87], v[56:71]
    s_waitcnt lgkmcnt(0)
    v_exp_f32 v20, v20
    v_exp_f32 v21, v21
    v_exp_f32 v22, v22
    v_exp_f32 v23, v23
    v_cvt_pk_bf16_f32 v76, v16, v17
    v_cvt_pk_bf16_f32 v77, v18, v19
    v_cvt_pk_bf16_f32 v78, v20, v21
    v_cvt_pk_bf16_f32 v79, v22, v23
    v_mfma_f32_32x32x8bf16_1k v[8:23], v[114:115], v[216:217], 0
    v_exp_f32 v24, v24
    v_exp_f32 v25, v25
    v_exp_f32 v26, v26
    v_exp_f32 v27, v27
    v_mfma_f32_32x32x16_bf16 v[40:55], v[104:107], v[72:75], v[40:55]
    ds_read_b128 v[88:91], v220 offset:18432
    v_exp_f32 v28, v28
    v_exp_f32 v29, v29
    v_exp_f32 v30, v30
    v_exp_f32 v31, v31
    v_cvt_pk_bf16_f32 v80, v24, v25
    v_cvt_pk_bf16_f32 v81, v26, v27
    v_cvt_pk_bf16_f32 v82, v28, v29
    v_cvt_pk_bf16_f32 v83, v30, v31
    v_mfma_f32_32x32x16_bf16 v[8:23], v[92:95], v[208:211], v[8:23]
    ds_read_u16 v112, v222 offset:18432
    v_exp_f32 v32, v32
    v_exp_f32 v33, v33
    v_exp_f32 v34, v34
    v_exp_f32 v35, v35
    v_mfma_f32_32x32x16_bf16 v[40:55], v[96:99], v[76:79], v[40:55]
    ds_read_b128 v[108:111], v221 offset:16384
    v_exp_f32 v36, v36
    v_exp_f32 v37, v37
    v_exp_f32 v38, v38
    v_exp_f32 v39, v39
    v_cvt_pk_bf16_f32 v84, v32, v33
    v_cvt_pk_bf16_f32 v85, v34, v35
    v_cvt_pk_bf16_f32 v86, v36, v37
    v_cvt_pk_bf16_f32 v87, v38, v39
    v_mfma_f32_32x32x8bf16_1k v[24:39], v[114:115], v[218:219], 0
    v_exp_f32 v8, v8
    v_exp_f32 v9, v9
    v_exp_f32 v10, v10
    v_exp_f32 v11, v11
    v_mfma_f32_32x32x16_bf16 v[56:71], v[104:107], v[80:83], v[56:71]
    ds_read_b128 v[100:103], v221 offset:17408
    v_exp_f32 v12, v12
    v_exp_f32 v13, v13
    v_exp_f32 v14, v14
    v_exp_f32 v15, v15
    v_cvt_pk_bf16_f32 v72, v8, v9
    v_cvt_pk_bf16_f32 v73, v10, v11
    v_cvt_pk_bf16_f32 v74, v12, v13
    v_cvt_pk_bf16_f32 v75, v14, v15
    v_mfma_f32_32x32x16_bf16 v[24:39], v[92:95], v[212:215], v[24:39]
    v_exp_f32 v16, v16
    v_exp_f32 v17, v17
    v_exp_f32 v18, v18
    v_exp_f32 v19, v19
    v_mfma_f32_32x32x16_bf16 v[56:71], v[96:99], v[84:87], v[56:71]
    s_waitcnt lgkmcnt(0)
    v_exp_f32 v20, v20
    v_exp_f32 v21, v21
    v_exp_f32 v22, v22
    v_exp_f32 v23, v23
    v_cvt_pk_bf16_f32 v76, v16, v17
    v_cvt_pk_bf16_f32 v77, v18, v19
    v_cvt_pk_bf16_f32 v78, v20, v21
    v_cvt_pk_bf16_f32 v79, v22, v23
    v_mfma_f32_32x32x8bf16_1k v[8:23], v[112:113], v[216:217], 0
    v_exp_f32 v24, v24
    v_exp_f32 v25, v25
    v_exp_f32 v26, v26
    v_exp_f32 v27, v27
    v_mfma_f32_32x32x16_bf16 v[40:55], v[108:111], v[72:75], v[40:55]
    ds_read_b128 v[92:95], v220 offset:21504
    v_exp_f32 v28, v28
    v_exp_f32 v29, v29
    v_exp_f32 v30, v30
    v_exp_f32 v31, v31
    v_cvt_pk_bf16_f32 v80, v24, v25
    v_cvt_pk_bf16_f32 v81, v26, v27
    v_cvt_pk_bf16_f32 v82, v28, v29
    v_cvt_pk_bf16_f32 v83, v30, v31
    v_mfma_f32_32x32x16_bf16 v[8:23], v[88:91], v[208:211], v[8:23]
    ds_read_u16 v114, v222 offset:21504
    v_exp_f32 v32, v32
    v_exp_f32 v33, v33
    v_exp_f32 v34, v34
    v_exp_f32 v35, v35
    v_mfma_f32_32x32x16_bf16 v[40:55], v[100:103], v[76:79], v[40:55]
    ds_read_b128 v[104:107], v221 offset:19456
    v_exp_f32 v36, v36
    v_exp_f32 v37, v37
    v_exp_f32 v38, v38
    v_exp_f32 v39, v39
    v_cvt_pk_bf16_f32 v84, v32, v33
    v_cvt_pk_bf16_f32 v85, v34, v35
    v_cvt_pk_bf16_f32 v86, v36, v37
    v_cvt_pk_bf16_f32 v87, v38, v39
    v_mfma_f32_32x32x8bf16_1k v[24:39], v[112:113], v[218:219], 0
    v_exp_f32 v8, v8
    v_exp_f32 v9, v9
    v_exp_f32 v10, v10
    v_exp_f32 v11, v11
    v_mfma_f32_32x32x16_bf16 v[56:71], v[108:111], v[80:83], v[56:71]
    ds_read_b128 v[96:99], v221 offset:20480
    v_exp_f32 v12, v12
    v_exp_f32 v13, v13
    v_exp_f32 v14, v14
    v_exp_f32 v15, v15
    v_cvt_pk_bf16_f32 v72, v8, v9
    v_cvt_pk_bf16_f32 v73, v10, v11
    v_cvt_pk_bf16_f32 v74, v12, v13
    v_cvt_pk_bf16_f32 v75, v14, v15
    v_mfma_f32_32x32x16_bf16 v[24:39], v[88:91], v[212:215], v[24:39]
    ds_read2_b32 v[132:133], v134 offset1:4
    v_exp_f32 v16, v16
    v_exp_f32 v17, v17
    v_exp_f32 v18, v18
    v_exp_f32 v19, v19
    v_mfma_f32_32x32x16_bf16 v[56:71], v[100:103], v[84:87], v[56:71]
    s_waitcnt lgkmcnt(0)
    v_exp_f32 v20, v20
    v_exp_f32 v21, v21
    v_exp_f32 v22, v22
    v_exp_f32 v23, v23
    v_cvt_pk_bf16_f32 v76, v16, v17
    v_cvt_pk_bf16_f32 v77, v18, v19
    v_cvt_pk_bf16_f32 v78, v20, v21
    v_cvt_pk_bf16_f32 v79, v22, v23
    v_mfma_f32_32x32x8bf16_1k v[8:23], v[114:115], v[216:217], 0
    v_exp_f32 v24, v24
    v_exp_f32 v25, v25
    v_exp_f32 v26, v26
    v_exp_f32 v27, v27
    v_mfma_f32_32x32x16_bf16 v[40:55], v[104:107], v[72:75], v[40:55]
    v_cmp_gt_u32 vcc, 6, v133
    s_cbranch_vccz ATT_c24_ok
ATT_c24_spin:
    ds_read2_b32 v[132:133], v134 offset1:4
    s_waitcnt lgkmcnt(0)
    v_cmp_gt_u32 vcc, 6, v133
    s_cbranch_vccnz ATT_c24_spin
ATT_c24_ok:
    ds_read_b128 v[88:91], v220 offset:24576
    v_exp_f32 v28, v28
    v_exp_f32 v29, v29
    v_exp_f32 v30, v30
    v_exp_f32 v31, v31
    v_cvt_pk_bf16_f32 v80, v24, v25
    v_cvt_pk_bf16_f32 v81, v26, v27
    v_cvt_pk_bf16_f32 v82, v28, v29
    v_cvt_pk_bf16_f32 v83, v30, v31
    v_mfma_f32_32x32x16_bf16 v[8:23], v[92:95], v[208:211], v[8:23]
    ds_read_u16 v112, v222 offset:24576
    v_exp_f32 v32, v32
    v_exp_f32 v33, v33
    v_exp_f32 v34, v34
    v_exp_f32 v35, v35
    v_mfma_f32_32x32x16_bf16 v[40:55], v[96:99], v[76:79], v[40:55]
    ds_read_b128 v[108:111], v221 offset:22528
    v_exp_f32 v36, v36
    v_exp_f32 v37, v37
    v_exp_f32 v38, v38
    v_exp_f32 v39, v39
    v_cvt_pk_bf16_f32 v84, v32, v33
    v_cvt_pk_bf16_f32 v85, v34, v35
    v_cvt_pk_bf16_f32 v86, v36, v37
    v_cvt_pk_bf16_f32 v87, v38, v39
    v_mfma_f32_32x32x8bf16_1k v[24:39], v[114:115], v[218:219], 0
    v_exp_f32 v8, v8
    v_exp_f32 v9, v9
    v_exp_f32 v10, v10
    v_exp_f32 v11, v11
    v_mfma_f32_32x32x16_bf16 v[56:71], v[104:107], v[80:83], v[56:71]
    ds_read_b128 v[100:103], v221 offset:23552
    v_exp_f32 v12, v12
    v_exp_f32 v13, v13
    v_exp_f32 v14, v14
    v_exp_f32 v15, v15
    v_cvt_pk_bf16_f32 v72, v8, v9
    v_cvt_pk_bf16_f32 v73, v10, v11
    v_cvt_pk_bf16_f32 v74, v12, v13
    v_cvt_pk_bf16_f32 v75, v14, v15
    v_mfma_f32_32x32x16_bf16 v[24:39], v[92:95], v[212:215], v[24:39]
    v_exp_f32 v16, v16
    v_exp_f32 v17, v17
    v_exp_f32 v18, v18
    v_exp_f32 v19, v19
    v_mfma_f32_32x32x16_bf16 v[56:71], v[96:99], v[84:87], v[56:71]
    s_waitcnt lgkmcnt(0)
    v_exp_f32 v20, v20
    v_exp_f32 v21, v21
    v_exp_f32 v22, v22
    v_exp_f32 v23, v23
    v_cvt_pk_bf16_f32 v76, v16, v17
    v_cvt_pk_bf16_f32 v77, v18, v19
    v_cvt_pk_bf16_f32 v78, v20, v21
    v_cvt_pk_bf16_f32 v79, v22, v23
    v_mfma_f32_32x32x8bf16_1k v[8:23], v[112:113], v[216:217], 0
    v_exp_f32 v24, v24
    v_exp_f32 v25, v25
    v_exp_f32 v26, v26
    v_exp_f32 v27, v27
    v_mfma_f32_32x32x16_bf16 v[40:55], v[108:111], v[72:75], v[40:55]
    s_mov_b64 exec, 1
    ds_add_u32 v135, v136
    s_mov_b64 exec, -1
    ds_read_b128 v[92:95], v220 offset:27648
    v_exp_f32 v28, v28
    v_exp_f32 v29, v29
    v_exp_f32 v30, v30
    v_exp_f32 v31, v31
    v_cvt_pk_bf16_f32 v80, v24, v25
    v_cvt_pk_bf16_f32 v81, v26, v27
    v_cvt_pk_bf16_f32 v82, v28, v29
    v_cvt_pk_bf16_f32 v83, v30, v31
    v_mfma_f32_32x32x16_bf16 v[8:23], v[88:91], v[208:211], v[8:23]
    ds_read_u16 v114, v222 offset:27648
    v_exp_f32 v32, v32
    v_exp_f32 v33, v33
    v_exp_f32 v34, v34
    v_exp_f32 v35, v35
    v_mfma_f32_32x32x16_bf16 v[40:55], v[100:103], v[76:79], v[40:55]
    ds_read_b128 v[104:107], v221 offset:25600
    v_exp_f32 v36, v36
    v_exp_f32 v37, v37
    v_exp_f32 v38, v38
    v_exp_f32 v39, v39
    v_cvt_pk_bf16_f32 v84, v32, v33
    v_cvt_pk_bf16_f32 v85, v34, v35
    v_cvt_pk_bf16_f32 v86, v36, v37
    v_cvt_pk_bf16_f32 v87, v38, v39
    v_mfma_f32_32x32x8bf16_1k v[24:39], v[112:113], v[218:219], 0
    v_exp_f32 v8, v8
    v_exp_f32 v9, v9
    v_exp_f32 v10, v10
    v_exp_f32 v11, v11
    v_mfma_f32_32x32x16_bf16 v[56:71], v[108:111], v[80:83], v[56:71]
    ds_read_b128 v[96:99], v221 offset:26624
    v_exp_f32 v12, v12
    v_exp_f32 v13, v13
    v_exp_f32 v14, v14
    v_exp_f32 v15, v15
    v_cvt_pk_bf16_f32 v72, v8, v9
    v_cvt_pk_bf16_f32 v73, v10, v11
    v_cvt_pk_bf16_f32 v74, v12, v13
    v_cvt_pk_bf16_f32 v75, v14, v15
    v_mfma_f32_32x32x16_bf16 v[24:39], v[88:91], v[212:215], v[24:39]
    v_exp_f32 v16, v16
    v_exp_f32 v17, v17
    v_exp_f32 v18, v18
    v_exp_f32 v19, v19
    v_mfma_f32_32x32x16_bf16 v[56:71], v[100:103], v[84:87], v[56:71]
    s_waitcnt lgkmcnt(0)
    v_exp_f32 v20, v20
    v_exp_f32 v21, v21
    v_exp_f32 v22, v22
    v_exp_f32 v23, v23
    v_cvt_pk_bf16_f32 v76, v16, v17
    v_cvt_pk_bf16_f32 v77, v18, v19
    v_cvt_pk_bf16_f32 v78, v20, v21
    v_cvt_pk_bf16_f32 v79, v22, v23
    v_mfma_f32_32x32x8bf16_1k v[8:23], v[114:115], v[216:217], 0
    v_exp_f32 v24, v24
    v_exp_f32 v25, v25
    v_exp_f32 v26, v26
    v_exp_f32 v27, v27
    v_mfma_f32_32x32x16_bf16 v[40:55], v[104:107], v[72:75], v[40:55]
    ds_read_b128 v[88:91], v220 offset:30720
    v_exp_f32 v28, v28
    v_exp_f32 v29, v29
    v_exp_f32 v30, v30
    v_exp_f32 v31, v31
    v_cvt_pk_bf16_f32 v80, v24, v25
    v_cvt_pk_bf16_f32 v81, v26, v27
    v_cvt_pk_bf16_f32 v82, v28, v29
    v_cvt_pk_bf16_f32 v83, v30, v31
    v_mfma_f32_32x32x16_bf16 v[8:23], v[92:95], v[208:211], v[8:23]
    ds_read_u16 v112, v222 offset:30720
    v_exp_f32 v32, v32
    v_exp_f32 v33, v33
    v_exp_f32 v34, v34
    v_exp_f32 v35, v35
    v_mfma_f32_32x32x16_bf16 v[40:55], v[96:99], v[76:79], v[40:55]
    ds_read_b128 v[108:111], v221 offset:28672
    v_exp_f32 v36, v36
    v_exp_f32 v37, v37
    v_exp_f32 v38, v38
    v_exp_f32 v39, v39
    v_cvt_pk_bf16_f32 v84, v32, v33
    v_cvt_pk_bf16_f32 v85, v34, v35
    v_cvt_pk_bf16_f32 v86, v36, v37
    v_cvt_pk_bf16_f32 v87, v38, v39
    v_mfma_f32_32x32x8bf16_1k v[24:39], v[114:115], v[218:219], 0
    v_exp_f32 v8, v8
    v_exp_f32 v9, v9
    v_exp_f32 v10, v10
    v_exp_f32 v11, v11
    v_mfma_f32_32x32x16_bf16 v[56:71], v[104:107], v[80:83], v[56:71]
    ds_read_b128 v[100:103], v221 offset:29696
    v_exp_f32 v12, v12
    v_exp_f32 v13, v13
    v_exp_f32 v14, v14
    v_exp_f32 v15, v15
    v_cvt_pk_bf16_f32 v72, v8, v9
    v_cvt_pk_bf16_f32 v73, v10, v11
    v_cvt_pk_bf16_f32 v74, v12, v13
    v_cvt_pk_bf16_f32 v75, v14, v15
    v_mfma_f32_32x32x16_bf16 v[24:39], v[92:95], v[212:215], v[24:39]
    v_exp_f32 v16, v16
    v_exp_f32 v17, v17
    v_exp_f32 v18, v18
    v_exp_f32 v19, v19
    v_mfma_f32_32x32x16_bf16 v[56:71], v[96:99], v[84:87], v[56:71]
    s_waitcnt lgkmcnt(0)
    v_exp_f32 v20, v20
    v_exp_f32 v21, v21
    v_exp_f32 v22, v22
    v_exp_f32 v23, v23
    v_cvt_pk_bf16_f32 v76, v16, v17
    v_cvt_pk_bf16_f32 v77, v18, v19
    v_cvt_pk_bf16_f32 v78, v20, v21
    v_cvt_pk_bf16_f32 v79, v22, v23
    v_mfma_f32_32x32x8bf16_1k v[8:23], v[112:113], v[216:217], 0
    v_exp_f32 v24, v24
    v_exp_f32 v25, v25
    v_exp_f32 v26, v26
    v_exp_f32 v27, v27
    v_mfma_f32_32x32x16_bf16 v[40:55], v[108:111], v[72:75], v[40:55]
    ds_read_b128 v[92:95], v220 offset:33792
    v_exp_f32 v28, v28
    v_exp_f32 v29, v29
    v_exp_f32 v30, v30
    v_exp_f32 v31, v31
    v_cvt_pk_bf16_f32 v80, v24, v25
    v_cvt_pk_bf16_f32 v81, v26, v27
    v_cvt_pk_bf16_f32 v82, v28, v29
    v_cvt_pk_bf16_f32 v83, v30, v31
    v_mfma_f32_32x32x16_bf16 v[8:23], v[88:91], v[208:211], v[8:23]
    ds_read_u16 v114, v222 offset:33792
    v_exp_f32 v32, v32
    v_exp_f32 v33, v33
    v_exp_f32 v34, v34
    v_exp_f32 v35, v35
    v_mfma_f32_32x32x16_bf16 v[40:55], v[100:103], v[76:79], v[40:55]
    ds_read_b128 v[104:107], v221 offset:31744
    v_exp_f32 v36, v36
    v_exp_f32 v37, v37
    v_exp_f32 v38, v38
    v_exp_f32 v39, v39
    v_cvt_pk_bf16_f32 v84, v32, v33
    v_cvt_pk_bf16_f32 v85, v34, v35
    v_cvt_pk_bf16_f32 v86, v36, v37
    v_cvt_pk_bf16_f32 v87, v38, v39
    v_mfma_f32_32x32x8bf16_1k v[24:39], v[112:113], v[218:219], 0
    v_exp_f32 v8, v8
    v_exp_f32 v9, v9
    v_exp_f32 v10, v10
    v_exp_f32 v11, v11
    v_mfma_f32_32x32x16_bf16 v[56:71], v[108:111], v[80:83], v[56:71]
    ds_read_b128 v[96:99], v221 offset:32768
    v_exp_f32 v12, v12
    v_exp_f32 v13, v13
    v_exp_f32 v14, v14
    v_exp_f32 v15, v15
    v_cvt_pk_bf16_f32 v72, v8, v9
    v_cvt_pk_bf16_f32 v73, v10, v11
    v_cvt_pk_bf16_f32 v74, v12, v13
    v_cvt_pk_bf16_f32 v75, v14, v15
    v_mfma_f32_32x32x16_bf16 v[24:39], v[88:91], v[212:215], v[24:39]
    ds_read2_b32 v[132:133], v134 offset1:4
    v_exp_f32 v16, v16
    v_exp_f32 v17, v17
    v_exp_f32 v18, v18
    v_exp_f32 v19, v19
    v_mfma_f32_32x32x16_bf16 v[56:71], v[100:103], v[84:87], v[56:71]
    s_waitcnt lgkmcnt(0)
    v_exp_f32 v20, v20
    v_exp_f32 v21, v21
    v_exp_f32 v22, v22
    v_exp_f32 v23, v23
    v_cvt_pk_bf16_f32 v76, v16, v17
    v_cvt_pk_bf16_f32 v77, v18, v19
    v_cvt_pk_bf16_f32 v78, v20, v21
    v_cvt_pk_bf16_f32 v79, v22, v23
    v_mfma_f32_32x32x8bf16_1k v[8:23], v[114:115], v[216:217], 0
    v_exp_f32 v24, v24
    v_exp_f32 v25, v25
    v_exp_f32 v26, v26
    v_exp_f32 v27, v27
    v_mfma_f32_32x32x16_bf16 v[40:55], v[104:107], v[72:75], v[40:55]
    v_cmp_gt_u32 vcc, 8, v133
    s_cbranch_vccz ATT_c28_ok
ATT_c28_spin:
    ds_read2_b32 v[132:133], v134 offset1:4
    s_waitcnt lgkmcnt(0)
    v_cmp_gt_u32 vcc, 8, v133
    s_cbranch_vccnz ATT_c28_spin
ATT_c28_ok:
    ds_read_b128 v[88:91], v220 offset:36864
    v_exp_f32 v28, v28
    v_exp_f32 v29, v29
    v_exp_f32 v30, v30
    v_exp_f32 v31, v31
    v_cvt_pk_bf16_f32 v80, v24, v25
    v_cvt_pk_bf16_f32 v81, v26, v27
    v_cvt_pk_bf16_f32 v82, v28, v29
    v_cvt_pk_bf16_f32 v83, v30, v31
    v_mfma_f32_32x32x16_bf16 v[8:23], v[92:95], v[208:211], v[8:23]
    ds_read_u16 v112, v222 offset:36864
    v_exp_f32 v32, v32
    v_exp_f32 v33, v33
    v_exp_f32 v34, v34
    v_exp_f32 v35, v35
    v_mfma_f32_32x32x16_bf16 v[40:55], v[96:99], v[76:79], v[40:55]
    ds_read_b128 v[108:111], v221 offset:34816
    v_exp_f32 v36, v36
    v_exp_f32 v37, v37
    v_exp_f32 v38, v38
    v_exp_f32 v39, v39
    v_cvt_pk_bf16_f32 v84, v32, v33
    v_cvt_pk_bf16_f32 v85, v34, v35
    v_cvt_pk_bf16_f32 v86, v36, v37
    v_cvt_pk_bf16_f32 v87, v38, v39
    v_mfma_f32_32x32x8bf16_1k v[24:39], v[114:115], v[218:219], 0
    v_exp_f32 v8, v8
    v_exp_f32 v9, v9
    v_exp_f32 v10, v10
    v_exp_f32 v11, v11
    v_mfma_f32_32x32x16_bf16 v[56:71], v[104:107], v[80:83], v[56:71]
    ds_read_b128 v[100:103], v221 offset:35840
    v_exp_f32 v12, v12
    v_exp_f32 v13, v13
    v_exp_f32 v14, v14
    v_exp_f32 v15, v15
    v_cvt_pk_bf16_f32 v72, v8, v9
    v_cvt_pk_bf16_f32 v73, v10, v11
    v_cvt_pk_bf16_f32 v74, v12, v13
    v_cvt_pk_bf16_f32 v75, v14, v15
    v_mfma_f32_32x32x16_bf16 v[24:39], v[92:95], v[212:215], v[24:39]
    v_exp_f32 v16, v16
    v_exp_f32 v17, v17
    v_exp_f32 v18, v18
    v_exp_f32 v19, v19
    v_mfma_f32_32x32x16_bf16 v[56:71], v[96:99], v[84:87], v[56:71]
    s_waitcnt lgkmcnt(0)
    v_exp_f32 v20, v20
    v_exp_f32 v21, v21
    v_exp_f32 v22, v22
    v_exp_f32 v23, v23
    v_cvt_pk_bf16_f32 v76, v16, v17
    v_cvt_pk_bf16_f32 v77, v18, v19
    v_cvt_pk_bf16_f32 v78, v20, v21
    v_cvt_pk_bf16_f32 v79, v22, v23
    v_mfma_f32_32x32x8bf16_1k v[8:23], v[112:113], v[216:217], 0
    v_exp_f32 v24, v24
    v_exp_f32 v25, v25
    v_exp_f32 v26, v26
    v_exp_f32 v27, v27
    v_mfma_f32_32x32x16_bf16 v[40:55], v[108:111], v[72:75], v[40:55]
    s_mov_b64 exec, 1
    ds_add_u32 v135, v136
    s_mov_b64 exec, -1
    ds_read_b128 v[92:95], v220 offset:39936
    v_exp_f32 v28, v28
    v_exp_f32 v29, v29
    v_exp_f32 v30, v30
    v_exp_f32 v31, v31
    v_cvt_pk_bf16_f32 v80, v24, v25
    v_cvt_pk_bf16_f32 v81, v26, v27
    v_cvt_pk_bf16_f32 v82, v28, v29
    v_cvt_pk_bf16_f32 v83, v30, v31
    v_mfma_f32_32x32x16_bf16 v[8:23], v[88:91], v[208:211], v[8:23]
    ds_read_u16 v114, v222 offset:39936
    v_exp_f32 v32, v32
    v_exp_f32 v33, v33
    v_exp_f32 v34, v34
    v_exp_f32 v35, v35
    v_mfma_f32_32x32x16_bf16 v[40:55], v[100:103], v[76:79], v[40:55]
    ds_read_b128 v[104:107], v221 offset:37888
    v_exp_f32 v36, v36
    v_exp_f32 v37, v37
    v_exp_f32 v38, v38
    v_exp_f32 v39, v39
    v_cvt_pk_bf16_f32 v84, v32, v33
    v_cvt_pk_bf16_f32 v85, v34, v35
    v_cvt_pk_bf16_f32 v86, v36, v37
    v_cvt_pk_bf16_f32 v87, v38, v39
    v_mfma_f32_32x32x8bf16_1k v[24:39], v[112:113], v[218:219], 0
    v_exp_f32 v8, v8
    v_exp_f32 v9, v9
    v_exp_f32 v10, v10
    v_exp_f32 v11, v11
    v_mfma_f32_32x32x16_bf16 v[56:71], v[108:111], v[80:83], v[56:71]
    ds_read_b128 v[96:99], v221 offset:38912
    v_exp_f32 v12, v12
    v_exp_f32 v13, v13
    v_exp_f32 v14, v14
    v_exp_f32 v15, v15
    v_cvt_pk_bf16_f32 v72, v8, v9
    v_cvt_pk_bf16_f32 v73, v10, v11
    v_cvt_pk_bf16_f32 v74, v12, v13
    v_cvt_pk_bf16_f32 v75, v14, v15
    v_mfma_f32_32x32x16_bf16 v[24:39], v[88:91], v[212:215], v[24:39]
    v_exp_f32 v16, v16
    v_exp_f32 v17, v17
    v_exp_f32 v18, v18
    v_exp_f32 v19, v19
    v_mfma_f32_32x32x16_bf16 v[56:71], v[100:103], v[84:87], v[56:71]
    s_waitcnt lgkmcnt(0)
    v_exp_f32 v20, v20
    v_exp_f32 v21, v21
    v_exp_f32 v22, v22
    v_exp_f32 v23, v23
    v_cvt_pk_bf16_f32 v76, v16, v17
    v_cvt_pk_bf16_f32 v77, v18, v19
    v_cvt_pk_bf16_f32 v78, v20, v21
    v_cvt_pk_bf16_f32 v79, v22, v23
    v_mfma_f32_32x32x8bf16_1k v[8:23], v[114:115], v[216:217], 0
    v_exp_f32 v24, v24
    v_exp_f32 v25, v25
    v_exp_f32 v26, v26
    v_exp_f32 v27, v27
    v_mfma_f32_32x32x16_bf16 v[40:55], v[104:107], v[72:75], v[40:55]
    ds_read_b128 v[88:91], v220 offset:43008
    v_exp_f32 v28, v28
    v_exp_f32 v29, v29
    v_exp_f32 v30, v30
    v_exp_f32 v31, v31
    v_cvt_pk_bf16_f32 v80, v24, v25
    v_cvt_pk_bf16_f32 v81, v26, v27
    v_cvt_pk_bf16_f32 v82, v28, v29
    v_cvt_pk_bf16_f32 v83, v30, v31
    v_mfma_f32_32x32x16_bf16 v[8:23], v[92:95], v[208:211], v[8:23]
    ds_read_u16 v112, v222 offset:43008
    v_exp_f32 v32, v32
    v_exp_f32 v33, v33
    v_exp_f32 v34, v34
    v_exp_f32 v35, v35
    v_mfma_f32_32x32x16_bf16 v[40:55], v[96:99], v[76:79], v[40:55]
    ds_read_b128 v[108:111], v221 offset:40960
    v_exp_f32 v36, v36
    v_exp_f32 v37, v37
    v_exp_f32 v38, v38
    v_exp_f32 v39, v39
    v_cvt_pk_bf16_f32 v84, v32, v33
    v_cvt_pk_bf16_f32 v85, v34, v35
    v_cvt_pk_bf16_f32 v86, v36, v37
    v_cvt_pk_bf16_f32 v87, v38, v39
    v_mfma_f32_32x32x8bf16_1k v[24:39], v[114:115], v[218:219], 0
    v_exp_f32 v8, v8
    v_exp_f32 v9, v9
    v_exp_f32 v10, v10
    v_exp_f32 v11, v11
    v_mfma_f32_32x32x16_bf16 v[56:71], v[104:107], v[80:83], v[56:71]
    ds_read_b128 v[100:103], v221 offset:41984
    v_exp_f32 v12, v12
    v_exp_f32 v13, v13
    v_exp_f32 v14, v14
    v_exp_f32 v15, v15
    v_cvt_pk_bf16_f32 v72, v8, v9
    v_cvt_pk_bf16_f32 v73, v10, v11
    v_cvt_pk_bf16_f32 v74, v12, v13
    v_cvt_pk_bf16_f32 v75, v14, v15
    v_mfma_f32_32x32x16_bf16 v[24:39], v[92:95], v[212:215], v[24:39]
    v_exp_f32 v16, v16
    v_exp_f32 v17, v17
    v_exp_f32 v18, v18
    v_exp_f32 v19, v19
    v_mfma_f32_32x32x16_bf16 v[56:71], v[96:99], v[84:87], v[56:71]
    s_waitcnt lgkmcnt(0)
    v_exp_f32 v20, v20
    v_exp_f32 v21, v21
    v_exp_f32 v22, v22
    v_exp_f32 v23, v23
    v_cvt_pk_bf16_f32 v76, v16, v17
    v_cvt_pk_bf16_f32 v77, v18, v19
    v_cvt_pk_bf16_f32 v78, v20, v21
    v_cvt_pk_bf16_f32 v79, v22, v23
    v_mfma_f32_32x32x8bf16_1k v[8:23], v[112:113], v[216:217], 0
    v_exp_f32 v24, v24
    v_exp_f32 v25, v25
    v_exp_f32 v26, v26
    v_exp_f32 v27, v27
    v_mfma_f32_32x32x16_bf16 v[40:55], v[108:111], v[72:75], v[40:55]
    ds_read_b128 v[92:95], v220 offset:46080
    v_exp_f32 v28, v28
    v_exp_f32 v29, v29
    v_exp_f32 v30, v30
    v_exp_f32 v31, v31
    v_cvt_pk_bf16_f32 v80, v24, v25
    v_cvt_pk_bf16_f32 v81, v26, v27
    v_cvt_pk_bf16_f32 v82, v28, v29
    v_cvt_pk_bf16_f32 v83, v30, v31
    v_mfma_f32_32x32x16_bf16 v[8:23], v[88:91], v[208:211], v[8:23]
    ds_read_u16 v114, v222 offset:46080
    v_exp_f32 v32, v32
    v_exp_f32 v33, v33
    v_exp_f32 v34, v34
    v_exp_f32 v35, v35
    v_mfma_f32_32x32x16_bf16 v[40:55], v[100:103], v[76:79], v[40:55]
    ds_read_b128 v[104:107], v221 offset:44032
    v_exp_f32 v36, v36
    v_exp_f32 v37, v37
    v_exp_f32 v38, v38
    v_exp_f32 v39, v39
    v_cvt_pk_bf16_f32 v84, v32, v33
    v_cvt_pk_bf16_f32 v85, v34, v35
    v_cvt_pk_bf16_f32 v86, v36, v37
    v_cvt_pk_bf16_f32 v87, v38, v39
    v_mfma_f32_32x32x8bf16_1k v[24:39], v[112:113], v[218:219], 0
    v_exp_f32 v8, v8
    v_exp_f32 v9, v9
    v_exp_f32 v10, v10
    v_exp_f32 v11, v11
    v_mfma_f32_32x32x16_bf16 v[56:71], v[108:111], v[80:83], v[56:71]
    ds_read_b128 v[96:99], v221 offset:45056
    v_exp_f32 v12, v12
    v_exp_f32 v13, v13
    v_exp_f32 v14, v14
    v_exp_f32 v15, v15
    v_cvt_pk_bf16_f32 v72, v8, v9
    v_cvt_pk_bf16_f32 v73, v10, v11
    v_cvt_pk_bf16_f32 v74, v12, v13
    v_cvt_pk_bf16_f32 v75, v14, v15
    v_mfma_f32_32x32x16_bf16 v[24:39], v[88:91], v[212:215], v[24:39]
    ds_read2_b32 v[132:133], v134 offset1:4
    v_exp_f32 v16, v16
    v_exp_f32 v17, v17
    v_exp_f32 v18, v18
    v_exp_f32 v19, v19
    v_mfma_f32_32x32x16_bf16 v[56:71], v[100:103], v[84:87], v[56:71]
    s_waitcnt lgkmcnt(0)
    v_exp_f32 v20, v20
    v_exp_f32 v21, v21
    v_exp_f32 v22, v22
    v_exp_f32 v23, v23
    v_cvt_pk_bf16_f32 v76, v16, v17
    v_cvt_pk_bf16_f32 v77, v18, v19
    v_cvt_pk_bf16_f32 v78, v20, v21
    v_cvt_pk_bf16_f32 v79, v22, v23
    v_mfma_f32_32x32x8bf16_1k v[8:23], v[114:115], v[216:217], 0
    v_exp_f32 v24, v24
    v_exp_f32 v25, v25
    v_exp_f32 v26, v26
    v_exp_f32 v27, v27
    v_mfma_f32_32x32x16_bf16 v[40:55], v[104:107], v[72:75], v[40:55]
    v_cmp_gt_u32 vcc, 9, v133
    s_cbranch_vccz ATT_c32_ok
ATT_c32_spin:
    ds_read2_b32 v[132:133], v134 offset1:4
    s_waitcnt lgkmcnt(0)
    v_cmp_gt_u32 vcc, 9, v133
    s_cbranch_vccnz ATT_c32_spin
ATT_c32_ok:
    ds_read_b128 v[88:91], v220 offset:49152
    v_exp_f32 v28, v28
    v_exp_f32 v29, v29
    v_exp_f32 v30, v30
    v_exp_f32 v31, v31
    v_cvt_pk_bf16_f32 v80, v24, v25
    v_cvt_pk_bf16_f32 v81, v26, v27
    v_cvt_pk_bf16_f32 v82, v28, v29
    v_cvt_pk_bf16_f32 v83, v30, v31
    v_mfma_f32_32x32x16_bf16 v[8:23], v[92:95], v[208:211], v[8:23]
    ds_read_u16 v112, v222 offset:49152
    v_exp_f32 v32, v32
    v_exp_f32 v33, v33
    v_exp_f32 v34, v34
    v_exp_f32 v35, v35
    v_mfma_f32_32x32x16_bf16 v[40:55], v[96:99], v[76:79], v[40:55]
    ds_read_b128 v[108:111], v221 offset:47104
    v_exp_f32 v36, v36
    v_exp_f32 v37, v37
    v_exp_f32 v38, v38
    v_exp_f32 v39, v39
    v_cvt_pk_bf16_f32 v84, v32, v33
    v_cvt_pk_bf16_f32 v85, v34, v35
    v_cvt_pk_bf16_f32 v86, v36, v37
    v_cvt_pk_bf16_f32 v87, v38, v39
    v_mfma_f32_32x32x8bf16_1k v[24:39], v[114:115], v[218:219], 0
    v_exp_f32 v8, v8
    v_exp_f32 v9, v9
    v_exp_f32 v10, v10
    v_exp_f32 v11, v11
    v_mfma_f32_32x32x16_bf16 v[56:71], v[104:107], v[80:83], v[56:71]
    ds_read_b128 v[100:103], v221 offset:48128
    v_exp_f32 v12, v12
    v_exp_f32 v13, v13
    v_exp_f32 v14, v14
    v_exp_f32 v15, v15
    v_cvt_pk_bf16_f32 v72, v8, v9
    v_cvt_pk_bf16_f32 v73, v10, v11
    v_cvt_pk_bf16_f32 v74, v12, v13
    v_cvt_pk_bf16_f32 v75, v14, v15
    v_mfma_f32_32x32x16_bf16 v[24:39], v[92:95], v[212:215], v[24:39]
    v_exp_f32 v16, v16
    v_exp_f32 v17, v17
    v_exp_f32 v18, v18
    v_exp_f32 v19, v19
    v_mfma_f32_32x32x16_bf16 v[56:71], v[96:99], v[84:87], v[56:71]
    s_waitcnt lgkmcnt(0)
    v_exp_f32 v20, v20
    v_exp_f32 v21, v21
    v_exp_f32 v22, v22
    v_exp_f32 v23, v23
    v_cvt_pk_bf16_f32 v76, v16, v17
    v_cvt_pk_bf16_f32 v77, v18, v19
    v_cvt_pk_bf16_f32 v78, v20, v21
    v_cvt_pk_bf16_f32 v79, v22, v23
    v_mfma_f32_32x32x8bf16_1k v[8:23], v[112:113], v[216:217], 0
    v_exp_f32 v24, v24
    v_exp_f32 v25, v25
    v_exp_f32 v26, v26
    v_exp_f32 v27, v27
    v_mfma_f32_32x32x16_bf16 v[40:55], v[108:111], v[72:75], v[40:55]
    s_mov_b64 exec, 1
    ds_add_u32 v135, v136
    s_mov_b64 exec, -1
    ds_read_b128 v[92:95], v220 offset:52224
    v_exp_f32 v28, v28
    v_exp_f32 v29, v29
    v_exp_f32 v30, v30
    v_exp_f32 v31, v31
    v_cvt_pk_bf16_f32 v80, v24, v25
    v_cvt_pk_bf16_f32 v81, v26, v27
    v_cvt_pk_bf16_f32 v82, v28, v29
    v_cvt_pk_bf16_f32 v83, v30, v31
    v_mfma_f32_32x32x16_bf16 v[8:23], v[88:91], v[208:211], v[8:23]
    ds_read_u16 v114, v222 offset:52224
    v_exp_f32 v32, v32
    v_exp_f32 v33, v33
    v_exp_f32 v34, v34
    v_exp_f32 v35, v35
    v_mfma_f32_32x32x16_bf16 v[40:55], v[100:103], v[76:79], v[40:55]
    ds_read_b128 v[104:107], v221 offset:50176
    v_exp_f32 v36, v36
    v_exp_f32 v37, v37
    v_exp_f32 v38, v38
    v_exp_f32 v39, v39
    v_cvt_pk_bf16_f32 v84, v32, v33
    v_cvt_pk_bf16_f32 v85, v34, v35
    v_cvt_pk_bf16_f32 v86, v36, v37
    v_cvt_pk_bf16_f32 v87, v38, v39
    v_mfma_f32_32x32x8bf16_1k v[24:39], v[112:113], v[218:219], 0
    v_exp_f32 v8, v8
    v_exp_f32 v9, v9
    v_exp_f32 v10, v10
    v_exp_f32 v11, v11
    v_mfma_f32_32x32x16_bf16 v[56:71], v[108:111], v[80:83], v[56:71]
    ds_read_b128 v[96:99], v221 offset:51200
    v_exp_f32 v12, v12
    v_exp_f32 v13, v13
    v_exp_f32 v14, v14
    v_exp_f32 v15, v15
    v_cvt_pk_bf16_f32 v72, v8, v9
    v_cvt_pk_bf16_f32 v73, v10, v11
    v_cvt_pk_bf16_f32 v74, v12, v13
    v_cvt_pk_bf16_f32 v75, v14, v15
    v_mfma_f32_32x32x16_bf16 v[24:39], v[88:91], v[212:215], v[24:39]
    v_exp_f32 v16, v16
    v_exp_f32 v17, v17
    v_exp_f32 v18, v18
    v_exp_f32 v19, v19
    v_mfma_f32_32x32x16_bf16 v[56:71], v[100:103], v[84:87], v[56:71]
    s_waitcnt lgkmcnt(0)
    v_exp_f32 v20, v20
    v_exp_f32 v21, v21
    v_exp_f32 v22, v22
    v_exp_f32 v23, v23
    v_cvt_pk_bf16_f32 v76, v16, v17
    v_cvt_pk_bf16_f32 v77, v18, v19
    v_cvt_pk_bf16_f32 v78, v20, v21
    v_cvt_pk_bf16_f32 v79, v22, v23
    v_mfma_f32_32x32x8bf16_1k v[8:23], v[114:115], v[216:217], 0
    v_exp_f32 v24, v24
    v_exp_f32 v25, v25
    v_exp_f32 v26, v26
    v_exp_f32 v27, v27
    v_mfma_f32_32x32x16_bf16 v[40:55], v[104:107], v[72:75], v[40:55]
    ds_read_b128 v[88:91], v220 offset:55296
    v_exp_f32 v28, v28
    v_exp_f32 v29, v29
    v_exp_f32 v30, v30
    v_exp_f32 v31, v31
    v_cvt_pk_bf16_f32 v80, v24, v25
    v_cvt_pk_bf16_f32 v81, v26, v27
    v_cvt_pk_bf16_f32 v82, v28, v29
    v_cvt_pk_bf16_f32 v83, v30, v31
    v_mfma_f32_32x32x16_bf16 v[8:23], v[92:95], v[208:211], v[8:23]
    ds_read_u16 v112, v222 offset:55296
    v_exp_f32 v32, v32
    v_exp_f32 v33, v33
    v_exp_f32 v34, v34
    v_exp_f32 v35, v35
    v_mfma_f32_32x32x16_bf16 v[40:55], v[96:99], v[76:79], v[40:55]
    ds_read_b128 v[108:111], v221 offset:53248
    v_exp_f32 v36, v36
    v_exp_f32 v37, v37
    v_exp_f32 v38, v38
    v_exp_f32 v39, v39
    v_cvt_pk_bf16_f32 v84, v32, v33
    v_cvt_pk_bf16_f32 v85, v34, v35
    v_cvt_pk_bf16_f32 v86, v36, v37
    v_cvt_pk_bf16_f32 v87, v38, v39
    v_mfma_f32_32x32x8bf16_1k v[24:39], v[114:115], v[218:219], 0
    v_exp_f32 v8, v8
    v_exp_f32 v9, v9
    v_exp_f32 v10, v10
    v_exp_f32 v11, v11
    v_mfma_f32_32x32x16_bf16 v[56:71], v[104:107], v[80:83], v[56:71]
    ds_read_b128 v[100:103], v221 offset:54272
    v_exp_f32 v12, v12
    v_exp_f32 v13, v13
    v_exp_f32 v14, v14
    v_exp_f32 v15, v15
    v_cvt_pk_bf16_f32 v72, v8, v9
    v_cvt_pk_bf16_f32 v73, v10, v11
    v_cvt_pk_bf16_f32 v74, v12, v13
    v_cvt_pk_bf16_f32 v75, v14, v15
    v_mfma_f32_32x32x16_bf16 v[24:39], v[92:95], v[212:215], v[24:39]
    v_exp_f32 v16, v16
    v_exp_f32 v17, v17
    v_exp_f32 v18, v18
    v_exp_f32 v19, v19
    v_mfma_f32_32x32x16_bf16 v[56:71], v[96:99], v[84:87], v[56:71]
    s_waitcnt lgkmcnt(0)
    v_exp_f32 v20, v20
    v_exp_f32 v21, v21
    v_exp_f32 v22, v22
    v_exp_f32 v23, v23
    v_cvt_pk_bf16_f32 v76, v16, v17
    v_cvt_pk_bf16_f32 v77, v18, v19
    v_cvt_pk_bf16_f32 v78, v20, v21
    v_cvt_pk_bf16_f32 v79, v22, v23
    v_mfma_f32_32x32x8bf16_1k v[8:23], v[112:113], v[216:217], 0
    v_exp_f32 v24, v24
    v_exp_f32 v25, v25
    v_exp_f32 v26, v26
    v_exp_f32 v27, v27
    v_mfma_f32_32x32x16_bf16 v[40:55], v[108:111], v[72:75], v[40:55]
    ds_read_b128 v[92:95], v220 offset:58368
    v_exp_f32 v28, v28
    v_exp_f32 v29, v29
    v_exp_f32 v30, v30
    v_exp_f32 v31, v31
    v_cvt_pk_bf16_f32 v80, v24, v25
    v_cvt_pk_bf16_f32 v81, v26, v27
    v_cvt_pk_bf16_f32 v82, v28, v29
    v_cvt_pk_bf16_f32 v83, v30, v31
    v_mfma_f32_32x32x16_bf16 v[8:23], v[88:91], v[208:211], v[8:23]
    ds_read_u16 v114, v222 offset:58368
    v_exp_f32 v32, v32
    v_exp_f32 v33, v33
    v_exp_f32 v34, v34
    v_exp_f32 v35, v35
    v_mfma_f32_32x32x16_bf16 v[40:55], v[100:103], v[76:79], v[40:55]
    ds_read_b128 v[104:107], v221 offset:56320
    v_exp_f32 v36, v36
    v_exp_f32 v37, v37
    v_exp_f32 v38, v38
    v_exp_f32 v39, v39
    v_cvt_pk_bf16_f32 v84, v32, v33
    v_cvt_pk_bf16_f32 v85, v34, v35
    v_cvt_pk_bf16_f32 v86, v36, v37
    v_cvt_pk_bf16_f32 v87, v38, v39
    v_mfma_f32_32x32x8bf16_1k v[24:39], v[112:113], v[218:219], 0
    v_exp_f32 v8, v8
    v_exp_f32 v9, v9
    v_exp_f32 v10, v10
    v_exp_f32 v11, v11
    v_mfma_f32_32x32x16_bf16 v[56:71], v[108:111], v[80:83], v[56:71]
    ds_read_b128 v[96:99], v221 offset:57344
    v_exp_f32 v12, v12
    v_exp_f32 v13, v13
    v_exp_f32 v14, v14
    v_exp_f32 v15, v15
    v_cvt_pk_bf16_f32 v72, v8, v9
    v_cvt_pk_bf16_f32 v73, v10, v11
    v_cvt_pk_bf16_f32 v74, v12, v13
    v_cvt_pk_bf16_f32 v75, v14, v15
    v_mfma_f32_32x32x16_bf16 v[24:39], v[88:91], v[212:215], v[24:39]
    ds_read2_b32 v[132:133], v134 offset1:4
    v_exp_f32 v16, v16
    v_exp_f32 v17, v17
    v_exp_f32 v18, v18
    v_exp_f32 v19, v19
    v_mfma_f32_32x32x16_bf16 v[56:71], v[100:103], v[84:87], v[56:71]
    s_waitcnt lgkmcnt(0)
    v_exp_f32 v20, v20
    v_exp_f32 v21, v21
    v_exp_f32 v22, v22
    v_exp_f32 v23, v23
    v_cvt_pk_bf16_f32 v76, v16, v17
    v_cvt_pk_bf16_f32 v77, v18, v19
    v_cvt_pk_bf16_f32 v78, v20, v21
    v_cvt_pk_bf16_f32 v79, v22, v23
    v_mfma_f32_32x32x8bf16_1k v[8:23], v[114:115], v[216:217], 0
    v_exp_f32 v24, v24
    v_exp_f32 v25, v25
    v_exp_f32 v26, v26
    v_exp_f32 v27, v27
    v_mfma_f32_32x32x16_bf16 v[40:55], v[104:107], v[72:75], v[40:55]
    v_cmp_gt_u32 vcc, 10, v133
    s_cbranch_vccz ATT_c36_ok
ATT_c36_spin:
    ds_read2_b32 v[132:133], v134 offset1:4
    s_waitcnt lgkmcnt(0)
    v_cmp_gt_u32 vcc, 10, v133
    s_cbranch_vccnz ATT_c36_spin
ATT_c36_ok:
    ds_read_b128 v[88:91], v220 offset:0
    v_exp_f32 v28, v28
    v_exp_f32 v29, v29
    v_exp_f32 v30, v30
    v_exp_f32 v31, v31
    v_cvt_pk_bf16_f32 v80, v24, v25
    v_cvt_pk_bf16_f32 v81, v26, v27
    v_cvt_pk_bf16_f32 v82, v28, v29
    v_cvt_pk_bf16_f32 v83, v30, v31
    v_mfma_f32_32x32x16_bf16 v[8:23], v[92:95], v[208:211], v[8:23]
    ds_read_u16 v112, v222 offset:0
    v_exp_f32 v32, v32
    v_exp_f32 v33, v33
    v_exp_f32 v34, v34
    v_exp_f32 v35, v35
    v_mfma_f32_32x32x16_bf16 v[40:55], v[96:99], v[76:79], v[40:55]
    ds_read_b128 v[108:111], v221 offset:59392
    v_exp_f32 v36, v36
    v_exp_f32 v37, v37
    v_exp_f32 v38, v38
    v_exp_f32 v39, v39
    v_cvt_pk_bf16_f32 v84, v32, v33
    v_cvt_pk_bf16_f32 v85, v34, v35
    v_cvt_pk_bf16_f32 v86, v36, v37
    v_cvt_pk_bf16_f32 v87, v38, v39
    v_mfma_f32_32x32x8bf16_1k v[24:39], v[114:115], v[218:219], 0
    v_exp_f32 v8, v8
    v_exp_f32 v9, v9
    v_exp_f32 v10, v10
    v_exp_f32 v11, v11
    v_mfma_f32_32x32x16_bf16 v[56:71], v[104:107], v[80:83], v[56:71]
    ds_read_b128 v[100:103], v221 offset:60416
    v_exp_f32 v12, v12
    v_exp_f32 v13, v13
    v_exp_f32 v14, v14
    v_exp_f32 v15, v15
    v_cvt_pk_bf16_f32 v72, v8, v9
    v_cvt_pk_bf16_f32 v73, v10, v11
    v_cvt_pk_bf16_f32 v74, v12, v13
    v_cvt_pk_bf16_f32 v75, v14, v15
    v_mfma_f32_32x32x16_bf16 v[24:39], v[92:95], v[212:215], v[24:39]
    v_exp_f32 v16, v16
    v_exp_f32 v17, v17
    v_exp_f32 v18, v18
    v_exp_f32 v19, v19
    v_mfma_f32_32x32x16_bf16 v[56:71], v[96:99], v[84:87], v[56:71]
    s_waitcnt lgkmcnt(0)
    v_exp_f32 v20, v20
    v_exp_f32 v21, v21
    v_exp_f32 v22, v22
    v_exp_f32 v23, v23
    v_cvt_pk_bf16_f32 v76, v16, v17
    v_cvt_pk_bf16_f32 v77, v18, v19
    v_cvt_pk_bf16_f32 v78, v20, v21
    v_cvt_pk_bf16_f32 v79, v22, v23
    v_mfma_f32_32x32x8bf16_1k v[8:23], v[112:113], v[216:217], 0
    v_exp_f32 v24, v24
    v_exp_f32 v25, v25
    v_exp_f32 v26, v26
    v_exp_f32 v27, v27
    v_mfma_f32_32x32x16_bf16 v[40:55], v[108:111], v[72:75], v[40:55]
    s_mov_b64 exec, 1
    ds_add_u32 v135, v136
    s_mov_b64 exec, -1
    ds_read_b128 v[92:95], v220 offset:3072
    v_exp_f32 v28, v28
    v_exp_f32 v29, v29
    v_exp_f32 v30, v30
    v_exp_f32 v31, v31
    v_cvt_pk_bf16_f32 v80, v24, v25
    v_cvt_pk_bf16_f32 v81, v26, v27
    v_cvt_pk_bf16_f32 v82, v28, v29
    v_cvt_pk_bf16_f32 v83, v30, v31
    v_mfma_f32_32x32x16_bf16 v[8:23], v[88:91], v[208:211], v[8:23]
    ds_read_u16 v114, v222 offset:3072
    v_exp_f32 v32, v32
    v_exp_f32 v33, v33
    v_exp_f32 v34, v34
    v_exp_f32 v35, v35
    v_mfma_f32_32x32x16_bf16 v[40:55], v[100:103], v[76:79], v[40:55]
    ds_read_b128 v[104:107], v221 offset:1024
    v_exp_f32 v36, v36
    v_exp_f32 v37, v37
    v_exp_f32 v38, v38
    v_exp_f32 v39, v39
    v_cvt_pk_bf16_f32 v84, v32, v33
    v_cvt_pk_bf16_f32 v85, v34, v35
    v_cvt_pk_bf16_f32 v86, v36, v37
    v_cvt_pk_bf16_f32 v87, v38, v39
    v_mfma_f32_32x32x8bf16_1k v[24:39], v[112:113], v[218:219], 0
    v_exp_f32 v8, v8
    v_exp_f32 v9, v9
    v_exp_f32 v10, v10
    v_exp_f32 v11, v11
    v_mfma_f32_32x32x16_bf16 v[56:71], v[108:111], v[80:83], v[56:71]
    ds_read_b128 v[96:99], v221 offset:2048
    v_exp_f32 v12, v12
    v_exp_f32 v13, v13
    v_exp_f32 v14, v14
    v_exp_f32 v15, v15
    v_cvt_pk_bf16_f32 v72, v8, v9
    v_cvt_pk_bf16_f32 v73, v10, v11
    v_cvt_pk_bf16_f32 v74, v12, v13
    v_cvt_pk_bf16_f32 v75, v14, v15
    v_mfma_f32_32x32x16_bf16 v[24:39], v[88:91], v[212:215], v[24:39]
    v_exp_f32 v16, v16
    v_exp_f32 v17, v17
    v_exp_f32 v18, v18
    v_exp_f32 v19, v19
    v_mfma_f32_32x32x16_bf16 v[56:71], v[100:103], v[84:87], v[56:71]
    s_waitcnt lgkmcnt(0)
    v_exp_f32 v20, v20
    v_exp_f32 v21, v21
    v_exp_f32 v22, v22
    v_exp_f32 v23, v23
    v_cvt_pk_bf16_f32 v76, v16, v17
    v_cvt_pk_bf16_f32 v77, v18, v19
    v_cvt_pk_bf16_f32 v78, v20, v21
    v_cvt_pk_bf16_f32 v79, v22, v23
    v_mfma_f32_32x32x8bf16_1k v[8:23], v[114:115], v[216:217], 0
    v_exp_f32 v24, v24
    v_exp_f32 v25, v25
    v_exp_f32 v26, v26
    v_exp_f32 v27, v27
    v_mfma_f32_32x32x16_bf16 v[40:55], v[104:107], v[72:75], v[40:55]
    ds_read_b128 v[88:91], v220 offset:6144
    v_exp_f32 v28, v28
    v_exp_f32 v29, v29
    v_exp_f32 v30, v30
    v_exp_f32 v31, v31
    v_cvt_pk_bf16_f32 v80, v24, v25
    v_cvt_pk_bf16_f32 v81, v26, v27
    v_cvt_pk_bf16_f32 v82, v28, v29
    v_cvt_pk_bf16_f32 v83, v30, v31
    v_mfma_f32_32x32x16_bf16 v[8:23], v[92:95], v[208:211], v[8:23]
    ds_read_u16 v112, v222 offset:6144
    v_exp_f32 v32, v32
    v_exp_f32 v33, v33
    v_exp_f32 v34, v34
    v_exp_f32 v35, v35
    v_mfma_f32_32x32x16_bf16 v[40:55], v[96:99], v[76:79], v[40:55]
    ds_read_b128 v[108:111], v221 offset:4096
    v_exp_f32 v36, v36
    v_exp_f32 v37, v37
    v_exp_f32 v38, v38
    v_exp_f32 v39, v39
    v_cvt_pk_bf16_f32 v84, v32, v33
    v_cvt_pk_bf16_f32 v85, v34, v35
    v_cvt_pk_bf16_f32 v86, v36, v37
    v_cvt_pk_bf16_f32 v87, v38, v39
    v_mfma_f32_32x32x8bf16_1k v[24:39], v[114:115], v[218:219], 0
    v_exp_f32 v8, v8
    v_exp_f32 v9, v9
    v_exp_f32 v10, v10
    v_exp_f32 v11, v11
    v_mfma_f32_32x32x16_bf16 v[56:71], v[104:107], v[80:83], v[56:71]
    ds_read_b128 v[100:103], v221 offset:5120
    v_exp_f32 v12, v12
    v_exp_f32 v13, v13
    v_exp_f32 v14, v14
    v_exp_f32 v15, v15
    v_cvt_pk_bf16_f32 v72, v8, v9
    v_cvt_pk_bf16_f32 v73, v10, v11
    v_cvt_pk_bf16_f32 v74, v12, v13
    v_cvt_pk_bf16_f32 v75, v14, v15
    v_mfma_f32_32x32x16_bf16 v[24:39], v[92:95], v[212:215], v[24:39]
    v_exp_f32 v16, v16
    v_exp_f32 v17, v17
    v_exp_f32 v18, v18
    v_exp_f32 v19, v19
    v_mfma_f32_32x32x16_bf16 v[56:71], v[96:99], v[84:87], v[56:71]
    s_waitcnt lgkmcnt(0)
    v_exp_f32 v20, v20
    v_exp_f32 v21, v21
    v_exp_f32 v22, v22
    v_exp_f32 v23, v23
    v_cvt_pk_bf16_f32 v76, v16, v17
    v_cvt_pk_bf16_f32 v77, v18, v19
    v_cvt_pk_bf16_f32 v78, v20, v21
    v_cvt_pk_bf16_f32 v79, v22, v23
    v_mfma_f32_32x32x8bf16_1k v[8:23], v[112:113], v[216:217], 0
    v_exp_f32 v24, v24
    v_exp_f32 v25, v25
    v_exp_f32 v26, v26
    v_exp_f32 v27, v27
    v_mfma_f32_32x32x16_bf16 v[40:55], v[108:111], v[72:75], v[40:55]
    ds_read_b128 v[92:95], v220 offset:9216
    v_exp_f32 v28, v28
    v_exp_f32 v29, v29
    v_exp_f32 v30, v30
    v_exp_f32 v31, v31
    v_cvt_pk_bf16_f32 v80, v24, v25
    v_cvt_pk_bf16_f32 v81, v26, v27
    v_cvt_pk_bf16_f32 v82, v28, v29
    v_cvt_pk_bf16_f32 v83, v30, v31
    v_mfma_f32_32x32x16_bf16 v[8:23], v[88:91], v[208:211], v[8:23]
    ds_read_u16 v114, v222 offset:9216
    v_exp_f32 v32, v32
    v_exp_f32 v33, v33
    v_exp_f32 v34, v34
    v_exp_f32 v35, v35
    v_mfma_f32_32x32x16_bf16 v[40:55], v[100:103], v[76:79], v[40:55]
    ds_read_b128 v[104:107], v221 offset:7168
    v_exp_f32 v36, v36
    v_exp_f32 v37, v37
    v_exp_f32 v38, v38
    v_exp_f32 v39, v39
    v_cvt_pk_bf16_f32 v84, v32, v33
    v_cvt_pk_bf16_f32 v85, v34, v35
    v_cvt_pk_bf16_f32 v86, v36, v37
    v_cvt_pk_bf16_f32 v87, v38, v39
    v_mfma_f32_32x32x8bf16_1k v[24:39], v[112:113], v[218:219], 0
    v_exp_f32 v8, v8
    v_exp_f32 v9, v9
    v_exp_f32 v10, v10
    v_exp_f32 v11, v11
    v_mfma_f32_32x32x16_bf16 v[56:71], v[108:111], v[80:83], v[56:71]
    ds_read_b128 v[96:99], v221 offset:8192
    v_exp_f32 v12, v12
    v_exp_f32 v13, v13
    v_exp_f32 v14, v14
    v_exp_f32 v15, v15
    v_cvt_pk_bf16_f32 v72, v8, v9
    v_cvt_pk_bf16_f32 v73, v10, v11
    v_cvt_pk_bf16_f32 v74, v12, v13
    v_cvt_pk_bf16_f32 v75, v14, v15
    v_mfma_f32_32x32x16_bf16 v[24:39], v[88:91], v[212:215], v[24:39]
    ds_read2_b32 v[132:133], v134 offset1:4
    v_exp_f32 v16, v16
    v_exp_f32 v17, v17
    v_exp_f32 v18, v18
    v_exp_f32 v19, v19
    v_mfma_f32_32x32x16_bf16 v[56:71], v[100:103], v[84:87], v[56:71]
    s_waitcnt lgkmcnt(0)
    v_exp_f32 v20, v20
    v_exp_f32 v21, v21
    v_exp_f32 v22, v22
    v_exp_f32 v23, v23
    v_cvt_pk_bf16_f32 v76, v16, v17
    v_cvt_pk_bf16_f32 v77, v18, v19
    v_cvt_pk_bf16_f32 v78, v20, v21
    v_cvt_pk_bf16_f32 v79, v22, v23
    v_mfma_f32_32x32x8bf16_1k v[8:23], v[114:115], v[216:217], 0
    v_exp_f32 v24, v24
    v_exp_f32 v25, v25
    v_exp_f32 v26, v26
    v_exp_f32 v27, v27
    v_mfma_f32_32x32x16_bf16 v[40:55], v[104:107], v[72:75], v[40:55]
    v_cmp_gt_u32 vcc, 12, v133
    s_cbranch_vccz ATT_c40_ok
ATT_c40_spin:
    ds_read2_b32 v[132:133], v134 offset1:4
    s_waitcnt lgkmcnt(0)
    v_cmp_gt_u32 vcc, 12, v133
    s_cbranch_vccnz ATT_c40_spin
ATT_c40_ok:
    ds_read_b128 v[88:91], v220 offset:12288
    v_exp_f32 v28, v28
    v_exp_f32 v29, v29
    v_exp_f32 v30, v30
    v_exp_f32 v31, v31
    v_cvt_pk_bf16_f32 v80, v24, v25
    v_cvt_pk_bf16_f32 v81, v26, v27
    v_cvt_pk_bf16_f32 v82, v28, v29
    v_cvt_pk_bf16_f32 v83, v30, v31
    v_mfma_f32_32x32x16_bf16 v[8:23], v[92:95], v[208:211], v[8:23]
    ds_read_u16 v112, v222 offset:12288
    v_exp_f32 v32, v32
    v_exp_f32 v33, v33
    v_exp_f32 v34, v34
    v_exp_f32 v35, v35
    v_mfma_f32_32x32x16_bf16 v[40:55], v[96:99], v[76:79], v[40:55]
    ds_read_b128 v[108:111], v221 offset:10240
    v_exp_f32 v36, v36
    v_exp_f32 v37, v37
    v_exp_f32 v38, v38
    v_exp_f32 v39, v39
    v_cvt_pk_bf16_f32 v84, v32, v33
    v_cvt_pk_bf16_f32 v85, v34, v35
    v_cvt_pk_bf16_f32 v86, v36, v37
    v_cvt_pk_bf16_f32 v87, v38, v39
    v_mfma_f32_32x32x8bf16_1k v[24:39], v[114:115], v[218:219], 0
    v_exp_f32 v8, v8
    v_exp_f32 v9, v9
    v_exp_f32 v10, v10
    v_exp_f32 v11, v11
    v_mfma_f32_32x32x16_bf16 v[56:71], v[104:107], v[80:83], v[56:71]
    ds_read_b128 v[100:103], v221 offset:11264
    v_exp_f32 v12, v12
    v_exp_f32 v13, v13
    v_exp_f32 v14, v14
    v_exp_f32 v15, v15
    v_cvt_pk_bf16_f32 v72, v8, v9
    v_cvt_pk_bf16_f32 v73, v10, v11
    v_cvt_pk_bf16_f32 v74, v12, v13
    v_cvt_pk_bf16_f32 v75, v14, v15
    v_mfma_f32_32x32x16_bf16 v[24:39], v[92:95], v[212:215], v[24:39]
    v_exp_f32 v16, v16
    v_exp_f32 v17, v17
    v_exp_f32 v18, v18
    v_exp_f32 v19, v19
    v_mfma_f32_32x32x16_bf16 v[56:71], v[96:99], v[84:87], v[56:71]
    s_waitcnt lgkmcnt(0)
    v_exp_f32 v20, v20
    v_exp_f32 v21, v21
    v_exp_f32 v22, v22
    v_exp_f32 v23, v23
    v_cvt_pk_bf16_f32 v76, v16, v17
    v_cvt_pk_bf16_f32 v77, v18, v19
    v_cvt_pk_bf16_f32 v78, v20, v21
    v_cvt_pk_bf16_f32 v79, v22, v23
    v_mfma_f32_32x32x8bf16_1k v[8:23], v[112:113], v[216:217], 0
    v_exp_f32 v24, v24
    v_exp_f32 v25, v25
    v_exp_f32 v26, v26
    v_exp_f32 v27, v27
    v_mfma_f32_32x32x16_bf16 v[40:55], v[108:111], v[72:75], v[40:55]
    s_mov_b64 exec, 1
    ds_add_u32 v135, v136
    s_mov_b64 exec, -1
    ds_read_b128 v[92:95], v220 offset:15360
    v_exp_f32 v28, v28
    v_exp_f32 v29, v29
    v_exp_f32 v30, v30
    v_exp_f32 v31, v31
    v_cvt_pk_bf16_f32 v80, v24, v25
    v_cvt_pk_bf16_f32 v81, v26, v27
    v_cvt_pk_bf16_f32 v82, v28, v29
    v_cvt_pk_bf16_f32 v83, v30, v31
    v_mfma_f32_32x32x16_bf16 v[8:23], v[88:91], v[208:211], v[8:23]
    ds_read_u16 v114, v222 offset:15360
    v_exp_f32 v32, v32
    v_exp_f32 v33, v33
    v_exp_f32 v34, v34
    v_exp_f32 v35, v35
    v_mfma_f32_32x32x16_bf16 v[40:55], v[100:103], v[76:79], v[40:55]
    ds_read_b128 v[104:107], v221 offset:13312
    v_exp_f32 v36, v36
    v_exp_f32 v37, v37
    v_exp_f32 v38, v38
    v_exp_f32 v39, v39
    v_cvt_pk_bf16_f32 v84, v32, v33
    v_cvt_pk_bf16_f32 v85, v34, v35
    v_cvt_pk_bf16_f32 v86, v36, v37
    v_cvt_pk_bf16_f32 v87, v38, v39
    v_mfma_f32_32x32x8bf16_1k v[24:39], v[112:113], v[218:219], 0
    v_exp_f32 v8, v8
    v_exp_f32 v9, v9
    v_exp_f32 v10, v10
    v_exp_f32 v11, v11
    v_mfma_f32_32x32x16_bf16 v[56:71], v[108:111], v[80:83], v[56:71]
    ds_read_b128 v[96:99], v221 offset:14336
    v_exp_f32 v12, v12
    v_exp_f32 v13, v13
    v_exp_f32 v14, v14
    v_exp_f32 v15, v15
    v_cvt_pk_bf16_f32 v72, v8, v9
    v_cvt_pk_bf16_f32 v73, v10, v11
    v_cvt_pk_bf16_f32 v74, v12, v13
    v_cvt_pk_bf16_f32 v75, v14, v15
    v_mfma_f32_32x32x16_bf16 v[24:39], v[88:91], v[212:215], v[24:39]
    v_exp_f32 v16, v16
    v_exp_f32 v17, v17
    v_exp_f32 v18, v18
    v_exp_f32 v19, v19
    v_mfma_f32_32x32x16_bf16 v[56:71], v[100:103], v[84:87], v[56:71]
    s_waitcnt lgkmcnt(0)
    v_exp_f32 v20, v20
    v_exp_f32 v21, v21
    v_exp_f32 v22, v22
    v_exp_f32 v23, v23
    v_cvt_pk_bf16_f32 v76, v16, v17
    v_cvt_pk_bf16_f32 v77, v18, v19
    v_cvt_pk_bf16_f32 v78, v20, v21
    v_cvt_pk_bf16_f32 v79, v22, v23
    v_mfma_f32_32x32x8bf16_1k v[8:23], v[114:115], v[216:217], 0
    v_exp_f32 v24, v24
    v_exp_f32 v25, v25
    v_exp_f32 v26, v26
    v_exp_f32 v27, v27
    v_mfma_f32_32x32x16_bf16 v[40:55], v[104:107], v[72:75], v[40:55]
    ds_read_b128 v[88:91], v220 offset:18432
    v_exp_f32 v28, v28
    v_exp_f32 v29, v29
    v_exp_f32 v30, v30
    v_exp_f32 v31, v31
    v_cvt_pk_bf16_f32 v80, v24, v25
    v_cvt_pk_bf16_f32 v81, v26, v27
    v_cvt_pk_bf16_f32 v82, v28, v29
    v_cvt_pk_bf16_f32 v83, v30, v31
    v_mfma_f32_32x32x16_bf16 v[8:23], v[92:95], v[208:211], v[8:23]
    ds_read_u16 v112, v222 offset:18432
    v_exp_f32 v32, v32
    v_exp_f32 v33, v33
    v_exp_f32 v34, v34
    v_exp_f32 v35, v35
    v_mfma_f32_32x32x16_bf16 v[40:55], v[96:99], v[76:79], v[40:55]
    ds_read_b128 v[108:111], v221 offset:16384
    v_exp_f32 v36, v36
    v_exp_f32 v37, v37
    v_exp_f32 v38, v38
    v_exp_f32 v39, v39
    v_cvt_pk_bf16_f32 v84, v32, v33
    v_cvt_pk_bf16_f32 v85, v34, v35
    v_cvt_pk_bf16_f32 v86, v36, v37
    v_cvt_pk_bf16_f32 v87, v38, v39
    v_mfma_f32_32x32x8bf16_1k v[24:39], v[114:115], v[218:219], 0
    v_exp_f32 v8, v8
    v_exp_f32 v9, v9
    v_exp_f32 v10, v10
    v_exp_f32 v11, v11
    v_mfma_f32_32x32x16_bf16 v[56:71], v[104:107], v[80:83], v[56:71]
    ds_read_b128 v[100:103], v221 offset:17408
    v_exp_f32 v12, v12
    v_exp_f32 v13, v13
    v_exp_f32 v14, v14
    v_exp_f32 v15, v15
    v_cvt_pk_bf16_f32 v72, v8, v9
    v_cvt_pk_bf16_f32 v73, v10, v11
    v_cvt_pk_bf16_f32 v74, v12, v13
    v_cvt_pk_bf16_f32 v75, v14, v15
    v_mfma_f32_32x32x16_bf16 v[24:39], v[92:95], v[212:215], v[24:39]
    v_exp_f32 v16, v16
    v_exp_f32 v17, v17
    v_exp_f32 v18, v18
    v_exp_f32 v19, v19
    v_mfma_f32_32x32x16_bf16 v[56:71], v[96:99], v[84:87], v[56:71]
    s_waitcnt lgkmcnt(0)
    v_exp_f32 v20, v20
    v_exp_f32 v21, v21
    v_exp_f32 v22, v22
    v_exp_f32 v23, v23
    v_cvt_pk_bf16_f32 v76, v16, v17
    v_cvt_pk_bf16_f32 v77, v18, v19
    v_cvt_pk_bf16_f32 v78, v20, v21
    v_cvt_pk_bf16_f32 v79, v22, v23
    v_mfma_f32_32x32x8bf16_1k v[8:23], v[112:113], v[216:217], 0
    v_exp_f32 v24, v24
    v_exp_f32 v25, v25
    v_exp_f32 v26, v26
    v_exp_f32 v27, v27
    v_mfma_f32_32x32x16_bf16 v[40:55], v[108:111], v[72:75], v[40:55]
    ds_read_b128 v[92:95], v220 offset:21504
    v_exp_f32 v28, v28
    v_exp_f32 v29, v29
    v_exp_f32 v30, v30
    v_exp_f32 v31, v31
    v_cvt_pk_bf16_f32 v80, v24, v25
    v_cvt_pk_bf16_f32 v81, v26, v27
    v_cvt_pk_bf16_f32 v82, v28, v29
    v_cvt_pk_bf16_f32 v83, v30, v31
    v_mfma_f32_32x32x16_bf16 v[8:23], v[88:91], v[208:211], v[8:23]
    ds_read_u16 v114, v222 offset:21504
    v_exp_f32 v32, v32
    v_exp_f32 v33, v33
    v_exp_f32 v34, v34
    v_exp_f32 v35, v35
    v_mfma_f32_32x32x16_bf16 v[40:55], v[100:103], v[76:79], v[40:55]
    ds_read_b128 v[104:107], v221 offset:19456
    v_exp_f32 v36, v36
    v_exp_f32 v37, v37
    v_exp_f32 v38, v38
    v_exp_f32 v39, v39
    v_cvt_pk_bf16_f32 v84, v32, v33
    v_cvt_pk_bf16_f32 v85, v34, v35
    v_cvt_pk_bf16_f32 v86, v36, v37
    v_cvt_pk_bf16_f32 v87, v38, v39
    v_mfma_f32_32x32x8bf16_1k v[24:39], v[112:113], v[218:219], 0
    v_exp_f32 v8, v8
    v_exp_f32 v9, v9
    v_exp_f32 v10, v10
    v_exp_f32 v11, v11
    v_mfma_f32_32x32x16_bf16 v[56:71], v[108:111], v[80:83], v[56:71]
    ds_read_b128 v[96:99], v221 offset:20480
    v_exp_f32 v12, v12
    v_exp_f32 v13, v13
    v_exp_f32 v14, v14
    v_exp_f32 v15, v15
    v_cvt_pk_bf16_f32 v72, v8, v9
    v_cvt_pk_bf16_f32 v73, v10, v11
    v_cvt_pk_bf16_f32 v74, v12, v13
    v_cvt_pk_bf16_f32 v75, v14, v15
    v_mfma_f32_32x32x16_bf16 v[24:39], v[88:91], v[212:215], v[24:39]
    ds_read2_b32 v[132:133], v134 offset1:4
    v_exp_f32 v16, v16
    v_exp_f32 v17, v17
    v_exp_f32 v18, v18
    v_exp_f32 v19, v19
    v_mfma_f32_32x32x16_bf16 v[56:71], v[100:103], v[84:87], v[56:71]
    s_waitcnt lgkmcnt(0)
    v_exp_f32 v20, v20
    v_exp_f32 v21, v21
    v_exp_f32 v22, v22
    v_exp_f32 v23, v23
    v_cvt_pk_bf16_f32 v76, v16, v17
    v_cvt_pk_bf16_f32 v77, v18, v19
    v_cvt_pk_bf16_f32 v78, v20, v21
    v_cvt_pk_bf16_f32 v79, v22, v23
    v_mfma_f32_32x32x8bf16_1k v[8:23], v[114:115], v[216:217], 0
    v_exp_f32 v24, v24
    v_exp_f32 v25, v25
    v_exp_f32 v26, v26
    v_exp_f32 v27, v27
    v_mfma_f32_32x32x16_bf16 v[40:55], v[104:107], v[72:75], v[40:55]
    v_cmp_gt_u32 vcc, 13, v133
    s_cbranch_vccz ATT_c44_ok
ATT_c44_spin:
    ds_read2_b32 v[132:133], v134 offset1:4
    s_waitcnt lgkmcnt(0)
    v_cmp_gt_u32 vcc, 13, v133
    s_cbranch_vccnz ATT_c44_spin
ATT_c44_ok:
    ds_read_b128 v[88:91], v220 offset:24576
    v_exp_f32 v28, v28
    v_exp_f32 v29, v29
    v_exp_f32 v30, v30
    v_exp_f32 v31, v31
    v_cvt_pk_bf16_f32 v80, v24, v25
    v_cvt_pk_bf16_f32 v81, v26, v27
    v_cvt_pk_bf16_f32 v82, v28, v29
    v_cvt_pk_bf16_f32 v83, v30, v31
    v_mfma_f32_32x32x16_bf16 v[8:23], v[92:95], v[208:211], v[8:23]
    ds_read_u16 v112, v222 offset:24576
    v_exp_f32 v32, v32
    v_exp_f32 v33, v33
    v_exp_f32 v34, v34
    v_exp_f32 v35, v35
    v_mfma_f32_32x32x16_bf16 v[40:55], v[96:99], v[76:79], v[40:55]
    ds_read_b128 v[108:111], v221 offset:22528
    v_exp_f32 v36, v36
    v_exp_f32 v37, v37
    v_exp_f32 v38, v38
    v_exp_f32 v39, v39
    v_cvt_pk_bf16_f32 v84, v32, v33
    v_cvt_pk_bf16_f32 v85, v34, v35
    v_cvt_pk_bf16_f32 v86, v36, v37
    v_cvt_pk_bf16_f32 v87, v38, v39
    v_mfma_f32_32x32x8bf16_1k v[24:39], v[114:115], v[218:219], 0
    v_exp_f32 v8, v8
    v_exp_f32 v9, v9
    v_exp_f32 v10, v10
    v_exp_f32 v11, v11
    v_mfma_f32_32x32x16_bf16 v[56:71], v[104:107], v[80:83], v[56:71]
    ds_read_b128 v[100:103], v221 offset:23552
    v_exp_f32 v12, v12
    v_exp_f32 v13, v13
    v_exp_f32 v14, v14
    v_exp_f32 v15, v15
    v_cvt_pk_bf16_f32 v72, v8, v9
    v_cvt_pk_bf16_f32 v73, v10, v11
    v_cvt_pk_bf16_f32 v74, v12, v13
    v_cvt_pk_bf16_f32 v75, v14, v15
    v_mfma_f32_32x32x16_bf16 v[24:39], v[92:95], v[212:215], v[24:39]
    v_exp_f32 v16, v16
    v_exp_f32 v17, v17
    v_exp_f32 v18, v18
    v_exp_f32 v19, v19
    v_mfma_f32_32x32x16_bf16 v[56:71], v[96:99], v[84:87], v[56:71]
    s_waitcnt lgkmcnt(0)
    v_exp_f32 v20, v20
    v_exp_f32 v21, v21
    v_exp_f32 v22, v22
    v_exp_f32 v23, v23
    v_cvt_pk_bf16_f32 v76, v16, v17
    v_cvt_pk_bf16_f32 v77, v18, v19
    v_cvt_pk_bf16_f32 v78, v20, v21
    v_cvt_pk_bf16_f32 v79, v22, v23
    v_mfma_f32_32x32x8bf16_1k v[8:23], v[112:113], v[216:217], 0
    v_exp_f32 v24, v24
    v_exp_f32 v25, v25
    v_exp_f32 v26, v26
    v_exp_f32 v27, v27
    v_mfma_f32_32x32x16_bf16 v[40:55], v[108:111], v[72:75], v[40:55]
    s_mov_b64 exec, 1
    ds_add_u32 v135, v136
    s_mov_b64 exec, -1
    ds_read_b128 v[92:95], v220 offset:27648
    v_exp_f32 v28, v28
    v_exp_f32 v29, v29
    v_exp_f32 v30, v30
    v_exp_f32 v31, v31
    v_cvt_pk_bf16_f32 v80, v24, v25
    v_cvt_pk_bf16_f32 v81, v26, v27
    v_cvt_pk_bf16_f32 v82, v28, v29
    v_cvt_pk_bf16_f32 v83, v30, v31
    v_mfma_f32_32x32x16_bf16 v[8:23], v[88:91], v[208:211], v[8:23]
    ds_read_u16 v114, v222 offset:27648
    v_exp_f32 v32, v32
    v_exp_f32 v33, v33
    v_exp_f32 v34, v34
    v_exp_f32 v35, v35
    v_mfma_f32_32x32x16_bf16 v[40:55], v[100:103], v[76:79], v[40:55]
    ds_read_b128 v[104:107], v221 offset:25600
    v_exp_f32 v36, v36
    v_exp_f32 v37, v37
    v_exp_f32 v38, v38
    v_exp_f32 v39, v39
    v_cvt_pk_bf16_f32 v84, v32, v33
    v_cvt_pk_bf16_f32 v85, v34, v35
    v_cvt_pk_bf16_f32 v86, v36, v37
    v_cvt_pk_bf16_f32 v87, v38, v39
    v_mfma_f32_32x32x8bf16_1k v[24:39], v[112:113], v[218:219], 0
    v_exp_f32 v8, v8
    v_exp_f32 v9, v9
    v_exp_f32 v10, v10
    v_exp_f32 v11, v11
    v_mfma_f32_32x32x16_bf16 v[56:71], v[108:111], v[80:83], v[56:71]
    ds_read_b128 v[96:99], v221 offset:26624
    v_exp_f32 v12, v12
    v_exp_f32 v13, v13
    v_exp_f32 v14, v14
    v_exp_f32 v15, v15
    v_cvt_pk_bf16_f32 v72, v8, v9
    v_cvt_pk_bf16_f32 v73, v10, v11
    v_cvt_pk_bf16_f32 v74, v12, v13
    v_cvt_pk_bf16_f32 v75, v14, v15
    v_mfma_f32_32x32x16_bf16 v[24:39], v[88:91], v[212:215], v[24:39]
    v_exp_f32 v16, v16
    v_exp_f32 v17, v17
    v_exp_f32 v18, v18
    v_exp_f32 v19, v19
    v_mfma_f32_32x32x16_bf16 v[56:71], v[100:103], v[84:87], v[56:71]
    s_waitcnt lgkmcnt(0)
    v_exp_f32 v20, v20
    v_exp_f32 v21, v21
    v_exp_f32 v22, v22
    v_exp_f32 v23, v23
    v_cvt_pk_bf16_f32 v76, v16, v17
    v_cvt_pk_bf16_f32 v77, v18, v19
    v_cvt_pk_bf16_f32 v78, v20, v21
    v_cvt_pk_bf16_f32 v79, v22, v23
    v_mfma_f32_32x32x8bf16_1k v[8:23], v[114:115], v[216:217], 0
    v_exp_f32 v24, v24
    v_exp_f32 v25, v25
    v_exp_f32 v26, v26
    v_exp_f32 v27, v27
    v_mfma_f32_32x32x16_bf16 v[40:55], v[104:107], v[72:75], v[40:55]
    ds_read_b128 v[88:91], v220 offset:30720
    v_exp_f32 v28, v28
    v_exp_f32 v29, v29
    v_exp_f32 v30, v30
    v_exp_f32 v31, v31
    v_cvt_pk_bf16_f32 v80, v24, v25
    v_cvt_pk_bf16_f32 v81, v26, v27
    v_cvt_pk_bf16_f32 v82, v28, v29
    v_cvt_pk_bf16_f32 v83, v30, v31
    v_mfma_f32_32x32x16_bf16 v[8:23], v[92:95], v[208:211], v[8:23]
    ds_read_u16 v112, v222 offset:30720
    v_exp_f32 v32, v32
    v_exp_f32 v33, v33
    v_exp_f32 v34, v34
    v_exp_f32 v35, v35
    v_mfma_f32_32x32x16_bf16 v[40:55], v[96:99], v[76:79], v[40:55]
    ds_read_b128 v[108:111], v221 offset:28672
    v_exp_f32 v36, v36
    v_exp_f32 v37, v37
    v_exp_f32 v38, v38
    v_exp_f32 v39, v39
    v_cvt_pk_bf16_f32 v84, v32, v33
    v_cvt_pk_bf16_f32 v85, v34, v35
    v_cvt_pk_bf16_f32 v86, v36, v37
    v_cvt_pk_bf16_f32 v87, v38, v39
    v_mfma_f32_32x32x8bf16_1k v[24:39], v[114:115], v[218:219], 0
    v_exp_f32 v8, v8
    v_exp_f32 v9, v9
    v_exp_f32 v10, v10
    v_exp_f32 v11, v11
    v_mfma_f32_32x32x16_bf16 v[56:71], v[104:107], v[80:83], v[56:71]
    ds_read_b128 v[100:103], v221 offset:29696
    v_exp_f32 v12, v12
    v_exp_f32 v13, v13
    v_exp_f32 v14, v14
    v_exp_f32 v15, v15
    v_cvt_pk_bf16_f32 v72, v8, v9
    v_cvt_pk_bf16_f32 v73, v10, v11
    v_cvt_pk_bf16_f32 v74, v12, v13
    v_cvt_pk_bf16_f32 v75, v14, v15
    v_mfma_f32_32x32x16_bf16 v[24:39], v[92:95], v[212:215], v[24:39]
    v_exp_f32 v16, v16
    v_exp_f32 v17, v17
    v_exp_f32 v18, v18
    v_exp_f32 v19, v19
    v_mfma_f32_32x32x16_bf16 v[56:71], v[96:99], v[84:87], v[56:71]
    s_waitcnt lgkmcnt(0)
    v_exp_f32 v20, v20
    v_exp_f32 v21, v21
    v_exp_f32 v22, v22
    v_exp_f32 v23, v23
    v_cvt_pk_bf16_f32 v76, v16, v17
    v_cvt_pk_bf16_f32 v77, v18, v19
    v_cvt_pk_bf16_f32 v78, v20, v21
    v_cvt_pk_bf16_f32 v79, v22, v23
    v_mfma_f32_32x32x8bf16_1k v[8:23], v[112:113], v[216:217], 0
    v_exp_f32 v24, v24
    v_exp_f32 v25, v25
    v_exp_f32 v26, v26
    v_exp_f32 v27, v27
    v_mfma_f32_32x32x16_bf16 v[40:55], v[108:111], v[72:75], v[40:55]
    ds_read_b128 v[92:95], v220 offset:33792
    v_exp_f32 v28, v28
    v_exp_f32 v29, v29
    v_exp_f32 v30, v30
    v_exp_f32 v31, v31
    v_cvt_pk_bf16_f32 v80, v24, v25
    v_cvt_pk_bf16_f32 v81, v26, v27
    v_cvt_pk_bf16_f32 v82, v28, v29
    v_cvt_pk_bf16_f32 v83, v30, v31
    v_mfma_f32_32x32x16_bf16 v[8:23], v[88:91], v[208:211], v[8:23]
    ds_read_u16 v114, v222 offset:33792
    v_exp_f32 v32, v32
    v_exp_f32 v33, v33
    v_exp_f32 v34, v34
    v_exp_f32 v35, v35
    v_mfma_f32_32x32x16_bf16 v[40:55], v[100:103], v[76:79], v[40:55]
    ds_read_b128 v[104:107], v221 offset:31744
    v_exp_f32 v36, v36
    v_exp_f32 v37, v37
    v_exp_f32 v38, v38
    v_exp_f32 v39, v39
    v_cvt_pk_bf16_f32 v84, v32, v33
    v_cvt_pk_bf16_f32 v85, v34, v35
    v_cvt_pk_bf16_f32 v86, v36, v37
    v_cvt_pk_bf16_f32 v87, v38, v39
    v_mfma_f32_32x32x8bf16_1k v[24:39], v[112:113], v[218:219], 0
    v_exp_f32 v8, v8
    v_exp_f32 v9, v9
    v_exp_f32 v10, v10
    v_exp_f32 v11, v11
    v_mfma_f32_32x32x16_bf16 v[56:71], v[108:111], v[80:83], v[56:71]
    ds_read_b128 v[96:99], v221 offset:32768
    v_exp_f32 v12, v12
    v_exp_f32 v13, v13
    v_exp_f32 v14, v14
    v_exp_f32 v15, v15
    v_cvt_pk_bf16_f32 v72, v8, v9
    v_cvt_pk_bf16_f32 v73, v10, v11
    v_cvt_pk_bf16_f32 v74, v12, v13
    v_cvt_pk_bf16_f32 v75, v14, v15
    v_mfma_f32_32x32x16_bf16 v[24:39], v[88:91], v[212:215], v[24:39]
    ds_read2_b32 v[132:133], v134 offset1:4
    v_exp_f32 v16, v16
    v_exp_f32 v17, v17
    v_exp_f32 v18, v18
    v_exp_f32 v19, v19
    v_mfma_f32_32x32x16_bf16 v[56:71], v[100:103], v[84:87], v[56:71]
    s_waitcnt lgkmcnt(0)
    v_exp_f32 v20, v20
    v_exp_f32 v21, v21
    v_exp_f32 v22, v22
    v_exp_f32 v23, v23
    v_cvt_pk_bf16_f32 v76, v16, v17
    v_cvt_pk_bf16_f32 v77, v18, v19
    v_cvt_pk_bf16_f32 v78, v20, v21
    v_cvt_pk_bf16_f32 v79, v22, v23
    v_mfma_f32_32x32x8bf16_1k v[8:23], v[114:115], v[216:217], 0
    v_exp_f32 v24, v24
    v_exp_f32 v25, v25
    v_exp_f32 v26, v26
    v_exp_f32 v27, v27
    v_mfma_f32_32x32x16_bf16 v[40:55], v[104:107], v[72:75], v[40:55]
    v_cmp_gt_u32 vcc, 14, v133
    s_cbranch_vccz ATT_c48_ok
ATT_c48_spin:
    ds_read2_b32 v[132:133], v134 offset1:4
    s_waitcnt lgkmcnt(0)
    v_cmp_gt_u32 vcc, 14, v133
    s_cbranch_vccnz ATT_c48_spin
ATT_c48_ok:
    ds_read_b128 v[88:91], v220 offset:36864
    v_exp_f32 v28, v28
    v_exp_f32 v29, v29
    v_exp_f32 v30, v30
    v_exp_f32 v31, v31
    v_cvt_pk_bf16_f32 v80, v24, v25
    v_cvt_pk_bf16_f32 v81, v26, v27
    v_cvt_pk_bf16_f32 v82, v28, v29
    v_cvt_pk_bf16_f32 v83, v30, v31
    v_mfma_f32_32x32x16_bf16 v[8:23], v[92:95], v[208:211], v[8:23]
    ds_read_u16 v112, v222 offset:36864
    v_exp_f32 v32, v32
    v_exp_f32 v33, v33
    v_exp_f32 v34, v34
    v_exp_f32 v35, v35
    v_mfma_f32_32x32x16_bf16 v[40:55], v[96:99], v[76:79], v[40:55]
    ds_read_b128 v[108:111], v221 offset:34816
    v_exp_f32 v36, v36
    v_exp_f32 v37, v37
    v_exp_f32 v38, v38
    v_exp_f32 v39, v39
    v_cvt_pk_bf16_f32 v84, v32, v33
    v_cvt_pk_bf16_f32 v85, v34, v35
    v_cvt_pk_bf16_f32 v86, v36, v37
    v_cvt_pk_bf16_f32 v87, v38, v39
    v_mfma_f32_32x32x8bf16_1k v[24:39], v[114:115], v[218:219], 0
    v_exp_f32 v8, v8
    v_exp_f32 v9, v9
    v_exp_f32 v10, v10
    v_exp_f32 v11, v11
    v_mfma_f32_32x32x16_bf16 v[56:71], v[104:107], v[80:83], v[56:71]
    ds_read_b128 v[100:103], v221 offset:35840
    v_exp_f32 v12, v12
    v_exp_f32 v13, v13
    v_exp_f32 v14, v14
    v_exp_f32 v15, v15
    v_cvt_pk_bf16_f32 v72, v8, v9
    v_cvt_pk_bf16_f32 v73, v10, v11
    v_cvt_pk_bf16_f32 v74, v12, v13
    v_cvt_pk_bf16_f32 v75, v14, v15
    v_mfma_f32_32x32x16_bf16 v[24:39], v[92:95], v[212:215], v[24:39]
    v_exp_f32 v16, v16
    v_exp_f32 v17, v17
    v_exp_f32 v18, v18
    v_exp_f32 v19, v19
    v_mfma_f32_32x32x16_bf16 v[56:71], v[96:99], v[84:87], v[56:71]
    s_waitcnt lgkmcnt(0)
    v_exp_f32 v20, v20
    v_exp_f32 v21, v21
    v_exp_f32 v22, v22
    v_exp_f32 v23, v23
    v_cvt_pk_bf16_f32 v76, v16, v17
    v_cvt_pk_bf16_f32 v77, v18, v19
    v_cvt_pk_bf16_f32 v78, v20, v21
    v_cvt_pk_bf16_f32 v79, v22, v23
    v_mfma_f32_32x32x8bf16_1k v[8:23], v[112:113], v[216:217], 0
    v_exp_f32 v24, v24
    v_exp_f32 v25, v25
    v_exp_f32 v26, v26
    v_exp_f32 v27, v27
    v_mfma_f32_32x32x16_bf16 v[40:55], v[108:111], v[72:75], v[40:55]
    ds_read_b128 v[92:95], v220 offset:39936
    v_exp_f32 v28, v28
    v_exp_f32 v29, v29
    v_exp_f32 v30, v30
    v_exp_f32 v31, v31
    v_cvt_pk_bf16_f32 v80, v24, v25
    v_cvt_pk_bf16_f32 v81, v26, v27
    v_cvt_pk_bf16_f32 v82, v28, v29
    v_cvt_pk_bf16_f32 v83, v30, v31
    v_mfma_f32_32x32x16_bf16 v[8:23], v[88:91], v[208:211], v[8:23]
    ds_read_u16 v114, v222 offset:39936
    v_exp_f32 v32, v32
    v_exp_f32 v33, v33
    v_exp_f32 v34, v34
    v_exp_f32 v35, v35
    v_mfma_f32_32x32x16_bf16 v[40:55], v[100:103], v[76:79], v[40:55]
    ds_read_b128 v[104:107], v221 offset:37888
    v_exp_f32 v36, v36
    v_exp_f32 v37, v37
    v_exp_f32 v38, v38
    v_exp_f32 v39, v39
    v_cvt_pk_bf16_f32 v84, v32, v33
    v_cvt_pk_bf16_f32 v85, v34, v35
    v_cvt_pk_bf16_f32 v86, v36, v37
    v_cvt_pk_bf16_f32 v87, v38, v39
    v_mfma_f32_32x32x8bf16_1k v[24:39], v[112:113], v[218:219], 0
    v_exp_f32 v8, v8
    v_exp_f32 v9, v9
    v_exp_f32 v10, v10
    v_exp_f32 v11, v11
    v_mfma_f32_32x32x16_bf16 v[56:71], v[108:111], v[80:83], v[56:71]
    ds_read_b128 v[96:99], v221 offset:38912
    v_exp_f32 v12, v12
    v_exp_f32 v13, v13
    v_exp_f32 v14, v14
    v_exp_f32 v15, v15
    v_cvt_pk_bf16_f32 v72, v8, v9
    v_cvt_pk_bf16_f32 v73, v10, v11
    v_cvt_pk_bf16_f32 v74, v12, v13
    v_cvt_pk_bf16_f32 v75, v14, v15
    v_mfma_f32_32x32x16_bf16 v[24:39], v[88:91], v[212:215], v[24:39]
    v_exp_f32 v16, v16
    v_exp_f32 v17, v17
    v_exp_f32 v18, v18
    v_exp_f32 v19, v19
    v_mfma_f32_32x32x16_bf16 v[56:71], v[100:103], v[84:87], v[56:71]
    s_waitcnt lgkmcnt(0)
    v_exp_f32 v20, v20
    v_exp_f32 v21, v21
    v_exp_f32 v22, v22
    v_exp_f32 v23, v23
    v_cvt_pk_bf16_f32 v76, v16, v17
    v_cvt_pk_bf16_f32 v77, v18, v19
    v_cvt_pk_bf16_f32 v78, v20, v21
    v_cvt_pk_bf16_f32 v79, v22, v23
    v_mfma_f32_32x32x8bf16_1k v[8:23], v[114:115], v[216:217], 0
    v_exp_f32 v24, v24
    v_exp_f32 v25, v25
    v_exp_f32 v26, v26
    v_exp_f32 v27, v27
    v_mfma_f32_32x32x16_bf16 v[40:55], v[104:107], v[72:75], v[40:55]
    ds_read_b128 v[88:91], v220 offset:43008
    v_exp_f32 v28, v28
    v_exp_f32 v29, v29
    v_exp_f32 v30, v30
    v_exp_f32 v31, v31
    v_cvt_pk_bf16_f32 v80, v24, v25
    v_cvt_pk_bf16_f32 v81, v26, v27
    v_cvt_pk_bf16_f32 v82, v28, v29
    v_cvt_pk_bf16_f32 v83, v30, v31
    v_mfma_f32_32x32x16_bf16 v[8:23], v[92:95], v[208:211], v[8:23]
    ds_read_u16 v112, v222 offset:43008
    v_exp_f32 v32, v32
    v_exp_f32 v33, v33
    v_exp_f32 v34, v34
    v_exp_f32 v35, v35
    v_mfma_f32_32x32x16_bf16 v[40:55], v[96:99], v[76:79], v[40:55]
    ds_read_b128 v[108:111], v221 offset:40960
    v_exp_f32 v36, v36
    v_exp_f32 v37, v37
    v_exp_f32 v38, v38
    v_exp_f32 v39, v39
    v_cvt_pk_bf16_f32 v84, v32, v33
    v_cvt_pk_bf16_f32 v85, v34, v35
    v_cvt_pk_bf16_f32 v86, v36, v37
    v_cvt_pk_bf16_f32 v87, v38, v39
    v_mfma_f32_32x32x8bf16_1k v[24:39], v[114:115], v[218:219], 0
    v_exp_f32 v8, v8
    v_exp_f32 v9, v9
    v_exp_f32 v10, v10
    v_exp_f32 v11, v11
    v_mfma_f32_32x32x16_bf16 v[56:71], v[104:107], v[80:83], v[56:71]
    ds_read_b128 v[100:103], v221 offset:41984
    v_exp_f32 v12, v12
    v_exp_f32 v13, v13
    v_exp_f32 v14, v14
    v_exp_f32 v15, v15
    v_cvt_pk_bf16_f32 v72, v8, v9
    v_cvt_pk_bf16_f32 v73, v10, v11
    v_cvt_pk_bf16_f32 v74, v12, v13
    v_cvt_pk_bf16_f32 v75, v14, v15
    v_mfma_f32_32x32x16_bf16 v[24:39], v[92:95], v[212:215], v[24:39]
    v_exp_f32 v16, v16
    v_exp_f32 v17, v17
    v_exp_f32 v18, v18
    v_exp_f32 v19, v19
    v_mfma_f32_32x32x16_bf16 v[56:71], v[96:99], v[84:87], v[56:71]
    s_waitcnt lgkmcnt(0)
    v_exp_f32 v20, v20
    v_exp_f32 v21, v21
    v_exp_f32 v22, v22
    v_exp_f32 v23, v23
    v_cvt_pk_bf16_f32 v76, v16, v17
    v_cvt_pk_bf16_f32 v77, v18, v19
    v_cvt_pk_bf16_f32 v78, v20, v21
    v_cvt_pk_bf16_f32 v79, v22, v23
    v_mfma_f32_32x32x8bf16_1k v[8:23], v[112:113], v[216:217], 0
    v_exp_f32 v24, v24
    v_exp_f32 v25, v25
    v_exp_f32 v26, v26
    v_exp_f32 v27, v27
    v_mfma_f32_32x32x16_bf16 v[40:55], v[108:111], v[72:75], v[40:55]
    ds_read_b128 v[92:95], v220 offset:46080
    v_exp_f32 v28, v28
    v_exp_f32 v29, v29
    v_exp_f32 v30, v30
    v_exp_f32 v31, v31
    v_cvt_pk_bf16_f32 v80, v24, v25
    v_cvt_pk_bf16_f32 v81, v26, v27
    v_cvt_pk_bf16_f32 v82, v28, v29
    v_cvt_pk_bf16_f32 v83, v30, v31
    v_mfma_f32_32x32x16_bf16 v[8:23], v[88:91], v[208:211], v[8:23]
    ds_read_u16 v114, v222 offset:46080
    v_exp_f32 v32, v32
    v_exp_f32 v33, v33
    v_exp_f32 v34, v34
    v_exp_f32 v35, v35
    v_mfma_f32_32x32x16_bf16 v[40:55], v[100:103], v[76:79], v[40:55]
    ds_read_b128 v[104:107], v221 offset:44032
    v_exp_f32 v36, v36
    v_exp_f32 v37, v37
    v_exp_f32 v38, v38
    v_exp_f32 v39, v39
    v_cvt_pk_bf16_f32 v84, v32, v33
    v_cvt_pk_bf16_f32 v85, v34, v35
    v_cvt_pk_bf16_f32 v86, v36, v37
    v_cvt_pk_bf16_f32 v87, v38, v39
    v_mfma_f32_32x32x8bf16_1k v[24:39], v[112:113], v[218:219], 0
    v_exp_f32 v8, v8
    v_exp_f32 v9, v9
    v_exp_f32 v10, v10
    v_exp_f32 v11, v11
    v_mfma_f32_32x32x16_bf16 v[56:71], v[108:111], v[80:83], v[56:71]
    ds_read_b128 v[96:99], v221 offset:45056
    v_exp_f32 v12, v12
    v_exp_f32 v13, v13
    v_exp_f32 v14, v14
    v_exp_f32 v15, v15
    v_cvt_pk_bf16_f32 v72, v8, v9
    v_cvt_pk_bf16_f32 v73, v10, v11
    v_cvt_pk_bf16_f32 v74, v12, v13
    v_cvt_pk_bf16_f32 v75, v14, v15
    v_mfma_f32_32x32x16_bf16 v[24:39], v[88:91], v[212:215], v[24:39]
    ds_read2_b32 v[132:133], v134 offset1:4
    v_exp_f32 v16, v16
    v_exp_f32 v17, v17
    v_exp_f32 v18, v18
    v_exp_f32 v19, v19
    v_mfma_f32_32x32x16_bf16 v[56:71], v[100:103], v[84:87], v[56:71]
    s_waitcnt lgkmcnt(0)
    v_exp_f32 v20, v20
    v_exp_f32 v21, v21
    v_exp_f32 v22, v22
    v_exp_f32 v23, v23
    v_cvt_pk_bf16_f32 v76, v16, v17
    v_cvt_pk_bf16_f32 v77, v18, v19
    v_cvt_pk_bf16_f32 v78, v20, v21
    v_cvt_pk_bf16_f32 v79, v22, v23
    v_mfma_f32_32x32x8bf16_1k v[8:23], v[114:115], v[216:217], 0
    v_exp_f32 v24, v24
    v_exp_f32 v25, v25
    v_exp_f32 v26, v26
    v_exp_f32 v27, v27
    v_mfma_f32_32x32x16_bf16 v[40:55], v[104:107], v[72:75], v[40:55]
    v_cmp_gt_u32 vcc, 15, v133
    s_cbranch_vccz ATT_c52_ok
ATT_c52_spin:
    ds_read2_b32 v[132:133], v134 offset1:4
    s_waitcnt lgkmcnt(0)
    v_cmp_gt_u32 vcc, 15, v133
    s_cbranch_vccnz ATT_c52_spin
ATT_c52_ok:
    ds_read_b128 v[88:91], v220 offset:49152
    v_exp_f32 v28, v28
    v_exp_f32 v29, v29
    v_exp_f32 v30, v30
    v_exp_f32 v31, v31
    v_cvt_pk_bf16_f32 v80, v24, v25
    v_cvt_pk_bf16_f32 v81, v26, v27
    v_cvt_pk_bf16_f32 v82, v28, v29
    v_cvt_pk_bf16_f32 v83, v30, v31
    v_mfma_f32_32x32x16_bf16 v[8:23], v[92:95], v[208:211], v[8:23]
    ds_read_u16 v112, v222 offset:49152
    v_exp_f32 v32, v32
    v_exp_f32 v33, v33
    v_exp_f32 v34, v34
    v_exp_f32 v35, v35
    v_mfma_f32_32x32x16_bf16 v[40:55], v[96:99], v[76:79], v[40:55]
    ds_read_b128 v[108:111], v221 offset:47104
    v_exp_f32 v36, v36
    v_exp_f32 v37, v37
    v_exp_f32 v38, v38
    v_exp_f32 v39, v39
    v_cvt_pk_bf16_f32 v84, v32, v33
    v_cvt_pk_bf16_f32 v85, v34, v35
    v_cvt_pk_bf16_f32 v86, v36, v37
    v_cvt_pk_bf16_f32 v87, v38, v39
    v_mfma_f32_32x32x8bf16_1k v[24:39], v[114:115], v[218:219], 0
    v_exp_f32 v8, v8
    v_exp_f32 v9, v9
    v_exp_f32 v10, v10
    v_exp_f32 v11, v11
    v_mfma_f32_32x32x16_bf16 v[56:71], v[104:107], v[80:83], v[56:71]
    ds_read_b128 v[100:103], v221 offset:48128
    v_exp_f32 v12, v12
    v_exp_f32 v13, v13
    v_exp_f32 v14, v14
    v_exp_f32 v15, v15
    v_cvt_pk_bf16_f32 v72, v8, v9
    v_cvt_pk_bf16_f32 v73, v10, v11
    v_cvt_pk_bf16_f32 v74, v12, v13
    v_cvt_pk_bf16_f32 v75, v14, v15
    v_mfma_f32_32x32x16_bf16 v[24:39], v[92:95], v[212:215], v[24:39]
    v_exp_f32 v16, v16
    v_exp_f32 v17, v17
    v_exp_f32 v18, v18
    v_exp_f32 v19, v19
    v_mfma_f32_32x32x16_bf16 v[56:71], v[96:99], v[84:87], v[56:71]
    s_waitcnt lgkmcnt(0)
    v_exp_f32 v20, v20
    v_exp_f32 v21, v21
    v_exp_f32 v22, v22
    v_exp_f32 v23, v23
    v_cvt_pk_bf16_f32 v76, v16, v17
    v_cvt_pk_bf16_f32 v77, v18, v19
    v_cvt_pk_bf16_f32 v78, v20, v21
    v_cvt_pk_bf16_f32 v79, v22, v23
    v_mfma_f32_32x32x8bf16_1k v[8:23], v[112:113], v[216:217], 0
    v_exp_f32 v24, v24
    v_exp_f32 v25, v25
    v_exp_f32 v26, v26
    v_exp_f32 v27, v27
    v_mfma_f32_32x32x16_bf16 v[40:55], v[108:111], v[72:75], v[40:55]
    ds_read_b128 v[92:95], v220 offset:52224
    v_exp_f32 v28, v28
    v_exp_f32 v29, v29
    v_exp_f32 v30, v30
    v_exp_f32 v31, v31
    v_cvt_pk_bf16_f32 v80, v24, v25
    v_cvt_pk_bf16_f32 v81, v26, v27
    v_cvt_pk_bf16_f32 v82, v28, v29
    v_cvt_pk_bf16_f32 v83, v30, v31
    v_mfma_f32_32x32x16_bf16 v[8:23], v[88:91], v[208:211], v[8:23]
    ds_read_u16 v114, v222 offset:52224
    v_exp_f32 v32, v32
    v_exp_f32 v33, v33
    v_exp_f32 v34, v34
    v_exp_f32 v35, v35
    v_mfma_f32_32x32x16_bf16 v[40:55], v[100:103], v[76:79], v[40:55]
    ds_read_b128 v[104:107], v221 offset:50176
    v_exp_f32 v36, v36
    v_exp_f32 v37, v37
    v_exp_f32 v38, v38
    v_exp_f32 v39, v39
    v_cvt_pk_bf16_f32 v84, v32, v33
    v_cvt_pk_bf16_f32 v85, v34, v35
    v_cvt_pk_bf16_f32 v86, v36, v37
    v_cvt_pk_bf16_f32 v87, v38, v39
    v_mfma_f32_32x32x8bf16_1k v[24:39], v[112:113], v[218:219], 0
    v_exp_f32 v8, v8
    v_exp_f32 v9, v9
    v_exp_f32 v10, v10
    v_exp_f32 v11, v11
    v_mfma_f32_32x32x16_bf16 v[56:71], v[108:111], v[80:83], v[56:71]
    ds_read_b128 v[96:99], v221 offset:51200
    v_exp_f32 v12, v12
    v_exp_f32 v13, v13
    v_exp_f32 v14, v14
    v_exp_f32 v15, v15
    v_cvt_pk_bf16_f32 v72, v8, v9
    v_cvt_pk_bf16_f32 v73, v10, v11
    v_cvt_pk_bf16_f32 v74, v12, v13
    v_cvt_pk_bf16_f32 v75, v14, v15
    v_mfma_f32_32x32x16_bf16 v[24:39], v[88:91], v[212:215], v[24:39]
    v_exp_f32 v16, v16
    v_exp_f32 v17, v17
    v_exp_f32 v18, v18
    v_exp_f32 v19, v19
    v_mfma_f32_32x32x16_bf16 v[56:71], v[100:103], v[84:87], v[56:71]
    s_waitcnt lgkmcnt(0)
    v_exp_f32 v20, v20
    v_exp_f32 v21, v21
    v_exp_f32 v22, v22
    v_exp_f32 v23, v23
    v_cvt_pk_bf16_f32 v76, v16, v17
    v_cvt_pk_bf16_f32 v77, v18, v19
    v_cvt_pk_bf16_f32 v78, v20, v21
    v_cvt_pk_bf16_f32 v79, v22, v23
    v_mfma_f32_32x32x8bf16_1k v[8:23], v[114:115], v[216:217], 0
    v_exp_f32 v24, v24
    v_exp_f32 v25, v25
    v_exp_f32 v26, v26
    v_exp_f32 v27, v27
    v_mfma_f32_32x32x16_bf16 v[40:55], v[104:107], v[72:75], v[40:55]
    ds_read_b128 v[88:91], v220 offset:55296
    v_exp_f32 v28, v28
    v_exp_f32 v29, v29
    v_exp_f32 v30, v30
    v_exp_f32 v31, v31
    v_cvt_pk_bf16_f32 v80, v24, v25
    v_cvt_pk_bf16_f32 v81, v26, v27
    v_cvt_pk_bf16_f32 v82, v28, v29
    v_cvt_pk_bf16_f32 v83, v30, v31
    v_mfma_f32_32x32x16_bf16 v[8:23], v[92:95], v[208:211], v[8:23]
    ds_read_u16 v112, v222 offset:55296
    v_exp_f32 v32, v32
    v_exp_f32 v33, v33
    v_exp_f32 v34, v34
    v_exp_f32 v35, v35
    v_mfma_f32_32x32x16_bf16 v[40:55], v[96:99], v[76:79], v[40:55]
    ds_read_b128 v[108:111], v221 offset:53248
    v_exp_f32 v36, v36
    v_exp_f32 v37, v37
    v_exp_f32 v38, v38
    v_exp_f32 v39, v39
    v_cvt_pk_bf16_f32 v84, v32, v33
    v_cvt_pk_bf16_f32 v85, v34, v35
    v_cvt_pk_bf16_f32 v86, v36, v37
    v_cvt_pk_bf16_f32 v87, v38, v39
    v_mfma_f32_32x32x8bf16_1k v[24:39], v[114:115], v[218:219], 0
    v_exp_f32 v8, v8
    v_exp_f32 v9, v9
    v_exp_f32 v10, v10
    v_exp_f32 v11, v11
    v_mfma_f32_32x32x16_bf16 v[56:71], v[104:107], v[80:83], v[56:71]
    ds_read_b128 v[100:103], v221 offset:54272
    v_exp_f32 v12, v12
    v_exp_f32 v13, v13
    v_exp_f32 v14, v14
    v_exp_f32 v15, v15
    v_cvt_pk_bf16_f32 v72, v8, v9
    v_cvt_pk_bf16_f32 v73, v10, v11
    v_cvt_pk_bf16_f32 v74, v12, v13
    v_cvt_pk_bf16_f32 v75, v14, v15
    v_mfma_f32_32x32x16_bf16 v[24:39], v[92:95], v[212:215], v[24:39]
    v_exp_f32 v16, v16
    v_exp_f32 v17, v17
    v_exp_f32 v18, v18
    v_exp_f32 v19, v19
    v_mfma_f32_32x32x16_bf16 v[56:71], v[96:99], v[84:87], v[56:71]
    s_waitcnt lgkmcnt(0)
    v_exp_f32 v20, v20
    v_exp_f32 v21, v21
    v_exp_f32 v22, v22
    v_exp_f32 v23, v23
    v_cvt_pk_bf16_f32 v76, v16, v17
    v_cvt_pk_bf16_f32 v77, v18, v19
    v_cvt_pk_bf16_f32 v78, v20, v21
    v_cvt_pk_bf16_f32 v79, v22, v23
    v_mfma_f32_32x32x8bf16_1k v[8:23], v[112:113], v[216:217], 0
    v_exp_f32 v24, v24
    v_exp_f32 v25, v25
    v_exp_f32 v26, v26
    v_exp_f32 v27, v27
    v_mfma_f32_32x32x16_bf16 v[40:55], v[108:111], v[72:75], v[40:55]
    ds_read_b128 v[92:95], v220 offset:58368
    v_exp_f32 v28, v28
    v_exp_f32 v29, v29
    v_exp_f32 v30, v30
    v_exp_f32 v31, v31
    v_cvt_pk_bf16_f32 v80, v24, v25
    v_cvt_pk_bf16_f32 v81, v26, v27
    v_cvt_pk_bf16_f32 v82, v28, v29
    v_cvt_pk_bf16_f32 v83, v30, v31
    v_mfma_f32_32x32x16_bf16 v[8:23], v[88:91], v[208:211], v[8:23]
    ds_read_u16 v114, v222 offset:58368
    v_exp_f32 v32, v32
    v_exp_f32 v33, v33
    v_exp_f32 v34, v34
    v_exp_f32 v35, v35
    v_mfma_f32_32x32x16_bf16 v[40:55], v[100:103], v[76:79], v[40:55]
    ds_read_b128 v[104:107], v221 offset:56320
    v_exp_f32 v36, v36
    v_exp_f32 v37, v37
    v_exp_f32 v38, v38
    v_exp_f32 v39, v39
    v_cvt_pk_bf16_f32 v84, v32, v33
    v_cvt_pk_bf16_f32 v85, v34, v35
    v_cvt_pk_bf16_f32 v86, v36, v37
    v_cvt_pk_bf16_f32 v87, v38, v39
    v_mfma_f32_32x32x8bf16_1k v[24:39], v[112:113], v[218:219], 0
    v_exp_f32 v8, v8
    v_exp_f32 v9, v9
    v_exp_f32 v10, v10
    v_exp_f32 v11, v11
    v_mfma_f32_32x32x16_bf16 v[56:71], v[108:111], v[80:83], v[56:71]
    ds_read_b128 v[96:99], v221 offset:57344
    v_exp_f32 v12, v12
    v_exp_f32 v13, v13
    v_exp_f32 v14, v14
    v_exp_f32 v15, v15
    v_cvt_pk_bf16_f32 v72, v8, v9
    v_cvt_pk_bf16_f32 v73, v10, v11
    v_cvt_pk_bf16_f32 v74, v12, v13
    v_cvt_pk_bf16_f32 v75, v14, v15
    v_mfma_f32_32x32x16_bf16 v[24:39], v[88:91], v[212:215], v[24:39]
    ds_read2_b32 v[132:133], v134 offset1:4
    v_exp_f32 v16, v16
    v_exp_f32 v17, v17
    v_exp_f32 v18, v18
    v_exp_f32 v19, v19
    v_mfma_f32_32x32x16_bf16 v[56:71], v[100:103], v[84:87], v[56:71]
    s_waitcnt lgkmcnt(0)
    v_exp_f32 v20, v20
    v_exp_f32 v21, v21
    v_exp_f32 v22, v22
    v_exp_f32 v23, v23
    v_cvt_pk_bf16_f32 v76, v16, v17
    v_cvt_pk_bf16_f32 v77, v18, v19
    v_cvt_pk_bf16_f32 v78, v20, v21
    v_cvt_pk_bf16_f32 v79, v22, v23
    v_mfma_f32_32x32x8bf16_1k v[8:23], v[114:115], v[216:217], 0
    v_exp_f32 v24, v24
    v_exp_f32 v25, v25
    v_exp_f32 v26, v26
    v_exp_f32 v27, v27
    v_mfma_f32_32x32x16_bf16 v[40:55], v[104:107], v[72:75], v[40:55]
    v_cmp_gt_u32 vcc, 17, v133
    s_cbranch_vccz ATT_c56_ok
ATT_c56_spin:
    ds_read2_b32 v[132:133], v134 offset1:4
    s_waitcnt lgkmcnt(0)
    v_cmp_gt_u32 vcc, 17, v133
    s_cbranch_vccnz ATT_c56_spin
ATT_c56_ok:
    ds_read_b128 v[88:91], v220 offset:0
    v_exp_f32 v28, v28
    v_exp_f32 v29, v29
    v_exp_f32 v30, v30
    v_exp_f32 v31, v31
    v_cvt_pk_bf16_f32 v80, v24, v25
    v_cvt_pk_bf16_f32 v81, v26, v27
    v_cvt_pk_bf16_f32 v82, v28, v29
    v_cvt_pk_bf16_f32 v83, v30, v31
    v_mfma_f32_32x32x16_bf16 v[8:23], v[92:95], v[208:211], v[8:23]
    ds_read_u16 v112, v222 offset:0
    v_exp_f32 v32, v32
    v_exp_f32 v33, v33
    v_exp_f32 v34, v34
    v_exp_f32 v35, v35
    v_mfma_f32_32x32x16_bf16 v[40:55], v[96:99], v[76:79], v[40:55]
    ds_read_b128 v[108:111], v221 offset:59392
    v_exp_f32 v36, v36
    v_exp_f32 v37, v37
    v_exp_f32 v38, v38
    v_exp_f32 v39, v39
    v_cvt_pk_bf16_f32 v84, v32, v33
    v_cvt_pk_bf16_f32 v85, v34, v35
    v_cvt_pk_bf16_f32 v86, v36, v37
    v_cvt_pk_bf16_f32 v87, v38, v39
    v_mfma_f32_32x32x8bf16_1k v[24:39], v[114:115], v[218:219], 0
    v_exp_f32 v8, v8
    v_exp_f32 v9, v9
    v_exp_f32 v10, v10
    v_exp_f32 v11, v11
    v_mfma_f32_32x32x16_bf16 v[56:71], v[104:107], v[80:83], v[56:71]
    ds_read_b128 v[100:103], v221 offset:60416
    v_exp_f32 v12, v12
    v_exp_f32 v13, v13
    v_exp_f32 v14, v14
    v_exp_f32 v15, v15
    v_cvt_pk_bf16_f32 v72, v8, v9
    v_cvt_pk_bf16_f32 v73, v10, v11
    v_cvt_pk_bf16_f32 v74, v12, v13
    v_cvt_pk_bf16_f32 v75, v14, v15
    v_mfma_f32_32x32x16_bf16 v[24:39], v[92:95], v[212:215], v[24:39]
    v_exp_f32 v16, v16
    v_exp_f32 v17, v17
    v_exp_f32 v18, v18
    v_exp_f32 v19, v19
    v_mfma_f32_32x32x16_bf16 v[56:71], v[96:99], v[84:87], v[56:71]
    s_waitcnt lgkmcnt(0)
    v_exp_f32 v20, v20
    v_exp_f32 v21, v21
    v_exp_f32 v22, v22
    v_exp_f32 v23, v23
    v_cvt_pk_bf16_f32 v76, v16, v17
    v_cvt_pk_bf16_f32 v77, v18, v19
    v_cvt_pk_bf16_f32 v78, v20, v21
    v_cvt_pk_bf16_f32 v79, v22, v23
    v_mfma_f32_32x32x8bf16_1k v[8:23], v[112:113], v[216:217], 0
    v_exp_f32 v24, v24
    v_exp_f32 v25, v25
    v_exp_f32 v26, v26
    v_exp_f32 v27, v27
    v_mfma_f32_32x32x16_bf16 v[40:55], v[108:111], v[72:75], v[40:55]
    ds_read_b128 v[92:95], v220 offset:3072
    v_exp_f32 v28, v28
    v_exp_f32 v29, v29
    v_exp_f32 v30, v30
    v_exp_f32 v31, v31
    v_cvt_pk_bf16_f32 v80, v24, v25
    v_cvt_pk_bf16_f32 v81, v26, v27
    v_cvt_pk_bf16_f32 v82, v28, v29
    v_cvt_pk_bf16_f32 v83, v30, v31
    v_mfma_f32_32x32x16_bf16 v[8:23], v[88:91], v[208:211], v[8:23]
    ds_read_u16 v114, v222 offset:3072
    v_exp_f32 v32, v32
    v_exp_f32 v33, v33
    v_exp_f32 v34, v34
    v_exp_f32 v35, v35
    v_mfma_f32_32x32x16_bf16 v[40:55], v[100:103], v[76:79], v[40:55]
    ds_read_b128 v[104:107], v221 offset:1024
    v_exp_f32 v36, v36
    v_exp_f32 v37, v37
    v_exp_f32 v38, v38
    v_exp_f32 v39, v39
    v_cvt_pk_bf16_f32 v84, v32, v33
    v_cvt_pk_bf16_f32 v85, v34, v35
    v_cvt_pk_bf16_f32 v86, v36, v37
    v_cvt_pk_bf16_f32 v87, v38, v39
    v_mfma_f32_32x32x8bf16_1k v[24:39], v[112:113], v[218:219], 0
    v_exp_f32 v8, v8
    v_exp_f32 v9, v9
    v_exp_f32 v10, v10
    v_exp_f32 v11, v11
    v_mfma_f32_32x32x16_bf16 v[56:71], v[108:111], v[80:83], v[56:71]
    ds_read_b128 v[96:99], v221 offset:2048
    v_exp_f32 v12, v12
    v_exp_f32 v13, v13
    v_exp_f32 v14, v14
    v_exp_f32 v15, v15
    v_cvt_pk_bf16_f32 v72, v8, v9
    v_cvt_pk_bf16_f32 v73, v10, v11
    v_cvt_pk_bf16_f32 v74, v12, v13
    v_cvt_pk_bf16_f32 v75, v14, v15
    v_mfma_f32_32x32x16_bf16 v[24:39], v[88:91], v[212:215], v[24:39]
    v_exp_f32 v16, v16
    v_exp_f32 v17, v17
    v_exp_f32 v18, v18
    v_exp_f32 v19, v19
    v_mfma_f32_32x32x16_bf16 v[56:71], v[100:103], v[84:87], v[56:71]
    s_waitcnt lgkmcnt(0)
    v_exp_f32 v20, v20
    v_exp_f32 v21, v21
    v_exp_f32 v22, v22
    v_exp_f32 v23, v23
    v_cvt_pk_bf16_f32 v76, v16, v17
    v_cvt_pk_bf16_f32 v77, v18, v19
    v_cvt_pk_bf16_f32 v78, v20, v21
    v_cvt_pk_bf16_f32 v79, v22, v23
    v_mfma_f32_32x32x8bf16_1k v[8:23], v[114:115], v[216:217], 0
    v_exp_f32 v24, v24
    v_exp_f32 v25, v25
    v_exp_f32 v26, v26
    v_exp_f32 v27, v27
    v_mfma_f32_32x32x16_bf16 v[40:55], v[104:107], v[72:75], v[40:55]
    ds_read_b128 v[88:91], v220 offset:6144
    v_exp_f32 v28, v28
    v_exp_f32 v29, v29
    v_exp_f32 v30, v30
    v_exp_f32 v31, v31
    v_cvt_pk_bf16_f32 v80, v24, v25
    v_cvt_pk_bf16_f32 v81, v26, v27
    v_cvt_pk_bf16_f32 v82, v28, v29
    v_cvt_pk_bf16_f32 v83, v30, v31
    v_mfma_f32_32x32x16_bf16 v[8:23], v[92:95], v[208:211], v[8:23]
    ds_read_u16 v112, v222 offset:6144
    v_exp_f32 v32, v32
    v_exp_f32 v33, v33
    v_exp_f32 v34, v34
    v_exp_f32 v35, v35
    v_mfma_f32_32x32x16_bf16 v[40:55], v[96:99], v[76:79], v[40:55]
    ds_read_b128 v[108:111], v221 offset:4096
    v_exp_f32 v36, v36
    v_exp_f32 v37, v37
    v_exp_f32 v38, v38
    v_exp_f32 v39, v39
    v_cvt_pk_bf16_f32 v84, v32, v33
    v_cvt_pk_bf16_f32 v85, v34, v35
    v_cvt_pk_bf16_f32 v86, v36, v37
    v_cvt_pk_bf16_f32 v87, v38, v39
    v_mfma_f32_32x32x8bf16_1k v[24:39], v[114:115], v[218:219], 0
    v_exp_f32 v8, v8
    v_exp_f32 v9, v9
    v_exp_f32 v10, v10
    v_exp_f32 v11, v11
    v_mfma_f32_32x32x16_bf16 v[56:71], v[104:107], v[80:83], v[56:71]
    ds_read_b128 v[100:103], v221 offset:5120
    v_exp_f32 v12, v12
    v_exp_f32 v13, v13
    v_exp_f32 v14, v14
    v_exp_f32 v15, v15
    v_cvt_pk_bf16_f32 v72, v8, v9
    v_cvt_pk_bf16_f32 v73, v10, v11
    v_cvt_pk_bf16_f32 v74, v12, v13
    v_cvt_pk_bf16_f32 v75, v14, v15
    v_mfma_f32_32x32x16_bf16 v[24:39], v[92:95], v[212:215], v[24:39]
    v_exp_f32 v16, v16
    v_exp_f32 v17, v17
    v_exp_f32 v18, v18
    v_exp_f32 v19, v19
    v_mfma_f32_32x32x16_bf16 v[56:71], v[96:99], v[84:87], v[56:71]
    s_waitcnt lgkmcnt(0)
    v_exp_f32 v20, v20
    v_exp_f32 v21, v21
    v_exp_f32 v22, v22
    v_exp_f32 v23, v23
    v_cvt_pk_bf16_f32 v76, v16, v17
    v_cvt_pk_bf16_f32 v77, v18, v19
    v_cvt_pk_bf16_f32 v78, v20, v21
    v_cvt_pk_bf16_f32 v79, v22, v23
    v_mfma_f32_32x32x8bf16_1k v[8:23], v[112:113], v[216:217], 0
    v_exp_f32 v24, v24
    v_exp_f32 v25, v25
    v_exp_f32 v26, v26
    v_exp_f32 v27, v27
    v_mfma_f32_32x32x16_bf16 v[40:55], v[108:111], v[72:75], v[40:55]
    ds_read_b128 v[92:95], v220 offset:9216
    v_exp_f32 v28, v28
    v_exp_f32 v29, v29
    v_exp_f32 v30, v30
    v_exp_f32 v31, v31
    v_cvt_pk_bf16_f32 v80, v24, v25
    v_cvt_pk_bf16_f32 v81, v26, v27
    v_cvt_pk_bf16_f32 v82, v28, v29
    v_cvt_pk_bf16_f32 v83, v30, v31
    v_mfma_f32_32x32x16_bf16 v[8:23], v[88:91], v[208:211], v[8:23]
    ds_read_u16 v114, v222 offset:9216
    v_exp_f32 v32, v32
    v_exp_f32 v33, v33
    v_exp_f32 v34, v34
    v_exp_f32 v35, v35
    v_mfma_f32_32x32x16_bf16 v[40:55], v[100:103], v[76:79], v[40:55]
    ds_read_b128 v[104:107], v221 offset:7168
    v_exp_f32 v36, v36
    v_exp_f32 v37, v37
    v_exp_f32 v38, v38
    v_exp_f32 v39, v39
    v_cvt_pk_bf16_f32 v84, v32, v33
    v_cvt_pk_bf16_f32 v85, v34, v35
    v_cvt_pk_bf16_f32 v86, v36, v37
    v_cvt_pk_bf16_f32 v87, v38, v39
    v_mfma_f32_32x32x8bf16_1k v[24:39], v[112:113], v[218:219], 0
    v_exp_f32 v8, v8
    v_exp_f32 v9, v9
    v_exp_f32 v10, v10
    v_exp_f32 v11, v11
    v_mfma_f32_32x32x16_bf16 v[56:71], v[108:111], v[80:83], v[56:71]
    ds_read_b128 v[96:99], v221 offset:8192
    v_exp_f32 v12, v12
    v_exp_f32 v13, v13
    v_exp_f32 v14, v14
    v_exp_f32 v15, v15
    v_cvt_pk_bf16_f32 v72, v8, v9
    v_cvt_pk_bf16_f32 v73, v10, v11
    v_cvt_pk_bf16_f32 v74, v12, v13
    v_cvt_pk_bf16_f32 v75, v14, v15
    v_mfma_f32_32x32x16_bf16 v[24:39], v[88:91], v[212:215], v[24:39]
    ds_read2_b32 v[132:133], v134 offset1:4
    v_exp_f32 v16, v16
    v_exp_f32 v17, v17
    v_exp_f32 v18, v18
    v_exp_f32 v19, v19
    v_mfma_f32_32x32x16_bf16 v[56:71], v[100:103], v[84:87], v[56:71]
    s_waitcnt lgkmcnt(0)
    v_exp_f32 v20, v20
    v_exp_f32 v21, v21
    v_exp_f32 v22, v22
    v_exp_f32 v23, v23
    v_cvt_pk_bf16_f32 v76, v16, v17
    v_cvt_pk_bf16_f32 v77, v18, v19
    v_cvt_pk_bf16_f32 v78, v20, v21
    v_cvt_pk_bf16_f32 v79, v22, v23
    v_mfma_f32_32x32x8bf16_1k v[8:23], v[114:115], v[216:217], 0
    v_exp_f32 v24, v24
    v_exp_f32 v25, v25
    v_exp_f32 v26, v26
    v_exp_f32 v27, v27
    v_mfma_f32_32x32x16_bf16 v[40:55], v[104:107], v[72:75], v[40:55]
    v_cmp_gt_u32 vcc, 18, v133
    s_cbranch_vccz ATT_c60_ok
ATT_c60_spin:
    ds_read2_b32 v[132:133], v134 offset1:4
    s_waitcnt lgkmcnt(0)
    v_cmp_gt_u32 vcc, 18, v133
    s_cbranch_vccnz ATT_c60_spin
ATT_c60_ok:
    ds_read_b128 v[88:91], v220 offset:12288
    v_exp_f32 v28, v28
    v_exp_f32 v29, v29
    v_exp_f32 v30, v30
    v_exp_f32 v31, v31
    v_cvt_pk_bf16_f32 v80, v24, v25
    v_cvt_pk_bf16_f32 v81, v26, v27
    v_cvt_pk_bf16_f32 v82, v28, v29
    v_cvt_pk_bf16_f32 v83, v30, v31
    v_mfma_f32_32x32x16_bf16 v[8:23], v[92:95], v[208:211], v[8:23]
    ds_read_u16 v112, v222 offset:12288
    v_exp_f32 v32, v32
    v_exp_f32 v33, v33
    v_exp_f32 v34, v34
    v_exp_f32 v35, v35
    v_mfma_f32_32x32x16_bf16 v[40:55], v[96:99], v[76:79], v[40:55]
    ds_read_b128 v[108:111], v221 offset:10240
    v_exp_f32 v36, v36
    v_exp_f32 v37, v37
    v_exp_f32 v38, v38
    v_exp_f32 v39, v39
    v_cvt_pk_bf16_f32 v84, v32, v33
    v_cvt_pk_bf16_f32 v85, v34, v35
    v_cvt_pk_bf16_f32 v86, v36, v37
    v_cvt_pk_bf16_f32 v87, v38, v39
    v_mfma_f32_32x32x8bf16_1k v[24:39], v[114:115], v[218:219], 0
    v_exp_f32 v8, v8
    v_exp_f32 v9, v9
    v_exp_f32 v10, v10
    v_exp_f32 v11, v11
    v_mfma_f32_32x32x16_bf16 v[56:71], v[104:107], v[80:83], v[56:71]
    ds_read_b128 v[100:103], v221 offset:11264
    v_exp_f32 v12, v12
    v_exp_f32 v13, v13
    v_exp_f32 v14, v14
    v_exp_f32 v15, v15
    v_cvt_pk_bf16_f32 v72, v8, v9
    v_cvt_pk_bf16_f32 v73, v10, v11
    v_cvt_pk_bf16_f32 v74, v12, v13
    v_cvt_pk_bf16_f32 v75, v14, v15
    v_mfma_f32_32x32x16_bf16 v[24:39], v[92:95], v[212:215], v[24:39]
    v_exp_f32 v16, v16
    v_exp_f32 v17, v17
    v_exp_f32 v18, v18
    v_exp_f32 v19, v19
    v_mfma_f32_32x32x16_bf16 v[56:71], v[96:99], v[84:87], v[56:71]
    s_waitcnt lgkmcnt(0)
    v_exp_f32 v20, v20
    v_exp_f32 v21, v21
    v_exp_f32 v22, v22
    v_exp_f32 v23, v23
    v_cvt_pk_bf16_f32 v76, v16, v17
    v_cvt_pk_bf16_f32 v77, v18, v19
    v_cvt_pk_bf16_f32 v78, v20, v21
    v_cvt_pk_bf16_f32 v79, v22, v23
    v_mfma_f32_32x32x8bf16_1k v[8:23], v[112:113], v[216:217], 0
    v_exp_f32 v24, v24
    v_exp_f32 v25, v25
    v_exp_f32 v26, v26
    v_exp_f32 v27, v27
    v_mfma_f32_32x32x16_bf16 v[40:55], v[108:111], v[72:75], v[40:55]
    ds_read_b128 v[92:95], v220 offset:15360
    v_exp_f32 v28, v28
    v_exp_f32 v29, v29
    v_exp_f32 v30, v30
    v_exp_f32 v31, v31
    v_cvt_pk_bf16_f32 v80, v24, v25
    v_cvt_pk_bf16_f32 v81, v26, v27
    v_cvt_pk_bf16_f32 v82, v28, v29
    v_cvt_pk_bf16_f32 v83, v30, v31
    v_mfma_f32_32x32x16_bf16 v[8:23], v[88:91], v[208:211], v[8:23]
    ds_read_u16 v114, v222 offset:15360
    v_exp_f32 v32, v32
    v_exp_f32 v33, v33
    v_exp_f32 v34, v34
    v_exp_f32 v35, v35
    v_mfma_f32_32x32x16_bf16 v[40:55], v[100:103], v[76:79], v[40:55]
    ds_read_b128 v[104:107], v221 offset:13312
    v_exp_f32 v36, v36
    v_exp_f32 v37, v37
    v_exp_f32 v38, v38
    v_exp_f32 v39, v39
    v_cvt_pk_bf16_f32 v84, v32, v33
    v_cvt_pk_bf16_f32 v85, v34, v35
    v_cvt_pk_bf16_f32 v86, v36, v37
    v_cvt_pk_bf16_f32 v87, v38, v39
    v_mfma_f32_32x32x8bf16_1k v[24:39], v[112:113], v[218:219], 0
    v_exp_f32 v8, v8
    v_exp_f32 v9, v9
    v_exp_f32 v10, v10
    v_exp_f32 v11, v11
    v_mfma_f32_32x32x16_bf16 v[56:71], v[108:111], v[80:83], v[56:71]
    ds_read_b128 v[96:99], v221 offset:14336
    v_exp_f32 v12, v12
    v_exp_f32 v13, v13
    v_exp_f32 v14, v14
    v_exp_f32 v15, v15
    v_cvt_pk_bf16_f32 v72, v8, v9
    v_cvt_pk_bf16_f32 v73, v10, v11
    v_cvt_pk_bf16_f32 v74, v12, v13
    v_cvt_pk_bf16_f32 v75, v14, v15
    v_mfma_f32_32x32x16_bf16 v[24:39], v[88:91], v[212:215], v[24:39]
    v_exp_f32 v16, v16
    v_exp_f32 v17, v17
    v_exp_f32 v18, v18
    v_exp_f32 v19, v19
    v_mfma_f32_32x32x16_bf16 v[56:71], v[100:103], v[84:87], v[56:71]
    s_waitcnt lgkmcnt(0)
    v_exp_f32 v20, v20
    v_exp_f32 v21, v21
    v_exp_f32 v22, v22
    v_exp_f32 v23, v23
    v_cvt_pk_bf16_f32 v76, v16, v17
    v_cvt_pk_bf16_f32 v77, v18, v19
    v_cvt_pk_bf16_f32 v78, v20, v21
    v_cvt_pk_bf16_f32 v79, v22, v23
    v_mfma_f32_32x32x8bf16_1k v[8:23], v[114:115], v[216:217], 0
    v_exp_f32 v24, v24
    v_exp_f32 v25, v25
    v_exp_f32 v26, v26
    v_exp_f32 v27, v27
    v_mfma_f32_32x32x16_bf16 v[40:55], v[104:107], v[72:75], v[40:55]
    ds_read_b128 v[88:91], v220 offset:18432
    v_exp_f32 v28, v28
    v_exp_f32 v29, v29
    v_exp_f32 v30, v30
    v_exp_f32 v31, v31
    v_cvt_pk_bf16_f32 v80, v24, v25
    v_cvt_pk_bf16_f32 v81, v26, v27
    v_cvt_pk_bf16_f32 v82, v28, v29
    v_cvt_pk_bf16_f32 v83, v30, v31
    v_mfma_f32_32x32x16_bf16 v[8:23], v[92:95], v[208:211], v[8:23]
    ds_read_u16 v112, v222 offset:18432
    v_exp_f32 v32, v32
    v_exp_f32 v33, v33
    v_exp_f32 v34, v34
    v_exp_f32 v35, v35
    v_mfma_f32_32x32x16_bf16 v[40:55], v[96:99], v[76:79], v[40:55]
    ds_read_b128 v[108:111], v221 offset:16384
    v_exp_f32 v36, v36
    v_exp_f32 v37, v37
    v_exp_f32 v38, v38
    v_exp_f32 v39, v39
    v_cvt_pk_bf16_f32 v84, v32, v33
    v_cvt_pk_bf16_f32 v85, v34, v35
    v_cvt_pk_bf16_f32 v86, v36, v37
    v_cvt_pk_bf16_f32 v87, v38, v39
    v_mfma_f32_32x32x8bf16_1k v[24:39], v[114:115], v[218:219], 0
    v_exp_f32 v8, v8
    v_exp_f32 v9, v9
    v_exp_f32 v10, v10
    v_exp_f32 v11, v11
    v_mfma_f32_32x32x16_bf16 v[56:71], v[104:107], v[80:83], v[56:71]
    ds_read_b128 v[100:103], v221 offset:17408
    v_exp_f32 v12, v12
    v_exp_f32 v13, v13
    v_exp_f32 v14, v14
    v_exp_f32 v15, v15
    v_cvt_pk_bf16_f32 v72, v8, v9
    v_cvt_pk_bf16_f32 v73, v10, v11
    v_cvt_pk_bf16_f32 v74, v12, v13
    v_cvt_pk_bf16_f32 v75, v14, v15
    v_mfma_f32_32x32x16_bf16 v[24:39], v[92:95], v[212:215], v[24:39]
    v_exp_f32 v16, v16
    v_exp_f32 v17, v17
    v_exp_f32 v18, v18
    v_exp_f32 v19, v19
    v_mfma_f32_32x32x16_bf16 v[56:71], v[96:99], v[84:87], v[56:71]
    s_waitcnt lgkmcnt(0)
    v_exp_f32 v20, v20
    v_exp_f32 v21, v21
    v_exp_f32 v22, v22
    v_exp_f32 v23, v23
    v_cvt_pk_bf16_f32 v76, v16, v17
    v_cvt_pk_bf16_f32 v77, v18, v19
    v_cvt_pk_bf16_f32 v78, v20, v21
    v_cvt_pk_bf16_f32 v79, v22, v23
    v_mfma_f32_32x32x8bf16_1k v[8:23], v[112:113], v[216:217], 0
    v_exp_f32 v24, v24
    v_exp_f32 v25, v25
    v_exp_f32 v26, v26
    v_exp_f32 v27, v27
    v_mfma_f32_32x32x16_bf16 v[40:55], v[108:111], v[72:75], v[40:55]
    ds_read_b128 v[92:95], v220 offset:21504
    v_exp_f32 v28, v28
    v_exp_f32 v29, v29
    v_exp_f32 v30, v30
    v_exp_f32 v31, v31
    v_cvt_pk_bf16_f32 v80, v24, v25
    v_cvt_pk_bf16_f32 v81, v26, v27
    v_cvt_pk_bf16_f32 v82, v28, v29
    v_cvt_pk_bf16_f32 v83, v30, v31
    v_mfma_f32_32x32x16_bf16 v[8:23], v[88:91], v[208:211], v[8:23]
    ds_read_u16 v114, v222 offset:21504
    v_exp_f32 v32, v32
    v_exp_f32 v33, v33
    v_exp_f32 v34, v34
    v_exp_f32 v35, v35
    v_mfma_f32_32x32x16_bf16 v[40:55], v[100:103], v[76:79], v[40:55]
    ds_read_b128 v[104:107], v221 offset:19456
    v_exp_f32 v36, v36
    v_exp_f32 v37, v37
    v_exp_f32 v38, v38
    v_exp_f32 v39, v39
    v_cvt_pk_bf16_f32 v84, v32, v33
    v_cvt_pk_bf16_f32 v85, v34, v35
    v_cvt_pk_bf16_f32 v86, v36, v37
    v_cvt_pk_bf16_f32 v87, v38, v39
    v_mfma_f32_32x32x8bf16_1k v[24:39], v[112:113], v[218:219], 0
    v_exp_f32 v8, v8
    v_exp_f32 v9, v9
    v_exp_f32 v10, v10
    v_exp_f32 v11, v11
    v_mfma_f32_32x32x16_bf16 v[56:71], v[108:111], v[80:83], v[56:71]
    ds_read_b128 v[96:99], v221 offset:20480
    v_exp_f32 v12, v12
    v_exp_f32 v13, v13
    v_exp_f32 v14, v14
    v_exp_f32 v15, v15
    v_cvt_pk_bf16_f32 v72, v8, v9
    v_cvt_pk_bf16_f32 v73, v10, v11
    v_cvt_pk_bf16_f32 v74, v12, v13
    v_cvt_pk_bf16_f32 v75, v14, v15
    v_mfma_f32_32x32x16_bf16 v[24:39], v[88:91], v[212:215], v[24:39]
    v_exp_f32 v16, v16
    v_exp_f32 v17, v17
    v_exp_f32 v18, v18
    v_exp_f32 v19, v19
    v_mfma_f32_32x32x16_bf16 v[56:71], v[100:103], v[84:87], v[56:71]
    s_waitcnt lgkmcnt(0)
    v_exp_f32 v20, v20
    v_exp_f32 v21, v21
    v_exp_f32 v22, v22
    v_exp_f32 v23, v23
    v_cvt_pk_bf16_f32 v76, v16, v17
    v_cvt_pk_bf16_f32 v77, v18, v19
    v_cvt_pk_bf16_f32 v78, v20, v21
    v_cvt_pk_bf16_f32 v79, v22, v23
    v_mfma_f32_32x32x8bf16_1k v[8:23], v[114:115], v[216:217], 0
    v_exp_f32 v24, v24
    v_exp_f32 v25, v25
    v_exp_f32 v26, v26
    v_exp_f32 v27, v27
    v_mfma_f32_32x32x16_bf16 v[40:55], v[104:107], v[72:75], v[40:55]
    v_exp_f32 v28, v28
    v_exp_f32 v29, v29
    v_exp_f32 v30, v30
    v_exp_f32 v31, v31
    v_cvt_pk_bf16_f32 v80, v24, v25
    v_cvt_pk_bf16_f32 v81, v26, v27
    v_cvt_pk_bf16_f32 v82, v28, v29
    v_cvt_pk_bf16_f32 v83, v30, v31
    v_mfma_f32_32x32x16_bf16 v[8:23], v[92:95], v[208:211], v[8:23]
    v_exp_f32 v32, v32
    v_exp_f32 v33, v33
    v_exp_f32 v34, v34
    v_exp_f32 v35, v35
    v_mfma_f32_32x32x16_bf16 v[40:55], v[96:99], v[76:79], v[40:55]
    ds_read_b128 v[108:111], v221 offset:22528
    v_exp_f32 v36, v36
    v_exp_f32 v37, v37
    v_exp_f32 v38, v38
    v_exp_f32 v39, v39
    v_cvt_pk_bf16_f32 v84, v32, v33
    v_cvt_pk_bf16_f32 v85, v34, v35
    v_cvt_pk_bf16_f32 v86, v36, v37
    v_cvt_pk_bf16_f32 v87, v38, v39
    v_mfma_f32_32x32x8bf16_1k v[24:39], v[114:115], v[218:219], 0
    v_exp_f32 v8, v8
    v_exp_f32 v9, v9
    v_exp_f32 v10, v10
    v_exp_f32 v11, v11
    v_mfma_f32_32x32x16_bf16 v[56:71], v[104:107], v[80:83], v[56:71]
    ds_read_b128 v[100:103], v221 offset:23552
    v_exp_f32 v12, v12
    v_exp_f32 v13, v13
    v_exp_f32 v14, v14
    v_exp_f32 v15, v15
    v_cvt_pk_bf16_f32 v72, v8, v9
    v_cvt_pk_bf16_f32 v73, v10, v11
    v_cvt_pk_bf16_f32 v74, v12, v13
    v_cvt_pk_bf16_f32 v75, v14, v15
    v_mfma_f32_32x32x16_bf16 v[24:39], v[92:95], v[212:215], v[24:39]
    v_exp_f32 v16, v16
    v_exp_f32 v17, v17
    v_exp_f32 v18, v18
    v_exp_f32 v19, v19
    v_mfma_f32_32x32x16_bf16 v[56:71], v[96:99], v[84:87], v[56:71]
    s_waitcnt lgkmcnt(0)
    v_exp_f32 v20, v20
    v_exp_f32 v21, v21
    v_exp_f32 v22, v22
    v_exp_f32 v23, v23
    v_cvt_pk_bf16_f32 v76, v16, v17
    v_cvt_pk_bf16_f32 v77, v18, v19
    v_cvt_pk_bf16_f32 v78, v20, v21
    v_cvt_pk_bf16_f32 v79, v22, v23
    v_exp_f32 v24, v24
    v_exp_f32 v25, v25
    v_exp_f32 v26, v26
    v_exp_f32 v27, v27
    v_mfma_f32_32x32x16_bf16 v[40:55], v[108:111], v[72:75], v[40:55]
    v_exp_f32 v28, v28
    v_exp_f32 v29, v29
    v_exp_f32 v30, v30
    v_exp_f32 v31, v31
    v_cvt_pk_bf16_f32 v80, v24, v25
    v_cvt_pk_bf16_f32 v81, v26, v27
    v_cvt_pk_bf16_f32 v82, v28, v29
    v_cvt_pk_bf16_f32 v83, v30, v31
    v_exp_f32 v32, v32
    v_exp_f32 v33, v33
    v_exp_f32 v34, v34
    v_exp_f32 v35, v35
    v_mfma_f32_32x32x16_bf16 v[40:55], v[100:103], v[76:79], v[40:55]
    v_exp_f32 v36, v36
    v_exp_f32 v37, v37
    v_exp_f32 v38, v38
    v_exp_f32 v39, v39
    v_cvt_pk_bf16_f32 v84, v32, v33
    v_cvt_pk_bf16_f32 v85, v34, v35
    v_cvt_pk_bf16_f32 v86, v36, v37
    v_cvt_pk_bf16_f32 v87, v38, v39
    v_mfma_f32_32x32x16_bf16 v[56:71], v[108:111], v[80:83], v[56:71]
    s_nop 0
    v_mfma_f32_32x32x16_bf16 v[56:71], v[100:103], v[84:87], v[56:71]
    s_mul_i32 s42, s36, 36864
    s_lshl_b32 s43, s21, 10
    s_add_u32 s43, s43, s42
    s_add_u32 s43, s43, 29622272
    s_lshl_b32 s44, s21, 7
    s_add_u32 s44, s44, s42
    s_add_u32 s44, s44, 29655040
    s_add_u32 s45, s43, 36864
    v_bfe_u32 v3, v248, 9, 1
    v_mul_u32_u24 v3, 36864, v3
    v_bfe_u32 v4, v248, 4, 5
    v_lshl_add_u32 v3, v4, 2, v3
    v_mov_b32 v1, 0x1f800000
    v_mov_b32 v2, 0x5f800000
    v_cmp_nge_f32 vcc, v50, v1
    v_cmp_nle_f32 s[48:49], v50, v2
    s_or_b64 vcc, vcc, s[48:49]
    v_cmp_nge_f32 s[48:49], v66, v1
    s_or_b64 vcc, vcc, s[48:49]
    v_cmp_nle_f32 s[48:49], v66, v2
    s_or_b64 vcc, vcc, s[48:49]
    s_cbranch_vccnz ATT_fallback
ATT_finish:
    v_rcp_f32 v1, v50
    v_rcp_f32 v2, v66
    s_nop 0
    v_mul_f32 v40, v40, v1
    v_mul_f32 v41, v41, v1
    v_mul_f32 v42, v42, v1
    v_mul_f32 v43, v43, v1
    v_mul_f32 v44, v44, v1
    v_mul_f32 v45, v45, v1
    v_mul_f32 v46, v46, v1
    v_mul_f32 v47, v47, v1
    v_mul_f32 v48, v48, v1
    v_mul_f32 v49, v49, v1
    v_cvt_pk_bf16_f32 v72, v40, v41
    v_cvt_pk_bf16_f32 v73, v42, v43
    v_cvt_pk_bf16_f32 v74, v44, v45
    v_cvt_pk_bf16_f32 v75, v46, v47
    v_cvt_pk_bf16_f32 v76, v48, v49
    v_mul_f32 v56, v56, v2
    v_mul_f32 v57, v57, v2
    v_mul_f32 v58, v58, v2
    v_mul_f32 v59, v59, v2
    v_mul_f32 v60, v60, v2
    v_mul_f32 v61, v61, v2
    v_mul_f32 v62, v62, v2
    v_mul_f32 v63, v63, v2
    v_mul_f32 v64, v64, v2
    v_mul_f32 v65, v65, v2
    v_cvt_pk_bf16_f32 v80, v56, v57
    v_cvt_pk_bf16_f32 v81, v58, v59
    v_cvt_pk_bf16_f32 v82, v60, v61
    v_cvt_pk_bf16_f32 v83, v62, v63
    v_cvt_pk_bf16_f32 v84, v64, v65
    s_nop 1
    v_permlane32_swap_b32 v76, v84
    v_min_u32 v72, -2, v72
    v_min_u32 v73, -2, v73
    v_min_u32 v74, -2, v74
    v_min_u32 v75, -2, v75
    v_min_u32 v76, -2, v76
    v_min_u32 v80, -2, v80
    v_min_u32 v81, -2, v81
    v_min_u32 v82, -2, v82
    v_min_u32 v83, -2, v83
    buffer_store_dwordx4 v[72:75], v248, s[4:7], s43 offen sc1
    buffer_store_dwordx4 v[80:83], v248, s[4:7], s45 offen sc1
    buffer_store_dword v76, v3, s[4:7], s44 offen sc1
    s_barrier
    s_branch PK_end
PH_role1:
    v_mfma_f32_16x16x32_bf16 v[144:147], v[224:227], v[64:67], v[144:147]
    ds_read_b64_tr_b16 v[236:237], v243 offset:0
    ds_read_b64_tr_b16 v[238:239], v243 offset:512
    v_mfma_f32_16x16x32_bf16 v[148:151], v[224:227], v[68:71], v[148:151]
    s_waitcnt lgkmcnt(4)
    s_and_b32 s54, s23, 1
    s_lshl_b32 s54, s54, 3
    s_add_u32 s54, s54, s22
    v_bfe_u32 v210, v248, 4, 3
    v_lshlrev_b32 v212, 5, v210
    s_lshl_b32 s55, s24, 3
    v_mfma_f32_16x16x32_bf16 v[152:155], v[228:231], v[64:67], v[152:155]
    ds_read_b64_tr_b16 v[224:225], v240 offset:4096
    ds_read_b64_tr_b16 v[226:227], v240 offset:4608
    v_mfma_f32_16x16x32_bf16 v[156:159], v[228:231], v[68:71], v[156:159]
    s_waitcnt lgkmcnt(4)
    v_add_f32 v170, 1.0, v170
    v_add_f32 v171, 1.0, v171
    v_rcp_f32 v168, v168
    v_mfma_f32_16x16x32_bf16 v[176:179], v[232:235], v[64:67], v[176:179]
    ds_read_b64_tr_b16 v[228:229], v241 offset:4096
    ds_read_b64_tr_b16 v[230:231], v241 offset:4608
    v_mfma_f32_16x16x32_bf16 v[180:183], v[232:235], v[68:71], v[180:183]
    s_waitcnt lgkmcnt(4)
    s_add_u32 s55, s55, s23
    v_add_u32 v212, s55, v212
    v_and_b32 v211, 3, v210
    v_lshrrev_b32 v210, 2, v210
    v_lshl_add_u32 v210, v211, 3, v210
    s_lshr_b32 s55, s54, 1
    v_mfma_f32_16x16x32_bf16 v[184:187], v[236:239], v[64:67], v[184:187]
    ds_read_b64_tr_b16 v[232:233], v242 offset:4096
    ds_read_b64_tr_b16 v[234:235], v242 offset:4608
    v_mfma_f32_16x16x32_bf16 v[188:191], v[236:239], v[68:71], v[188:191]
    s_waitcnt lgkmcnt(4)
    v_rcp_f32 v169, v169
    v_rcp_f32 v170, v170
    v_mfma_f32_16x16x32_bf16 v[144:147], v[224:227], v[72:75], v[144:147]
    ds_read_b64_tr_b16 v[236:237], v243 offset:4096
    ds_read_b64_tr_b16 v[238:239], v243 offset:4608
    v_mfma_f32_16x16x32_bf16 v[148:151], v[224:227], v[76:79], v[148:151]
    s_waitcnt lgkmcnt(4)
    s_lshl_b32 s55, s55, 5
    s_lshl_b32 s56, s38, 1
    s_add_u32 s55, s55, s56
    v_add_u32 v210, s55, v210
    v_and_b32 v211, 0x80, v248
    v_cmp_eq_u32 vcc, 0, v211
    v_mfma_f32_16x16x32_bf16 v[152:155], v[228:231], v[72:75], v[152:155]
    ds_read_b64_tr_b16 v[224:225], v240 offset:8192
    ds_read_b64_tr_b16 v[226:227], v240 offset:8704
    v_mfma_f32_16x16x32_bf16 v[156:159], v[228:231], v[76:79], v[156:159]
    s_waitcnt lgkmcnt(4)
    v_rcp_f32 v171, v171
    v_mul_f32 v172, s50, v172
    v_mul_f32 v173, s50, v173
    v_mfma_f32_16x16x32_bf16 v[176:179], v[232:235], v[72:75], v[176:179]
    ds_read_b64_tr_b16 v[228:229], v241 offset:8192
    ds_read_b64_tr_b16 v[230:231], v241 offset:8704
    v_mfma_f32_16x16x32_bf16 v[180:183], v[232:235], v[76:79], v[180:183]
    s_waitcnt lgkmcnt(4)
    s_mul_i32 s49, s21, 196608
    s_mul_i32 s52, s36, 3072
    v_cndmask_b32 v212, v210, v212, vcc
    v_lshlrev_b32 v212, 7, v212
    v_add_u32 v212, 46010368, v212
    v_mfma_f32_16x16x32_bf16 v[184:187], v[236:239], v[72:75], v[184:187]
    ds_read_b64_tr_b16 v[232:233], v242 offset:8192
    ds_read_b64_tr_b16 v[234:235], v242 offset:8704
    v_mfma_f32_16x16x32_bf16 v[188:191], v[236:239], v[76:79], v[188:191]
    s_waitcnt lgkmcnt(4)
    v_mul_f32 v174, s50, v174
    v_mul_f32 v175, s50, v175
    v_exp_f32 v172, v172
    s_setprio 3
    v_mfma_f32_16x16x32_bf16 v[144:147], v[224:227], v[80:83], v[144:147]
    ds_read_b64_tr_b16 v[236:237], v243 offset:8192
    ds_read_b64_tr_b16 v[238:239], v243 offset:8704
    v_mfma_f32_16x16x32_bf16 v[148:151], v[224:227], v[84:87], v[148:151]
    s_waitcnt lgkmcnt(4)
    s_add_u32 s49, s49, s52
    s_add_u32 s49, s49, 4456448
    s_lshl_b32 s37, s54, 2
    s_add_u32 s37, s37, s36
    s_mul_i32 s56, s37, 294912
    v_mfma_f32_16x16x32_bf16 v[152:155], v[228:231], v[80:83], v[152:155]
    ds_read_b64_tr_b16 v[224:225], v240 offset:12288
    ds_read_b64_tr_b16 v[226:227], v240 offset:12800
    v_mfma_f32_16x16x32_bf16 v[156:159], v[228:231], v[84:87], v[156:159]
    s_waitcnt lgkmcnt(4)
    v_exp_f32 v173, v173
    v_exp_f32 v174, v174
    v_mfma_f32_16x16x32_bf16 v[176:179], v[232:235], v[80:83], v[176:179]
    ds_read_b64_tr_b16 v[228:229], v241 offset:12288
    ds_read_b64_tr_b16 v[230:231], v241 offset:12800
    v_mfma_f32_16x16x32_bf16 v[180:183], v[232:235], v[84:87], v[180:183]
    s_waitcnt lgkmcnt(4)
    s_add_u32 s56, s56, 10747904
    s_mul_i32 s43, s57, 36864
    s_add_u32 s43, s43, s56
    s_mul_i32 s44, s58, 36864
    s_add_u32 s44, s44, s56
    v_mfma_f32_16x16x32_bf16 v[184:187], v[236:239], v[80:83], v[184:187]
    ds_read_b64_tr_b16 v[232:233], v242 offset:12288
    ds_read_b64_tr_b16 v[234:235], v242 offset:12800
    v_mfma_f32_16x16x32_bf16 v[188:191], v[236:239], v[84:87], v[188:191]
    s_waitcnt lgkmcnt(4)
    v_exp_f32 v175, v175
    v_add_f32 v172, 1.0, v172
    v_add_f32 v173, 1.0, v173
    v_mfma_f32_16x16x32_bf16 v[144:147], v[224:227], v[88:91], v[144:147]
    ds_read_b64_tr_b16 v[236:237], v243 offset:12288
    ds_read_b64_tr_b16 v[238:239], v243 offset:12800
    v_mfma_f32_16x16x32_bf16 v[148:151], v[224:227], v[92:95], v[148:151]
    s_waitcnt lgkmcnt(4)
    s_add_u32 m0, s46, 40960
    s_mul_i32 s48, s10, 73728
    s_add_u32 s48, s48, s39
    buffer_load_dwordx4 v251, s[16:19], s48 offen offset:0 lds
    v_mfma_f32_16x16x32_bf16 v[152:155], v[228:231], v[88:91], v[152:155]
    ds_read_b64_tr_b16 v[224:225], v240 offset:16384
    ds_read_b64_tr_b16 v[226:227], v240 offset:16896
    v_mfma_f32_16x16x32_bf16 v[156:159], v[228:231], v[92:95], v[156:159]
    s_waitcnt lgkmcnt(4)
    v_add_f32 v174, 1.0, v174
    v_add_f32 v175, 1.0, v175
    v_rcp_f32 v172, v172
    v_mfma_f32_16x16x32_bf16 v[176:179], v[232:235], v[88:91], v[176:179]
    ds_read_b64_tr_b16 v[228:229], v241 offset:16384
    ds_read_b64_tr_b16 v[230:231], v241 offset:16896
    v_mfma_f32_16x16x32_bf16 v[180:183], v[232:235], v[92:95], v[180:183]
    s_waitcnt lgkmcnt(4)
    buffer_load_dwordx4 v252, s[16:19], s48 offen offset:1024 lds
    v_mfma_f32_16x16x32_bf16 v[184:187], v[236:239], v[88:91], v[184:187]
    ds_read_b64_tr_b16 v[232:233], v242 offset:16384
    ds_read_b64_tr_b16 v[234:235], v242 offset:16896
    v_mfma_f32_16x16x32_bf16 v[188:191], v[236:239], v[92:95], v[188:191]
    s_waitcnt lgkmcnt(4)
    v_rcp_f32 v173, v173
    v_rcp_f32 v174, v174
    v_mfma_f32_16x16x32_bf16 v[144:147], v[224:227], v[96:99], v[144:147]
    ds_read_b64_tr_b16 v[236:237], v243 offset:16384
    ds_read_b64_tr_b16 v[238:239], v243 offset:16896
    v_mfma_f32_16x16x32_bf16 v[148:151], v[224:227], v[100:103], v[148:151]
    s_waitcnt lgkmcnt(4)
    buffer_load_dwordx4 v253, s[16:19], s48 offen offset:2048 lds
    v_mfma_f32_16x16x32_bf16 v[152:155], v[228:231], v[96:99], v[152:155]
    ds_read_b64_tr_b16 v[224:225], v240 offset:20480
    ds_read_b64_tr_b16 v[226:227], v240 offset:20992
    v_mfma_f32_16x16x32_bf16 v[156:159], v[228:231], v[100:103], v[156:159]
    s_waitcnt lgkmcnt(4)
    v_rcp_f32 v175, v175
    v_mul_f32 v192, s50, v192
    v_mul_f32 v193, s50, v193
    v_mfma_f32_16x16x32_bf16 v[176:179], v[232:235], v[96:99], v[176:179]
    ds_read_b64_tr_b16 v[228:229], v241 offset:20480
    ds_read_b64_tr_b16 v[230:231], v241 offset:20992
    v_mfma_f32_16x16x32_bf16 v[180:183], v[232:235], v[100:103], v[180:183]
    s_waitcnt lgkmcnt(4)
    buffer_load_dwordx4 v254, s[16:19], s48 offen offset:3072 lds
    s_setprio 2
    v_mfma_f32_16x16x32_bf16 v[184:187], v[236:239], v[96:99], v[184:187]
    ds_read_b64_tr_b16 v[232:233], v242 offset:20480
    ds_read_b64_tr_b16 v[234:235], v242 offset:20992
    v_mfma_f32_16x16x32_bf16 v[188:191], v[236:239], v[100:103], v[188:191]
    s_waitcnt lgkmcnt(4)
    v_mul_f32 v194, s50, v194
    v_mul_f32 v195, s50, v195
    v_exp_f32 v192, v192
    v_mfma_f32_16x16x32_bf16 v[144:147], v[224:227], v[104:107], v[144:147]
    ds_read_b64_tr_b16 v[236:237], v243 offset:20480
    ds_read_b64_tr_b16 v[238:239], v243 offset:20992
    v_mfma_f32_16x16x32_bf16 v[148:151], v[224:227], v[108:111], v[148:151]
    s_waitcnt lgkmcnt(4)
    s_add_u32 m0, s47, 57344
    s_mul_i32 s48, s10, 73728
    s_add_u32 s48, s48, s45
    buffer_load_dwordx4 v255, s[16:19], s48 offen lds
    v_mfma_f32_16x16x32_bf16 v[152:155], v[228:231], v[104:107], v[152:155]
    ds_read_b64_tr_b16 v[224:225], v240 offset:24576
    ds_read_b64_tr_b16 v[226:227], v240 offset:25088
    v_mfma_f32_16x16x32_bf16 v[156:159], v[228:231], v[108:111], v[156:159]
    s_waitcnt lgkmcnt(4)
    v_exp_f32 v193, v193
    v_exp_f32 v194, v194
    v_mfma_f32_16x16x32_bf16 v[176:179], v[232:235], v[104:107], v[176:179]
    ds_read_b64_tr_b16 v[228:229], v241 offset:24576
    ds_read_b64_tr_b16 v[230:231], v241 offset:25088
    v_mfma_f32_16x16x32_bf16 v[180:183], v[232:235], v[108:111], v[180:183]
    s_waitcnt lgkmcnt(4)
    buffer_load_dword v213, v212, s[4:7], 0 offen sc1
    v_mfma_f32_16x16x32_bf16 v[184:187], v[236:239], v[104:107], v[184:187]
    ds_read_b64_tr_b16 v[232:233], v242 offset:24576
    ds_read_b64_tr_b16 v[234:235], v242 offset:25088
    v_mfma_f32_16x16x32_bf16 v[188:191], v[236:239], v[108:111], v[188:191]
    s_waitcnt lgkmcnt(4)
    v_exp_f32 v195, v195
    v_add_f32 v192, 1.0, v192
    v_add_f32 v193, 1.0, v193
    v_mfma_f32_16x16x32_bf16 v[144:147], v[224:227], v[112:115], v[144:147]
    ds_read_b64_tr_b16 v[236:237], v243 offset:24576
    ds_read_b64_tr_b16 v[238:239], v243 offset:25088
    v_mfma_f32_16x16x32_bf16 v[148:151], v[224:227], v[116:119], v[148:151]
    s_waitcnt lgkmcnt(4)
    v_add_f32 v194, 1.0, v194
    v_add_f32 v195, 1.0, v195
    v_rcp_f32 v192, v192
    v_mfma_f32_16x16x32_bf16 v[152:155], v[228:231], v[112:115], v[152:155]
    ds_read_b64_tr_b16 v[224:225], v240 offset:28672
    ds_read_b64_tr_b16 v[226:227], v240 offset:29184
    v_mfma_f32_16x16x32_bf16 v[156:159], v[228:231], v[116:119], v[156:159]
    s_waitcnt lgkmcnt(4)
    v_rcp_f32 v193, v193
    v_rcp_f32 v194, v194
    v_mfma_f32_16x16x32_bf16 v[176:179], v[232:235], v[112:115], v[176:179]
    ds_read_b64_tr_b16 v[228:229], v241 offset:28672
    ds_read_b64_tr_b16 v[230:231], v241 offset:29184
    v_mfma_f32_16x16x32_bf16 v[180:183], v[232:235], v[116:119], v[180:183]
    s_waitcnt lgkmcnt(4)
    v_rcp_f32 v195, v195
    v_mul_f32 v196, s50, v196
    v_mul_f32 v197, s50, v197
    v_mfma_f32_16x16x32_bf16 v[184:187], v[236:239], v[112:115], v[184:187]
    ds_read_b64_tr_b16 v[232:233], v242 offset:28672
    ds_read_b64_tr_b16 v[234:235], v242 offset:29184
    v_mfma_f32_16x16x32_bf16 v[188:191], v[236:239], v[116:119], v[188:191]
    s_waitcnt lgkmcnt(4)
    v_mul_f32 v198, s50, v198
    v_mul_f32 v199, s50, v199
    v_mfma_f32_16x16x32_bf16 v[144:147], v[224:227], v[120:123], v[144:147]
    ds_read_b64_tr_b16 v[236:237], v243 offset:28672
    ds_read_b64_tr_b16 v[238:239], v243 offset:29184
    v_mfma_f32_16x16x32_bf16 v[148:151], v[224:227], v[124:127], v[148:151]
    s_waitcnt lgkmcnt(4)
    v_exp_f32 v196, v196
    v_exp_f32 v197, v197
    v_mfma_f32_16x16x32_bf16 v[152:155], v[228:231], v[120:123], v[152:155]
    ds_read_b64_tr_b16 v[224:225], v240 offset:32768
    ds_read_b64_tr_b16 v[226:227], v240 offset:33280
    v_mfma_f32_16x16x32_bf16 v[156:159], v[228:231], v[124:127], v[156:159]
    s_waitcnt lgkmcnt(4)
    v_exp_f32 v198, v198
    v_exp_f32 v199, v199
    s_setprio 1
    v_mfma_f32_16x16x32_bf16 v[176:179], v[232:235], v[120:123], v[176:179]
    ds_read_b64_tr_b16 v[228:229], v241 offset:32768
    ds_read_b64_tr_b16 v[230:231], v241 offset:33280
    v_mfma_f32_16x16x32_bf16 v[180:183], v[232:235], v[124:127], v[180:183]
    s_waitcnt lgkmcnt(4)
    v_add_f32 v196, 1.0, v196
    v_add_f32 v197, 1.0, v197
    v_mfma_f32_16x16x32_bf16 v[184:187], v[236:239], v[120:123], v[184:187]
    ds_read_b64_tr_b16 v[232:233], v242 offset:32768
    ds_read_b64_tr_b16 v[234:235], v242 offset:33280
    v_mfma_f32_16x16x32_bf16 v[188:191], v[236:239], v[124:127], v[188:191]
    s_waitcnt lgkmcnt(4)
    v_add_f32 v198, 1.0, v198
    v_add_f32 v199, 1.0, v199
    v_rcp_f32 v196, v196
    v_mfma_f32_16x16x32_bf16 v[144:147], v[224:227], v[128:131], v[144:147]
    ds_read_b64_tr_b16 v[236:237], v243 offset:32768
    ds_read_b64_tr_b16 v[238:239], v243 offset:33280
    v_mfma_f32_16x16x32_bf16 v[148:151], v[224:227], v[132:135], v[148:151]
    s_waitcnt lgkmcnt(4)
    v_rcp_f32 v197, v197
    v_rcp_f32 v198, v198
    v_mfma_f32_16x16x32_bf16 v[152:155], v[228:231], v[128:131], v[152:155]
    ds_read_b64_tr_b16 v[224:225], v240 offset:36864
    ds_read_b64_tr_b16 v[226:227], v240 offset:37376
    v_mfma_f32_16x16x32_bf16 v[156:159], v[228:231], v[132:135], v[156:159]
    s_waitcnt lgkmcnt(4)
    v_rcp_f32 v199, v199
    v_mfma_f32_16x16x32_bf16 v[176:179], v[232:235], v[128:131], v[176:179]
    ds_read_b64_tr_b16 v[228:229], v241 offset:36864
    ds_read_b64_tr_b16 v[230:231], v241 offset:37376
    v_mfma_f32_16x16x32_bf16 v[180:183], v[232:235], v[132:135], v[180:183]
    s_waitcnt lgkmcnt(4)
    v_mul_f32 v200, s50, v200
    v_mul_f32 v201, s50, v201
    v_mul_f32 v202, s50, v202
    v_mul_f32 v203, s50, v203
    v_mfma_f32_16x16x32_bf16 v[184:187], v[236:239], v[128:131], v[184:187]
    ds_read_b64_tr_b16 v[232:233], v242 offset:36864
    ds_read_b64_tr_b16 v[234:235], v242 offset:37376
    v_mfma_f32_16x16x32_bf16 v[188:191], v[236:239], v[132:135], v[188:191]
    s_waitcnt lgkmcnt(4)
    v_exp_f32 v200, v200
    v_exp_f32 v201, v201
    v_mfma_f32_16x16x32_bf16 v[144:147], v[224:227], v[136:139], v[144:147]
    ds_read_b64_tr_b16 v[236:237], v243 offset:36864
    ds_read_b64_tr_b16 v[238:239], v243 offset:37376
    v_mfma_f32_16x16x32_bf16 v[148:151], v[224:227], v[140:143], v[148:151]
    s_waitcnt lgkmcnt(4)
    v_exp_f32 v202, v202
    v_exp_f32 v203, v203
    v_mfma_f32_16x16x32_bf16 v[152:155], v[228:231], v[136:139], v[152:155]
    v_mfma_f32_16x16x32_bf16 v[156:159], v[228:231], v[140:143], v[156:159]
    s_waitcnt lgkmcnt(2)
    v_add_f32 v200, 1.0, v200
    v_add_f32 v201, 1.0, v201
    v_mfma_f32_16x16x32_bf16 v[176:179], v[232:235], v[136:139], v[176:179]
    v_mfma_f32_16x16x32_bf16 v[180:183], v[232:235], v[140:143], v[180:183]
    s_waitcnt lgkmcnt(0)
    v_add_f32 v202, 1.0, v202
    v_add_f32 v203, 1.0, v203
    v_rcp_f32 v200, v200
    v_mfma_f32_16x16x32_bf16 v[184:187], v[236:239], v[136:139], v[184:187]
    v_mfma_f32_16x16x32_bf16 v[188:191], v[236:239], v[140:143], v[188:191]
    v_rcp_f32 v201, v201
    v_rcp_f32 v202, v202
    v_rcp_f32 v203, v203
    v_mul_f32 v204, s50, v204
    v_mul_f32 v205, s50, v205
    v_mul_f32 v206, s50, v206
    v_mul_f32 v207, s50, v207
    v_exp_f32 v204, v204
    v_exp_f32 v205, v205
    v_exp_f32 v206, v206
    v_exp_f32 v207, v207
    v_add_f32 v204, 1.0, v204
    v_add_f32 v205, 1.0, v205
    v_add_f32 v206, 1.0, v206
    v_add_f32 v207, 1.0, v207
    v_rcp_f32 v204, v204
    v_rcp_f32 v205, v205
    v_rcp_f32 v206, v206
    v_rcp_f32 v207, v207
    s_setprio 2
    s_nop 7
    v_mul_f32 v144, v144, v160
    v_mul_f32 v145, v145, v161
    v_mul_f32 v146, v146, v162
    v_mul_f32 v147, v147, v163
    v_mul_f32 v148, v148, v164
    v_mul_f32 v149, v149, v165
    v_mul_f32 v150, v150, v166
    v_mul_f32 v151, v151, v167
    v_mul_f32 v152, v152, v168
    v_mul_f32 v153, v153, v169
    v_mul_f32 v154, v154, v170
    v_mul_f32 v155, v155, v171
    v_mul_f32 v156, v156, v172
    v_mul_f32 v157, v157, v173
    v_mul_f32 v158, v158, v174
    v_mul_f32 v159, v159, v175
    v_mul_f32 v192, v176, v192
    v_mul_f32 v193, v177, v193
    v_mul_f32 v194, v178, v194
    v_mul_f32 v195, v179, v195
    v_mul_f32 v196, v180, v196
    v_mul_f32 v197, v181, v197
    v_mul_f32 v198, v182, v198
    v_mul_f32 v199, v183, v199
    v_mul_f32 v200, v184, v200
    v_mul_f32 v201, v185, v201
    v_mul_f32 v202, v186, v202
    v_mul_f32 v203, v187, v203
    v_mul_f32 v204, v188, v204
    v_mul_f32 v205, v189, v205
    v_mul_f32 v206, v190, v206
    v_mul_f32 v207, v191, v207
    v_cvt_pk_bf16_f32 v176, v144, v145
    v_cvt_pk_bf16_f32 v177, v146, v147
    v_cvt_pk_bf16_f32 v178, v148, v149
    v_cvt_pk_bf16_f32 v179, v150, v151
    v_cvt_pk_bf16_f32 v180, v152, v153
    v_cvt_pk_bf16_f32 v181, v154, v155
    v_cvt_pk_bf16_f32 v182, v156, v157
    v_cvt_pk_bf16_f32 v183, v158, v159
    v_cvt_pk_bf16_f32 v184, v192, v193
    v_cvt_pk_bf16_f32 v185, v194, v195
    v_cvt_pk_bf16_f32 v186, v196, v197
    v_cvt_pk_bf16_f32 v187, v198, v199
    v_cvt_pk_bf16_f32 v188, v200, v201
    v_cvt_pk_bf16_f32 v189, v202, v203
    v_cvt_pk_bf16_f32 v190, v204, v205
    v_cvt_pk_bf16_f32 v191, v206, v207
    v_permlane16_swap_b32 v176, v178
    v_permlane16_swap_b32 v177, v179
    v_permlane16_swap_b32 v180, v182
    v_permlane16_swap_b32 v181, v183
    v_permlane16_swap_b32 v184, v186
    v_permlane16_swap_b32 v185, v187
    v_permlane16_swap_b32 v188, v190
    v_permlane16_swap_b32 v189, v191
    s_load_dwordx2 s[28:29], s[0:1], 16
    s_load_dwordx2 s[32:33], s[0:1], 0
    s_load_dwordx2 s[56:57], s[0:1], 56
    s_setprio 2
    s_waitcnt vmcnt(0)
    v_cmp_gt_u32 vcc, 1, v213
    s_cbranch_vccz POLL1_ok
    s_mov_b32 s63, 1048576
POLL1_spin:
    s_sleep 2
    buffer_load_dword v213, v212, s[4:7], 0 offen sc1
    s_waitcnt vmcnt(0)
    v_cmp_gt_u32 vcc, 1, v213
    s_sub_u32 s63, s63, 1
    s_cbranch_scc1 POLL1_ok
    s_cbranch_vccnz POLL1_spin
POLL1_ok:
    v_bfe_u32 v245, v248, 4, 2
    v_lshlrev_b32 v245, 2, v245
    v_add_u32 v245, 117056, v245
    s_lshl_b32 s54, s20, 2
    s_add_u32 s54, s54, 117056
    v_mov_b32 v244, s54
    v_mov_b32 v207, 1
    s_lshl_b32 s53, s8, 12
    s_add_u32 s53, s53, s43
    buffer_load_dwordx4 v[108:111], v248, s[4:7], s53 offen offset:0 sc1
    buffer_load_dwordx4 v[112:115], v248, s[4:7], s53 offen offset:1024 sc1
    buffer_load_dwordx4 v[116:119], v248, s[4:7], s53 offen offset:2048 sc1
    buffer_load_dwordx4 v[120:123], v248, s[4:7], s53 offen offset:3072 sc1
    s_add_u32 m0, s52, 139264
    s_add_u32 s48, s40, 2
    s_and_b32 s48, s48, 15
    s_mul_i32 s48, s48, 12288
    s_add_u32 s48, s48, s49
    buffer_load_dwordx4 v248, s[4:7], s48 offen offset:0 sc1 lds
    buffer_load_dwordx4 v248, s[4:7], s48 offen offset:1024 sc1 lds
    buffer_load_dwordx4 v248, s[4:7], s48 offen offset:2048 sc1 lds
    s_lshl_b32 s53, s9, 12
    s_add_u32 s53, s53, s43
    buffer_load_dwordx4 v[124:127], v248, s[4:7], s53 offen offset:0 sc1
    buffer_load_dwordx4 v[128:131], v248, s[4:7], s53 offen offset:1024 sc1
    buffer_load_dwordx4 v[132:135], v248, s[4:7], s53 offen offset:2048 sc1
    buffer_load_dwordx4 v[136:139], v248, s[4:7], s53 offen offset:3072 sc1
    v_lshrrev_b32 v0, 4, v248
    v_lshrrev_b32 v1, 5, v0
    v_bfe_u32 v2, v0, 4, 1
    v_bfe_u32 v3, v0, 2, 2
    v_and_b32 v4, 1, v0
    v_bfe_u32 v5, v0, 1, 1
    v_lshlrev_b32 v4, 5, v4
    v_lshl_add_u32 v4, v2, 4, v4
    v_lshl_add_u32 v4, v5, 3, v4
    v_lshl_add_u32 v6, v1, 3, v3
    v_lshl_add_u32 v7, v6, 8, v4
    v_xor_b32 v5, s38, v3
    v_lshl_add_u32 v196, v5, 6, v7
    v_xor_b32 v197, 64, v196
    v_xor_b32 v198, 128, v196
    v_xor_b32 v199, 192, v196
    v_lshl_add_u32 v204, v6, 6, v4
    v_add_u32 v205, 61440, v204
    v_lshl_add_u32 v6, v1, 2, v3
    v_lshl_add_u32 v250, v6, 6, v4
    v_add_u32 v247, 49152, v250
    v_mul_u32_u24 v6, 72, v1
    v_lshrrev_b32 v5, 1, v3
    v_mul_u32_u24 v5, 18, v5
    v_and_b32 v7, 1, v3
    v_add3_u32 v6, v6, v5, v7
    v_add_u32 v6, 16, v6
    v_lshl_add_u32 v192, v6, 6, v4
    v_add_u32 v249, 49152, v192
    v_and_b32 v5, 31, v0
    v_mul_u32_u24 v5, 1152, v5
    v_lshl_add_u32 v246, v1, 5, v5
    s_mul_i32 s26, s37, 20
    s_mul_i32 s54, s24, 5
    s_add_u32 s26, s26, s54
    s_lshl_b32 s26, s26, 13
    s_add_u32 s26, s26, 31981568
    s_lshr_b32 s54, s24, 1
    s_mul_i32 s54, s54, 576
    s_add_u32 s41, s54, 256
    s_and_b32 s55, s24, 1
    s_mul_i32 s55, s55, 320
    s_add_u32 s27, s54, s55
    s_lshl_b32 s55, s38, 6
    s_add_u32 s27, s27, s55
    s_mul_i32 s50, s37, 36864
    s_mul_i32 s51, s37, 36864
    s_add_u32 s51, s51, 29622272
    s_waitcnt lgkmcnt(0)
    s_mov_b32 s30, 663552
    s_mov_b32 s31, 0x20000
    s_mov_b32 s34, 2359296
    s_mov_b32 s35, 0x20000
    s_mov_b32 s58, 2359296
    s_mov_b32 s59, 0x20000
    v_add_u32 v200, 61440, v196
    v_add_u32 v201, 61440, v197
    v_add_u32 v202, 61440, v198
    v_add_u32 v203, 61440, v199
    s_setprio 0
    ds_read_b64_tr_b16 v[88:89], v196 offset:0
    ds_read_b64_tr_b16 v[90:91], v196 offset:1024
    ds_read_b64_tr_b16 v[92:93], v197 offset:0
    ds_read_b64_tr_b16 v[94:95], v197 offset:1024
    ds_read_b64_tr_b16 v[96:97], v198 offset:0
    ds_read_b64_tr_b16 v[98:99], v198 offset:1024
    ds_read_b64_tr_b16 v[100:101], v199 offset:0
    ds_read_b64_tr_b16 v[102:103], v199 offset:1024
    ds_read_b64_tr_b16 v[104:105], v204 offset:16384
    ds_read_b64_tr_b16 v[106:107], v204 offset:16640
    s_waitcnt vmcnt(10) lgkmcnt(8)
    v_mfma_f32_32x32x16_bf16 v[8:23], v[88:91], v[108:111], 0
    ds_read_b64_tr_b16 v[88:89], v196 offset:4096
    ds_read_b64_tr_b16 v[90:91], v196 offset:5120
    s_add_u32 m0, s52, 151552
    s_add_u32 s48, s40, 3
    s_and_b32 s48, s48, 15
    s_mul_i32 s48, s48, 12288
    s_add_u32 s48, s48, s49
    buffer_load_dwordx4 v248, s[4:7], s48 offen offset:0 sc1 lds
    s_waitcnt lgkmcnt(8)
    v_mfma_f32_32x32x16_bf16 v[24:39], v[92:95], v[108:111], 0
    ds_read_b64_tr_b16 v[92:93], v197 offset:4096
    ds_read_b64_tr_b16 v[94:95], v197 offset:5120
    buffer_load_dwordx4 v248, s[4:7], s48 offen offset:1024 sc1 lds
    s_waitcnt lgkmcnt(8)
    v_mfma_f32_32x32x16_bf16 v[40:55], v[96:99], v[108:111], 0
    ds_read_b64_tr_b16 v[96:97], v198 offset:4096
    ds_read_b64_tr_b16 v[98:99], v198 offset:5120
    buffer_load_dwordx4 v248, s[4:7], s48 offen offset:2048 sc1 lds
    s_waitcnt lgkmcnt(8)
    v_mfma_f32_32x32x16_bf16 v[56:71], v[100:103], v[108:111], 0
    ds_read_b64_tr_b16 v[100:101], v199 offset:4096
    ds_read_b64_tr_b16 v[102:103], v199 offset:5120
    s_lshl_b32 s53, s10, 12
    s_add_u32 s53, s53, s43
    buffer_load_dwordx4 v[140:143], v248, s[4:7], s53 offen offset:0 sc1
    s_waitcnt lgkmcnt(8)
    v_mfma_f32_32x32x16_bf16 v[72:87], v[104:107], v[108:111], 0
    ds_read_b64_tr_b16 v[104:105], v204 offset:17408
    ds_read_b64_tr_b16 v[106:107], v204 offset:17664
    buffer_load_dwordx4 v[144:147], v248, s[4:7], s53 offen offset:1024 sc1
    s_waitcnt vmcnt(14) lgkmcnt(8)
    v_mfma_f32_32x32x16_bf16 v[8:23], v[88:91], v[112:115], v[8:23]
    ds_read_b64_tr_b16 v[88:89], v196 offset:8192
    ds_read_b64_tr_b16 v[90:91], v196 offset:9216
    buffer_load_dwordx4 v[148:151], v248, s[4:7], s53 offen offset:2048 sc1
    s_waitcnt lgkmcnt(8)
    v_mfma_f32_32x32x16_bf16 v[24:39], v[92:95], v[112:115], v[24:39]
    ds_read_b64_tr_b16 v[92:93], v197 offset:8192
    ds_read_b64_tr_b16 v[94:95], v197 offset:9216
    buffer_load_dwordx4 v[152:155], v248, s[4:7], s53 offen offset:3072 sc1
    s_waitcnt lgkmcnt(8)
    v_mfma_f32_32x32x16_bf16 v[40:55], v[96:99], v[112:115], v[40:55]
    ds_read_b64_tr_b16 v[96:97], v198 offset:8192
    ds_read_b64_tr_b16 v[98:99], v198 offset:9216
    buffer_store_dwordx4 v[176:179], v248, s[4:7], s61 offen offset:0 sc1
    s_waitcnt lgkmcnt(8)
    v_mfma_f32_32x32x16_bf16 v[56:71], v[100:103], v[112:115], v[56:71]
    ds_read_b64_tr_b16 v[100:101], v199 offset:8192
    ds_read_b64_tr_b16 v[102:103], v199 offset:9216
    s_lshl_b32 s53, s11, 12
    s_add_u32 s53, s53, s43
    buffer_load_dwordx4 v[156:159], v248, s[4:7], s53 offen offset:0 sc1
    s_waitcnt lgkmcnt(8)
    v_mfma_f32_32x32x16_bf16 v[72:87], v[104:107], v[112:115], v[72:87]
    ds_read_b64_tr_b16 v[104:105], v204 offset:18432
    ds_read_b64_tr_b16 v[106:107], v204 offset:18688
    buffer_load_dwordx4 v[160:163], v248, s[4:7], s53 offen offset:1024 sc1
    s_waitcnt vmcnt(18) lgkmcnt(8)
    v_mfma_f32_32x32x16_bf16 v[8:23], v[88:91], v[116:119], v[8:23]
    s_waitcnt vmcnt(7)
    s_mov_b64 exec, 1
    ds_add_u32 v244, v207
    s_mov_b64 exec, -1
    ds_read_b64_tr_b16 v[88:89], v196 offset:12288
    ds_read_b64_tr_b16 v[90:91], v196 offset:13312
    buffer_load_dwordx4 v[164:167], v248, s[4:7], s53 offen offset:2048 sc1
    s_waitcnt lgkmcnt(9)
    v_mfma_f32_32x32x16_bf16 v[24:39], v[92:95], v[116:119], v[24:39]
    ds_read_b64_tr_b16 v[92:93], v197 offset:12288
    ds_read_b64_tr_b16 v[94:95], v197 offset:13312
    buffer_load_dwordx4 v[168:171], v248, s[4:7], s53 offen offset:3072 sc1
    s_waitcnt lgkmcnt(9)
    v_mfma_f32_32x32x16_bf16 v[40:55], v[96:99], v[116:119], v[40:55]
    ds_read_b64_tr_b16 v[96:97], v198 offset:12288
    ds_read_b64_tr_b16 v[98:99], v198 offset:13312
    s_waitcnt lgkmcnt(9)
    v_mfma_f32_32x32x16_bf16 v[56:71], v[100:103], v[116:119], v[56:71]
    ds_read2_b32 v[238:239], v245 offset1:4
    ds_read_b64_tr_b16 v[100:101], v199 offset:12288
    ds_read_b64_tr_b16 v[102:103], v199 offset:13312
    s_waitcnt lgkmcnt(10)
    v_mfma_f32_32x32x16_bf16 v[72:87], v[104:107], v[116:119], v[72:87]
    ds_read_b64_tr_b16 v[104:105], v204 offset:19456
    ds_read_b64_tr_b16 v[106:107], v204 offset:19712
    s_waitcnt lgkmcnt(9)
    v_mfma_f32_32x32x16_bf16 v[8:23], v[88:91], v[120:123], v[8:23]
    s_waitcnt lgkmcnt(4)
    s_setprio 2
    v_cmp_gt_u32 vcc, 1, v238
    v_cmp_gt_u32 s[62:63], 1, v239
    s_or_b64 vcc, vcc, s[62:63]
    s_cbranch_vccz GM_c1_ok
GM_c1_spin:
    ds_read2_b32 v[238:239], v245 offset1:4
    s_waitcnt lgkmcnt(0)
    v_cmp_gt_u32 vcc, 1, v238
    v_cmp_gt_u32 s[62:63], 1, v239
    s_or_b64 vcc, vcc, s[62:63]
    s_cbranch_vccnz GM_c1_spin
GM_c1_ok:
    s_setprio 0
    ds_read_b64_tr_b16 v[88:89], v196 offset:20480
    ds_read_b64_tr_b16 v[90:91], v196 offset:21504
    buffer_store_dwordx4 v[180:183], v248, s[4:7], s61 offen offset:1024 sc1
    v_mfma_f32_32x32x16_bf16 v[24:39], v[92:95], v[120:123], v[24:39]
    ds_read_b64_tr_b16 v[92:93], v197 offset:20480
    ds_read_b64_tr_b16 v[94:95], v197 offset:21504
    s_add_u32 m0, s52, 102400
    s_add_u32 s48, s40, 4
    s_and_b32 s48, s48, 15
    s_mul_i32 s48, s48, 12288
    s_add_u32 s48, s48, s49
    buffer_load_dwordx4 v248, s[4:7], s48 offen offset:0 sc1 lds
    v_mfma_f32_32x32x16_bf16 v[40:55], v[96:99], v[120:123], v[40:55]
    ds_read_b64_tr_b16 v[96:97], v198 offset:20480
    ds_read_b64_tr_b16 v[98:99], v198 offset:21504
    buffer_load_dwordx4 v248, s[4:7], s48 offen offset:1024 sc1 lds
    s_waitcnt lgkmcnt(8)
    v_mfma_f32_32x32x16_bf16 v[56:71], v[100:103], v[120:123], v[56:71]
    ds_read_b64_tr_b16 v[100:101], v199 offset:20480
    ds_read_b64_tr_b16 v[102:103], v199 offset:21504
    buffer_load_dwordx4 v248, s[4:7], s48 offen offset:2048 sc1 lds
    s_waitcnt lgkmcnt(8)
    v_mfma_f32_32x32x16_bf16 v[72:87], v[104:107], v[120:123], v[72:87]
    ds_read_b64_tr_b16 v[104:105], v204 offset:36864
    ds_read_b64_tr_b16 v[106:107], v204 offset:37120
    s_add_u32 m0, s46, 61440
    s_mul_i32 s48, s11, 73728
    s_add_u32 s48, s48, s39
    buffer_load_dwordx4 v251, s[16:19], s48 offen offset:0 lds
    s_waitcnt lgkmcnt(8)
    v_mfma_f32_32x32x16_bf16 v[8:23], v[88:91], v[124:127], v[8:23]
    ds_read_b64_tr_b16 v[88:89], v196 offset:24576
    ds_read_b64_tr_b16 v[90:91], v196 offset:25600
    buffer_load_dwordx4 v252, s[16:19], s48 offen offset:1024 lds
    s_waitcnt lgkmcnt(8)
    v_mfma_f32_32x32x16_bf16 v[24:39], v[92:95], v[124:127], v[24:39]
    ds_read_b64_tr_b16 v[92:93], v197 offset:24576
    ds_read_b64_tr_b16 v[94:95], v197 offset:25600
    buffer_load_dwordx4 v253, s[16:19], s48 offen offset:2048 lds
    s_waitcnt lgkmcnt(8)
    v_mfma_f32_32x32x16_bf16 v[40:55], v[96:99], v[124:127], v[40:55]
    ds_read_b64_tr_b16 v[96:97], v198 offset:24576
    ds_read_b64_tr_b16 v[98:99], v198 offset:25600
    buffer_load_dwordx4 v254, s[16:19], s48 offen offset:3072 lds
    s_waitcnt lgkmcnt(8)
    v_mfma_f32_32x32x16_bf16 v[56:71], v[100:103], v[124:127], v[56:71]
    ds_read_b64_tr_b16 v[100:101], v199 offset:24576
    ds_read_b64_tr_b16 v[102:103], v199 offset:25600
    s_add_u32 m0, s47, 77824
    s_mul_i32 s48, s11, 73728
    s_add_u32 s48, s48, s45
    buffer_load_dwordx4 v255, s[16:19], s48 offen lds
    s_waitcnt lgkmcnt(8)
    v_mfma_f32_32x32x16_bf16 v[72:87], v[104:107], v[124:127], v[72:87]
    ds_read_b64_tr_b16 v[104:105], v204 offset:37888
    ds_read_b64_tr_b16 v[106:107], v204 offset:38144
    s_add_u32 m0, s46, 81920
    s_mul_i32 s48, s12, 73728
    s_add_u32 s48, s48, s39
    buffer_load_dwordx4 v251, s[16:19], s48 offen offset:0 lds
    s_waitcnt lgkmcnt(8)
    v_mfma_f32_32x32x16_bf16 v[8:23], v[88:91], v[128:131], v[8:23]
    ds_read_b64_tr_b16 v[88:89], v196 offset:28672
    ds_read_b64_tr_b16 v[90:91], v196 offset:29696
    buffer_load_dwordx4 v252, s[16:19], s48 offen offset:1024 lds
    s_waitcnt lgkmcnt(8)
    v_mfma_f32_32x32x16_bf16 v[24:39], v[92:95], v[128:131], v[24:39]
    ds_read_b64_tr_b16 v[92:93], v197 offset:28672
    ds_read_b64_tr_b16 v[94:95], v197 offset:29696
    buffer_load_dwordx4 v253, s[16:19], s48 offen offset:2048 lds
    s_waitcnt lgkmcnt(8)
    v_mfma_f32_32x32x16_bf16 v[40:55], v[96:99], v[128:131], v[40:55]
    ds_read_b64_tr_b16 v[96:97], v198 offset:28672
    ds_read_b64_tr_b16 v[98:99], v198 offset:29696
    buffer_load_dwordx4 v254, s[16:19], s48 offen offset:3072 lds
    s_waitcnt lgkmcnt(8)
    v_mfma_f32_32x32x16_bf16 v[56:71], v[100:103], v[128:131], v[56:71]
    ds_read_b64_tr_b16 v[100:101], v199 offset:28672
    ds_read_b64_tr_b16 v[102:103], v199 offset:29696
    s_add_u32 m0, s47, 98304
    s_mul_i32 s48, s12, 73728
    s_add_u32 s48, s48, s45
    buffer_load_dwordx4 v255, s[16:19], s48 offen lds
    s_waitcnt lgkmcnt(8)
    v_mfma_f32_32x32x16_bf16 v[72:87], v[104:107], v[128:131], v[72:87]
    ds_read_b64_tr_b16 v[104:105], v204 offset:38912
    ds_read_b64_tr_b16 v[106:107], v204 offset:39168
    s_lshl_b32 s53, s12, 12
    s_add_u32 s53, s53, s43
    buffer_load_dwordx4 v[108:111], v248, s[4:7], s53 offen offset:0 sc1
    s_waitcnt lgkmcnt(8)
    v_mfma_f32_32x32x16_bf16 v[8:23], v[88:91], v[132:135], v[8:23]
    s_mov_b64 exec, 1
    ds_add_u32 v244, v207
    s_mov_b64 exec, -1
    ds_read_b64_tr_b16 v[88:89], v196 offset:32768
    ds_read_b64_tr_b16 v[90:91], v196 offset:33792
    buffer_load_dwordx4 v[112:115], v248, s[4:7], s53 offen offset:1024 sc1
    s_waitcnt lgkmcnt(9)
    v_mfma_f32_32x32x16_bf16 v[24:39], v[92:95], v[132:135], v[24:39]
    ds_read_b64_tr_b16 v[92:93], v197 offset:32768
    ds_read_b64_tr_b16 v[94:95], v197 offset:33792
    buffer_load_dwordx4 v[116:119], v248, s[4:7], s53 offen offset:2048 sc1
    s_waitcnt lgkmcnt(9)
    v_mfma_f32_32x32x16_bf16 v[40:55], v[96:99], v[132:135], v[40:55]
    ds_read_b64_tr_b16 v[96:97], v198 offset:32768
    ds_read_b64_tr_b16 v[98:99], v198 offset:33792
    buffer_load_dwordx4 v[120:123], v248, s[4:7], s53 offen offset:3072 sc1
    s_waitcnt lgkmcnt(9)
    v_mfma_f32_32x32x16_bf16 v[56:71], v[100:103], v[132:135], v[56:71]
    ds_read2_b32 v[238:239], v245 offset1:4
    ds_read_b64_tr_b16 v[100:101], v199 offset:32768
    ds_read_b64_tr_b16 v[102:103], v199 offset:33792
    s_waitcnt lgkmcnt(10)
    v_mfma_f32_32x32x16_bf16 v[72:87], v[104:107], v[132:135], v[72:87]
    ds_read_b64_tr_b16 v[104:105], v204 offset:39936
    ds_read_b64_tr_b16 v[106:107], v204 offset:40192
    s_waitcnt lgkmcnt(9)
    v_mfma_f32_32x32x16_bf16 v[8:23], v[88:91], v[136:139], v[8:23]
    s_waitcnt lgkmcnt(4)
    s_setprio 2
    v_cmp_gt_u32 vcc, 2, v239
    s_cbranch_vccz GM_c2_ok
GM_c2_spin:
    ds_read2_b32 v[238:239], v245 offset1:4
    s_waitcnt lgkmcnt(0)
    v_cmp_gt_u32 vcc, 2, v239
    s_cbranch_vccnz GM_c2_spin
GM_c2_ok:
    s_setprio 0
    ds_read_b64_tr_b16 v[88:89], v196 offset:40960
    ds_read_b64_tr_b16 v[90:91], v196 offset:41984
    buffer_store_dwordx4 v[184:187], v248, s[4:7], s61 offen offset:2048 sc1
    v_mfma_f32_32x32x16_bf16 v[24:39], v[92:95], v[136:139], v[24:39]
    ds_read_b64_tr_b16 v[92:93], v197 offset:40960
    ds_read_b64_tr_b16 v[94:95], v197 offset:41984
    s_add_u32 m0, s46, 0
    s_mul_i32 s48, s8, 73728
    s_add_u32 s48, s48, s42
    buffer_load_dwordx4 v251, s[16:19], s48 offen offset:0 lds
    v_mfma_f32_32x32x16_bf16 v[40:55], v[96:99], v[136:139], v[40:55]
    ds_read_b64_tr_b16 v[96:97], v198 offset:40960
    ds_read_b64_tr_b16 v[98:99], v198 offset:41984
    buffer_load_dwordx4 v252, s[16:19], s48 offen offset:1024 lds
    s_waitcnt lgkmcnt(8)
    v_mfma_f32_32x32x16_bf16 v[56:71], v[100:103], v[136:139], v[56:71]
    ds_read_b64_tr_b16 v[100:101], v199 offset:40960
    ds_read_b64_tr_b16 v[102:103], v199 offset:41984
    buffer_load_dwordx4 v253, s[16:19], s48 offen offset:2048 lds
    s_waitcnt lgkmcnt(8)
    v_mfma_f32_32x32x16_bf16 v[72:87], v[104:107], v[136:139], v[72:87]
    ds_read_b64_tr_b16 v[104:105], v204 offset:57344
    ds_read_b64_tr_b16 v[106:107], v204 offset:57600
    buffer_load_dwordx4 v254, s[16:19], s48 offen offset:3072 lds
    s_waitcnt vmcnt(31) lgkmcnt(8)
    v_mfma_f32_32x32x16_bf16 v[8:23], v[88:91], v[140:143], v[8:23]
    ds_read_b64_tr_b16 v[88:89], v196 offset:45056
    ds_read_b64_tr_b16 v[90:91], v196 offset:46080
    s_lshl_b32 s53, s8, 12
    s_add_u32 s53, s53, s44
    buffer_load_dwordx4 v[124:127], v248, s[4:7], s53 offen offset:0 sc1
    s_waitcnt lgkmcnt(8)
    v_mfma_f32_32x32x16_bf16 v[24:39], v[92:95], v[140:143], v[24:39]
    ds_read_b64_tr_b16 v[92:93], v197 offset:45056
    ds_read_b64_tr_b16 v[94:95], v197 offset:46080
    buffer_load_dwordx4 v[128:131], v248, s[4:7], s53 offen offset:1024 sc1
    s_waitcnt lgkmcnt(8)
    v_mfma_f32_32x32x16_bf16 v[40:55], v[96:99], v[140:143], v[40:55]
    ds_read_b64_tr_b16 v[96:97], v198 offset:45056
    ds_read_b64_tr_b16 v[98:99], v198 offset:46080
    buffer_load_dwordx4 v[132:135], v248, s[4:7], s53 offen offset:2048 sc1
    s_waitcnt lgkmcnt(8)
    v_mfma_f32_32x32x16_bf16 v[56:71], v[100:103], v[140:143], v[56:71]
    ds_read_b64_tr_b16 v[100:101], v199 offset:45056
    ds_read_b64_tr_b16 v[102:103], v199 offset:46080
    buffer_load_dwordx4 v[136:139], v248, s[4:7], s53 offen offset:3072 sc1
    s_waitcnt lgkmcnt(8)
    v_mfma_f32_32x32x16_bf16 v[72:87], v[104:107], v[140:143], v[72:87]
    ds_read_b64_tr_b16 v[104:105], v204 offset:58368
    ds_read_b64_tr_b16 v[106:107], v204 offset:58624
    s_waitcnt vmcnt(34) lgkmcnt(8)
    v_mfma_f32_32x32x16_bf16 v[8:23], v[88:91], v[144:147], v[8:23]
    ds_read_b64_tr_b16 v[88:89], v196 offset:49152
    ds_read_b64_tr_b16 v[90:91], v196 offset:50176
    s_waitcnt lgkmcnt(8)
    v_mfma_f32_32x32x16_bf16 v[24:39], v[92:95], v[144:147], v[24:39]
    ds_read_b64_tr_b16 v[92:93], v197 offset:49152
    ds_read_b64_tr_b16 v[94:95], v197 offset:50176
    s_waitcnt lgkmcnt(8)
    v_mfma_f32_32x32x16_bf16 v[40:55], v[96:99], v[144:147], v[40:55]
    ds_read_b64_tr_b16 v[96:97], v198 offset:49152
    ds_read_b64_tr_b16 v[98:99], v198 offset:50176
    s_waitcnt lgkmcnt(8)
    v_mfma_f32_32x32x16_bf16 v[56:71], v[100:103], v[144:147], v[56:71]
    ds_read_b64_tr_b16 v[100:101], v199 offset:49152
    ds_read_b64_tr_b16 v[102:103], v199 offset:50176
    s_waitcnt lgkmcnt(8)
    v_mfma_f32_32x32x16_bf16 v[72:87], v[104:107], v[144:147], v[72:87]
    ds_read_b64_tr_b16 v[104:105], v204 offset:59392
    ds_read_b64_tr_b16 v[106:107], v204 offset:59648
    s_waitcnt vmcnt(33) lgkmcnt(8)
    v_mfma_f32_32x32x16_bf16 v[8:23], v[88:91], v[148:151], v[8:23]
    s_waitcnt vmcnt(18)
    s_mov_b64 exec, 1
    ds_add_u32 v244, v207
    s_mov_b64 exec, -1
    ds_read_b64_tr_b16 v[88:89], v196 offset:53248
    ds_read_b64_tr_b16 v[90:91], v196 offset:54272
    s_waitcnt lgkmcnt(9)
    v_mfma_f32_32x32x16_bf16 v[24:39], v[92:95], v[148:151], v[24:39]
    ds_read_b64_tr_b16 v[92:93], v197 offset:53248
    ds_read_b64_tr_b16 v[94:95], v197 offset:54272
    s_waitcnt lgkmcnt(9)
    v_mfma_f32_32x32x16_bf16 v[40:55], v[96:99], v[148:151], v[40:55]
    ds_read_b64_tr_b16 v[96:97], v198 offset:53248
    ds_read_b64_tr_b16 v[98:99], v198 offset:54272
    s_waitcnt lgkmcnt(9)
    v_mfma_f32_32x32x16_bf16 v[56:71], v[100:103], v[148:151], v[56:71]
    ds_read2_b32 v[238:239], v245 offset1:4
    ds_read_b64_tr_b16 v[100:101], v199 offset:53248
    ds_read_b64_tr_b16 v[102:103], v199 offset:54272
    s_waitcnt lgkmcnt(10)
    v_mfma_f32_32x32x16_bf16 v[72:87], v[104:107], v[148:151], v[72:87]
    ds_read_b64_tr_b16 v[104:105], v204 offset:60416
    ds_read_b64_tr_b16 v[106:107], v204 offset:60672
    s_waitcnt lgkmcnt(9)
    v_mfma_f32_32x32x16_bf16 v[8:23], v[88:91], v[152:155], v[8:23]
    s_waitcnt lgkmcnt(4)
    s_setprio 2
    v_cmp_gt_u32 vcc, 1, v238
    v_cmp_gt_u32 s[62:63], 3, v239
    s_or_b64 vcc, vcc, s[62:63]
    s_cbranch_vccz GM_c3_ok
GM_c3_spin:
    ds_read2_b32 v[238:239], v245 offset1:4
    s_waitcnt lgkmcnt(0)
    v_cmp_gt_u32 vcc, 1, v238
    v_cmp_gt_u32 s[62:63], 3, v239
    s_or_b64 vcc, vcc, s[62:63]
    s_cbranch_vccnz GM_c3_spin
GM_c3_ok:
    s_setprio 0
    ds_read_b64_tr_b16 v[88:89], v200 offset:0
    ds_read_b64_tr_b16 v[90:91], v200 offset:1024
    buffer_store_dwordx4 v[188:191], v248, s[4:7], s61 offen offset:3072 sc1
    v_mfma_f32_32x32x16_bf16 v[24:39], v[92:95], v[152:155], v[24:39]
    ds_read_b64_tr_b16 v[92:93], v201 offset:0
    ds_read_b64_tr_b16 v[94:95], v201 offset:1024
    s_add_u32 m0, s52, 114688
    s_add_u32 s48, s40, 5
    s_and_b32 s48, s48, 15
    s_mul_i32 s48, s48, 12288
    s_add_u32 s48, s48, s49
    buffer_load_dwordx4 v248, s[4:7], s48 offen offset:0 sc1 lds
    v_mfma_f32_32x32x16_bf16 v[40:55], v[96:99], v[152:155], v[40:55]
    ds_read_b64_tr_b16 v[96:97], v202 offset:0
    ds_read_b64_tr_b16 v[98:99], v202 offset:1024
    buffer_load_dwordx4 v248, s[4:7], s48 offen offset:1024 sc1 lds
    s_waitcnt lgkmcnt(8)
    v_mfma_f32_32x32x16_bf16 v[56:71], v[100:103], v[152:155], v[56:71]
    ds_read_b64_tr_b16 v[100:101], v203 offset:0
    ds_read_b64_tr_b16 v[102:103], v203 offset:1024
    s_mov_b32 exec_lo, 0xffcfffff
    buffer_load_dwordx4 v248, s[4:7], s48 offen offset:2048 sc1 lds
    s_mov_b32 exec_lo, -1
    s_waitcnt lgkmcnt(8)
    v_mfma_f32_32x32x16_bf16 v[72:87], v[104:107], v[152:155], v[72:87]
    ds_read_b64_tr_b16 v[104:105], v205 offset:16384
    ds_read_b64_tr_b16 v[106:107], v205 offset:16640
    s_add_u32 m0, s46, 20480
    s_mul_i32 s48, s9, 73728
    s_add_u32 s48, s48, s42
    buffer_load_dwordx4 v251, s[16:19], s48 offen offset:0 lds
    s_waitcnt lgkmcnt(8)
    v_mfma_f32_32x32x16_bf16 v[8:23], v[88:91], v[156:159], v[8:23]
    ds_read_b64_tr_b16 v[88:89], v200 offset:4096
    ds_read_b64_tr_b16 v[90:91], v200 offset:5120
    buffer_load_dwordx4 v252, s[16:19], s48 offen offset:1024 lds
    s_waitcnt lgkmcnt(8)
    v_mfma_f32_32x32x16_bf16 v[24:39], v[92:95], v[156:159], v[24:39]
    ds_read_b64_tr_b16 v[92:93], v201 offset:4096
    ds_read_b64_tr_b16 v[94:95], v201 offset:5120
    buffer_load_dwordx4 v253, s[16:19], s48 offen offset:2048 lds
    s_waitcnt lgkmcnt(8)
    v_mfma_f32_32x32x16_bf16 v[40:55], v[96:99], v[156:159], v[40:55]
    ds_read_b64_tr_b16 v[96:97], v202 offset:4096
    ds_read_b64_tr_b16 v[98:99], v202 offset:5120
    buffer_load_dwordx4 v254, s[16:19], s48 offen offset:3072 lds
    s_waitcnt lgkmcnt(8)
    v_mfma_f32_32x32x16_bf16 v[56:71], v[100:103], v[156:159], v[56:71]
    ds_read_b64_tr_b16 v[100:101], v203 offset:4096
    ds_read_b64_tr_b16 v[102:103], v203 offset:5120
    s_lshl_b32 s53, s9, 12
    s_add_u32 s53, s53, s44
    buffer_load_dwordx4 v[140:143], v248, s[4:7], s53 offen offset:0 sc1
    s_waitcnt lgkmcnt(8)
    v_mfma_f32_32x32x16_bf16 v[72:87], v[104:107], v[156:159], v[72:87]
    ds_read_b64_tr_b16 v[104:105], v205 offset:17408
    ds_read_b64_tr_b16 v[106:107], v205 offset:17664
    buffer_load_dwordx4 v[144:147], v248, s[4:7], s53 offen offset:1024 sc1
    s_waitcnt lgkmcnt(8)
    v_mfma_f32_32x32x16_bf16 v[8:23], v[88:91], v[160:163], v[8:23]
    ds_read_b64_tr_b16 v[88:89], v200 offset:8192
    ds_read_b64_tr_b16 v[90:91], v200 offset:9216
    buffer_load_dwordx4 v[148:151], v248, s[4:7], s53 offen offset:2048 sc1
    s_waitcnt lgkmcnt(8)
    v_mfma_f32_32x32x16_bf16 v[24:39], v[92:95], v[160:163], v[24:39]
    ds_read_b64_tr_b16 v[92:93], v201 offset:8192
    ds_read_b64_tr_b16 v[94:95], v201 offset:9216
    buffer_load_dwordx4 v[152:155], v248, s[4:7], s53 offen offset:3072 sc1
    s_waitcnt lgkmcnt(8)
    v_mfma_f32_32x32x16_bf16 v[40:55], v[96:99], v[160:163], v[40:55]
    ds_read_b64_tr_b16 v[96:97], v202 offset:8192
    ds_read_b64_tr_b16 v[98:99], v202 offset:9216
    s_waitcnt lgkmcnt(8)
    v_mfma_f32_32x32x16_bf16 v[56:71], v[100:103], v[160:163], v[56:71]
    ds_read_b64_tr_b16 v[100:101], v203 offset:8192
    ds_read_b64_tr_b16 v[102:103], v203 offset:9216
    s_waitcnt lgkmcnt(8)
    v_mfma_f32_32x32x16_bf16 v[72:87], v[104:107], v[160:163], v[72:87]
    ds_read_b64_tr_b16 v[104:105], v205 offset:18432
    ds_read_b64_tr_b16 v[106:107], v205 offset:18688
    s_waitcnt lgkmcnt(8)
    v_mfma_f32_32x32x16_bf16 v[8:23], v[88:91], v[164:167], v[8:23]
    s_waitcnt vmcnt(25)
    s_mov_b64 exec, 1
    ds_add_u32 v244, v207
    s_mov_b64 exec, -1
    ds_read_b64_tr_b16 v[88:89], v200 offset:12288
    ds_read_b64_tr_b16 v[90:91], v200 offset:13312
    s_waitcnt lgkmcnt(9)
    v_mfma_f32_32x32x16_bf16 v[24:39], v[92:95], v[164:167], v[24:39]
    ds_read_b64_tr_b16 v[92:93], v201 offset:12288
    ds_read_b64_tr_b16 v[94:95], v201 offset:13312
    s_waitcnt lgkmcnt(9)
    v_mfma_f32_32x32x16_bf16 v[40:55], v[96:99], v[164:167], v[40:55]
    ds_read_b64_tr_b16 v[96:97], v202 offset:12288
    ds_read_b64_tr_b16 v[98:99], v202 offset:13312
    s_waitcnt lgkmcnt(9)
    v_mfma_f32_32x32x16_bf16 v[56:71], v[100:103], v[164:167], v[56:71]
    ds_read2_b32 v[238:239], v245 offset1:4
    ds_read_b64_tr_b16 v[100:101], v203 offset:12288
    ds_read_b64_tr_b16 v[102:103], v203 offset:13312
    s_waitcnt lgkmcnt(10)
    v_mfma_f32_32x32x16_bf16 v[72:87], v[104:107], v[164:167], v[72:87]
    ds_read_b64_tr_b16 v[104:105], v205 offset:19456
    ds_read_b64_tr_b16 v[106:107], v205 offset:19712
    s_waitcnt lgkmcnt(9)
    v_mfma_f32_32x32x16_bf16 v[8:23], v[88:91], v[168:171], v[8:23]
    s_waitcnt lgkmcnt(4)
    s_setprio 2
    v_cmp_gt_u32 vcc, 2, v238
    v_cmp_gt_u32 s[62:63], 4, v239
    s_or_b64 vcc, vcc, s[62:63]
    s_cbranch_vccz GM_c4_ok
GM_c4_spin:
    ds_read2_b32 v[238:239], v245 offset1:4
    s_waitcnt lgkmcnt(0)
    v_cmp_gt_u32 vcc, 2, v238
    v_cmp_gt_u32 s[62:63], 4, v239
    s_or_b64 vcc, vcc, s[62:63]
    s_cbranch_vccnz GM_c4_spin
GM_c4_ok:
    s_setprio 0
    ds_read_b64_tr_b16 v[88:89], v200 offset:20480
    ds_read_b64_tr_b16 v[90:91], v200 offset:21504
    s_add_u32 m0, s52, 126976
    s_add_u32 s48, s40, 6
    s_and_b32 s48, s48, 15
    s_mul_i32 s48, s48, 12288
    s_add_u32 s48, s48, s49
    buffer_load_dwordx4 v248, s[4:7], s48 offen offset:0 sc1 lds
    v_mfma_f32_32x32x16_bf16 v[24:39], v[92:95], v[168:171], v[24:39]
    ds_read_b64_tr_b16 v[92:93], v201 offset:20480
    ds_read_b64_tr_b16 v[94:95], v201 offset:21504
    buffer_load_dwordx4 v248, s[4:7], s48 offen offset:1024 sc1 lds
    v_mfma_f32_32x32x16_bf16 v[40:55], v[96:99], v[168:171], v[40:55]
    ds_read_b64_tr_b16 v[96:97], v202 offset:20480
    ds_read_b64_tr_b16 v[98:99], v202 offset:21504
    buffer_load_dwordx4 v248, s[4:7], s48 offen offset:2048 sc1 lds
    s_waitcnt lgkmcnt(8)
    v_mfma_f32_32x32x16_bf16 v[56:71], v[100:103], v[168:171], v[56:71]
    ds_read_b64_tr_b16 v[100:101], v203 offset:20480
    ds_read_b64_tr_b16 v[102:103], v203 offset:21504
    s_add_u32 m0, s46, 40960
    s_mul_i32 s48, s10, 73728
    s_add_u32 s48, s48, s42
    buffer_load_dwordx4 v251, s[16:19], s48 offen offset:0 lds
    s_waitcnt lgkmcnt(8)
    v_mfma_f32_32x32x16_bf16 v[72:87], v[104:107], v[168:171], v[72:87]
    ds_read_b64_tr_b16 v[104:105], v205 offset:36864
    ds_read_b64_tr_b16 v[106:107], v205 offset:37120
    buffer_load_dwordx4 v252, s[16:19], s48 offen offset:1024 lds
    s_waitcnt vmcnt(29) lgkmcnt(8)
    v_mfma_f32_32x32x16_bf16 v[8:23], v[88:91], v[108:111], v[8:23]
    ds_read_b64_tr_b16 v[88:89], v200 offset:24576
    ds_read_b64_tr_b16 v[90:91], v200 offset:25600
    buffer_load_dwordx4 v253, s[16:19], s48 offen offset:2048 lds
    s_waitcnt lgkmcnt(8)
    v_mfma_f32_32x32x16_bf16 v[24:39], v[92:95], v[108:111], v[24:39]
    ds_read_b64_tr_b16 v[92:93], v201 offset:24576
    ds_read_b64_tr_b16 v[94:95], v201 offset:25600
    buffer_load_dwordx4 v254, s[16:19], s48 offen offset:3072 lds
    s_waitcnt lgkmcnt(8)
    v_mfma_f32_32x32x16_bf16 v[40:55], v[96:99], v[108:111], v[40:55]
    ds_read_b64_tr_b16 v[96:97], v202 offset:24576
    ds_read_b64_tr_b16 v[98:99], v202 offset:25600
    s_lshl_b32 s53, s10, 12
    s_add_u32 s53, s53, s44
    buffer_load_dwordx4 v[156:159], v248, s[4:7], s53 offen offset:0 sc1
    s_waitcnt lgkmcnt(8)
    v_mfma_f32_32x32x16_bf16 v[56:71], v[100:103], v[108:111], v[56:71]
    ds_read_b64_tr_b16 v[100:101], v203 offset:24576
    ds_read_b64_tr_b16 v[102:103], v203 offset:25600
    buffer_load_dwordx4 v[160:163], v248, s[4:7], s53 offen offset:1024 sc1
    s_waitcnt lgkmcnt(8)
    v_mfma_f32_32x32x16_bf16 v[72:87], v[104:107], v[108:111], v[72:87]
    ds_read_b64_tr_b16 v[104:105], v205 offset:37888
    ds_read_b64_tr_b16 v[106:107], v205 offset:38144
    buffer_load_dwordx4 v[164:167], v248, s[4:7], s53 offen offset:2048 sc1
    s_waitcnt vmcnt(33) lgkmcnt(8)
    v_mfma_f32_32x32x16_bf16 v[8:23], v[88:91], v[112:115], v[8:23]
    ds_read_b64_tr_b16 v[88:89], v200 offset:28672
    ds_read_b64_tr_b16 v[90:91], v200 offset:29696
    buffer_load_dwordx4 v[168:171], v248, s[4:7], s53 offen offset:3072 sc1
    s_waitcnt lgkmcnt(8)
    v_mfma_f32_32x32x16_bf16 v[24:39], v[92:95], v[112:115], v[24:39]
    ds_read_b64_tr_b16 v[92:93], v201 offset:28672
    ds_read_b64_tr_b16 v[94:95], v201 offset:29696
    s_waitcnt lgkmcnt(8)
    v_mfma_f32_32x32x16_bf16 v[40:55], v[96:99], v[112:115], v[40:55]
    ds_read_b64_tr_b16 v[96:97], v202 offset:28672
    ds_read_b64_tr_b16 v[98:99], v202 offset:29696
    s_waitcnt lgkmcnt(8)
    v_mfma_f32_32x32x16_bf16 v[56:71], v[100:103], v[112:115], v[56:71]
    ds_read_b64_tr_b16 v[100:101], v203 offset:28672
    ds_read_b64_tr_b16 v[102:103], v203 offset:29696
    s_waitcnt lgkmcnt(8)
    v_mfma_f32_32x32x16_bf16 v[72:87], v[104:107], v[112:115], v[72:87]
    ds_read_b64_tr_b16 v[104:105], v205 offset:38912
    ds_read_b64_tr_b16 v[106:107], v205 offset:39168
    s_waitcnt vmcnt(33) lgkmcnt(8)
    v_mfma_f32_32x32x16_bf16 v[8:23], v[88:91], v[116:119], v[8:23]
    s_waitcnt vmcnt(19)
    s_mov_b64 exec, 1
    ds_add_u32 v244, v207
    s_mov_b64 exec, -1
    ds_read_b64_tr_b16 v[88:89], v200 offset:32768
    ds_read_b64_tr_b16 v[90:91], v200 offset:33792
    s_waitcnt lgkmcnt(9)
    v_mfma_f32_32x32x16_bf16 v[24:39], v[92:95], v[116:119], v[24:39]
    ds_read_b64_tr_b16 v[92:93], v201 offset:32768
    ds_read_b64_tr_b16 v[94:95], v201 offset:33792
    s_waitcnt lgkmcnt(9)
    v_mfma_f32_32x32x16_bf16 v[40:55], v[96:99], v[116:119], v[40:55]
    ds_read_b64_tr_b16 v[96:97], v202 offset:32768
    ds_read_b64_tr_b16 v[98:99], v202 offset:33792
    s_waitcnt lgkmcnt(9)
    v_mfma_f32_32x32x16_bf16 v[56:71], v[100:103], v[116:119], v[56:71]
    ds_read2_b32 v[238:239], v245 offset1:4
    ds_read_b64_tr_b16 v[100:101], v203 offset:32768
    ds_read_b64_tr_b16 v[102:103], v203 offset:33792
    s_waitcnt lgkmcnt(10)
    v_mfma_f32_32x32x16_bf16 v[72:87], v[104:107], v[116:119], v[72:87]
    ds_read_b64_tr_b16 v[104:105], v205 offset:39936
    ds_read_b64_tr_b16 v[106:107], v205 offset:40192
    s_waitcnt lgkmcnt(9)
    v_mfma_f32_32x32x16_bf16 v[8:23], v[88:91], v[120:123], v[8:23]
    s_waitcnt lgkmcnt(4)
    s_setprio 2
    v_cmp_gt_u32 vcc, 5, v239
    s_cbranch_vccz GM_c5_ok
GM_c5_spin:
    ds_read2_b32 v[238:239], v245 offset1:4
    s_waitcnt lgkmcnt(0)
    v_cmp_gt_u32 vcc, 5, v239
    s_cbranch_vccnz GM_c5_spin
GM_c5_ok:
    s_setprio 0
    ds_read_b64_tr_b16 v[88:89], v196 offset:0
    ds_read_b64_tr_b16 v[90:91], v196 offset:1024
    s_add_u32 m0, s46, 61440
    s_mul_i32 s48, s11, 73728
    s_add_u32 s48, s48, s42
    buffer_load_dwordx4 v251, s[16:19], s48 offen offset:0 lds
    v_mfma_f32_32x32x16_bf16 v[24:39], v[92:95], v[120:123], v[24:39]
    ds_read_b64_tr_b16 v[92:93], v197 offset:0
    ds_read_b64_tr_b16 v[94:95], v197 offset:1024
    buffer_load_dwordx4 v252, s[16:19], s48 offen offset:1024 lds
    v_mfma_f32_32x32x16_bf16 v[40:55], v[96:99], v[120:123], v[40:55]
    ds_read_b64_tr_b16 v[96:97], v198 offset:0
    ds_read_b64_tr_b16 v[98:99], v198 offset:1024
    buffer_load_dwordx4 v253, s[16:19], s48 offen offset:2048 lds
    s_waitcnt lgkmcnt(8)
    v_mfma_f32_32x32x16_bf16 v[56:71], v[100:103], v[120:123], v[56:71]
    ds_read_b64_tr_b16 v[100:101], v199 offset:0
    ds_read_b64_tr_b16 v[102:103], v199 offset:1024
    buffer_load_dwordx4 v254, s[16:19], s48 offen offset:3072 lds
    s_waitcnt lgkmcnt(8)
    v_mfma_f32_32x32x16_bf16 v[72:87], v[104:107], v[120:123], v[72:87]
    ds_read_b64_tr_b16 v[104:105], v196 offset:4096
    ds_read_b64_tr_b16 v[106:107], v196 offset:5120
    s_waitcnt lgkmcnt(8)
    v_mfma_f32_32x32x16_bf16 v[8:23], v[88:91], v[124:127], v[8:23]
    ds_read_b64_tr_b16 v[88:89], v197 offset:4096
    ds_read_b64_tr_b16 v[90:91], v197 offset:5120
    s_lshl_b32 s53, s11, 12
    s_add_u32 s53, s53, s44
    buffer_load_dwordx4 v[108:111], v248, s[4:7], s53 offen offset:0 sc1
    s_waitcnt lgkmcnt(8)
    v_mfma_f32_32x32x16_bf16 v[24:39], v[92:95], v[124:127], v[24:39]
    ds_read_b64_tr_b16 v[92:93], v198 offset:4096
    ds_read_b64_tr_b16 v[94:95], v198 offset:5120
    buffer_load_dwordx4 v[112:115], v248, s[4:7], s53 offen offset:1024 sc1
    s_waitcnt lgkmcnt(8)
    v_mfma_f32_32x32x16_bf16 v[40:55], v[96:99], v[124:127], v[40:55]
    ds_read_b64_tr_b16 v[96:97], v199 offset:4096
    ds_read_b64_tr_b16 v[98:99], v199 offset:5120
    buffer_load_dwordx4 v[116:119], v248, s[4:7], s53 offen offset:2048 sc1
    s_waitcnt lgkmcnt(8)
    v_mfma_f32_32x32x16_bf16 v[56:71], v[100:103], v[124:127], v[56:71]
    ds_read_b64_tr_b16 v[100:101], v196 offset:8192
    ds_read_b64_tr_b16 v[102:103], v196 offset:9216
    buffer_load_dwordx4 v[120:123], v248, s[4:7], s53 offen offset:3072 sc1
    s_waitcnt lgkmcnt(8)
    v_mfma_f32_32x32x16_bf16 v[8:23], v[104:107], v[128:131], v[8:23]
    ds_read_b64_tr_b16 v[104:105], v197 offset:8192
    ds_read_b64_tr_b16 v[106:107], v197 offset:9216
    s_setprio 2
    s_lshr_b32 s60, s2, 3
    s_lshl_b32 s60, s60, 2
    s_add_u32 s60, s60, s36
    s_mul_i32 s60, s60, 5248
    s_add_u32 s60, s60, 0
    v_lshlrev_b32 v194, 3, v248
    v_add_u32 v194, s60, v194
    s_mov_b64 exec, 0x7f
    buffer_load_dword v195, v194, s[28:31], 0 offen
    s_mov_b64 exec, -1
    s_setprio 0
    s_waitcnt lgkmcnt(8)
    v_mfma_f32_32x32x16_bf16 v[24:39], v[88:91], v[128:131], v[24:39]
    ds_read_b64_tr_b16 v[88:89], v198 offset:8192
    ds_read_b64_tr_b16 v[90:91], v198 offset:9216
    s_waitcnt lgkmcnt(8)
    v_mfma_f32_32x32x16_bf16 v[40:55], v[92:95], v[128:131], v[40:55]
    s_waitcnt vmcnt(17)
    s_mov_b64 exec, 1
    ds_add_u32 v244, v207
    s_mov_b64 exec, -1
    ds_read_b64_tr_b16 v[92:93], v199 offset:8192
    ds_read_b64_tr_b16 v[94:95], v199 offset:9216
    s_waitcnt lgkmcnt(9)
    v_mfma_f32_32x32x16_bf16 v[56:71], v[96:99], v[128:131], v[56:71]
    ds_read_b64_tr_b16 v[96:97], v196 offset:12288
    ds_read_b64_tr_b16 v[98:99], v196 offset:13312
    s_waitcnt lgkmcnt(9)
    v_mfma_f32_32x32x16_bf16 v[8:23], v[100:103], v[132:135], v[8:23]
    ds_read_b64_tr_b16 v[100:101], v197 offset:12288
    ds_read_b64_tr_b16 v[102:103], v197 offset:13312
    s_waitcnt lgkmcnt(9)
    v_mfma_f32_32x32x16_bf16 v[24:39], v[104:107], v[132:135], v[24:39]
    ds_read2_b32 v[238:239], v245 offset1:4
    ds_read_b64_tr_b16 v[104:105], v198 offset:12288
    ds_read_b64_tr_b16 v[106:107], v198 offset:13312
    s_waitcnt lgkmcnt(10)
    v_mfma_f32_32x32x16_bf16 v[40:55], v[88:91], v[132:135], v[40:55]
    ds_read_b64_tr_b16 v[88:89], v199 offset:12288
    ds_read_b64_tr_b16 v[90:91], v199 offset:13312
    s_waitcnt lgkmcnt(9)
    v_mfma_f32_32x32x16_bf16 v[56:71], v[92:95], v[132:135], v[56:71]
    s_waitcnt lgkmcnt(4)
    s_setprio 2
    v_cmp_gt_u32 vcc, 4, v238
    v_cmp_gt_u32 s[62:63], 6, v239
    s_or_b64 vcc, vcc, s[62:63]
    s_cbranch_vccz GM_c6_ok
GM_c6_spin:
    ds_read2_b32 v[238:239], v245 offset1:4
    s_waitcnt lgkmcnt(0)
    v_cmp_gt_u32 vcc, 4, v238
    v_cmp_gt_u32 s[62:63], 6, v239
    s_or_b64 vcc, vcc, s[62:63]
    s_cbranch_vccnz GM_c6_spin
GM_c6_ok:
    s_setprio 0
    s_setprio 2
    s_cmp_lg_u32 s20, 4
    s_cbranch_scc1 PH2_pub
    s_lshl_b32 s62, s2, 7
    s_add_u32 s62, s62, 46010368
    v_mov_b32 v210, 2
    s_mov_b64 exec, 1
    buffer_store_dword v210, off, s[4:7], s62 sc1
    s_mov_b64 exec, -1
PH2_pub:
    s_setprio 0
    ds_read_b64_tr_b16 v[92:93], v196 offset:20480
    ds_read_b64_tr_b16 v[94:95], v196 offset:21504
    s_add_u32 m0, s52, 139264
    s_add_u32 s48, s40, 7
    s_and_b32 s48, s48, 15
    s_mul_i32 s48, s48, 12288
    s_add_u32 s48, s48, s49
    buffer_load_dwordx4 v248, s[4:7], s48 offen offset:0 sc1 lds
    v_mfma_f32_32x32x16_bf16 v[8:23], v[96:99], v[136:139], v[8:23]
    ds_read_b64_tr_b16 v[96:97], v197 offset:20480
    ds_read_b64_tr_b16 v[98:99], v197 offset:21504
    buffer_load_dwordx4 v248, s[4:7], s48 offen offset:1024 sc1 lds
    v_mfma_f32_32x32x16_bf16 v[24:39], v[100:103], v[136:139], v[24:39]
    ds_read_b64_tr_b16 v[100:101], v198 offset:20480
    ds_read_b64_tr_b16 v[102:103], v198 offset:21504
    buffer_load_dwordx4 v248, s[4:7], s48 offen offset:2048 sc1 lds
    s_waitcnt lgkmcnt(8)
    v_mfma_f32_32x32x16_bf16 v[40:55], v[104:107], v[136:139], v[40:55]
    ds_read_b64_tr_b16 v[104:105], v199 offset:20480
    ds_read_b64_tr_b16 v[106:107], v199 offset:21504
    s_add_u32 m0, s46, 81920
    s_mul_i32 s48, s12, 73728
    s_add_u32 s48, s48, s42
    buffer_load_dwordx4 v251, s[16:19], s48 offen offset:0 lds
    s_waitcnt lgkmcnt(8)
    v_mfma_f32_32x32x16_bf16 v[56:71], v[88:91], v[136:139], v[56:71]
    ds_read_b64_tr_b16 v[88:89], v196 offset:24576
    ds_read_b64_tr_b16 v[90:91], v196 offset:25600
    buffer_load_dwordx4 v252, s[16:19], s48 offen offset:1024 lds
    s_waitcnt lgkmcnt(8)
    v_mfma_f32_32x32x16_bf16 v[8:23], v[92:95], v[140:143], v[8:23]
    ds_read_b64_tr_b16 v[92:93], v197 offset:24576
    ds_read_b64_tr_b16 v[94:95], v197 offset:25600
    buffer_load_dwordx4 v253, s[16:19], s48 offen offset:2048 lds
    s_waitcnt lgkmcnt(8)
    v_mfma_f32_32x32x16_bf16 v[24:39], v[96:99], v[140:143], v[24:39]
    ds_read_b64_tr_b16 v[96:97], v198 offset:24576
    ds_read_b64_tr_b16 v[98:99], v198 offset:25600
    buffer_load_dwordx4 v254, s[16:19], s48 offen offset:3072 lds
    s_waitcnt lgkmcnt(8)
    v_mfma_f32_32x32x16_bf16 v[40:55], v[100:103], v[140:143], v[40:55]
    ds_read_b64_tr_b16 v[100:101], v199 offset:24576
    ds_read_b64_tr_b16 v[102:103], v199 offset:25600
    s_lshl_b32 s53, s12, 12
    s_add_u32 s53, s53, s44
    buffer_load_dwordx4 v[124:127], v248, s[4:7], s53 offen offset:0 sc1
    s_waitcnt lgkmcnt(8)
    v_mfma_f32_32x32x16_bf16 v[56:71], v[104:107], v[140:143], v[56:71]
    ds_read_b64_tr_b16 v[104:105], v196 offset:28672
    ds_read_b64_tr_b16 v[106:107], v196 offset:29696
    buffer_load_dwordx4 v[128:131], v248, s[4:7], s53 offen offset:1024 sc1
    s_waitcnt lgkmcnt(8)
    v_mfma_f32_32x32x16_bf16 v[8:23], v[88:91], v[144:147], v[8:23]
    ds_read_b64_tr_b16 v[88:89], v197 offset:28672
    ds_read_b64_tr_b16 v[90:91], v197 offset:29696
    buffer_load_dwordx4 v[132:135], v248, s[4:7], s53 offen offset:2048 sc1
    s_waitcnt lgkmcnt(8)
    v_mfma_f32_32x32x16_bf16 v[24:39], v[92:95], v[144:147], v[24:39]
    ds_read_b64_tr_b16 v[92:93], v198 offset:28672
    ds_read_b64_tr_b16 v[94:95], v198 offset:29696
    buffer_load_dwordx4 v[136:139], v248, s[4:7], s53 offen offset:3072 sc1
    s_waitcnt lgkmcnt(8)
    v_mfma_f32_32x32x16_bf16 v[40:55], v[96:99], v[144:147], v[40:55]
    s_waitcnt vmcnt(24)
    s_mov_b64 exec, 1
    ds_add_u32 v244, v207
    s_mov_b64 exec, -1
    ds_read_b64_tr_b16 v[96:97], v199 offset:28672
    ds_read_b64_tr_b16 v[98:99], v199 offset:29696
    s_setprio 2
    s_lshr_b32 s60, s2, 3
    s_lshl_b32 s60, s60, 2
    s_add_u32 s60, s60, s36
    s_mul_i32 s60, s60, 5248
    s_add_u32 s60, s60, 896
    v_lshlrev_b32 v194, 3, v248
    v_add_u32 v194, s60, v194
    s_mov_b64 exec, 0x7f
    buffer_load_dword v195, v194, s[28:31], 0 offen
    s_mov_b64 exec, -1
    s_setprio 0
    s_waitcnt lgkmcnt(9)
    v_mfma_f32_32x32x16_bf16 v[56:71], v[100:103], v[144:147], v[56:71]
    ds_read_b64_tr_b16 v[100:101], v196 offset:32768
    ds_read_b64_tr_b16 v[102:103], v196 offset:33792
    s_waitcnt lgkmcnt(9)
    v_mfma_f32_32x32x16_bf16 v[8:23], v[104:107], v[148:151], v[8:23]
    ds_read_b64_tr_b16 v[104:105], v197 offset:32768
    ds_read_b64_tr_b16 v[106:107], v197 offset:33792
    s_waitcnt lgkmcnt(9)
    v_mfma_f32_32x32x16_bf16 v[24:39], v[88:91], v[148:151], v[24:39]
    ds_read2_b32 v[238:239], v245 offset1:4
    ds_read_b64_tr_b16 v[88:89], v198 offset:32768
    ds_read_b64_tr_b16 v[90:91], v198 offset:33792
    s_waitcnt lgkmcnt(10)
    v_mfma_f32_32x32x16_bf16 v[40:55], v[92:95], v[148:151], v[40:55]
    ds_read_b64_tr_b16 v[92:93], v199 offset:32768
    ds_read_b64_tr_b16 v[94:95], v199 offset:33792
    s_waitcnt lgkmcnt(9)
    v_mfma_f32_32x32x16_bf16 v[56:71], v[96:99], v[148:151], v[56:71]
    s_waitcnt lgkmcnt(4)
    s_setprio 2
    v_cmp_gt_u32 vcc, 4, v238
    v_cmp_gt_u32 s[62:63], 7, v239
    s_or_b64 vcc, vcc, s[62:63]
    s_cbranch_vccz GM_c7_ok
GM_c7_spin:
    ds_read2_b32 v[238:239], v245 offset1:4
    s_waitcnt lgkmcnt(0)
    v_cmp_gt_u32 vcc, 4, v238
    v_cmp_gt_u32 s[62:63], 7, v239
    s_or_b64 vcc, vcc, s[62:63]
    s_cbranch_vccnz GM_c7_spin
GM_c7_ok:
    s_setprio 0
    ds_read_b64_tr_b16 v[96:97], v196 offset:40960
    ds_read_b64_tr_b16 v[98:99], v196 offset:41984
    s_add_u32 m0, s52, 151552
    s_add_u32 s48, s40, 8
    s_and_b32 s48, s48, 15
    s_mul_i32 s48, s48, 12288
    s_add_u32 s48, s48, s49
    buffer_load_dwordx4 v248, s[4:7], s48 offen offset:0 sc1 lds
    v_mfma_f32_32x32x16_bf16 v[8:23], v[100:103], v[152:155], v[8:23]
    ds_read_b64_tr_b16 v[100:101], v197 offset:40960
    ds_read_b64_tr_b16 v[102:103], v197 offset:41984
    buffer_load_dwordx4 v248, s[4:7], s48 offen offset:1024 sc1 lds
    v_mfma_f32_32x32x16_bf16 v[24:39], v[104:107], v[152:155], v[24:39]
    ds_read_b64_tr_b16 v[104:105], v198 offset:40960
    ds_read_b64_tr_b16 v[106:107], v198 offset:41984
    buffer_load_dwordx4 v248, s[4:7], s48 offen offset:2048 sc1 lds
    s_waitcnt lgkmcnt(8)
    v_mfma_f32_32x32x16_bf16 v[40:55], v[88:91], v[152:155], v[40:55]
    ds_read_b64_tr_b16 v[88:89], v199 offset:40960
    ds_read_b64_tr_b16 v[90:91], v199 offset:41984
    s_add_u32 m0, s46, 0
    s_mul_i32 s48, s13, 73728
    s_add_u32 s48, s48, s39
    buffer_load_dwordx4 v251, s[16:19], s48 offen offset:0 lds
    s_waitcnt lgkmcnt(8)
    v_mfma_f32_32x32x16_bf16 v[56:71], v[92:95], v[152:155], v[56:71]
    ds_read_b64_tr_b16 v[92:93], v196 offset:45056
    ds_read_b64_tr_b16 v[94:95], v196 offset:46080
    buffer_load_dwordx4 v252, s[16:19], s48 offen offset:1024 lds
    s_waitcnt vmcnt(29) lgkmcnt(8)
    v_mfma_f32_32x32x16_bf16 v[8:23], v[96:99], v[156:159], v[8:23]
    ds_read_b64_tr_b16 v[96:97], v197 offset:45056
    ds_read_b64_tr_b16 v[98:99], v197 offset:46080
    buffer_load_dwordx4 v253, s[16:19], s48 offen offset:2048 lds
    s_waitcnt lgkmcnt(8)
    v_mfma_f32_32x32x16_bf16 v[24:39], v[100:103], v[156:159], v[24:39]
    ds_read_b64_tr_b16 v[100:101], v198 offset:45056
    ds_read_b64_tr_b16 v[102:103], v198 offset:46080
    buffer_load_dwordx4 v254, s[16:19], s48 offen offset:3072 lds
    s_waitcnt lgkmcnt(8)
    v_mfma_f32_32x32x16_bf16 v[40:55], v[104:107], v[156:159], v[40:55]
    ds_read_b64_tr_b16 v[104:105], v199 offset:45056
    ds_read_b64_tr_b16 v[106:107], v199 offset:46080
    s_add_u32 m0, s47, 16384
    s_mul_i32 s48, s13, 73728
    s_add_u32 s48, s48, s45
    buffer_load_dwordx4 v255, s[16:19], s48 offen lds
    s_waitcnt lgkmcnt(8)
    v_mfma_f32_32x32x16_bf16 v[56:71], v[88:91], v[156:159], v[56:71]
    ds_read_b64_tr_b16 v[88:89], v196 offset:49152
    ds_read_b64_tr_b16 v[90:91], v196 offset:50176
    buffer_load_dword v213, v212, s[4:7], 0 offen sc1
    s_waitcnt vmcnt(32) lgkmcnt(8)
    v_mfma_f32_32x32x16_bf16 v[8:23], v[92:95], v[160:163], v[8:23]
    ds_read_b64_tr_b16 v[92:93], v197 offset:49152
    ds_read_b64_tr_b16 v[94:95], v197 offset:50176
    s_waitcnt lgkmcnt(8)
    v_mfma_f32_32x32x16_bf16 v[24:39], v[96:99], v[160:163], v[24:39]
    ds_read_b64_tr_b16 v[96:97], v198 offset:49152
    ds_read_b64_tr_b16 v[98:99], v198 offset:50176
    s_waitcnt lgkmcnt(8)
    v_mfma_f32_32x32x16_bf16 v[40:55], v[100:103], v[160:163], v[40:55]
    s_waitcnt vmcnt(18)
    s_mov_b64 exec, 1
    ds_add_u32 v244, v207
    s_mov_b64 exec, -1
    ds_read_b64_tr_b16 v[100:101], v199 offset:49152
    ds_read_b64_tr_b16 v[102:103], v199 offset:50176
    s_waitcnt lgkmcnt(9)
    v_mfma_f32_32x32x16_bf16 v[56:71], v[104:107], v[160:163], v[56:71]
    ds_read_b64_tr_b16 v[104:105], v196 offset:53248
    ds_read_b64_tr_b16 v[106:107], v196 offset:54272
    s_setprio 2
    s_waitcnt vmcnt(0)
    v_cmp_gt_u32 vcc, 2, v213
    s_cbranch_vccz POLL2_ok
    s_mov_b32 s63, 1048576
POLL2_spin:
    s_sleep 2
    buffer_load_dword v213, v212, s[4:7], 0 offen sc1
    s_waitcnt vmcnt(0)
    v_cmp_gt_u32 vcc, 2, v213
    s_sub_u32 s63, s63, 1
    s_cbranch_scc1 POLL2_ok
    s_cbranch_vccnz POLL2_spin
POLL2_ok:
    s_setprio 0
    s_waitcnt lgkmcnt(9)
    v_mfma_f32_32x32x16_bf16 v[8:23], v[88:91], v[164:167], v[8:23]
    ds_read_b64_tr_b16 v[88:89], v197 offset:53248
    ds_read_b64_tr_b16 v[90:91], v197 offset:54272
    s_lshl_b32 s53, s13, 12
    s_add_u32 s53, s53, s43
    buffer_load_dwordx4 v[140:143], v248, s[4:7], s53 offen offset:0 sc1
    s_waitcnt lgkmcnt(9)
    v_mfma_f32_32x32x16_bf16 v[24:39], v[92:95], v[164:167], v[24:39]
    ds_read2_b32 v[238:239], v245 offset1:4
    ds_read_b64_tr_b16 v[92:93], v198 offset:53248
    ds_read_b64_tr_b16 v[94:95], v198 offset:54272
    buffer_load_dwordx4 v[144:147], v248, s[4:7], s53 offen offset:1024 sc1
    s_waitcnt lgkmcnt(10)
    v_mfma_f32_32x32x16_bf16 v[40:55], v[96:99], v[164:167], v[40:55]
    ds_read_b64_tr_b16 v[96:97], v199 offset:53248
    ds_read_b64_tr_b16 v[98:99], v199 offset:54272
    buffer_load_dwordx4 v[148:151], v248, s[4:7], s53 offen offset:2048 sc1
    s_waitcnt lgkmcnt(9)
    v_mfma_f32_32x32x16_bf16 v[56:71], v[100:103], v[164:167], v[56:71]
    s_waitcnt lgkmcnt(4)
    s_setprio 2
    v_cmp_gt_u32 vcc, 5, v238
    v_cmp_gt_u32 s[62:63], 8, v239
    s_or_b64 vcc, vcc, s[62:63]
    s_cbranch_vccz GM_c8_ok
GM_c8_spin:
    ds_read2_b32 v[238:239], v245 offset1:4
    s_waitcnt lgkmcnt(0)
    v_cmp_gt_u32 vcc, 5, v238
    v_cmp_gt_u32 s[62:63], 8, v239
    s_or_b64 vcc, vcc, s[62:63]
    s_cbranch_vccnz GM_c8_spin
GM_c8_ok:
    s_setprio 0
    ds_read_b64_tr_b16 v[100:101], v200 offset:0
    ds_read_b64_tr_b16 v[102:103], v200 offset:1024
    buffer_load_dwordx4 v[152:155], v248, s[4:7], s53 offen offset:3072 sc1
    v_mfma_f32_32x32x16_bf16 v[8:23], v[104:107], v[168:171], v[8:23]
    ds_read_b64_tr_b16 v[104:105], v201 offset:0
    ds_read_b64_tr_b16 v[106:107], v201 offset:1024
    s_setprio 2
    s_lshr_b32 s60, s2, 3
    s_lshl_b32 s60, s60, 2
    s_add_u32 s60, s60, s36
    s_mul_i32 s60, s60, 5248
    s_add_u32 s60, s60, 1792
    v_lshlrev_b32 v194, 3, v248
    v_add_u32 v194, s60, v194
    s_mov_b64 exec, 0x7f
    buffer_load_dword v195, v194, s[28:31], 0 offen
    s_mov_b64 exec, -1
    s_setprio 0
    v_mfma_f32_32x32x16_bf16 v[24:39], v[88:91], v[168:171], v[24:39]
    ds_read_b64_tr_b16 v[88:89], v202 offset:0
    ds_read_b64_tr_b16 v[90:91], v202 offset:1024
    s_add_u32 m0, s52, 102400
    s_add_u32 s48, s40, 9
    s_and_b32 s48, s48, 15
    s_mul_i32 s48, s48, 12288
    s_add_u32 s48, s48, s49
    buffer_load_dwordx4 v248, s[4:7], s48 offen offset:0 sc1 lds
    s_waitcnt lgkmcnt(8)
    v_mfma_f32_32x32x16_bf16 v[40:55], v[92:95], v[168:171], v[40:55]
    ds_read_b64_tr_b16 v[92:93], v203 offset:0
    ds_read_b64_tr_b16 v[94:95], v203 offset:1024
    buffer_load_dwordx4 v248, s[4:7], s48 offen offset:1024 sc1 lds
    s_waitcnt lgkmcnt(8)
    v_mfma_f32_32x32x16_bf16 v[56:71], v[96:99], v[168:171], v[56:71]
    ds_read_b64_tr_b16 v[96:97], v200 offset:4096
    ds_read_b64_tr_b16 v[98:99], v200 offset:5120
    buffer_load_dwordx4 v248, s[4:7], s48 offen offset:2048 sc1 lds
    s_waitcnt lgkmcnt(8)
    v_mfma_f32_32x32x16_bf16 v[8:23], v[100:103], v[108:111], v[8:23]
    ds_read_b64_tr_b16 v[100:101], v201 offset:4096
    ds_read_b64_tr_b16 v[102:103], v201 offset:5120
    s_add_u32 m0, s46, 20480
    s_mul_i32 s48, s14, 73728
    s_add_u32 s48, s48, s39
    buffer_load_dwordx4 v251, s[16:19], s48 offen offset:0 lds
    s_waitcnt lgkmcnt(8)
    v_mfma_f32_32x32x16_bf16 v[24:39], v[104:107], v[108:111], v[24:39]
    ds_read_b64_tr_b16 v[104:105], v202 offset:4096
    ds_read_b64_tr_b16 v[106:107], v202 offset:5120
    buffer_load_dwordx4 v252, s[16:19], s48 offen offset:1024 lds
    s_waitcnt lgkmcnt(8)
    v_mfma_f32_32x32x16_bf16 v[40:55], v[88:91], v[108:111], v[40:55]
    ds_read_b64_tr_b16 v[88:89], v203 offset:4096
    ds_read_b64_tr_b16 v[90:91], v203 offset:5120
    buffer_load_dwordx4 v253, s[16:19], s48 offen offset:2048 lds
    s_waitcnt lgkmcnt(8)
    v_mfma_f32_32x32x16_bf16 v[56:71], v[92:95], v[108:111], v[56:71]
    ds_read_b64_tr_b16 v[92:93], v200 offset:8192
    ds_read_b64_tr_b16 v[94:95], v200 offset:9216
    buffer_load_dwordx4 v254, s[16:19], s48 offen offset:3072 lds
    s_waitcnt lgkmcnt(8)
    v_mfma_f32_32x32x16_bf16 v[8:23], v[96:99], v[112:115], v[8:23]
    ds_read_b64_tr_b16 v[96:97], v201 offset:8192
    ds_read_b64_tr_b16 v[98:99], v201 offset:9216
    s_add_u32 m0, s47, 36864
    s_mul_i32 s48, s14, 73728
    s_add_u32 s48, s48, s45
    buffer_load_dwordx4 v255, s[16:19], s48 offen lds
    s_waitcnt lgkmcnt(8)
    v_mfma_f32_32x32x16_bf16 v[24:39], v[100:103], v[112:115], v[24:39]
    ds_read_b64_tr_b16 v[100:101], v202 offset:8192
    ds_read_b64_tr_b16 v[102:103], v202 offset:9216
    s_lshl_b32 s53, s14, 12
    s_add_u32 s53, s53, s43
    buffer_load_dwordx4 v[156:159], v248, s[4:7], s53 offen offset:0 sc1
    s_waitcnt lgkmcnt(8)
    v_mfma_f32_32x32x16_bf16 v[40:55], v[104:107], v[112:115], v[40:55]
    s_mov_b64 exec, 1
    ds_add_u32 v244, v207
    s_mov_b64 exec, -1
    ds_read_b64_tr_b16 v[104:105], v203 offset:8192
    ds_read_b64_tr_b16 v[106:107], v203 offset:9216
    buffer_load_dwordx4 v[160:163], v248, s[4:7], s53 offen offset:1024 sc1
    s_waitcnt lgkmcnt(9)
    v_mfma_f32_32x32x16_bf16 v[56:71], v[88:91], v[112:115], v[56:71]
    ds_read_b64_tr_b16 v[88:89], v200 offset:12288
    ds_read_b64_tr_b16 v[90:91], v200 offset:13312
    buffer_load_dwordx4 v[164:167], v248, s[4:7], s53 offen offset:2048 sc1
    s_waitcnt lgkmcnt(9)
    v_mfma_f32_32x32x16_bf16 v[8:23], v[92:95], v[116:119], v[8:23]
    ds_read_b64_tr_b16 v[92:93], v201 offset:12288
    ds_read_b64_tr_b16 v[94:95], v201 offset:13312
    buffer_load_dwordx4 v[168:171], v248, s[4:7], s53 offen offset:3072 sc1
    s_waitcnt lgkmcnt(9)
    v_mfma_f32_32x32x16_bf16 v[24:39], v[96:99], v[116:119], v[24:39]
    ds_read2_b32 v[238:239], v245 offset1:4
    ds_read_b64_tr_b16 v[96:97], v202 offset:12288
    ds_read_b64_tr_b16 v[98:99], v202 offset:13312
    s_setprio 2
    s_lshr_b32 s60, s2, 3
    s_lshl_b32 s60, s60, 2
    s_add_u32 s60, s60, s36
    s_mul_i32 s60, s60, 5248
    s_add_u32 s60, s60, 2688
    v_lshlrev_b32 v194, 3, v248
    v_add_u32 v194, s60, v194
    s_mov_b64 exec, 0x7f
    buffer_load_dword v195, v194, s[28:31], 0 offen
    s_mov_b64 exec, -1
    s_setprio 0
    s_waitcnt lgkmcnt(10)
    v_mfma_f32_32x32x16_bf16 v[40:55], v[100:103], v[116:119], v[40:55]
    ds_read_b64_tr_b16 v[100:101], v203 offset:12288
    ds_read_b64_tr_b16 v[102:103], v203 offset:13312
    s_waitcnt lgkmcnt(9)
    v_mfma_f32_32x32x16_bf16 v[56:71], v[104:107], v[116:119], v[56:71]
    s_waitcnt lgkmcnt(4)
    s_setprio 2
    v_cmp_gt_u32 vcc, 9, v239
    s_cbranch_vccz GM_c9_ok
GM_c9_spin:
    ds_read2_b32 v[238:239], v245 offset1:4
    s_waitcnt lgkmcnt(0)
    v_cmp_gt_u32 vcc, 9, v239
    s_cbranch_vccnz GM_c9_spin
GM_c9_ok:
    s_setprio 0
    ds_read_b64_tr_b16 v[104:105], v200 offset:20480
    ds_read_b64_tr_b16 v[106:107], v200 offset:21504
    s_add_u32 m0, s46, 40960
    s_mul_i32 s48, s15, 73728
    s_add_u32 s48, s48, s39
    buffer_load_dwordx4 v251, s[16:19], s48 offen offset:0 lds
    v_mfma_f32_32x32x16_bf16 v[8:23], v[88:91], v[120:123], v[8:23]
    ds_read_b64_tr_b16 v[88:89], v201 offset:20480
    ds_read_b64_tr_b16 v[90:91], v201 offset:21504
    buffer_load_dwordx4 v252, s[16:19], s48 offen offset:1024 lds
    v_mfma_f32_32x32x16_bf16 v[24:39], v[92:95], v[120:123], v[24:39]
    ds_read_b64_tr_b16 v[92:93], v202 offset:20480
    ds_read_b64_tr_b16 v[94:95], v202 offset:21504
    buffer_load_dwordx4 v253, s[16:19], s48 offen offset:2048 lds
    s_waitcnt lgkmcnt(8)
    v_mfma_f32_32x32x16_bf16 v[40:55], v[96:99], v[120:123], v[40:55]
    ds_read_b64_tr_b16 v[96:97], v203 offset:20480
    ds_read_b64_tr_b16 v[98:99], v203 offset:21504
    buffer_load_dwordx4 v254, s[16:19], s48 offen offset:3072 lds
    s_waitcnt lgkmcnt(8)
    v_mfma_f32_32x32x16_bf16 v[56:71], v[100:103], v[120:123], v[56:71]
    ds_read_b64_tr_b16 v[100:101], v200 offset:24576
    ds_read_b64_tr_b16 v[102:103], v200 offset:25600
    s_add_u32 m0, s47, 57344
    s_mul_i32 s48, s15, 73728
    s_add_u32 s48, s48, s45
    buffer_load_dwordx4 v255, s[16:19], s48 offen lds
    s_waitcnt lgkmcnt(8)
    v_mfma_f32_32x32x16_bf16 v[8:23], v[104:107], v[124:127], v[8:23]
    ds_read_b64_tr_b16 v[104:105], v201 offset:24576
    ds_read_b64_tr_b16 v[106:107], v201 offset:25600
    s_lshl_b32 s53, s15, 12
    s_add_u32 s53, s53, s43
    buffer_load_dwordx4 v[108:111], v248, s[4:7], s53 offen offset:0 sc1
    s_waitcnt lgkmcnt(8)
    v_mfma_f32_32x32x16_bf16 v[24:39], v[88:91], v[124:127], v[24:39]
    ds_read_b64_tr_b16 v[88:89], v202 offset:24576
    ds_read_b64_tr_b16 v[90:91], v202 offset:25600
    buffer_load_dwordx4 v[112:115], v248, s[4:7], s53 offen offset:1024 sc1
    s_waitcnt lgkmcnt(8)
    v_mfma_f32_32x32x16_bf16 v[40:55], v[92:95], v[124:127], v[40:55]
    ds_read_b64_tr_b16 v[92:93], v203 offset:24576
    ds_read_b64_tr_b16 v[94:95], v203 offset:25600
    buffer_load_dwordx4 v[116:119], v248, s[4:7], s53 offen offset:2048 sc1
    s_waitcnt lgkmcnt(8)
    v_mfma_f32_32x32x16_bf16 v[56:71], v[96:99], v[124:127], v[56:71]
    ds_read_b64_tr_b16 v[96:97], v200 offset:28672
    ds_read_b64_tr_b16 v[98:99], v200 offset:29696
    buffer_load_dwordx4 v[120:123], v248, s[4:7], s53 offen offset:3072 sc1
    s_waitcnt lgkmcnt(8)
    v_mfma_f32_32x32x16_bf16 v[8:23], v[100:103], v[128:131], v[8:23]
    ds_read_b64_tr_b16 v[100:101], v201 offset:28672
    ds_read_b64_tr_b16 v[102:103], v201 offset:29696
    s_setprio 2
    s_lshr_b32 s60, s2, 3
    s_lshl_b32 s60, s60, 2
    s_add_u32 s60, s60, s36
    s_mul_i32 s60, s60, 5248
    s_add_u32 s60, s60, 3584
    v_lshlrev_b32 v194, 3, v248
    v_add_u32 v194, s60, v194
    s_mov_b64 exec, 0x7f
    buffer_load_dword v195, v194, s[28:31], 0 offen
    s_mov_b64 exec, -1
    s_setprio 0
    s_waitcnt lgkmcnt(8)
    v_mfma_f32_32x32x16_bf16 v[24:39], v[104:107], v[128:131], v[24:39]
    ds_read_b64_tr_b16 v[104:105], v202 offset:28672
    ds_read_b64_tr_b16 v[106:107], v202 offset:29696
    s_waitcnt lgkmcnt(8)
    v_mfma_f32_32x32x16_bf16 v[40:55], v[88:91], v[128:131], v[40:55]
    s_waitcnt vmcnt(20)
    s_mov_b64 exec, 1
    ds_add_u32 v244, v207
    s_mov_b64 exec, -1
    ds_read_b64_tr_b16 v[88:89], v203 offset:28672
    ds_read_b64_tr_b16 v[90:91], v203 offset:29696
    s_waitcnt lgkmcnt(9)
    v_mfma_f32_32x32x16_bf16 v[56:71], v[92:95], v[128:131], v[56:71]
    ds_read_b64_tr_b16 v[92:93], v200 offset:32768
    ds_read_b64_tr_b16 v[94:95], v200 offset:33792
    s_waitcnt lgkmcnt(9)
    v_mfma_f32_32x32x16_bf16 v[8:23], v[96:99], v[132:135], v[8:23]
    ds_read_b64_tr_b16 v[96:97], v201 offset:32768
    ds_read_b64_tr_b16 v[98:99], v201 offset:33792
    s_waitcnt lgkmcnt(9)
    v_mfma_f32_32x32x16_bf16 v[24:39], v[100:103], v[132:135], v[24:39]
    ds_read2_b32 v[238:239], v245 offset1:4
    ds_read_b64_tr_b16 v[100:101], v202 offset:32768
    ds_read_b64_tr_b16 v[102:103], v202 offset:33792
    s_waitcnt lgkmcnt(10)
    v_mfma_f32_32x32x16_bf16 v[40:55], v[104:107], v[132:135], v[40:55]
    ds_read_b64_tr_b16 v[104:105], v203 offset:32768
    ds_read_b64_tr_b16 v[106:107], v203 offset:33792
    s_waitcnt lgkmcnt(9)
    v_mfma_f32_32x32x16_bf16 v[56:71], v[88:91], v[132:135], v[56:71]
    s_waitcnt lgkmcnt(4)
    s_setprio 2
    v_cmp_gt_u32 vcc, 6, v238
    v_cmp_gt_u32 s[62:63], 10, v239
    s_or_b64 vcc, vcc, s[62:63]
    s_cbranch_vccz GM_c10_ok
GM_c10_spin:
    ds_read2_b32 v[238:239], v245 offset1:4
    s_waitcnt lgkmcnt(0)
    v_cmp_gt_u32 vcc, 6, v238
    v_cmp_gt_u32 s[62:63], 10, v239
    s_or_b64 vcc, vcc, s[62:63]
    s_cbranch_vccnz GM_c10_spin
GM_c10_ok:
    s_setprio 0
    ds_read_b64_tr_b16 v[88:89], v196 offset:0
    ds_read_b64_tr_b16 v[90:91], v196 offset:1024
    s_add_u32 m0, s52, 114688
    s_add_u32 s48, s40, 10
    s_and_b32 s48, s48, 15
    s_mul_i32 s48, s48, 12288
    s_add_u32 s48, s48, s49
    buffer_load_dwordx4 v248, s[4:7], s48 offen offset:0 sc1 lds
    v_mfma_f32_32x32x16_bf16 v[8:23], v[92:95], v[136:139], v[8:23]
    ds_read_b64_tr_b16 v[92:93], v197 offset:0
    ds_read_b64_tr_b16 v[94:95], v197 offset:1024
    buffer_load_dwordx4 v248, s[4:7], s48 offen offset:1024 sc1 lds
    v_mfma_f32_32x32x16_bf16 v[24:39], v[96:99], v[136:139], v[24:39]
    ds_read_b64_tr_b16 v[96:97], v198 offset:0
    ds_read_b64_tr_b16 v[98:99], v198 offset:1024
    s_mov_b32 exec_lo, 0xffcfffff
    buffer_load_dwordx4 v248, s[4:7], s48 offen offset:2048 sc1 lds
    s_mov_b32 exec_lo, -1
    s_waitcnt lgkmcnt(8)
    v_mfma_f32_32x32x16_bf16 v[40:55], v[100:103], v[136:139], v[40:55]
    ds_read_b64_tr_b16 v[100:101], v199 offset:0
    ds_read_b64_tr_b16 v[102:103], v199 offset:1024
    s_add_u32 m0, s46, 61440
    s_mul_i32 s48, s25, 73728
    s_add_u32 s48, s48, s39
    buffer_load_dwordx4 v251, s[16:19], s48 offen offset:0 lds
    s_waitcnt lgkmcnt(8)
    v_mfma_f32_32x32x16_bf16 v[56:71], v[104:107], v[136:139], v[56:71]
    ds_read_b64_tr_b16 v[104:105], v204 offset:16384
    ds_read_b64_tr_b16 v[106:107], v204 offset:16640
    buffer_load_dwordx4 v252, s[16:19], s48 offen offset:1024 lds
    s_waitcnt lgkmcnt(8)
    v_mfma_f32_32x32x16_bf16 v[8:23], v[88:91], v[140:143], v[8:23]
    ds_read_b64_tr_b16 v[88:89], v196 offset:4096
    ds_read_b64_tr_b16 v[90:91], v196 offset:5120
    buffer_load_dwordx4 v253, s[16:19], s48 offen offset:2048 lds
    s_waitcnt lgkmcnt(8)
    v_mfma_f32_32x32x16_bf16 v[24:39], v[92:95], v[140:143], v[24:39]
    ds_read_b64_tr_b16 v[92:93], v197 offset:4096
    ds_read_b64_tr_b16 v[94:95], v197 offset:5120
    buffer_load_dwordx4 v254, s[16:19], s48 offen offset:3072 lds
    s_waitcnt lgkmcnt(8)
    v_mfma_f32_32x32x16_bf16 v[40:55], v[96:99], v[140:143], v[40:55]
    ds_read_b64_tr_b16 v[96:97], v198 offset:4096
    ds_read_b64_tr_b16 v[98:99], v198 offset:5120
    s_add_u32 m0, s47, 77824
    s_mul_i32 s48, s25, 73728
    s_add_u32 s48, s48, s45
    buffer_load_dwordx4 v255, s[16:19], s48 offen lds
    s_waitcnt lgkmcnt(8)
    v_mfma_f32_32x32x16_bf16 v[56:71], v[100:103], v[140:143], v[56:71]
    ds_read_b64_tr_b16 v[100:101], v199 offset:4096
    ds_read_b64_tr_b16 v[102:103], v199 offset:5120
    s_lshl_b32 s53, s25, 12
    s_add_u32 s53, s53, s43
    buffer_load_dwordx4 v[124:127], v248, s[4:7], s53 offen offset:0 sc1
    s_waitcnt lgkmcnt(8)
    v_mfma_f32_32x32x16_bf16 v[72:87], v[104:107], v[140:143], v[72:87]
    ds_read_b64_tr_b16 v[104:105], v204 offset:17408
    ds_read_b64_tr_b16 v[106:107], v204 offset:17664
    buffer_load_dwordx4 v[128:131], v248, s[4:7], s53 offen offset:1024 sc1
    s_waitcnt lgkmcnt(8)
    v_mfma_f32_32x32x16_bf16 v[8:23], v[88:91], v[144:147], v[8:23]
    ds_read_b64_tr_b16 v[88:89], v196 offset:8192
    ds_read_b64_tr_b16 v[90:91], v196 offset:9216
    buffer_load_dwordx4 v[132:135], v248, s[4:7], s53 offen offset:2048 sc1
    s_waitcnt lgkmcnt(8)
    v_mfma_f32_32x32x16_bf16 v[24:39], v[92:95], v[144:147], v[24:39]
    ds_read_b64_tr_b16 v[92:93], v197 offset:8192
    ds_read_b64_tr_b16 v[94:95], v197 offset:9216
    buffer_load_dwordx4 v[136:139], v248, s[4:7], s53 offen offset:3072 sc1
    s_waitcnt lgkmcnt(8)
    v_mfma_f32_32x32x16_bf16 v[40:55], v[96:99], v[144:147], v[40:55]
    ds_read_b64_tr_b16 v[96:97], v198 offset:8192
    ds_read_b64_tr_b16 v[98:99], v198 offset:9216
    s_setprio 2
    s_getpc_b64 s[96:97]
CT_pc3:
    s_sub_u32 s96, s96, CT_pc3-CODE_BEGIN
    s_subb_u32 s97, s97, 0
    s_mov_b32 s98, CODE_END-CODE_BEGIN
    s_mov_b32 s99, 0x20000
    s_lshr_b32 s62, s2, 3
    s_mul_i32 s62, s62, 4
    s_add_u32 s62, s62, s36
    s_mul_i32 s62, s62, 768
    v_lshlrev_b32 v194, 3, v248
    v_add_u32 v194, s62, v194
    s_mov_b64 exec, 63
    buffer_load_dword v195, v194, s[96:99], 0 offen
    s_mov_b64 exec, -1
    s_setprio 0
    s_waitcnt lgkmcnt(8)
    v_mfma_f32_32x32x16_bf16 v[56:71], v[100:103], v[144:147], v[56:71]
    ds_read_b64_tr_b16 v[100:101], v199 offset:8192
    ds_read_b64_tr_b16 v[102:103], v199 offset:9216
    s_waitcnt lgkmcnt(8)
    v_mfma_f32_32x32x16_bf16 v[72:87], v[104:107], v[144:147], v[72:87]
    ds_read_b64_tr_b16 v[104:105], v204 offset:18432
    ds_read_b64_tr_b16 v[106:107], v204 offset:18688
    s_waitcnt lgkmcnt(8)
    v_mfma_f32_32x32x16_bf16 v[8:23], v[88:91], v[148:151], v[8:23]
    s_waitcnt vmcnt(28)
    s_mov_b64 exec, 1
    ds_add_u32 v244, v207
    s_mov_b64 exec, -1
    ds_read_b64_tr_b16 v[88:89], v196 offset:12288
    ds_read_b64_tr_b16 v[90:91], v196 offset:13312
    s_waitcnt lgkmcnt(9)
    v_mfma_f32_32x32x16_bf16 v[24:39], v[92:95], v[148:151], v[24:39]
    ds_read_b64_tr_b16 v[92:93], v197 offset:12288
    ds_read_b64_tr_b16 v[94:95], v197 offset:13312
    s_waitcnt lgkmcnt(9)
    v_mfma_f32_32x32x16_bf16 v[40:55], v[96:99], v[148:151], v[40:55]
    ds_read_b64_tr_b16 v[96:97], v198 offset:12288
    ds_read_b64_tr_b16 v[98:99], v198 offset:13312
    s_waitcnt lgkmcnt(9)
    v_mfma_f32_32x32x16_bf16 v[56:71], v[100:103], v[148:151], v[56:71]
    ds_read2_b32 v[238:239], v245 offset1:4
    ds_read_b64_tr_b16 v[100:101], v199 offset:12288
    ds_read_b64_tr_b16 v[102:103], v199 offset:13312
    s_waitcnt lgkmcnt(10)
    v_mfma_f32_32x32x16_bf16 v[72:87], v[104:107], v[148:151], v[72:87]
    ds_read_b64_tr_b16 v[104:105], v204 offset:19456
    ds_read_b64_tr_b16 v[106:107], v204 offset:19712
    s_waitcnt lgkmcnt(9)
    v_mfma_f32_32x32x16_bf16 v[8:23], v[88:91], v[152:155], v[8:23]
    s_waitcnt lgkmcnt(4)
    s_setprio 2
    v_cmp_gt_u32 vcc, 7, v238
    v_cmp_gt_u32 s[62:63], 11, v239
    s_or_b64 vcc, vcc, s[62:63]
    s_cbranch_vccz GM_c11_ok
GM_c11_spin:
    ds_read2_b32 v[238:239], v245 offset1:4
    s_waitcnt lgkmcnt(0)
    v_cmp_gt_u32 vcc, 7, v238
    v_cmp_gt_u32 s[62:63], 11, v239
    s_or_b64 vcc, vcc, s[62:63]
    s_cbranch_vccnz GM_c11_spin
GM_c11_ok:
    s_setprio 0
    ds_read_b64_tr_b16 v[88:89], v196 offset:20480
    ds_read_b64_tr_b16 v[90:91], v196 offset:21504
    s_add_u32 m0, s52, 126976
    s_add_u32 s48, s40, 11
    s_and_b32 s48, s48, 15
    s_mul_i32 s48, s48, 12288
    s_add_u32 s48, s48, s49
    buffer_load_dwordx4 v248, s[4:7], s48 offen offset:0 sc1 lds
    v_mfma_f32_32x32x16_bf16 v[24:39], v[92:95], v[152:155], v[24:39]
    ds_read_b64_tr_b16 v[92:93], v197 offset:20480
    ds_read_b64_tr_b16 v[94:95], v197 offset:21504
    buffer_load_dwordx4 v248, s[4:7], s48 offen offset:1024 sc1 lds
    v_mfma_f32_32x32x16_bf16 v[40:55], v[96:99], v[152:155], v[40:55]
    ds_read_b64_tr_b16 v[96:97], v198 offset:20480
    ds_read_b64_tr_b16 v[98:99], v198 offset:21504
    buffer_load_dwordx4 v248, s[4:7], s48 offen offset:2048 sc1 lds
    s_waitcnt lgkmcnt(8)
    v_mfma_f32_32x32x16_bf16 v[56:71], v[100:103], v[152:155], v[56:71]
    ds_read_b64_tr_b16 v[100:101], v199 offset:20480
    ds_read_b64_tr_b16 v[102:103], v199 offset:21504
    s_add_u32 m0, s46, 86016
    s_mul_i32 s48, s13, 73728
    s_add_u32 s48, s48, s42
    buffer_load_dwordx4 v251, s[16:19], s48 offen offset:0 lds
    s_waitcnt lgkmcnt(8)
    v_mfma_f32_32x32x16_bf16 v[72:87], v[104:107], v[152:155], v[72:87]
    ds_read_b64_tr_b16 v[104:105], v204 offset:36864
    ds_read_b64_tr_b16 v[106:107], v204 offset:37120
    buffer_load_dwordx4 v252, s[16:19], s48 offen offset:1024 lds
    s_waitcnt vmcnt(32) lgkmcnt(8)
    v_mfma_f32_32x32x16_bf16 v[8:23], v[88:91], v[156:159], v[8:23]
    ds_read_b64_tr_b16 v[88:89], v196 offset:24576
    ds_read_b64_tr_b16 v[90:91], v196 offset:25600
    buffer_load_dwordx4 v253, s[16:19], s48 offen offset:2048 lds
    s_waitcnt lgkmcnt(8)
    v_mfma_f32_32x32x16_bf16 v[24:39], v[92:95], v[156:159], v[24:39]
    ds_read_b64_tr_b16 v[92:93], v197 offset:24576
    ds_read_b64_tr_b16 v[94:95], v197 offset:25600
    buffer_load_dwordx4 v254, s[16:19], s48 offen offset:3072 lds
    s_waitcnt lgkmcnt(8)
    v_mfma_f32_32x32x16_bf16 v[40:55], v[96:99], v[156:159], v[40:55]
    ds_read_b64_tr_b16 v[96:97], v198 offset:24576
    ds_read_b64_tr_b16 v[98:99], v198 offset:25600
    s_lshl_b32 s53, s13, 12
    s_add_u32 s53, s53, s44
    buffer_load_dwordx4 v[140:143], v248, s[4:7], s53 offen offset:0 sc1
    s_waitcnt lgkmcnt(8)
    v_mfma_f32_32x32x16_bf16 v[56:71], v[100:103], v[156:159], v[56:71]
    ds_read_b64_tr_b16 v[100:101], v199 offset:24576
    ds_read_b64_tr_b16 v[102:103], v199 offset:25600
    buffer_load_dwordx4 v[144:147], v248, s[4:7], s53 offen offset:1024 sc1
    s_waitcnt lgkmcnt(8)
    v_mfma_f32_32x32x16_bf16 v[72:87], v[104:107], v[156:159], v[72:87]
    ds_read_b64_tr_b16 v[104:105], v204 offset:37888
    ds_read_b64_tr_b16 v[106:107], v204 offset:38144
    buffer_load_dwordx4 v[148:151], v248, s[4:7], s53 offen offset:2048 sc1
    s_waitcnt vmcnt(36) lgkmcnt(8)
    v_mfma_f32_32x32x16_bf16 v[8:23], v[88:91], v[160:163], v[8:23]
    ds_read_b64_tr_b16 v[88:89], v196 offset:28672
    ds_read_b64_tr_b16 v[90:91], v196 offset:29696
    buffer_load_dwordx4 v[152:155], v248, s[4:7], s53 offen offset:3072 sc1
    s_waitcnt lgkmcnt(8)
    v_mfma_f32_32x32x16_bf16 v[24:39], v[92:95], v[160:163], v[24:39]
    ds_read_b64_tr_b16 v[92:93], v197 offset:28672
    ds_read_b64_tr_b16 v[94:95], v197 offset:29696
    s_setprio 2
    s_lshr_b32 s60, s2, 3
    s_lshl_b32 s60, s60, 2
    s_add_u32 s60, s60, s36
    s_mul_i32 s60, s60, 5248
    s_add_u32 s60, s60, 4480
    v_lshlrev_b32 v194, 3, v248
    v_add_u32 v194, s60, v194
    s_mov_b64 exec, 0x7f
    buffer_load_dword v195, v194, s[28:31], 0 offen
    s_mov_b64 exec, -1
    s_setprio 0
    s_waitcnt lgkmcnt(8)
    v_mfma_f32_32x32x16_bf16 v[40:55], v[96:99], v[160:163], v[40:55]
    ds_read_b64_tr_b16 v[96:97], v198 offset:28672
    ds_read_b64_tr_b16 v[98:99], v198 offset:29696
    s_waitcnt lgkmcnt(8)
    v_mfma_f32_32x32x16_bf16 v[56:71], v[100:103], v[160:163], v[56:71]
    ds_read_b64_tr_b16 v[100:101], v199 offset:28672
    ds_read_b64_tr_b16 v[102:103], v199 offset:29696
    s_waitcnt lgkmcnt(8)
    v_mfma_f32_32x32x16_bf16 v[72:87], v[104:107], v[160:163], v[72:87]
    ds_read_b64_tr_b16 v[104:105], v204 offset:38912
    ds_read_b64_tr_b16 v[106:107], v204 offset:39168
    s_waitcnt vmcnt(37) lgkmcnt(8)
    v_mfma_f32_32x32x16_bf16 v[8:23], v[88:91], v[164:167], v[8:23]
    s_waitcnt vmcnt(22)
    s_mov_b64 exec, 1
    ds_add_u32 v244, v207
    s_mov_b64 exec, -1
    ds_read_b64_tr_b16 v[88:89], v196 offset:32768
    ds_read_b64_tr_b16 v[90:91], v196 offset:33792
    s_waitcnt lgkmcnt(9)
    v_mfma_f32_32x32x16_bf16 v[24:39], v[92:95], v[164:167], v[24:39]
    ds_read_b64_tr_b16 v[92:93], v197 offset:32768
    ds_read_b64_tr_b16 v[94:95], v197 offset:33792
    s_waitcnt lgkmcnt(9)
    v_mfma_f32_32x32x16_bf16 v[40:55], v[96:99], v[164:167], v[40:55]
    ds_read_b64_tr_b16 v[96:97], v198 offset:32768
    ds_read_b64_tr_b16 v[98:99], v198 offset:33792
    s_waitcnt lgkmcnt(9)
    v_mfma_f32_32x32x16_bf16 v[56:71], v[100:103], v[164:167], v[56:71]
    ds_read2_b32 v[238:239], v245 offset1:4
    ds_read_b64_tr_b16 v[100:101], v199 offset:32768
    ds_read_b64_tr_b16 v[102:103], v199 offset:33792
    s_waitcnt lgkmcnt(10)
    v_mfma_f32_32x32x16_bf16 v[72:87], v[104:107], v[164:167], v[72:87]
    ds_read_b64_tr_b16 v[104:105], v204 offset:39936
    ds_read_b64_tr_b16 v[106:107], v204 offset:40192
    s_waitcnt lgkmcnt(9)
    v_mfma_f32_32x32x16_bf16 v[8:23], v[88:91], v[168:171], v[8:23]
    s_waitcnt lgkmcnt(4)
    s_setprio 2
    v_cmp_gt_u32 vcc, 8, v238
    v_cmp_gt_u32 s[62:63], 12, v239
    s_or_b64 vcc, vcc, s[62:63]
    s_cbranch_vccz GM_c12_ok
GM_c12_spin:
    ds_read2_b32 v[238:239], v245 offset1:4
    s_waitcnt lgkmcnt(0)
    v_cmp_gt_u32 vcc, 8, v238
    v_cmp_gt_u32 s[62:63], 12, v239
    s_or_b64 vcc, vcc, s[62:63]
    s_cbranch_vccnz GM_c12_spin
GM_c12_ok:
    s_setprio 0
    ds_read_b64_tr_b16 v[88:89], v196 offset:40960
    ds_read_b64_tr_b16 v[90:91], v196 offset:41984
    s_add_u32 m0, s52, 139264
    s_add_u32 s48, s40, 12
    s_and_b32 s48, s48, 15
    s_mul_i32 s48, s48, 12288
    s_add_u32 s48, s48, s49
    buffer_load_dwordx4 v248, s[4:7], s48 offen offset:0 sc1 lds
    v_mfma_f32_32x32x16_bf16 v[24:39], v[92:95], v[168:171], v[24:39]
    ds_read_b64_tr_b16 v[92:93], v197 offset:40960
    ds_read_b64_tr_b16 v[94:95], v197 offset:41984
    buffer_load_dwordx4 v248, s[4:7], s48 offen offset:1024 sc1 lds
    v_mfma_f32_32x32x16_bf16 v[40:55], v[96:99], v[168:171], v[40:55]
    ds_read_b64_tr_b16 v[96:97], v198 offset:40960
    ds_read_b64_tr_b16 v[98:99], v198 offset:41984
    buffer_load_dwordx4 v248, s[4:7], s48 offen offset:2048 sc1 lds
    s_waitcnt lgkmcnt(8)
    v_mfma_f32_32x32x16_bf16 v[56:71], v[100:103], v[168:171], v[56:71]
    ds_read_b64_tr_b16 v[100:101], v199 offset:40960
    ds_read_b64_tr_b16 v[102:103], v199 offset:41984
    s_add_u32 m0, s46, 0
    s_mul_i32 s48, s14, 73728
    s_add_u32 s48, s48, s42
    buffer_load_dwordx4 v251, s[16:19], s48 offen offset:0 lds
    s_waitcnt lgkmcnt(8)
    v_mfma_f32_32x32x16_bf16 v[72:87], v[104:107], v[168:171], v[72:87]
    ds_read_b64_tr_b16 v[104:105], v204 offset:57344
    ds_read_b64_tr_b16 v[106:107], v204 offset:57600
    buffer_load_dwordx4 v252, s[16:19], s48 offen offset:1024 lds
    s_waitcnt lgkmcnt(8)
    v_mfma_f32_32x32x16_bf16 v[8:23], v[88:91], v[108:111], v[8:23]
    ds_read_b64_tr_b16 v[88:89], v196 offset:45056
    ds_read_b64_tr_b16 v[90:91], v196 offset:46080
    buffer_load_dwordx4 v253, s[16:19], s48 offen offset:2048 lds
    s_waitcnt lgkmcnt(8)
    v_mfma_f32_32x32x16_bf16 v[24:39], v[92:95], v[108:111], v[24:39]
    ds_read_b64_tr_b16 v[92:93], v197 offset:45056
    ds_read_b64_tr_b16 v[94:95], v197 offset:46080
    buffer_load_dwordx4 v254, s[16:19], s48 offen offset:3072 lds
    s_waitcnt lgkmcnt(8)
    v_mfma_f32_32x32x16_bf16 v[40:55], v[96:99], v[108:111], v[40:55]
    ds_read_b64_tr_b16 v[96:97], v198 offset:45056
    ds_read_b64_tr_b16 v[98:99], v198 offset:46080
    s_lshl_b32 s53, s14, 12
    s_add_u32 s53, s53, s44
    buffer_load_dwordx4 v[156:159], v248, s[4:7], s53 offen offset:0 sc1
    s_waitcnt lgkmcnt(8)
    v_mfma_f32_32x32x16_bf16 v[56:71], v[100:103], v[108:111], v[56:71]
    ds_read_b64_tr_b16 v[100:101], v199 offset:45056
    ds_read_b64_tr_b16 v[102:103], v199 offset:46080
    buffer_load_dwordx4 v[160:163], v248, s[4:7], s53 offen offset:1024 sc1
    s_waitcnt lgkmcnt(8)
    v_mfma_f32_32x32x16_bf16 v[72:87], v[104:107], v[108:111], v[72:87]
    ds_read_b64_tr_b16 v[104:105], v204 offset:58368
    ds_read_b64_tr_b16 v[106:107], v204 offset:58624
    buffer_load_dwordx4 v[164:167], v248, s[4:7], s53 offen offset:2048 sc1
    s_waitcnt lgkmcnt(8)
    v_mfma_f32_32x32x16_bf16 v[8:23], v[88:91], v[112:115], v[8:23]
    ds_read_b64_tr_b16 v[88:89], v196 offset:49152
    ds_read_b64_tr_b16 v[90:91], v196 offset:50176
    buffer_load_dwordx4 v[168:171], v248, s[4:7], s53 offen offset:3072 sc1
    s_waitcnt lgkmcnt(8)
    v_mfma_f32_32x32x16_bf16 v[24:39], v[92:95], v[112:115], v[24:39]
    ds_read_b64_tr_b16 v[92:93], v197 offset:49152
    ds_read_b64_tr_b16 v[94:95], v197 offset:50176
    s_setprio 2
    v_bfe_u32 v210, v248, 4, 2
    v_bfe_u32 v211, v248, 6, 1
    v_xor_b32 v211, s24, v211
    v_lshlrev_b32 v210, 1, v210
    v_lshl_add_u32 v210, v211, 3, v210
    s_lshl_b32 s60, s22, 5
    s_setprio 0
    s_waitcnt lgkmcnt(8)
    v_mfma_f32_32x32x16_bf16 v[40:55], v[96:99], v[112:115], v[40:55]
    ds_read_b64_tr_b16 v[96:97], v198 offset:49152
    ds_read_b64_tr_b16 v[98:99], v198 offset:50176
    s_setprio 2
    s_and_b32 s61, s23, 1
    s_add_u32 s60, s60, s61
    v_add_u32 v210, s60, v210
    v_cmp_ne_u32 vcc, s2, v210
    s_lshl_b32 s61, s36, 2
    s_add_u32 s61, s61, 46010388
    s_setprio 0
    s_waitcnt lgkmcnt(8)
    v_mfma_f32_32x32x16_bf16 v[56:71], v[100:103], v[112:115], v[56:71]
    ds_read_b64_tr_b16 v[100:101], v199 offset:49152
    ds_read_b64_tr_b16 v[102:103], v199 offset:50176
    s_setprio 2
    v_cndmask_b32 v208, 0, 1, vcc
    v_lshlrev_b32 v212, 7, v210
    v_add_u32 v212, s61, v212
    s_lshl_b32 s60, s2, 7
    s_add_u32 s61, s61, s60
    v_mov_b32 v209, 1
    s_setprio 0
    s_waitcnt lgkmcnt(8)
    v_mfma_f32_32x32x16_bf16 v[72:87], v[104:107], v[112:115], v[72:87]
    ds_read_b64_tr_b16 v[104:105], v204 offset:59392
    ds_read_b64_tr_b16 v[106:107], v204 offset:59648
    s_waitcnt lgkmcnt(8)
    v_mfma_f32_32x32x16_bf16 v[8:23], v[88:91], v[116:119], v[8:23]
    s_waitcnt vmcnt(20)
    s_mov_b64 exec, 1
    ds_add_u32 v244, v207
    s_mov_b64 exec, -1
    ds_read_b64_tr_b16 v[88:89], v196 offset:53248
    ds_read_b64_tr_b16 v[90:91], v196 offset:54272
    s_waitcnt lgkmcnt(9)
    v_mfma_f32_32x32x16_bf16 v[24:39], v[92:95], v[116:119], v[24:39]
    ds_read_b64_tr_b16 v[92:93], v197 offset:53248
    ds_read_b64_tr_b16 v[94:95], v197 offset:54272
    s_waitcnt lgkmcnt(9)
    v_mfma_f32_32x32x16_bf16 v[40:55], v[96:99], v[116:119], v[40:55]
    ds_read_b64_tr_b16 v[96:97], v198 offset:53248
    ds_read_b64_tr_b16 v[98:99], v198 offset:54272
    s_waitcnt lgkmcnt(9)
    v_mfma_f32_32x32x16_bf16 v[56:71], v[100:103], v[116:119], v[56:71]
    ds_read2_b32 v[238:239], v245 offset1:4
    ds_read_b64_tr_b16 v[100:101], v199 offset:53248
    ds_read_b64_tr_b16 v[102:103], v199 offset:54272
    s_waitcnt lgkmcnt(10)
    v_mfma_f32_32x32x16_bf16 v[72:87], v[104:107], v[116:119], v[72:87]
    ds_read_b64_tr_b16 v[104:105], v204 offset:60416
    ds_read_b64_tr_b16 v[106:107], v204 offset:60672
    s_waitcnt lgkmcnt(9)
    v_mfma_f32_32x32x16_bf16 v[8:23], v[88:91], v[120:123], v[8:23]
    s_waitcnt lgkmcnt(4)
    s_setprio 2
    v_cmp_gt_u32 vcc, 9, v238
    v_cmp_gt_u32 s[62:63], 13, v239
    s_or_b64 vcc, vcc, s[62:63]
    s_cbranch_vccz GM_c13_ok
GM_c13_spin:
    ds_read2_b32 v[238:239], v245 offset1:4
    s_waitcnt lgkmcnt(0)
    v_cmp_gt_u32 vcc, 9, v238
    v_cmp_gt_u32 s[62:63], 13, v239
    s_or_b64 vcc, vcc, s[62:63]
    s_cbranch_vccnz GM_c13_spin
GM_c13_ok:
    s_setprio 0
    ds_read_b64_tr_b16 v[88:89], v200 offset:0
    ds_read_b64_tr_b16 v[90:91], v200 offset:1024
    s_add_u32 m0, s52, 151552
    s_add_u32 s48, s40, 13
    s_and_b32 s48, s48, 15
    s_mul_i32 s48, s48, 12288
    s_add_u32 s48, s48, s49
    buffer_load_dwordx4 v248, s[4:7], s48 offen offset:0 sc1 lds
    v_mfma_f32_32x32x16_bf16 v[24:39], v[92:95], v[120:123], v[24:39]
    ds_read_b64_tr_b16 v[92:93], v201 offset:0
    ds_read_b64_tr_b16 v[94:95], v201 offset:1024
    buffer_load_dwordx4 v248, s[4:7], s48 offen offset:1024 sc1 lds
    v_mfma_f32_32x32x16_bf16 v[40:55], v[96:99], v[120:123], v[40:55]
    ds_read_b64_tr_b16 v[96:97], v202 offset:0
    ds_read_b64_tr_b16 v[98:99], v202 offset:1024
    buffer_load_dwordx4 v248, s[4:7], s48 offen offset:2048 sc1 lds
    s_waitcnt lgkmcnt(8)
    v_mfma_f32_32x32x16_bf16 v[56:71], v[100:103], v[120:123], v[56:71]
    ds_read_b64_tr_b16 v[100:101], v203 offset:0
    ds_read_b64_tr_b16 v[102:103], v203 offset:1024
    s_add_u32 m0, s46, 16384
    s_mul_i32 s48, s15, 73728
    s_add_u32 s48, s48, s42
    buffer_load_dwordx4 v251, s[16:19], s48 offen offset:0 lds
    s_waitcnt lgkmcnt(8)
    v_mfma_f32_32x32x16_bf16 v[72:87], v[104:107], v[120:123], v[72:87]
    ds_read_b64_tr_b16 v[104:105], v205 offset:16384
    ds_read_b64_tr_b16 v[106:107], v205 offset:16640
    buffer_load_dwordx4 v252, s[16:19], s48 offen offset:1024 lds
    s_waitcnt lgkmcnt(8)
    v_mfma_f32_32x32x16_bf16 v[8:23], v[88:91], v[124:127], v[8:23]
    ds_read_b64_tr_b16 v[88:89], v200 offset:4096
    ds_read_b64_tr_b16 v[90:91], v200 offset:5120
    buffer_load_dwordx4 v253, s[16:19], s48 offen offset:2048 lds
    s_waitcnt lgkmcnt(8)
    v_mfma_f32_32x32x16_bf16 v[24:39], v[92:95], v[124:127], v[24:39]
    ds_read_b64_tr_b16 v[92:93], v201 offset:4096
    ds_read_b64_tr_b16 v[94:95], v201 offset:5120
    buffer_load_dwordx4 v254, s[16:19], s48 offen offset:3072 lds
    s_waitcnt lgkmcnt(8)
    v_mfma_f32_32x32x16_bf16 v[40:55], v[96:99], v[124:127], v[40:55]
    ds_read_b64_tr_b16 v[96:97], v202 offset:4096
    ds_read_b64_tr_b16 v[98:99], v202 offset:5120
    s_lshl_b32 s53, s15, 12
    s_add_u32 s53, s53, s44
    buffer_load_dwordx4 v[108:111], v248, s[4:7], s53 offen offset:0 sc1
    s_waitcnt lgkmcnt(8)
    v_mfma_f32_32x32x16_bf16 v[56:71], v[100:103], v[124:127], v[56:71]
    ds_read_b64_tr_b16 v[100:101], v203 offset:4096
    ds_read_b64_tr_b16 v[102:103], v203 offset:5120
    buffer_load_dwordx4 v[112:115], v248, s[4:7], s53 offen offset:1024 sc1
    s_waitcnt lgkmcnt(8)
    v_mfma_f32_32x32x16_bf16 v[72:87], v[104:107], v[124:127], v[72:87]
    ds_read_b64_tr_b16 v[104:105], v205 offset:17408
    ds_read_b64_tr_b16 v[106:107], v205 offset:17664
    buffer_load_dwordx4 v[116:119], v248, s[4:7], s53 offen offset:2048 sc1
    s_waitcnt lgkmcnt(8)
    v_mfma_f32_32x32x16_bf16 v[8:23], v[88:91], v[128:131], v[8:23]
    ds_read_b64_tr_b16 v[88:89], v200 offset:8192
    ds_read_b64_tr_b16 v[90:91], v200 offset:9216
    buffer_load_dwordx4 v[120:123], v248, s[4:7], s53 offen offset:3072 sc1
    s_waitcnt lgkmcnt(8)
    v_mfma_f32_32x32x16_bf16 v[24:39], v[92:95], v[128:131], v[24:39]
    ds_read_b64_tr_b16 v[92:93], v201 offset:8192
    ds_read_b64_tr_b16 v[94:95], v201 offset:9216
    s_add_u32 s8, s27, s50
    s_add_u32 s9, s41, s50
    buffer_load_dwordx4 v[0:3], v246, s[32:35], s8 offen offset:0
    s_waitcnt lgkmcnt(8)
    v_mfma_f32_32x32x16_bf16 v[40:55], v[96:99], v[128:131], v[40:55]
    ds_read_b64_tr_b16 v[96:97], v202 offset:8192
    ds_read_b64_tr_b16 v[98:99], v202 offset:9216
    buffer_load_dwordx4 v[4:7], v246, s[32:35], s8 offen offset:16
    s_waitcnt lgkmcnt(8)
    v_mfma_f32_32x32x16_bf16 v[56:71], v[100:103], v[128:131], v[56:71]
    ds_read_b64_tr_b16 v[100:101], v203 offset:8192
    ds_read_b64_tr_b16 v[102:103], v203 offset:9216
    buffer_load_dwordx4 v[230:233], v246, s[32:35], s9 offen offset:0
    s_waitcnt lgkmcnt(8)
    v_mfma_f32_32x32x16_bf16 v[72:87], v[104:107], v[128:131], v[72:87]
    ds_read_b64_tr_b16 v[104:105], v205 offset:18432
    ds_read_b64_tr_b16 v[106:107], v205 offset:18688
    buffer_load_dwordx4 v[234:237], v246, s[32:35], s9 offen offset:16
    s_waitcnt lgkmcnt(8)
    v_mfma_f32_32x32x16_bf16 v[8:23], v[88:91], v[132:135], v[8:23]
    s_waitcnt vmcnt(8)
    s_mov_b64 exec, 1
    ds_add_u32 v244, v207
    s_mov_b64 exec, -1
    ds_read_b64_tr_b16 v[88:89], v200 offset:12288
    ds_read_b64_tr_b16 v[90:91], v200 offset:13312
    s_waitcnt lgkmcnt(9)
    v_mfma_f32_32x32x16_bf16 v[24:39], v[92:95], v[132:135], v[24:39]
    ds_read_b64_tr_b16 v[92:93], v201 offset:12288
    ds_read_b64_tr_b16 v[94:95], v201 offset:13312
    s_waitcnt lgkmcnt(9)
    v_mfma_f32_32x32x16_bf16 v[40:55], v[96:99], v[132:135], v[40:55]
    ds_read_b64_tr_b16 v[96:97], v202 offset:12288
    ds_read_b64_tr_b16 v[98:99], v202 offset:13312
    s_waitcnt lgkmcnt(9)
    v_mfma_f32_32x32x16_bf16 v[56:71], v[100:103], v[132:135], v[56:71]
    ds_read2_b32 v[238:239], v245 offset1:4
    ds_read_b64_tr_b16 v[100:101], v203 offset:12288
    ds_read_b64_tr_b16 v[102:103], v203 offset:13312
    s_waitcnt lgkmcnt(10)
    v_mfma_f32_32x32x16_bf16 v[72:87], v[104:107], v[132:135], v[72:87]
    ds_read_b64_tr_b16 v[104:105], v205 offset:19456
    ds_read_b64_tr_b16 v[106:107], v205 offset:19712
    s_waitcnt lgkmcnt(9)
    v_mfma_f32_32x32x16_bf16 v[8:23], v[88:91], v[136:139], v[8:23]
    s_waitcnt lgkmcnt(4)
    s_setprio 2
    v_cmp_gt_u32 vcc, 14, v239
    s_cbranch_vccz GM_c14_ok
GM_c14_spin:
    ds_read2_b32 v[238:239], v245 offset1:4
    s_waitcnt lgkmcnt(0)
    v_cmp_gt_u32 vcc, 14, v239
    s_cbranch_vccnz GM_c14_spin
GM_c14_ok:
    s_setprio 0
    ds_read_b64_tr_b16 v[88:89], v203 offset:24576
    ds_read_b64_tr_b16 v[90:91], v203 offset:25600
    s_add_u32 m0, s46, 32768
    s_mul_i32 s48, s25, 73728
    s_add_u32 s48, s48, s42
    buffer_load_dwordx4 v251, s[16:19], s48 offen offset:0 lds
    v_mfma_f32_32x32x16_bf16 v[24:39], v[92:95], v[136:139], v[24:39]
    ds_read_b64_tr_b16 v[92:93], v203 offset:28672
    ds_read_b64_tr_b16 v[94:95], v203 offset:29696
    buffer_load_dwordx4 v252, s[16:19], s48 offen offset:1024 lds
    v_mfma_f32_32x32x16_bf16 v[40:55], v[96:99], v[136:139], v[40:55]
    ds_read_b64_tr_b16 v[96:97], v203 offset:32768
    ds_read_b64_tr_b16 v[98:99], v203 offset:33792
    buffer_load_dwordx4 v253, s[16:19], s48 offen offset:2048 lds
    s_waitcnt lgkmcnt(8)
    v_mfma_f32_32x32x16_bf16 v[56:71], v[100:103], v[136:139], v[56:71]
    ds_read_b64_tr_b16 v[100:101], v203 offset:36864
    ds_read_b64_tr_b16 v[102:103], v203 offset:37888
    buffer_load_dwordx4 v254, s[16:19], s48 offen offset:3072 lds
    s_waitcnt lgkmcnt(8)
    v_mfma_f32_32x32x16_bf16 v[72:87], v[104:107], v[136:139], v[72:87]
    ds_read_b64_tr_b16 v[104:105], v199 offset:0
    ds_read_b64_tr_b16 v[106:107], v199 offset:1024
    s_waitcnt lgkmcnt(8)
    v_mfma_f32_32x32x16_bf16 v[56:71], v[88:91], v[140:143], v[56:71]
    ds_read_b64_tr_b16 v[88:89], v199 offset:4096
    ds_read_b64_tr_b16 v[90:91], v199 offset:5120
    s_lshl_b32 s53, s25, 12
    s_add_u32 s53, s53, s44
    buffer_load_dwordx4 v[124:127], v248, s[4:7], s53 offen offset:0 sc1
    s_waitcnt lgkmcnt(8)
    v_mfma_f32_32x32x16_bf16 v[56:71], v[92:95], v[144:147], v[56:71]
    ds_read_b64_tr_b16 v[92:93], v199 offset:8192
    ds_read_b64_tr_b16 v[94:95], v199 offset:9216
    buffer_load_dwordx4 v[128:131], v248, s[4:7], s53 offen offset:1024 sc1
    s_waitcnt lgkmcnt(8)
    v_mfma_f32_32x32x16_bf16 v[56:71], v[96:99], v[148:151], v[56:71]
    ds_read_b64_tr_b16 v[96:97], v199 offset:12288
    ds_read_b64_tr_b16 v[98:99], v199 offset:13312
    buffer_load_dwordx4 v[132:135], v248, s[4:7], s53 offen offset:2048 sc1
    s_waitcnt lgkmcnt(8)
    v_mfma_f32_32x32x16_bf16 v[56:71], v[100:103], v[152:155], v[56:71]
    ds_read_b64_tr_b16 v[100:101], v199 offset:16384
    ds_read_b64_tr_b16 v[102:103], v199 offset:17408
    buffer_load_dwordx4 v[136:139], v248, s[4:7], s53 offen offset:3072 sc1
    s_setprio 2
    v_cvt_pk_bf16_f32 v172, v72, v73
    v_cvt_pk_bf16_f32 v173, v74, v75
    v_cvt_pk_bf16_f32 v174, v76, v77
    v_cvt_pk_bf16_f32 v175, v78, v79
    v_cvt_pk_bf16_f32 v176, v80, v81
    v_cvt_pk_bf16_f32 v177, v82, v83
    v_cvt_pk_bf16_f32 v178, v84, v85
    v_cvt_pk_bf16_f32 v179, v86, v87
    s_setprio 0
    s_waitcnt lgkmcnt(8)
    v_mfma_f32_32x32x16_bf16 v[56:71], v[104:107], v[156:159], v[56:71]
    ds_read_b64_tr_b16 v[104:105], v199 offset:20480
    ds_read_b64_tr_b16 v[106:107], v199 offset:21504
    s_lshl_b32 s54, s38, 11
    s_add_u32 s54, s54, s26
    s_add_u32 s54, s54, 32768
    buffer_store_dwordx4 v[172:175], v248, s[4:7], s54 offen offset:0 sc1
    s_waitcnt lgkmcnt(8)
    v_mfma_f32_32x32x16_bf16 v[56:71], v[88:91], v[160:163], v[56:71]
    ds_read_b64_tr_b16 v[88:89], v199 offset:24576
    ds_read_b64_tr_b16 v[90:91], v199 offset:25600
    buffer_store_dwordx4 v[176:179], v248, s[4:7], s54 offen offset:1024 sc1
    s_waitcnt lgkmcnt(8)
    v_mfma_f32_32x32x16_bf16 v[56:71], v[92:95], v[164:167], v[56:71]
    s_waitcnt vmcnt(6)
    s_mov_b64 exec, 1
    ds_add_u32 v244, v207
    s_mov_b64 exec, -1
    ds_read_b64_tr_b16 v[92:93], v199 offset:28672
    ds_read_b64_tr_b16 v[94:95], v199 offset:29696
    s_waitcnt lgkmcnt(9)
    v_mfma_f32_32x32x16_bf16 v[56:71], v[96:99], v[168:171], v[56:71]
    ds_read_b64_tr_b16 v[96:97], v202 offset:24576
    ds_read_b64_tr_b16 v[98:99], v202 offset:25600
    s_waitcnt lgkmcnt(9)
    v_mfma_f32_32x32x16_bf16 v[56:71], v[100:103], v[108:111], v[56:71]
    ds_read_b64_tr_b16 v[100:101], v202 offset:28672
    ds_read_b64_tr_b16 v[102:103], v202 offset:29696
    s_waitcnt lgkmcnt(9)
    v_mfma_f32_32x32x16_bf16 v[56:71], v[104:107], v[112:115], v[56:71]
    ds_read2_b32 v[238:239], v245 offset1:4
    ds_read_b64_tr_b16 v[104:105], v202 offset:32768
    ds_read_b64_tr_b16 v[106:107], v202 offset:33792
    s_waitcnt lgkmcnt(10)
    v_mfma_f32_32x32x16_bf16 v[56:71], v[88:91], v[116:119], v[56:71]
    ds_read_b64_tr_b16 v[88:89], v202 offset:36864
    ds_read_b64_tr_b16 v[90:91], v202 offset:37888
    s_waitcnt lgkmcnt(9)
    v_mfma_f32_32x32x16_bf16 v[56:71], v[92:95], v[120:123], v[56:71]
    s_waitcnt lgkmcnt(4)
    s_setprio 2
    v_cmp_gt_u32 vcc, 10, v238
    v_cmp_gt_u32 s[62:63], 15, v239
    s_or_b64 vcc, vcc, s[62:63]
    s_cbranch_vccz GM_c15_ok
GM_c15_spin:
    ds_read2_b32 v[238:239], v245 offset1:4
    s_waitcnt lgkmcnt(0)
    v_cmp_gt_u32 vcc, 10, v238
    v_cmp_gt_u32 s[62:63], 15, v239
    s_or_b64 vcc, vcc, s[62:63]
    s_cbranch_vccnz GM_c15_spin
GM_c15_ok:
    s_setprio 0
    ds_read_b64_tr_b16 v[92:93], v199 offset:32768
    ds_read_b64_tr_b16 v[94:95], v199 offset:33792
    s_add_u32 m0, s52, 102400
    s_add_u32 s48, s40, 14
    s_and_b32 s48, s48, 15
    s_mul_i32 s48, s48, 12288
    s_add_u32 s48, s48, s49
    buffer_load_dwordx4 v248, s[4:7], s48 offen offset:0 sc1 lds
    v_mfma_f32_32x32x16_bf16 v[40:55], v[96:99], v[140:143], v[40:55]
    ds_read_b64_tr_b16 v[96:97], v199 offset:36864
    ds_read_b64_tr_b16 v[98:99], v199 offset:37888
    buffer_load_dwordx4 v248, s[4:7], s48 offen offset:1024 sc1 lds
    v_mfma_f32_32x32x16_bf16 v[40:55], v[100:103], v[144:147], v[40:55]
    ds_read_b64_tr_b16 v[100:101], v199 offset:40960
    ds_read_b64_tr_b16 v[102:103], v199 offset:41984
    buffer_load_dwordx4 v248, s[4:7], s48 offen offset:2048 sc1 lds
    s_waitcnt lgkmcnt(8)
    v_mfma_f32_32x32x16_bf16 v[40:55], v[104:107], v[148:151], v[40:55]
    ds_read_b64_tr_b16 v[104:105], v199 offset:45056
    ds_read_b64_tr_b16 v[106:107], v199 offset:46080
    s_add_u32 m0, s47, 49152
    s_add_u32 s48, s27, 0
    buffer_load_dwordx4 v255, s[28:31], s48 offen lds
    s_waitcnt lgkmcnt(8)
    v_mfma_f32_32x32x16_bf16 v[40:55], v[88:91], v[152:155], v[40:55]
    ds_read_b64_tr_b16 v[88:89], v198 offset:0
    ds_read_b64_tr_b16 v[90:91], v198 offset:1024
    s_add_u32 m0, s47, 53248
    s_add_u32 s48, s27, 73728
    buffer_load_dwordx4 v255, s[28:31], s48 offen lds
    s_waitcnt vmcnt(10) lgkmcnt(8)
    v_mfma_f32_32x32x16_bf16 v[56:71], v[92:95], v[124:127], v[56:71]
    ds_read_b64_tr_b16 v[92:93], v198 offset:4096
    ds_read_b64_tr_b16 v[94:95], v198 offset:5120
    s_add_u32 m0, s47, 57344
    s_add_u32 s48, s27, 147456
    buffer_load_dwordx4 v255, s[28:31], s48 offen lds
    s_waitcnt vmcnt(10) lgkmcnt(8)
    v_mfma_f32_32x32x16_bf16 v[56:71], v[96:99], v[128:131], v[56:71]
    ds_read_b64_tr_b16 v[96:97], v198 offset:8192
    ds_read_b64_tr_b16 v[98:99], v198 offset:9216
    s_add_u32 m0, s47, 61440
    s_add_u32 s48, s27, 221184
    buffer_load_dwordx4 v255, s[28:31], s48 offen lds
    s_waitcnt vmcnt(10) lgkmcnt(8)
    v_mfma_f32_32x32x16_bf16 v[56:71], v[100:103], v[132:135], v[56:71]
    ds_read_b64_tr_b16 v[100:101], v198 offset:12288
    ds_read_b64_tr_b16 v[102:103], v198 offset:13312
    s_add_u32 m0, s47, 65536
    s_add_u32 s48, s27, 294912
    buffer_load_dwordx4 v255, s[28:31], s48 offen lds
    s_waitcnt vmcnt(10) lgkmcnt(8)
    v_mfma_f32_32x32x16_bf16 v[56:71], v[104:107], v[136:139], v[56:71]
    ds_read_b64_tr_b16 v[104:105], v198 offset:16384
    ds_read_b64_tr_b16 v[106:107], v198 offset:17408
    s_add_u32 m0, s47, 69632
    s_add_u32 s48, s27, 368640
    buffer_load_dwordx4 v255, s[28:31], s48 offen lds
    s_waitcnt lgkmcnt(8)
    v_mfma_f32_32x32x16_bf16 v[40:55], v[88:91], v[156:159], v[40:55]
    ds_read_b64_tr_b16 v[88:89], v198 offset:20480
    ds_read_b64_tr_b16 v[90:91], v198 offset:21504
    s_add_u32 m0, s47, 73728
    s_add_u32 s48, s27, 442368
    buffer_load_dwordx4 v255, s[28:31], s48 offen lds
    s_waitcnt lgkmcnt(8)
    v_mfma_f32_32x32x16_bf16 v[40:55], v[92:95], v[160:163], v[40:55]
    ds_read_b64_tr_b16 v[92:93], v198 offset:24576
    ds_read_b64_tr_b16 v[94:95], v198 offset:25600
    s_add_u32 m0, s47, 77824
    s_add_u32 s48, s27, 516096
    buffer_load_dwordx4 v255, s[28:31], s48 offen lds
    s_waitcnt lgkmcnt(8)
    v_mfma_f32_32x32x16_bf16 v[40:55], v[96:99], v[164:167], v[40:55]
    s_mov_b64 exec, 1
    ds_add_u32 v244, v207
    s_mov_b64 exec, -1
    ds_read_b64_tr_b16 v[96:97], v198 offset:28672
    ds_read_b64_tr_b16 v[98:99], v198 offset:29696
    s_add_u32 m0, s47, 81920
    s_add_u32 s48, s27, 589824
    buffer_load_dwordx4 v255, s[28:31], s48 offen lds
    s_waitcnt lgkmcnt(9)
    v_mfma_f32_32x32x16_bf16 v[40:55], v[100:103], v[168:171], v[40:55]
    ds_read_b64_tr_b16 v[100:101], v198 offset:32768
    ds_read_b64_tr_b16 v[102:103], v198 offset:33792
    s_setprio 2
    v_cvt_pk_bf16_f32 v180, v56, v57
    v_cvt_pk_bf16_f32 v181, v58, v59
    v_cvt_pk_bf16_f32 v182, v60, v61
    v_cvt_pk_bf16_f32 v183, v62, v63
    v_cvt_pk_bf16_f32 v184, v64, v65
    v_cvt_pk_bf16_f32 v185, v66, v67
    v_cvt_pk_bf16_f32 v186, v68, v69
    v_cvt_pk_bf16_f32 v187, v70, v71
    s_setprio 0
    s_waitcnt lgkmcnt(9)
    v_mfma_f32_32x32x16_bf16 v[40:55], v[104:107], v[108:111], v[40:55]
    ds_read_b64_tr_b16 v[104:105], v198 offset:36864
    ds_read_b64_tr_b16 v[106:107], v198 offset:37888
    s_xor_b32 s54, s38, 3
    s_lshl_b32 s54, s54, 13
    s_add_u32 s54, s54, s26
    s_add_u32 s54, s54, 6144
    buffer_store_dwordx4 v[180:183], v248, s[4:7], s54 offen offset:0 sc1
    s_waitcnt lgkmcnt(9)
    v_mfma_f32_32x32x16_bf16 v[40:55], v[88:91], v[112:115], v[40:55]
    ds_read2_b32 v[238:239], v245 offset1:4
    ds_read_b64_tr_b16 v[88:89], v198 offset:40960
    ds_read_b64_tr_b16 v[90:91], v198 offset:41984
    buffer_store_dwordx4 v[184:187], v248, s[4:7], s54 offen offset:1024 sc1
    s_waitcnt lgkmcnt(10)
    v_mfma_f32_32x32x16_bf16 v[40:55], v[92:95], v[116:119], v[40:55]
    ds_read_b64_tr_b16 v[92:93], v198 offset:45056
    ds_read_b64_tr_b16 v[94:95], v198 offset:46080
    s_waitcnt lgkmcnt(9)
    v_mfma_f32_32x32x16_bf16 v[40:55], v[96:99], v[120:123], v[40:55]
    s_waitcnt lgkmcnt(4)
    s_setprio 2
    v_cmp_gt_u32 vcc, 11, v238
    s_cbranch_vccz GM_c16_ok
GM_c16_spin:
    ds_read2_b32 v[238:239], v245 offset1:4
    s_waitcnt lgkmcnt(0)
    v_cmp_gt_u32 vcc, 11, v238
    s_cbranch_vccnz GM_c16_spin
GM_c16_ok:
    s_setprio 0
    ds_read_b64_tr_b16 v[96:97], v201 offset:24576
    ds_read_b64_tr_b16 v[98:99], v201 offset:25600
    s_add_u32 m0, s52, 114688
    s_add_u32 s48, s40, 15
    s_and_b32 s48, s48, 15
    s_mul_i32 s48, s48, 12288
    s_add_u32 s48, s48, s49
    buffer_load_dwordx4 v248, s[4:7], s48 offen offset:0 sc1 lds
    v_mfma_f32_32x32x16_bf16 v[40:55], v[100:103], v[124:127], v[40:55]
    ds_read_b64_tr_b16 v[100:101], v201 offset:28672
    ds_read_b64_tr_b16 v[102:103], v201 offset:29696
    buffer_load_dwordx4 v248, s[4:7], s48 offen offset:1024 sc1 lds
    v_mfma_f32_32x32x16_bf16 v[40:55], v[104:107], v[128:131], v[40:55]
    ds_read_b64_tr_b16 v[104:105], v201 offset:32768
    ds_read_b64_tr_b16 v[106:107], v201 offset:33792
    s_mov_b32 exec_lo, 0xffcfffff
    buffer_load_dwordx4 v248, s[4:7], s48 offen offset:2048 sc1 lds
    s_mov_b32 exec_lo, -1
    s_waitcnt lgkmcnt(8)
    v_mfma_f32_32x32x16_bf16 v[40:55], v[88:91], v[132:135], v[40:55]
    ds_read_b64_tr_b16 v[88:89], v201 offset:36864
    ds_read_b64_tr_b16 v[90:91], v201 offset:37888
    s_waitcnt lgkmcnt(8)
    v_mfma_f32_32x32x16_bf16 v[40:55], v[92:95], v[136:139], v[40:55]
    ds_read_b64_tr_b16 v[92:93], v197 offset:0
    ds_read_b64_tr_b16 v[94:95], v197 offset:1024
    s_waitcnt lgkmcnt(8)
    v_mfma_f32_32x32x16_bf16 v[24:39], v[96:99], v[140:143], v[24:39]
    ds_read_b64_tr_b16 v[96:97], v197 offset:4096
    ds_read_b64_tr_b16 v[98:99], v197 offset:5120
    s_waitcnt lgkmcnt(8)
    v_mfma_f32_32x32x16_bf16 v[24:39], v[100:103], v[144:147], v[24:39]
    ds_read_b64_tr_b16 v[100:101], v197 offset:8192
    ds_read_b64_tr_b16 v[102:103], v197 offset:9216
    s_waitcnt lgkmcnt(8)
    v_mfma_f32_32x32x16_bf16 v[24:39], v[104:107], v[148:151], v[24:39]
    ds_read_b64_tr_b16 v[104:105], v197 offset:12288
    ds_read_b64_tr_b16 v[106:107], v197 offset:13312
    s_waitcnt lgkmcnt(8)
    v_mfma_f32_32x32x16_bf16 v[24:39], v[88:91], v[152:155], v[24:39]
    ds_read_b64_tr_b16 v[88:89], v197 offset:16384
    ds_read_b64_tr_b16 v[90:91], v197 offset:17408
    s_setprio 2
    v_cvt_pk_bf16_f32 v214, v40, v41
    v_cvt_pk_bf16_f32 v215, v42, v43
    v_cvt_pk_bf16_f32 v216, v44, v45
    v_cvt_pk_bf16_f32 v217, v46, v47
    v_cvt_pk_bf16_f32 v218, v48, v49
    v_cvt_pk_bf16_f32 v219, v50, v51
    v_cvt_pk_bf16_f32 v220, v52, v53
    v_cvt_pk_bf16_f32 v221, v54, v55
    s_setprio 0
    s_waitcnt lgkmcnt(8)
    v_mfma_f32_32x32x16_bf16 v[24:39], v[92:95], v[156:159], v[24:39]
    ds_read_b64_tr_b16 v[92:93], v197 offset:20480
    ds_read_b64_tr_b16 v[94:95], v197 offset:21504
    s_xor_b32 s54, s38, 2
    s_lshl_b32 s54, s54, 13
    s_add_u32 s54, s54, s26
    s_add_u32 s54, s54, 4096
    buffer_store_dwordx4 v[214:217], v248, s[4:7], s54 offen offset:0 sc1
    s_waitcnt lgkmcnt(8)
    v_mfma_f32_32x32x16_bf16 v[24:39], v[96:99], v[160:163], v[24:39]
    ds_read_b64_tr_b16 v[96:97], v197 offset:24576
    ds_read_b64_tr_b16 v[98:99], v197 offset:25600
    buffer_store_dwordx4 v[218:221], v248, s[4:7], s54 offen offset:1024 sc1
    s_waitcnt lgkmcnt(8)
    v_mfma_f32_32x32x16_bf16 v[24:39], v[100:103], v[164:167], v[24:39]
    s_waitcnt vmcnt(16)
    s_mov_b64 exec, 1
    ds_add_u32 v244, v207
    s_mov_b64 exec, -1
    ds_read_b64_tr_b16 v[100:101], v197 offset:28672
    ds_read_b64_tr_b16 v[102:103], v197 offset:29696
    s_waitcnt lgkmcnt(9)
    v_mfma_f32_32x32x16_bf16 v[24:39], v[104:107], v[168:171], v[24:39]
    ds_read_b64_tr_b16 v[104:105], v197 offset:32768
    ds_read_b64_tr_b16 v[106:107], v197 offset:33792
    s_waitcnt lgkmcnt(9)
    v_mfma_f32_32x32x16_bf16 v[24:39], v[88:91], v[108:111], v[24:39]
    ds_read_b64_tr_b16 v[88:89], v197 offset:36864
    ds_read_b64_tr_b16 v[90:91], v197 offset:37888
    s_waitcnt lgkmcnt(9)
    v_mfma_f32_32x32x16_bf16 v[24:39], v[92:95], v[112:115], v[24:39]
    ds_read2_b32 v[238:239], v245 offset1:4
    ds_read_b64_tr_b16 v[92:93], v197 offset:40960
    ds_read_b64_tr_b16 v[94:95], v197 offset:41984
    s_waitcnt lgkmcnt(10)
    v_mfma_f32_32x32x16_bf16 v[24:39], v[96:99], v[116:119], v[24:39]
    ds_read_b64_tr_b16 v[96:97], v197 offset:45056
    ds_read_b64_tr_b16 v[98:99], v197 offset:46080
    s_waitcnt lgkmcnt(9)
    v_mfma_f32_32x32x16_bf16 v[24:39], v[100:103], v[120:123], v[24:39]
    ds_read_b64_tr_b16 v[100:101], v200 offset:24576
    ds_read_b64_tr_b16 v[102:103], v200 offset:25600
    s_waitcnt lgkmcnt(9)
    v_mfma_f32_32x32x16_bf16 v[24:39], v[104:107], v[124:127], v[24:39]
    ds_read_b64_tr_b16 v[104:105], v200 offset:28672
    ds_read_b64_tr_b16 v[106:107], v200 offset:29696
    s_waitcnt lgkmcnt(9)
    v_mfma_f32_32x32x16_bf16 v[24:39], v[88:91], v[128:131], v[24:39]
    ds_read_b64_tr_b16 v[88:89], v200 offset:32768
    ds_read_b64_tr_b16 v[90:91], v200 offset:33792
    s_waitcnt lgkmcnt(8)
    v_mfma_f32_32x32x16_bf16 v[24:39], v[92:95], v[132:135], v[24:39]
    ds_read_b64_tr_b16 v[92:93], v200 offset:36864
    ds_read_b64_tr_b16 v[94:95], v200 offset:37888
    s_waitcnt lgkmcnt(8)
    v_mfma_f32_32x32x16_bf16 v[24:39], v[96:99], v[136:139], v[24:39]
    ds_read_b64_tr_b16 v[96:97], v196 offset:0
    ds_read_b64_tr_b16 v[98:99], v196 offset:1024
    s_waitcnt lgkmcnt(8)
    v_mfma_f32_32x32x16_bf16 v[8:23], v[100:103], v[140:143], v[8:23]
    ds_read_b64_tr_b16 v[100:101], v196 offset:4096
    ds_read_b64_tr_b16 v[102:103], v196 offset:5120
    s_waitcnt lgkmcnt(8)
    v_mfma_f32_32x32x16_bf16 v[8:23], v[104:107], v[144:147], v[8:23]
    ds_read_b64_tr_b16 v[104:105], v196 offset:8192
    ds_read_b64_tr_b16 v[106:107], v196 offset:9216
    s_waitcnt lgkmcnt(8)
    v_mfma_f32_32x32x16_bf16 v[8:23], v[88:91], v[148:151], v[8:23]
    ds_read_b64_tr_b16 v[88:89], v196 offset:12288
    ds_read_b64_tr_b16 v[90:91], v196 offset:13312
    s_waitcnt lgkmcnt(8)
    v_mfma_f32_32x32x16_bf16 v[8:23], v[92:95], v[152:155], v[8:23]
    ds_read_b64_tr_b16 v[92:93], v196 offset:16384
    ds_read_b64_tr_b16 v[94:95], v196 offset:17408
    s_setprio 2
    v_cvt_pk_bf16_f32 v222, v24, v25
    v_cvt_pk_bf16_f32 v223, v26, v27
    v_cvt_pk_bf16_f32 v224, v28, v29
    v_cvt_pk_bf16_f32 v225, v30, v31
    v_cvt_pk_bf16_f32 v226, v32, v33
    v_cvt_pk_bf16_f32 v227, v34, v35
    v_cvt_pk_bf16_f32 v228, v36, v37
    v_cvt_pk_bf16_f32 v229, v38, v39
    s_setprio 0
    s_waitcnt lgkmcnt(8)
    v_mfma_f32_32x32x16_bf16 v[8:23], v[96:99], v[156:159], v[8:23]
    ds_read_b64_tr_b16 v[96:97], v196 offset:20480
    ds_read_b64_tr_b16 v[98:99], v196 offset:21504
    s_xor_b32 s54, s38, 1
    s_lshl_b32 s54, s54, 13
    s_add_u32 s54, s54, s26
    s_add_u32 s54, s54, 2048
    buffer_store_dwordx4 v[222:225], v248, s[4:7], s54 offen offset:0 sc1
    s_waitcnt lgkmcnt(8)
    v_mfma_f32_32x32x16_bf16 v[8:23], v[100:103], v[160:163], v[8:23]
    ds_read_b64_tr_b16 v[100:101], v196 offset:24576
    ds_read_b64_tr_b16 v[102:103], v196 offset:25600
    buffer_store_dwordx4 v[226:229], v248, s[4:7], s54 offen offset:1024 sc1
    s_waitcnt lgkmcnt(8)
    v_mfma_f32_32x32x16_bf16 v[8:23], v[104:107], v[164:167], v[8:23]
    ds_read_b64_tr_b16 v[104:105], v196 offset:28672
    ds_read_b64_tr_b16 v[106:107], v196 offset:29696
    s_waitcnt lgkmcnt(8)
    v_mfma_f32_32x32x16_bf16 v[8:23], v[88:91], v[168:171], v[8:23]
    ds_read_b64_tr_b16 v[88:89], v196 offset:32768
    ds_read_b64_tr_b16 v[90:91], v196 offset:33792
    s_waitcnt lgkmcnt(8)
    v_mfma_f32_32x32x16_bf16 v[8:23], v[92:95], v[108:111], v[8:23]
    ds_read_b64_tr_b16 v[92:93], v196 offset:36864
    ds_read_b64_tr_b16 v[94:95], v196 offset:37888
    s_waitcnt lgkmcnt(8)
    v_mfma_f32_32x32x16_bf16 v[8:23], v[96:99], v[112:115], v[8:23]
    ds_read_b64_tr_b16 v[96:97], v196 offset:40960
    ds_read_b64_tr_b16 v[98:99], v196 offset:41984
    s_waitcnt lgkmcnt(8)
    v_mfma_f32_32x32x16_bf16 v[8:23], v[100:103], v[116:119], v[8:23]
    ds_read_b64_tr_b16 v[100:101], v196 offset:45056
    ds_read_b64_tr_b16 v[102:103], v196 offset:46080
    s_waitcnt lgkmcnt(8)
    v_mfma_f32_32x32x16_bf16 v[8:23], v[104:107], v[120:123], v[8:23]
    s_waitcnt lgkmcnt(6)
    v_mfma_f32_32x32x16_bf16 v[8:23], v[88:91], v[124:127], v[8:23]
    s_waitcnt lgkmcnt(4)
    v_mfma_f32_32x32x16_bf16 v[8:23], v[92:95], v[128:131], v[8:23]
    s_waitcnt lgkmcnt(2)
    v_mfma_f32_32x32x16_bf16 v[8:23], v[96:99], v[132:135], v[8:23]
    s_waitcnt lgkmcnt(0)
    v_mfma_f32_32x32x16_bf16 v[8:23], v[100:103], v[136:139], v[8:23]
    s_waitcnt vmcnt(0)
    s_mov_b64 exec, 1
    buffer_store_dword v209, off, s[4:7], s61 sc1
    s_mov_b64 exec, -1
    s_mov_b64 exec, 1
    ds_add_u32 v244, v207
    s_mov_b64 exec, -1
    ds_read2_b32 v[238:239], v245 offset1:4
    s_waitcnt lgkmcnt(0)
    s_setprio 2
    v_cmp_gt_u32 vcc, 18, v239
    s_cbranch_vccz GM_c18_ok
GM_c18_spin:
    ds_read2_b32 v[238:239], v245 offset1:4
    s_waitcnt lgkmcnt(0)
    v_cmp_gt_u32 vcc, 18, v239
    s_cbranch_vccnz GM_c18_spin
GM_c18_ok:
    s_setprio 0
    s_and_b32 s54, s24, 1
    s_lshl_b32 s54, s54, 2
    s_add_u32 s54, s54, s38
    s_cmp_eq_u32 s54, s36
    s_cbranch_scc1 FIN2
    s_setprio 2
    s_mov_b32 s63, 1048576
POLL3_0:
    buffer_load_dword v213, v212, s[4:7], 0 offen sc1
    s_waitcnt vmcnt(0)
    v_cmp_gt_u32 vcc, v208, v213
    s_sub_u32 s63, s63, 1
    s_cselect_b64 vcc, 0, vcc
    s_cbranch_vccnz POLL3_0
    s_lshl_b32 s54, s38, 13
    s_add_u32 s54, s54, s26
    s_add_u32 s55, s54, 4096
    buffer_load_dwordx4 v[24:27], v248, s[4:7], s54 offen offset:2048 sc1
    buffer_load_dwordx4 v[28:31], v248, s[4:7], s54 offen offset:3072 sc1
    buffer_load_dwordx4 v[32:35], v248, s[4:7], s55 offen offset:0 sc1
    buffer_load_dwordx4 v[36:39], v248, s[4:7], s55 offen offset:1024 sc1
    buffer_load_dwordx4 v[40:43], v248, s[4:7], s55 offen offset:2048 sc1
    buffer_load_dwordx4 v[44:47], v248, s[4:7], s55 offen offset:3072 sc1
    s_bitcmp1_b32 s24, 0
    s_cselect_b32 s54, 0x7ff00000, 0
    v_or_b32 v255, s54, v255
    s_setprio 0
    s_add_u32 m0, s47, 0
    s_add_u32 s48, s41, 0
    buffer_load_dwordx4 v255, s[28:31], s48 offen lds
    s_add_u32 m0, s47, 4096
    s_add_u32 s48, s41, 73728
    buffer_load_dwordx4 v255, s[28:31], s48 offen lds
    s_add_u32 m0, s47, 8192
    s_add_u32 s48, s41, 147456
    buffer_load_dwordx4 v255, s[28:31], s48 offen lds
    s_add_u32 m0, s47, 12288
    s_add_u32 s48, s41, 221184
    buffer_load_dwordx4 v255, s[28:31], s48 offen lds
    s_add_u32 m0, s47, 16384
    s_add_u32 s48, s41, 294912
    buffer_load_dwordx4 v255, s[28:31], s48 offen lds
    s_add_u32 m0, s47, 20480
    s_add_u32 s48, s41, 368640
    buffer_load_dwordx4 v255, s[28:31], s48 offen lds
    s_add_u32 m0, s47, 24576
    s_add_u32 s48, s41, 442368
    buffer_load_dwordx4 v255, s[28:31], s48 offen lds
    s_add_u32 m0, s47, 28672
    s_add_u32 s48, s41, 516096
    buffer_load_dwordx4 v255, s[28:31], s48 offen lds
    s_add_u32 m0, s47, 32768
    s_add_u32 s48, s41, 589824
    buffer_load_dwordx4 v255, s[28:31], s48 offen lds
    v_bfe_u32 v210, v248, 9, 1
    v_bfe_u32 v211, v248, 4, 5
    v_lshlrev_b32 v193, 2, v211
    v_lshl_add_u32 v193, v210, 9, v193
    s_mov_b32 s60, 0xbfb8aa3b
    v_lshlrev_b32 v212, 10, v211
    v_add_u32 v212, 1020, v212
    v_lshlrev_b32 v211, 7, v211
    v_cmp_eq_u32 vcc, 0, v210
    v_add_u32 v211, 32892, v211
    s_nop 0
    v_cndmask_b32 v212, v211, v212, vcc
    v_add_u32 v212, s51, v212
    s_mov_b32 s54, 0x00003f80
    s_mov_b32 s55, 0x3f800000
    s_waitcnt vmcnt(9)
    v_dot2_f32_bf16 v8, v24, s54, v8
    v_dot2_f32_bf16 v9, v24, s55, v9
    v_dot2_f32_bf16 v10, v25, s54, v10
    v_dot2_f32_bf16 v11, v25, s55, v11
    v_dot2_f32_bf16 v12, v26, s54, v12
    v_dot2_f32_bf16 v13, v26, s55, v13
    v_dot2_f32_bf16 v14, v27, s54, v14
    v_dot2_f32_bf16 v15, v27, s55, v15
    v_dot2_f32_bf16 v16, v28, s54, v16
    v_dot2_f32_bf16 v17, v28, s55, v17
    v_dot2_f32_bf16 v18, v29, s54, v18
    v_dot2_f32_bf16 v19, v29, s55, v19
    v_dot2_f32_bf16 v20, v30, s54, v20
    v_dot2_f32_bf16 v21, v30, s55, v21
    v_dot2_f32_bf16 v22, v31, s54, v22
    v_dot2_f32_bf16 v23, v31, s55, v23
    v_dot2_f32_bf16 v8, v32, s54, v8
    v_dot2_f32_bf16 v9, v32, s55, v9
    v_dot2_f32_bf16 v10, v33, s54, v10
    v_dot2_f32_bf16 v11, v33, s55, v11
    v_dot2_f32_bf16 v12, v34, s54, v12
    v_dot2_f32_bf16 v13, v34, s55, v13
    v_dot2_f32_bf16 v14, v35, s54, v14
    v_dot2_f32_bf16 v15, v35, s55, v15
    v_dot2_f32_bf16 v16, v36, s54, v16
    v_dot2_f32_bf16 v17, v36, s55, v17
    v_dot2_f32_bf16 v18, v37, s54, v18
    v_dot2_f32_bf16 v19, v37, s55, v19
    v_dot2_f32_bf16 v20, v38, s54, v20
    v_dot2_f32_bf16 v21, v38, s55, v21
    v_dot2_f32_bf16 v22, v39, s54, v22
    v_dot2_f32_bf16 v23, v39, s55, v23
    v_dot2_f32_bf16 v8, v40, s54, v8
    v_dot2_f32_bf16 v9, v40, s55, v9
    v_dot2_f32_bf16 v10, v41, s54, v10
    v_dot2_f32_bf16 v11, v41, s55, v11
    v_dot2_f32_bf16 v12, v42, s54, v12
    v_dot2_f32_bf16 v13, v42, s55, v13
    v_dot2_f32_bf16 v14, v43, s54, v14
    v_dot2_f32_bf16 v15, v43, s55, v15
    v_dot2_f32_bf16 v16, v44, s54, v16
    v_dot2_f32_bf16 v17, v44, s55, v17
    v_dot2_f32_bf16 v18, v45, s54, v18
    v_dot2_f32_bf16 v19, v45, s55, v19
    v_dot2_f32_bf16 v20, v46, s54, v20
    v_dot2_f32_bf16 v21, v46, s55, v21
    v_dot2_f32_bf16 v22, v47, s54, v22
    v_dot2_f32_bf16 v23, v47, s55, v23
    v_mul_f32 v214, s60, v8
    v_mul_f32 v215, s60, v9
    v_mul_f32 v216, s60, v10
    v_mul_f32 v217, s60, v11
    v_mul_f32 v218, s60, v12
    v_mul_f32 v219, s60, v13
    v_mul_f32 v220, s60, v14
    v_mul_f32 v221, s60, v15
    v_mul_f32 v222, s60, v16
    v_mul_f32 v223, s60, v17
    v_mul_f32 v224, s60, v18
    v_mul_f32 v225, s60, v19
    v_mul_f32 v226, s60, v20
    v_mul_f32 v227, s60, v21
    v_mul_f32 v228, s60, v22
    v_mul_f32 v229, s60, v23
    v_exp_f32 v214, v214
    v_exp_f32 v215, v215
    v_exp_f32 v216, v216
    v_exp_f32 v217, v217
    v_exp_f32 v218, v218
    v_exp_f32 v219, v219
    v_exp_f32 v220, v220
    v_exp_f32 v221, v221
    v_exp_f32 v222, v222
    v_exp_f32 v223, v223
    v_exp_f32 v224, v224
    v_exp_f32 v225, v225
    v_exp_f32 v226, v226
    v_exp_f32 v227, v227
    v_exp_f32 v228, v228
    v_exp_f32 v229, v229
    v_add_f32 v214, 1.0, v214
    v_add_f32 v215, 1.0, v215
    v_add_f32 v216, 1.0, v216
    v_add_f32 v217, 1.0, v217
    v_add_f32 v218, 1.0, v218
    v_add_f32 v219, 1.0, v219
    v_add_f32 v220, 1.0, v220
    v_add_f32 v221, 1.0, v221
    v_add_f32 v222, 1.0, v222
    v_add_f32 v223, 1.0, v223
    v_add_f32 v224, 1.0, v224
    v_add_f32 v225, 1.0, v225
    v_add_f32 v226, 1.0, v226
    v_add_f32 v227, 1.0, v227
    v_add_f32 v228, 1.0, v228
    v_add_f32 v229, 1.0, v229
    v_rcp_f32 v214, v214
    v_rcp_f32 v215, v215
    v_rcp_f32 v216, v216
    v_rcp_f32 v217, v217
    v_rcp_f32 v218, v218
    v_rcp_f32 v219, v219
    v_rcp_f32 v220, v220
    v_rcp_f32 v221, v221
    v_rcp_f32 v222, v222
    v_rcp_f32 v223, v223
    v_rcp_f32 v224, v224
    v_rcp_f32 v225, v225
    v_rcp_f32 v226, v226
    v_rcp_f32 v227, v227
    v_rcp_f32 v228, v228
    v_rcp_f32 v229, v229
    v_mul_f32 v8, v8, v214
    v_mul_f32 v9, v9, v215
    v_mul_f32 v10, v10, v216
    v_mul_f32 v11, v11, v217
    v_mul_f32 v12, v12, v218
    v_mul_f32 v13, v13, v219
    v_mul_f32 v14, v14, v220
    v_mul_f32 v15, v15, v221
    v_mul_f32 v16, v16, v222
    v_mul_f32 v17, v17, v223
    v_mul_f32 v18, v18, v224
    v_mul_f32 v19, v19, v225
    v_mul_f32 v20, v20, v226
    v_mul_f32 v21, v21, v227
    v_mul_f32 v22, v22, v228
    v_mul_f32 v23, v23, v229
    s_waitcnt vmcnt(0)
    s_barrier
    s_mov_b32 s63, 1048576
POLL4_0:
    buffer_load_dword v213, v212, s[4:7], 0 offen sc1
    s_waitcnt vmcnt(0)
    v_cmp_eq_u32 vcc, -1, v213
    s_sub_u32 s63, s63, 1
    s_cselect_b64 vcc, 0, vcc
    s_cbranch_vccnz POLL4_0
    v_mov_b32 v194, 0
    s_add_u32 s54, s51, 0
    buffer_load_dwordx4 v[24:27], v248, s[4:7], s54 offen offset:0 sc1
    buffer_load_dwordx4 v[28:31], v248, s[4:7], s54 offen offset:1024 sc1
    buffer_load_dwordx4 v[32:35], v248, s[4:7], s54 offen offset:2048 sc1
    buffer_load_dwordx4 v[36:39], v248, s[4:7], s54 offen offset:3072 sc1
    s_add_u32 s54, s51, 4096
    buffer_load_dwordx4 v[40:43], v248, s[4:7], s54 offen offset:0 sc1
    buffer_load_dwordx4 v[44:47], v248, s[4:7], s54 offen offset:1024 sc1
    buffer_load_dwordx4 v[48:51], v248, s[4:7], s54 offen offset:2048 sc1
    buffer_load_dwordx4 v[52:55], v248, s[4:7], s54 offen offset:3072 sc1
    ds_read_b64_tr_b16 v[168:169], v247 offset:0
    ds_read_b64_tr_b16 v[170:171], v247 offset:512
    ds_read_b64_tr_b16 v[188:189], v247 offset:1152
    ds_read_b64_tr_b16 v[190:191], v247 offset:1664
    s_waitcnt vmcnt(7) lgkmcnt(2)
    v_mfma_f32_32x32x16_bf16 v[214:229], v[168:171], v[24:27], 0
    ds_read_b64_tr_b16 v[168:169], v247 offset:2304
    ds_read_b64_tr_b16 v[170:171], v247 offset:2816
    s_add_u32 s54, s51, 8192
    buffer_load_dwordx4 v[56:59], v248, s[4:7], s54 offen offset:0 sc1
    v_max3_u32 v194, v194, v24, v25
    v_max3_u32 v194, v194, v26, v27
    s_waitcnt vmcnt(7) lgkmcnt(2)
    v_mfma_f32_32x32x16_bf16 v[214:229], v[188:191], v[28:31], v[214:229]
    ds_read_b64_tr_b16 v[188:189], v247 offset:3456
    ds_read_b64_tr_b16 v[190:191], v247 offset:3968
    buffer_load_dwordx4 v[60:63], v248, s[4:7], s54 offen offset:1024 sc1
    v_max3_u32 v194, v194, v28, v29
    v_max3_u32 v194, v194, v30, v31
    s_waitcnt vmcnt(7) lgkmcnt(2)
    v_mfma_f32_32x32x16_bf16 v[214:229], v[168:171], v[32:35], v[214:229]
    ds_read_b64_tr_b16 v[168:169], v247 offset:4608
    ds_read_b64_tr_b16 v[170:171], v247 offset:5120
    buffer_load_dwordx4 v[64:67], v248, s[4:7], s54 offen offset:2048 sc1
    v_max3_u32 v194, v194, v32, v33
    v_max3_u32 v194, v194, v34, v35
    s_waitcnt vmcnt(7) lgkmcnt(2)
    v_mfma_f32_32x32x16_bf16 v[214:229], v[188:191], v[36:39], v[214:229]
    ds_read_b64_tr_b16 v[188:189], v247 offset:5760
    ds_read_b64_tr_b16 v[190:191], v247 offset:6272
    buffer_load_dwordx4 v[68:71], v248, s[4:7], s54 offen offset:3072 sc1
    v_max3_u32 v194, v194, v36, v37
    v_max3_u32 v194, v194, v38, v39
    s_waitcnt vmcnt(7) lgkmcnt(2)
    v_mfma_f32_32x32x16_bf16 v[214:229], v[168:171], v[40:43], v[214:229]
    ds_read_b64_tr_b16 v[168:169], v247 offset:6912
    ds_read_b64_tr_b16 v[170:171], v247 offset:7424
    s_add_u32 s54, s51, 12288
    buffer_load_dwordx4 v[72:75], v248, s[4:7], s54 offen offset:0 sc1
    v_max3_u32 v194, v194, v40, v41
    v_max3_u32 v194, v194, v42, v43
    s_waitcnt vmcnt(7) lgkmcnt(2)
    v_mfma_f32_32x32x16_bf16 v[214:229], v[188:191], v[44:47], v[214:229]
    ds_read_b64_tr_b16 v[188:189], v247 offset:8064
    ds_read_b64_tr_b16 v[190:191], v247 offset:8576
    buffer_load_dwordx4 v[76:79], v248, s[4:7], s54 offen offset:1024 sc1
    v_max3_u32 v194, v194, v44, v45
    v_max3_u32 v194, v194, v46, v47
    s_waitcnt vmcnt(7) lgkmcnt(2)
    v_mfma_f32_32x32x16_bf16 v[214:229], v[168:171], v[48:51], v[214:229]
    ds_read_b64_tr_b16 v[168:169], v247 offset:9216
    ds_read_b64_tr_b16 v[170:171], v247 offset:9728
    buffer_load_dwordx4 v[80:83], v248, s[4:7], s54 offen offset:2048 sc1
    v_max3_u32 v194, v194, v48, v49
    v_max3_u32 v194, v194, v50, v51
    s_waitcnt vmcnt(7) lgkmcnt(2)
    v_mfma_f32_32x32x16_bf16 v[214:229], v[188:191], v[52:55], v[214:229]
    ds_read_b64_tr_b16 v[188:189], v247 offset:10368
    ds_read_b64_tr_b16 v[190:191], v247 offset:10880
    buffer_load_dwordx4 v[84:87], v248, s[4:7], s54 offen offset:3072 sc1
    v_max3_u32 v194, v194, v52, v53
    v_max3_u32 v194, v194, v54, v55
    s_waitcnt vmcnt(7) lgkmcnt(2)
    v_mfma_f32_32x32x16_bf16 v[214:229], v[168:171], v[56:59], v[214:229]
    ds_read_b64_tr_b16 v[168:169], v247 offset:11520
    ds_read_b64_tr_b16 v[170:171], v247 offset:12032
    s_add_u32 s54, s51, 16384
    buffer_load_dwordx4 v[88:91], v248, s[4:7], s54 offen offset:0 sc1
    v_max3_u32 v194, v194, v56, v57
    v_max3_u32 v194, v194, v58, v59
    s_waitcnt vmcnt(7) lgkmcnt(2)
    v_mfma_f32_32x32x16_bf16 v[214:229], v[188:191], v[60:63], v[214:229]
    ds_read_b64_tr_b16 v[188:189], v247 offset:12672
    ds_read_b64_tr_b16 v[190:191], v247 offset:13184
    buffer_load_dwordx4 v[92:95], v248, s[4:7], s54 offen offset:1024 sc1
    v_max3_u32 v194, v194, v60, v61
    v_max3_u32 v194, v194, v62, v63
    s_waitcnt vmcnt(7) lgkmcnt(2)
    v_mfma_f32_32x32x16_bf16 v[214:229], v[168:171], v[64:67], v[214:229]
    ds_read_b64_tr_b16 v[168:169], v247 offset:13824
    ds_read_b64_tr_b16 v[170:171], v247 offset:14336
    buffer_load_dwordx4 v[96:99], v248, s[4:7], s54 offen offset:2048 sc1
    v_max3_u32 v194, v194, v64, v65
    v_max3_u32 v194, v194, v66, v67
    s_waitcnt vmcnt(7) lgkmcnt(2)
    v_mfma_f32_32x32x16_bf16 v[214:229], v[188:191], v[68:71], v[214:229]
    ds_read_b64_tr_b16 v[188:189], v247 offset:14976
    ds_read_b64_tr_b16 v[190:191], v247 offset:15488
    buffer_load_dwordx4 v[100:103], v248, s[4:7], s54 offen offset:3072 sc1
    v_max3_u32 v194, v194, v68, v69
    v_max3_u32 v194, v194, v70, v71
    s_waitcnt vmcnt(7) lgkmcnt(2)
    v_mfma_f32_32x32x16_bf16 v[214:229], v[168:171], v[72:75], v[214:229]
    ds_read_b64_tr_b16 v[168:169], v247 offset:16128
    ds_read_b64_tr_b16 v[170:171], v247 offset:16640
    s_add_u32 s54, s51, 20480
    buffer_load_dwordx4 v[104:107], v248, s[4:7], s54 offen offset:0 sc1
    v_max3_u32 v194, v194, v72, v73
    v_max3_u32 v194, v194, v74, v75
    s_waitcnt vmcnt(7) lgkmcnt(2)
    v_mfma_f32_32x32x16_bf16 v[214:229], v[188:191], v[76:79], v[214:229]
    ds_read_b64_tr_b16 v[188:189], v247 offset:17280
    ds_read_b64_tr_b16 v[190:191], v247 offset:17792
    buffer_load_dwordx4 v[108:111], v248, s[4:7], s54 offen offset:1024 sc1
    v_max3_u32 v194, v194, v76, v77
    v_max3_u32 v194, v194, v78, v79
    s_waitcnt vmcnt(7) lgkmcnt(2)
    v_mfma_f32_32x32x16_bf16 v[214:229], v[168:171], v[80:83], v[214:229]
    ds_read_b64_tr_b16 v[168:169], v247 offset:18432
    ds_read_b64_tr_b16 v[170:171], v247 offset:18944
    buffer_load_dwordx4 v[112:115], v248, s[4:7], s54 offen offset:2048 sc1
    v_max3_u32 v194, v194, v80, v81
    v_max3_u32 v194, v194, v82, v83
    s_waitcnt vmcnt(7) lgkmcnt(2)
    v_mfma_f32_32x32x16_bf16 v[214:229], v[188:191], v[84:87], v[214:229]
    ds_read_b64_tr_b16 v[188:189], v247 offset:19584
    ds_read_b64_tr_b16 v[190:191], v247 offset:20096
    buffer_load_dwordx4 v[116:119], v248, s[4:7], s54 offen offset:3072 sc1
    v_max3_u32 v194, v194, v84, v85
    v_max3_u32 v194, v194, v86, v87
    s_waitcnt vmcnt(7) lgkmcnt(2)
    v_mfma_f32_32x32x16_bf16 v[214:229], v[168:171], v[88:91], v[214:229]
    ds_read_b64_tr_b16 v[168:169], v247 offset:20736
    ds_read_b64_tr_b16 v[170:171], v247 offset:21248
    s_add_u32 s54, s51, 24576
    buffer_load_dwordx4 v[120:123], v248, s[4:7], s54 offen offset:0 sc1
    v_max3_u32 v194, v194, v88, v89
    v_max3_u32 v194, v194, v90, v91
    s_waitcnt vmcnt(7) lgkmcnt(2)
    v_mfma_f32_32x32x16_bf16 v[214:229], v[188:191], v[92:95], v[214:229]
    ds_read_b64_tr_b16 v[188:189], v247 offset:21888
    ds_read_b64_tr_b16 v[190:191], v247 offset:22400
    buffer_load_dwordx4 v[124:127], v248, s[4:7], s54 offen offset:1024 sc1
    v_max3_u32 v194, v194, v92, v93
    v_max3_u32 v194, v194, v94, v95
    s_waitcnt vmcnt(7) lgkmcnt(2)
    v_mfma_f32_32x32x16_bf16 v[214:229], v[168:171], v[96:99], v[214:229]
    ds_read_b64_tr_b16 v[168:169], v247 offset:23040
    ds_read_b64_tr_b16 v[170:171], v247 offset:23552
    buffer_load_dwordx4 v[128:131], v248, s[4:7], s54 offen offset:2048 sc1
    v_max3_u32 v194, v194, v96, v97
    v_max3_u32 v194, v194, v98, v99
    s_waitcnt vmcnt(7) lgkmcnt(2)
    v_mfma_f32_32x32x16_bf16 v[214:229], v[188:191], v[100:103], v[214:229]
    ds_read_b64_tr_b16 v[188:189], v247 offset:24192
    ds_read_b64_tr_b16 v[190:191], v247 offset:24704
    buffer_load_dwordx4 v[132:135], v248, s[4:7], s54 offen offset:3072 sc1
    v_max3_u32 v194, v194, v100, v101
    v_max3_u32 v194, v194, v102, v103
    s_waitcnt vmcnt(7) lgkmcnt(2)
    v_mfma_f32_32x32x16_bf16 v[214:229], v[168:171], v[104:107], v[214:229]
    ds_read_b64_tr_b16 v[168:169], v247 offset:25344
    ds_read_b64_tr_b16 v[170:171], v247 offset:25856
    s_add_u32 s54, s51, 28672
    buffer_load_dwordx4 v[136:139], v248, s[4:7], s54 offen offset:0 sc1
    v_max3_u32 v194, v194, v104, v105
    v_max3_u32 v194, v194, v106, v107
    s_waitcnt vmcnt(7) lgkmcnt(2)
    v_mfma_f32_32x32x16_bf16 v[214:229], v[188:191], v[108:111], v[214:229]
    ds_read_b64_tr_b16 v[188:189], v247 offset:26496
    ds_read_b64_tr_b16 v[190:191], v247 offset:27008
    buffer_load_dwordx4 v[140:143], v248, s[4:7], s54 offen offset:1024 sc1
    v_max3_u32 v194, v194, v108, v109
    v_max3_u32 v194, v194, v110, v111
    s_waitcnt vmcnt(7) lgkmcnt(2)
    v_mfma_f32_32x32x16_bf16 v[214:229], v[168:171], v[112:115], v[214:229]
    ds_read_b64_tr_b16 v[168:169], v247 offset:27648
    ds_read_b64_tr_b16 v[170:171], v247 offset:28160
    buffer_load_dwordx4 v[144:147], v248, s[4:7], s54 offen offset:2048 sc1
    v_max3_u32 v194, v194, v112, v113
    v_max3_u32 v194, v194, v114, v115
    s_waitcnt vmcnt(7) lgkmcnt(2)
    v_mfma_f32_32x32x16_bf16 v[214:229], v[188:191], v[116:119], v[214:229]
    ds_read_b64_tr_b16 v[188:189], v247 offset:28800
    ds_read_b64_tr_b16 v[190:191], v247 offset:29312
    buffer_load_dwordx4 v[148:151], v248, s[4:7], s54 offen offset:3072 sc1
    v_max3_u32 v194, v194, v116, v117
    v_max3_u32 v194, v194, v118, v119
    s_waitcnt vmcnt(7) lgkmcnt(2)
    v_mfma_f32_32x32x16_bf16 v[214:229], v[168:171], v[120:123], v[214:229]
    ds_read_b64_tr_b16 v[168:169], v247 offset:29952
    ds_read_b64_tr_b16 v[170:171], v247 offset:30464
    s_add_u32 s54, s51, 32768
    buffer_load_dword v152, v193, s[4:7], s54 offen offset:0 sc1
    buffer_load_dword v153, v193, s[4:7], s54 offen offset:128 sc1
    buffer_load_dword v154, v193, s[4:7], s54 offen offset:256 sc1
    buffer_load_dword v155, v193, s[4:7], s54 offen offset:384 sc1
    v_max3_u32 v194, v194, v120, v121
    v_max3_u32 v194, v194, v122, v123
    s_waitcnt vmcnt(10) lgkmcnt(2)
    v_mfma_f32_32x32x16_bf16 v[214:229], v[188:191], v[124:127], v[214:229]
    ds_read_b64_tr_b16 v[188:189], v247 offset:31104
    ds_read_b64_tr_b16 v[190:191], v247 offset:31616
    buffer_load_dword v156, v193, s[4:7], s54 offen offset:1024 sc1
    buffer_load_dword v157, v193, s[4:7], s54 offen offset:1152 sc1
    buffer_load_dword v158, v193, s[4:7], s54 offen offset:1280 sc1
    buffer_load_dword v159, v193, s[4:7], s54 offen offset:1408 sc1
    v_max3_u32 v194, v194, v124, v125
    v_max3_u32 v194, v194, v126, v127
    s_waitcnt vmcnt(13) lgkmcnt(2)
    v_mfma_f32_32x32x16_bf16 v[214:229], v[168:171], v[128:131], v[214:229]
    ds_read_b64_tr_b16 v[168:169], v247 offset:32256
    ds_read_b64_tr_b16 v[170:171], v247 offset:32768
    buffer_load_dword v160, v193, s[4:7], s54 offen offset:2048 sc1
    buffer_load_dword v161, v193, s[4:7], s54 offen offset:2176 sc1
    buffer_load_dword v162, v193, s[4:7], s54 offen offset:2304 sc1
    buffer_load_dword v163, v193, s[4:7], s54 offen offset:2432 sc1
    v_max3_u32 v194, v194, v128, v129
    v_max3_u32 v194, v194, v130, v131
    s_waitcnt vmcnt(16) lgkmcnt(2)
    v_mfma_f32_32x32x16_bf16 v[214:229], v[188:191], v[132:135], v[214:229]
    ds_read_b64_tr_b16 v[188:189], v247 offset:33408
    ds_read_b64_tr_b16 v[190:191], v247 offset:33920
    buffer_load_dword v164, v193, s[4:7], s54 offen offset:3072 sc1
    buffer_load_dword v165, v193, s[4:7], s54 offen offset:3200 sc1
    buffer_load_dword v166, v193, s[4:7], s54 offen offset:3328 sc1
    buffer_load_dword v167, v193, s[4:7], s54 offen offset:3456 sc1
    v_max3_u32 v194, v194, v132, v133
    v_max3_u32 v194, v194, v134, v135
    s_waitcnt vmcnt(19) lgkmcnt(2)
    v_mfma_f32_32x32x16_bf16 v[214:229], v[168:171], v[136:139], v[214:229]
    ds_read_b64_tr_b16 v[168:169], v247 offset:34560
    ds_read_b64_tr_b16 v[170:171], v247 offset:35072
    v_max3_u32 v194, v194, v136, v137
    v_max3_u32 v194, v194, v138, v139
    s_waitcnt vmcnt(18) lgkmcnt(2)
    v_mfma_f32_32x32x16_bf16 v[214:229], v[188:191], v[140:143], v[214:229]
    ds_read_b64_tr_b16 v[188:189], v247 offset:35712
    ds_read_b64_tr_b16 v[190:191], v247 offset:36224
    v_max3_u32 v194, v194, v140, v141
    v_max3_u32 v194, v194, v142, v143
    s_waitcnt vmcnt(17) lgkmcnt(2)
    v_mfma_f32_32x32x16_bf16 v[214:229], v[168:171], v[144:147], v[214:229]
    ds_read_b64_tr_b16 v[168:169], v249 offset:0
    ds_read_b64_tr_b16 v[170:171], v249 offset:2304
    v_max3_u32 v194, v194, v144, v145
    v_max3_u32 v194, v194, v146, v147
    s_waitcnt vmcnt(16) lgkmcnt(2)
    v_mfma_f32_32x32x16_bf16 v[214:229], v[188:191], v[148:151], v[214:229]
    ds_read_b64_tr_b16 v[188:189], v249 offset:9216
    ds_read_b64_tr_b16 v[190:191], v249 offset:11520
    v_max3_u32 v194, v194, v148, v149
    v_max3_u32 v194, v194, v150, v151
    s_waitcnt vmcnt(12) lgkmcnt(2)
    v_mfma_f32_32x32x16_bf16 v[214:229], v[168:171], v[152:155], v[214:229]
    ds_read_b64_tr_b16 v[168:169], v249 offset:18432
    ds_read_b64_tr_b16 v[170:171], v249 offset:20736
    v_max3_u32 v194, v194, v152, v153
    v_max3_u32 v194, v194, v154, v155
    s_waitcnt vmcnt(8) lgkmcnt(2)
    v_mfma_f32_32x32x16_bf16 v[214:229], v[188:191], v[156:159], v[214:229]
    ds_read_b64_tr_b16 v[188:189], v249 offset:27648
    ds_read_b64_tr_b16 v[190:191], v249 offset:29952
    v_max3_u32 v194, v194, v156, v157
    v_max3_u32 v194, v194, v158, v159
    s_waitcnt vmcnt(4) lgkmcnt(2)
    v_mfma_f32_32x32x16_bf16 v[214:229], v[168:171], v[160:163], v[214:229]
    v_max3_u32 v194, v194, v160, v161
    v_max3_u32 v194, v194, v162, v163
    s_waitcnt vmcnt(0) lgkmcnt(0)
    v_mfma_f32_32x32x16_bf16 v[214:229], v[188:191], v[164:167], v[214:229]
    v_max3_u32 v194, v194, v164, v165
    v_max3_u32 v194, v194, v166, v167
    v_cmp_eq_u32 vcc, -1, v194
    s_cmp_lt_i32 s63, 1
    s_cselect_b64 vcc, 0, vcc
    s_cbranch_vccnz POLL4_0
    v_lshlrev_b32 v24, 16, v0
    v_and_b32 v25, 0xffff0000, v0
    v_lshlrev_b32 v26, 16, v1
    v_and_b32 v27, 0xffff0000, v1
    v_lshlrev_b32 v28, 16, v2
    v_and_b32 v29, 0xffff0000, v2
    v_lshlrev_b32 v30, 16, v3
    v_and_b32 v31, 0xffff0000, v3
    v_lshlrev_b32 v32, 16, v4
    v_and_b32 v33, 0xffff0000, v4
    v_lshlrev_b32 v34, 16, v5
    v_and_b32 v35, 0xffff0000, v5
    v_lshlrev_b32 v36, 16, v6
    v_and_b32 v37, 0xffff0000, v6
    v_lshlrev_b32 v38, 16, v7
    v_and_b32 v39, 0xffff0000, v7
    v_fma_f32 v8, v8, v214, v24
    v_fma_f32 v9, v9, v215, v25
    v_fma_f32 v10, v10, v216, v26
    v_fma_f32 v11, v11, v217, v27
    v_fma_f32 v12, v12, v218, v28
    v_fma_f32 v13, v13, v219, v29
    v_fma_f32 v14, v14, v220, v30
    v_fma_f32 v15, v15, v221, v31
    v_fma_f32 v16, v16, v222, v32
    v_fma_f32 v17, v17, v223, v33
    v_fma_f32 v18, v18, v224, v34
    v_fma_f32 v19, v19, v225, v35
    v_fma_f32 v20, v20, v226, v36
    v_fma_f32 v21, v21, v227, v37
    v_fma_f32 v22, v22, v228, v38
    v_fma_f32 v23, v23, v229, v39
    v_cvt_pk_bf16_f32 v0, v8, v9
    v_cvt_pk_bf16_f32 v1, v10, v11
    v_cvt_pk_bf16_f32 v2, v12, v13
    v_cvt_pk_bf16_f32 v3, v14, v15
    v_cvt_pk_bf16_f32 v4, v16, v17
    v_cvt_pk_bf16_f32 v5, v18, v19
    v_cvt_pk_bf16_f32 v6, v20, v21
    v_cvt_pk_bf16_f32 v7, v22, v23
    buffer_store_dwordx4 v[0:3], v246, s[56:59], s8 offen offset:0
    buffer_store_dwordx4 v[4:7], v246, s[56:59], s8 offen offset:16
    s_branch PK_end
FIN2:
    s_setprio 2
    s_mov_b32 s63, 1048576
POLL3_1:
    buffer_load_dword v213, v212, s[4:7], 0 offen sc1
    s_waitcnt vmcnt(0)
    v_cmp_gt_u32 vcc, v208, v213
    s_sub_u32 s63, s63, 1
    s_cselect_b64 vcc, 0, vcc
    s_cbranch_vccnz POLL3_1
    s_lshl_b32 s54, s38, 13
    s_add_u32 s54, s54, s26
    s_add_u32 s55, s54, 4096
    buffer_load_dwordx4 v[24:27], v248, s[4:7], s54 offen offset:2048 sc1
    buffer_load_dwordx4 v[28:31], v248, s[4:7], s54 offen offset:3072 sc1
    buffer_load_dwordx4 v[32:35], v248, s[4:7], s55 offen offset:0 sc1
    buffer_load_dwordx4 v[36:39], v248, s[4:7], s55 offen offset:1024 sc1
    buffer_load_dwordx4 v[40:43], v248, s[4:7], s55 offen offset:2048 sc1
    buffer_load_dwordx4 v[44:47], v248, s[4:7], s55 offen offset:3072 sc1
    s_add_u32 s54, s26, 32768
    buffer_load_dwordx4 v[48:51], v248, s[4:7], s54 offen offset:0 sc1
    buffer_load_dwordx4 v[52:55], v248, s[4:7], s54 offen offset:1024 sc1
    buffer_load_dwordx4 v[56:59], v248, s[4:7], s54 offen offset:2048 sc1
    buffer_load_dwordx4 v[60:63], v248, s[4:7], s54 offen offset:3072 sc1
    s_add_u32 s54, s26, 36864
    buffer_load_dwordx4 v[64:67], v248, s[4:7], s54 offen offset:0 sc1
    buffer_load_dwordx4 v[68:71], v248, s[4:7], s54 offen offset:1024 sc1
    buffer_load_dwordx4 v[72:75], v248, s[4:7], s54 offen offset:2048 sc1
    buffer_load_dwordx4 v[76:79], v248, s[4:7], s54 offen offset:3072 sc1
    s_add_u32 s54, s26, 73728
    buffer_load_dwordx4 v[80:83], v248, s[4:7], s54 offen offset:0 sc1
    buffer_load_dwordx4 v[84:87], v248, s[4:7], s54 offen offset:1024 sc1
    buffer_load_dwordx4 v[88:91], v248, s[4:7], s54 offen offset:2048 sc1
    buffer_load_dwordx4 v[92:95], v248, s[4:7], s54 offen offset:3072 sc1
    s_add_u32 s54, s26, 77824
    buffer_load_dwordx4 v[96:99], v248, s[4:7], s54 offen offset:0 sc1
    buffer_load_dwordx4 v[100:103], v248, s[4:7], s54 offen offset:1024 sc1
    buffer_load_dwordx4 v[104:107], v248, s[4:7], s54 offen offset:2048 sc1
    buffer_load_dwordx4 v[108:111], v248, s[4:7], s54 offen offset:3072 sc1
    s_bitcmp1_b32 s24, 0
    s_cselect_b32 s54, 0x7ff00000, 0
    v_or_b32 v255, s54, v255
    s_setprio 0
    s_add_u32 m0, s47, 0
    s_add_u32 s48, s41, 0
    buffer_load_dwordx4 v255, s[28:31], s48 offen lds
    s_add_u32 m0, s47, 4096
    s_add_u32 s48, s41, 73728
    buffer_load_dwordx4 v255, s[28:31], s48 offen lds
    s_add_u32 m0, s47, 8192
    s_add_u32 s48, s41, 147456
    buffer_load_dwordx4 v255, s[28:31], s48 offen lds
    s_add_u32 m0, s47, 12288
    s_add_u32 s48, s41, 221184
    buffer_load_dwordx4 v255, s[28:31], s48 offen lds
    s_add_u32 m0, s47, 16384
    s_add_u32 s48, s41, 294912
    buffer_load_dwordx4 v255, s[28:31], s48 offen lds
    s_add_u32 m0, s47, 20480
    s_add_u32 s48, s41, 368640
    buffer_load_dwordx4 v255, s[28:31], s48 offen lds
    s_add_u32 m0, s47, 24576
    s_add_u32 s48, s41, 442368
    buffer_load_dwordx4 v255, s[28:31], s48 offen lds
    s_add_u32 m0, s47, 28672
    s_add_u32 s48, s41, 516096
    buffer_load_dwordx4 v255, s[28:31], s48 offen lds
    s_add_u32 m0, s47, 32768
    s_add_u32 s48, s41, 589824
    buffer_load_dwordx4 v255, s[28:31], s48 offen lds
    v_bfe_u32 v210, v248, 9, 1
    v_bfe_u32 v211, v248, 4, 5
    v_lshlrev_b32 v193, 2, v211
    v_lshl_add_u32 v193, v210, 9, v193
    s_mov_b32 s60, 0xbfb8aa3b
    v_lshlrev_b32 v212, 10, v211
    v_add_u32 v212, 1020, v212
    v_lshlrev_b32 v211, 7, v211
    v_cmp_eq_u32 vcc, 0, v210
    v_add_u32 v211, 32892, v211
    s_nop 0
    v_cndmask_b32 v212, v211, v212, vcc
    v_add_u32 v212, s51, v212
    s_mov_b32 s54, 0x00003f80
    s_mov_b32 s55, 0x3f800000
    s_waitcnt vmcnt(25)
    v_dot2_f32_bf16 v8, v24, s54, v8
    v_dot2_f32_bf16 v9, v24, s55, v9
    v_dot2_f32_bf16 v10, v25, s54, v10
    v_dot2_f32_bf16 v11, v25, s55, v11
    v_dot2_f32_bf16 v12, v26, s54, v12
    v_dot2_f32_bf16 v13, v26, s55, v13
    v_dot2_f32_bf16 v14, v27, s54, v14
    v_dot2_f32_bf16 v15, v27, s55, v15
    v_dot2_f32_bf16 v16, v28, s54, v16
    v_dot2_f32_bf16 v17, v28, s55, v17
    v_dot2_f32_bf16 v18, v29, s54, v18
    v_dot2_f32_bf16 v19, v29, s55, v19
    v_dot2_f32_bf16 v20, v30, s54, v20
    v_dot2_f32_bf16 v21, v30, s55, v21
    v_dot2_f32_bf16 v22, v31, s54, v22
    v_dot2_f32_bf16 v23, v31, s55, v23
    v_dot2_f32_bf16 v8, v32, s54, v8
    v_dot2_f32_bf16 v9, v32, s55, v9
    v_dot2_f32_bf16 v10, v33, s54, v10
    v_dot2_f32_bf16 v11, v33, s55, v11
    v_dot2_f32_bf16 v12, v34, s54, v12
    v_dot2_f32_bf16 v13, v34, s55, v13
    v_dot2_f32_bf16 v14, v35, s54, v14
    v_dot2_f32_bf16 v15, v35, s55, v15
    v_dot2_f32_bf16 v16, v36, s54, v16
    v_dot2_f32_bf16 v17, v36, s55, v17
    v_dot2_f32_bf16 v18, v37, s54, v18
    v_dot2_f32_bf16 v19, v37, s55, v19
    v_dot2_f32_bf16 v20, v38, s54, v20
    v_dot2_f32_bf16 v21, v38, s55, v21
    v_dot2_f32_bf16 v22, v39, s54, v22
    v_dot2_f32_bf16 v23, v39, s55, v23
    v_dot2_f32_bf16 v8, v40, s54, v8
    v_dot2_f32_bf16 v9, v40, s55, v9
    v_dot2_f32_bf16 v10, v41, s54, v10
    v_dot2_f32_bf16 v11, v41, s55, v11
    v_dot2_f32_bf16 v12, v42, s54, v12
    v_dot2_f32_bf16 v13, v42, s55, v13
    v_dot2_f32_bf16 v14, v43, s54, v14
    v_dot2_f32_bf16 v15, v43, s55, v15
    v_dot2_f32_bf16 v16, v44, s54, v16
    v_dot2_f32_bf16 v17, v44, s55, v17
    v_dot2_f32_bf16 v18, v45, s54, v18
    v_dot2_f32_bf16 v19, v45, s55, v19
    v_dot2_f32_bf16 v20, v46, s54, v20
    v_dot2_f32_bf16 v21, v46, s55, v21
    v_dot2_f32_bf16 v22, v47, s54, v22
    v_dot2_f32_bf16 v23, v47, s55, v23
    v_mul_f32 v214, s60, v8
    v_mul_f32 v215, s60, v9
    v_mul_f32 v216, s60, v10
    v_mul_f32 v217, s60, v11
    v_mul_f32 v218, s60, v12
    v_mul_f32 v219, s60, v13
    v_mul_f32 v220, s60, v14
    v_mul_f32 v221, s60, v15
    v_mul_f32 v222, s60, v16
    v_mul_f32 v223, s60, v17
    v_mul_f32 v224, s60, v18
    v_mul_f32 v225, s60, v19
    v_mul_f32 v226, s60, v20
    v_mul_f32 v227, s60, v21
    v_mul_f32 v228, s60, v22
    v_mul_f32 v229, s60, v23
    v_exp_f32 v214, v214
    v_exp_f32 v215, v215
    v_exp_f32 v216, v216
    v_exp_f32 v217, v217
    v_exp_f32 v218, v218
    v_exp_f32 v219, v219
    v_exp_f32 v220, v220
    v_exp_f32 v221, v221
    v_exp_f32 v222, v222
    v_exp_f32 v223, v223
    v_exp_f32 v224, v224
    v_exp_f32 v225, v225
    v_exp_f32 v226, v226
    v_exp_f32 v227, v227
    v_exp_f32 v228, v228
    v_exp_f32 v229, v229
    v_add_f32 v214, 1.0, v214
    v_add_f32 v215, 1.0, v215
    v_add_f32 v216, 1.0, v216
    v_add_f32 v217, 1.0, v217
    v_add_f32 v218, 1.0, v218
    v_add_f32 v219, 1.0, v219
    v_add_f32 v220, 1.0, v220
    v_add_f32 v221, 1.0, v221
    v_add_f32 v222, 1.0, v222
    v_add_f32 v223, 1.0, v223
    v_add_f32 v224, 1.0, v224
    v_add_f32 v225, 1.0, v225
    v_add_f32 v226, 1.0, v226
    v_add_f32 v227, 1.0, v227
    v_add_f32 v228, 1.0, v228
    v_add_f32 v229, 1.0, v229
    v_rcp_f32 v214, v214
    v_rcp_f32 v215, v215
    v_rcp_f32 v216, v216
    v_rcp_f32 v217, v217
    v_rcp_f32 v218, v218
    v_rcp_f32 v219, v219
    v_rcp_f32 v220, v220
    v_rcp_f32 v221, v221
    v_rcp_f32 v222, v222
    v_rcp_f32 v223, v223
    v_rcp_f32 v224, v224
    v_rcp_f32 v225, v225
    v_rcp_f32 v226, v226
    v_rcp_f32 v227, v227
    v_rcp_f32 v228, v228
    v_rcp_f32 v229, v229
    v_mul_f32 v8, v8, v214
    v_mul_f32 v9, v9, v215
    v_mul_f32 v10, v10, v216
    v_mul_f32 v11, v11, v217
    v_mul_f32 v12, v12, v218
    v_mul_f32 v13, v13, v219
    v_mul_f32 v14, v14, v220
    v_mul_f32 v15, v15, v221
    v_mul_f32 v16, v16, v222
    v_mul_f32 v17, v17, v223
    v_mul_f32 v18, v18, v224
    v_mul_f32 v19, v19, v225
    v_mul_f32 v20, v20, v226
    v_mul_f32 v21, v21, v227
    v_mul_f32 v22, v22, v228
    v_mul_f32 v23, v23, v229
    s_waitcnt vmcnt(9)
    v_dot2_f32_bf16 v172, v48, s54, 0
    v_dot2_f32_bf16 v173, v48, s55, 0
    v_dot2_f32_bf16 v174, v49, s54, 0
    v_dot2_f32_bf16 v175, v49, s55, 0
    v_dot2_f32_bf16 v176, v50, s54, 0
    v_dot2_f32_bf16 v177, v50, s55, 0
    v_dot2_f32_bf16 v178, v51, s54, 0
    v_dot2_f32_bf16 v179, v51, s55, 0
    v_dot2_f32_bf16 v180, v52, s54, 0
    v_dot2_f32_bf16 v181, v52, s55, 0
    v_dot2_f32_bf16 v182, v53, s54, 0
    v_dot2_f32_bf16 v183, v53, s55, 0
    v_dot2_f32_bf16 v184, v54, s54, 0
    v_dot2_f32_bf16 v185, v54, s55, 0
    v_dot2_f32_bf16 v186, v55, s54, 0
    v_dot2_f32_bf16 v187, v55, s55, 0
    v_dot2_f32_bf16 v172, v56, s54, v172
    v_dot2_f32_bf16 v173, v56, s55, v173
    v_dot2_f32_bf16 v174, v57, s54, v174
    v_dot2_f32_bf16 v175, v57, s55, v175
    v_dot2_f32_bf16 v176, v58, s54, v176
    v_dot2_f32_bf16 v177, v58, s55, v177
    v_dot2_f32_bf16 v178, v59, s54, v178
    v_dot2_f32_bf16 v179, v59, s55, v179
    v_dot2_f32_bf16 v180, v60, s54, v180
    v_dot2_f32_bf16 v181, v60, s55, v181
    v_dot2_f32_bf16 v182, v61, s54, v182
    v_dot2_f32_bf16 v183, v61, s55, v183
    v_dot2_f32_bf16 v184, v62, s54, v184
    v_dot2_f32_bf16 v185, v62, s55, v185
    v_dot2_f32_bf16 v186, v63, s54, v186
    v_dot2_f32_bf16 v187, v63, s55, v187
    v_dot2_f32_bf16 v172, v64, s54, v172
    v_dot2_f32_bf16 v173, v64, s55, v173
    v_dot2_f32_bf16 v174, v65, s54, v174
    v_dot2_f32_bf16 v175, v65, s55, v175
    v_dot2_f32_bf16 v176, v66, s54, v176
    v_dot2_f32_bf16 v177, v66, s55, v177
    v_dot2_f32_bf16 v178, v67, s54, v178
    v_dot2_f32_bf16 v179, v67, s55, v179
    v_dot2_f32_bf16 v180, v68, s54, v180
    v_dot2_f32_bf16 v181, v68, s55, v181
    v_dot2_f32_bf16 v182, v69, s54, v182
    v_dot2_f32_bf16 v183, v69, s55, v183
    v_dot2_f32_bf16 v184, v70, s54, v184
    v_dot2_f32_bf16 v185, v70, s55, v185
    v_dot2_f32_bf16 v186, v71, s54, v186
    v_dot2_f32_bf16 v187, v71, s55, v187
    v_dot2_f32_bf16 v172, v72, s54, v172
    v_dot2_f32_bf16 v173, v72, s55, v173
    v_dot2_f32_bf16 v174, v73, s54, v174
    v_dot2_f32_bf16 v175, v73, s55, v175
    v_dot2_f32_bf16 v176, v74, s54, v176
    v_dot2_f32_bf16 v177, v74, s55, v177
    v_dot2_f32_bf16 v178, v75, s54, v178
    v_dot2_f32_bf16 v179, v75, s55, v179
    v_dot2_f32_bf16 v180, v76, s54, v180
    v_dot2_f32_bf16 v181, v76, s55, v181
    v_dot2_f32_bf16 v182, v77, s54, v182
    v_dot2_f32_bf16 v183, v77, s55, v183
    v_dot2_f32_bf16 v184, v78, s54, v184
    v_dot2_f32_bf16 v185, v78, s55, v185
    v_dot2_f32_bf16 v186, v79, s54, v186
    v_dot2_f32_bf16 v187, v79, s55, v187
    v_dot2_f32_bf16 v172, v80, s54, v172
    v_dot2_f32_bf16 v173, v80, s55, v173
    v_dot2_f32_bf16 v174, v81, s54, v174
    v_dot2_f32_bf16 v175, v81, s55, v175
    v_dot2_f32_bf16 v176, v82, s54, v176
    v_dot2_f32_bf16 v177, v82, s55, v177
    v_dot2_f32_bf16 v178, v83, s54, v178
    v_dot2_f32_bf16 v179, v83, s55, v179
    v_dot2_f32_bf16 v180, v84, s54, v180
    v_dot2_f32_bf16 v181, v84, s55, v181
    v_dot2_f32_bf16 v182, v85, s54, v182
    v_dot2_f32_bf16 v183, v85, s55, v183
    v_dot2_f32_bf16 v184, v86, s54, v184
    v_dot2_f32_bf16 v185, v86, s55, v185
    v_dot2_f32_bf16 v186, v87, s54, v186
    v_dot2_f32_bf16 v187, v87, s55, v187
    v_dot2_f32_bf16 v172, v88, s54, v172
    v_dot2_f32_bf16 v173, v88, s55, v173
    v_dot2_f32_bf16 v174, v89, s54, v174
    v_dot2_f32_bf16 v175, v89, s55, v175
    v_dot2_f32_bf16 v176, v90, s54, v176
    v_dot2_f32_bf16 v177, v90, s55, v177
    v_dot2_f32_bf16 v178, v91, s54, v178
    v_dot2_f32_bf16 v179, v91, s55, v179
    v_dot2_f32_bf16 v180, v92, s54, v180
    v_dot2_f32_bf16 v181, v92, s55, v181
    v_dot2_f32_bf16 v182, v93, s54, v182
    v_dot2_f32_bf16 v183, v93, s55, v183
    v_dot2_f32_bf16 v184, v94, s54, v184
    v_dot2_f32_bf16 v185, v94, s55, v185
    v_dot2_f32_bf16 v186, v95, s54, v186
    v_dot2_f32_bf16 v187, v95, s55, v187
    v_dot2_f32_bf16 v172, v96, s54, v172
    v_dot2_f32_bf16 v173, v96, s55, v173
    v_dot2_f32_bf16 v174, v97, s54, v174
    v_dot2_f32_bf16 v175, v97, s55, v175
    v_dot2_f32_bf16 v176, v98, s54, v176
    v_dot2_f32_bf16 v177, v98, s55, v177
    v_dot2_f32_bf16 v178, v99, s54, v178
    v_dot2_f32_bf16 v179, v99, s55, v179
    v_dot2_f32_bf16 v180, v100, s54, v180
    v_dot2_f32_bf16 v181, v100, s55, v181
    v_dot2_f32_bf16 v182, v101, s54, v182
    v_dot2_f32_bf16 v183, v101, s55, v183
    v_dot2_f32_bf16 v184, v102, s54, v184
    v_dot2_f32_bf16 v185, v102, s55, v185
    v_dot2_f32_bf16 v186, v103, s54, v186
    v_dot2_f32_bf16 v187, v103, s55, v187
    v_dot2_f32_bf16 v172, v104, s54, v172
    v_dot2_f32_bf16 v173, v104, s55, v173
    v_dot2_f32_bf16 v174, v105, s54, v174
    v_dot2_f32_bf16 v175, v105, s55, v175
    v_dot2_f32_bf16 v176, v106, s54, v176
    v_dot2_f32_bf16 v177, v106, s55, v177
    v_dot2_f32_bf16 v178, v107, s54, v178
    v_dot2_f32_bf16 v179, v107, s55, v179
    v_dot2_f32_bf16 v180, v108, s54, v180
    v_dot2_f32_bf16 v181, v108, s55, v181
    v_dot2_f32_bf16 v182, v109, s54, v182
    v_dot2_f32_bf16 v183, v109, s55, v183
    v_dot2_f32_bf16 v184, v110, s54, v184
    v_dot2_f32_bf16 v185, v110, s55, v185
    v_dot2_f32_bf16 v186, v111, s54, v186
    v_dot2_f32_bf16 v187, v111, s55, v187
    v_mul_f32 v214, s60, v172
    v_mul_f32 v215, s60, v173
    v_mul_f32 v216, s60, v174
    v_mul_f32 v217, s60, v175
    v_mul_f32 v218, s60, v176
    v_mul_f32 v219, s60, v177
    v_mul_f32 v220, s60, v178
    v_mul_f32 v221, s60, v179
    v_mul_f32 v222, s60, v180
    v_mul_f32 v223, s60, v181
    v_mul_f32 v224, s60, v182
    v_mul_f32 v225, s60, v183
    v_mul_f32 v226, s60, v184
    v_mul_f32 v227, s60, v185
    v_mul_f32 v228, s60, v186
    v_mul_f32 v229, s60, v187
    v_exp_f32 v214, v214
    v_exp_f32 v215, v215
    v_exp_f32 v216, v216
    v_exp_f32 v217, v217
    v_exp_f32 v218, v218
    v_exp_f32 v219, v219
    v_exp_f32 v220, v220
    v_exp_f32 v221, v221
    v_exp_f32 v222, v222
    v_exp_f32 v223, v223
    v_exp_f32 v224, v224
    v_exp_f32 v225, v225
    v_exp_f32 v226, v226
    v_exp_f32 v227, v227
    v_exp_f32 v228, v228
    v_exp_f32 v229, v229
    v_add_f32 v214, 1.0, v214
    v_add_f32 v215, 1.0, v215
    v_add_f32 v216, 1.0, v216
    v_add_f32 v217, 1.0, v217
    v_add_f32 v218, 1.0, v218
    v_add_f32 v219, 1.0, v219
    v_add_f32 v220, 1.0, v220
    v_add_f32 v221, 1.0, v221
    v_add_f32 v222, 1.0, v222
    v_add_f32 v223, 1.0, v223
    v_add_f32 v224, 1.0, v224
    v_add_f32 v225, 1.0, v225
    v_add_f32 v226, 1.0, v226
    v_add_f32 v227, 1.0, v227
    v_add_f32 v228, 1.0, v228
    v_add_f32 v229, 1.0, v229
    v_rcp_f32 v214, v214
    v_rcp_f32 v215, v215
    v_rcp_f32 v216, v216
    v_rcp_f32 v217, v217
    v_rcp_f32 v218, v218
    v_rcp_f32 v219, v219
    v_rcp_f32 v220, v220
    v_rcp_f32 v221, v221
    v_rcp_f32 v222, v222
    v_rcp_f32 v223, v223
    v_rcp_f32 v224, v224
    v_rcp_f32 v225, v225
    v_rcp_f32 v226, v226
    v_rcp_f32 v227, v227
    v_rcp_f32 v228, v228
    v_rcp_f32 v229, v229
    v_mul_f32 v172, v172, v214
    v_mul_f32 v173, v173, v215
    v_mul_f32 v174, v174, v216
    v_mul_f32 v175, v175, v217
    v_mul_f32 v176, v176, v218
    v_mul_f32 v177, v177, v219
    v_mul_f32 v178, v178, v220
    v_mul_f32 v179, v179, v221
    v_mul_f32 v180, v180, v222
    v_mul_f32 v181, v181, v223
    v_mul_f32 v182, v182, v224
    v_mul_f32 v183, v183, v225
    v_mul_f32 v184, v184, v226
    v_mul_f32 v185, v185, v227
    v_mul_f32 v186, v186, v228
    v_mul_f32 v187, v187, v229
    s_waitcnt vmcnt(0)
    s_barrier
    s_mov_b32 s63, 1048576
POLL4_1:
    buffer_load_dword v213, v212, s[4:7], 0 offen sc1
    s_waitcnt vmcnt(0)
    v_cmp_eq_u32 vcc, -1, v213
    s_sub_u32 s63, s63, 1
    s_cselect_b64 vcc, 0, vcc
    s_cbranch_vccnz POLL4_1
    v_mov_b32 v194, 0
    s_add_u32 s54, s51, 0
    buffer_load_dwordx4 v[24:27], v248, s[4:7], s54 offen offset:0 sc1
    buffer_load_dwordx4 v[28:31], v248, s[4:7], s54 offen offset:1024 sc1
    buffer_load_dwordx4 v[32:35], v248, s[4:7], s54 offen offset:2048 sc1
    buffer_load_dwordx4 v[36:39], v248, s[4:7], s54 offen offset:3072 sc1
    s_add_u32 s54, s51, 4096
    buffer_load_dwordx4 v[40:43], v248, s[4:7], s54 offen offset:0 sc1
    buffer_load_dwordx4 v[44:47], v248, s[4:7], s54 offen offset:1024 sc1
    buffer_load_dwordx4 v[48:51], v248, s[4:7], s54 offen offset:2048 sc1
    buffer_load_dwordx4 v[52:55], v248, s[4:7], s54 offen offset:3072 sc1
    s_add_u32 s54, s51, 8192
    buffer_load_dwordx4 v[56:59], v248, s[4:7], s54 offen offset:0 sc1
    buffer_load_dwordx4 v[60:63], v248, s[4:7], s54 offen offset:1024 sc1
    buffer_load_dwordx4 v[64:67], v248, s[4:7], s54 offen offset:2048 sc1
    buffer_load_dwordx4 v[68:71], v248, s[4:7], s54 offen offset:3072 sc1
    s_add_u32 s54, s51, 12288
    buffer_load_dwordx4 v[72:75], v248, s[4:7], s54 offen offset:0 sc1
    buffer_load_dwordx4 v[76:79], v248, s[4:7], s54 offen offset:1024 sc1
    buffer_load_dwordx4 v[80:83], v248, s[4:7], s54 offen offset:2048 sc1
    buffer_load_dwordx4 v[84:87], v248, s[4:7], s54 offen offset:3072 sc1
    s_add_u32 s54, s51, 16384
    buffer_load_dwordx4 v[88:91], v248, s[4:7], s54 offen offset:0 sc1
    buffer_load_dwordx4 v[92:95], v248, s[4:7], s54 offen offset:1024 sc1
    buffer_load_dwordx4 v[96:99], v248, s[4:7], s54 offen offset:2048 sc1
    buffer_load_dwordx4 v[100:103], v248, s[4:7], s54 offen offset:3072 sc1
    s_add_u32 s54, s51, 20480
    buffer_load_dwordx4 v[104:107], v248, s[4:7], s54 offen offset:0 sc1
    buffer_load_dwordx4 v[108:111], v248, s[4:7], s54 offen offset:1024 sc1
    buffer_load_dwordx4 v[112:115], v248, s[4:7], s54 offen offset:2048 sc1
    buffer_load_dwordx4 v[116:119], v248, s[4:7], s54 offen offset:3072 sc1
    s_add_u32 s54, s51, 24576
    buffer_load_dwordx4 v[120:123], v248, s[4:7], s54 offen offset:0 sc1
    buffer_load_dwordx4 v[124:127], v248, s[4:7], s54 offen offset:1024 sc1
    buffer_load_dwordx4 v[128:131], v248, s[4:7], s54 offen offset:2048 sc1
    buffer_load_dwordx4 v[132:135], v248, s[4:7], s54 offen offset:3072 sc1
    s_add_u32 s54, s51, 28672
    buffer_load_dwordx4 v[136:139], v248, s[4:7], s54 offen offset:0 sc1
    buffer_load_dwordx4 v[140:143], v248, s[4:7], s54 offen offset:1024 sc1
    buffer_load_dwordx4 v[144:147], v248, s[4:7], s54 offen offset:2048 sc1
    buffer_load_dwordx4 v[148:151], v248, s[4:7], s54 offen offset:3072 sc1
    s_add_u32 s54, s51, 32768
    buffer_load_dword v152, v193, s[4:7], s54 offen offset:0 sc1
    buffer_load_dword v153, v193, s[4:7], s54 offen offset:128 sc1
    buffer_load_dword v154, v193, s[4:7], s54 offen offset:256 sc1
    buffer_load_dword v155, v193, s[4:7], s54 offen offset:384 sc1
    buffer_load_dword v156, v193, s[4:7], s54 offen offset:1024 sc1
    buffer_load_dword v157, v193, s[4:7], s54 offen offset:1152 sc1
    buffer_load_dword v158, v193, s[4:7], s54 offen offset:1280 sc1
    buffer_load_dword v159, v193, s[4:7], s54 offen offset:1408 sc1
    buffer_load_dword v160, v193, s[4:7], s54 offen offset:2048 sc1
    buffer_load_dword v161, v193, s[4:7], s54 offen offset:2176 sc1
    buffer_load_dword v162, v193, s[4:7], s54 offen offset:2304 sc1
    buffer_load_dword v163, v193, s[4:7], s54 offen offset:2432 sc1
    buffer_load_dword v164, v193, s[4:7], s54 offen offset:3072 sc1
    buffer_load_dword v165, v193, s[4:7], s54 offen offset:3200 sc1
    buffer_load_dword v166, v193, s[4:7], s54 offen offset:3328 sc1
    buffer_load_dword v167, v193, s[4:7], s54 offen offset:3456 sc1
    ds_read_b64_tr_b16 v[168:169], v247 offset:0
    ds_read_b64_tr_b16 v[170:171], v247 offset:512
    ds_read_b64_tr_b16 v[240:241], v250 offset:0
    ds_read_b64_tr_b16 v[242:243], v250 offset:512
    ds_read_b64_tr_b16 v[188:189], v247 offset:1152
    ds_read_b64_tr_b16 v[190:191], v247 offset:1664
    ds_read_b64_tr_b16 v[252:253], v250 offset:1152
    ds_read_b64_tr_b16 v[254:255], v250 offset:1664
    s_waitcnt vmcnt(47) lgkmcnt(4)
    v_mfma_f32_32x32x16_bf16 v[214:229], v[168:171], v[24:27], 0
    v_mfma_f32_32x32x16_bf16 v[196:211], v[240:243], v[24:27], 0
    ds_read_b64_tr_b16 v[168:169], v247 offset:2304
    ds_read_b64_tr_b16 v[170:171], v247 offset:2816
    ds_read_b64_tr_b16 v[240:241], v250 offset:2304
    ds_read_b64_tr_b16 v[242:243], v250 offset:2816
    v_max3_u32 v194, v194, v24, v25
    v_max3_u32 v194, v194, v26, v27
    s_waitcnt vmcnt(46) lgkmcnt(4)
    v_mfma_f32_32x32x16_bf16 v[214:229], v[188:191], v[28:31], v[214:229]
    v_mfma_f32_32x32x16_bf16 v[196:211], v[252:255], v[28:31], v[196:211]
    ds_read_b64_tr_b16 v[188:189], v247 offset:3456
    ds_read_b64_tr_b16 v[190:191], v247 offset:3968
    ds_read_b64_tr_b16 v[252:253], v250 offset:3456
    ds_read_b64_tr_b16 v[254:255], v250 offset:3968
    v_max3_u32 v194, v194, v28, v29
    v_max3_u32 v194, v194, v30, v31
    s_waitcnt vmcnt(45) lgkmcnt(4)
    v_mfma_f32_32x32x16_bf16 v[214:229], v[168:171], v[32:35], v[214:229]
    v_mfma_f32_32x32x16_bf16 v[196:211], v[240:243], v[32:35], v[196:211]
    ds_read_b64_tr_b16 v[168:169], v247 offset:4608
    ds_read_b64_tr_b16 v[170:171], v247 offset:5120
    ds_read_b64_tr_b16 v[240:241], v250 offset:4608
    ds_read_b64_tr_b16 v[242:243], v250 offset:5120
    v_max3_u32 v194, v194, v32, v33
    v_max3_u32 v194, v194, v34, v35
    s_waitcnt vmcnt(44) lgkmcnt(4)
    v_mfma_f32_32x32x16_bf16 v[214:229], v[188:191], v[36:39], v[214:229]
    v_mfma_f32_32x32x16_bf16 v[196:211], v[252:255], v[36:39], v[196:211]
    ds_read_b64_tr_b16 v[188:189], v247 offset:5760
    ds_read_b64_tr_b16 v[190:191], v247 offset:6272
    ds_read_b64_tr_b16 v[252:253], v250 offset:5760
    ds_read_b64_tr_b16 v[254:255], v250 offset:6272
    v_max3_u32 v194, v194, v36, v37
    v_max3_u32 v194, v194, v38, v39
    s_waitcnt vmcnt(43) lgkmcnt(4)
    v_mfma_f32_32x32x16_bf16 v[214:229], v[168:171], v[40:43], v[214:229]
    v_mfma_f32_32x32x16_bf16 v[196:211], v[240:243], v[40:43], v[196:211]
    ds_read_b64_tr_b16 v[168:169], v247 offset:6912
    ds_read_b64_tr_b16 v[170:171], v247 offset:7424
    ds_read_b64_tr_b16 v[240:241], v250 offset:6912
    ds_read_b64_tr_b16 v[242:243], v250 offset:7424
    v_max3_u32 v194, v194, v40, v41
    v_max3_u32 v194, v194, v42, v43
    s_waitcnt vmcnt(42) lgkmcnt(4)
    v_mfma_f32_32x32x16_bf16 v[214:229], v[188:191], v[44:47], v[214:229]
    v_mfma_f32_32x32x16_bf16 v[196:211], v[252:255], v[44:47], v[196:211]
    ds_read_b64_tr_b16 v[188:189], v247 offset:8064
    ds_read_b64_tr_b16 v[190:191], v247 offset:8576
    ds_read_b64_tr_b16 v[252:253], v250 offset:8064
    ds_read_b64_tr_b16 v[254:255], v250 offset:8576
    v_max3_u32 v194, v194, v44, v45
    v_max3_u32 v194, v194, v46, v47
    s_waitcnt vmcnt(41) lgkmcnt(4)
    v_mfma_f32_32x32x16_bf16 v[214:229], v[168:171], v[48:51], v[214:229]
    v_mfma_f32_32x32x16_bf16 v[196:211], v[240:243], v[48:51], v[196:211]
    ds_read_b64_tr_b16 v[168:169], v247 offset:9216
    ds_read_b64_tr_b16 v[170:171], v247 offset:9728
    ds_read_b64_tr_b16 v[240:241], v250 offset:9216
    ds_read_b64_tr_b16 v[242:243], v250 offset:9728
    v_max3_u32 v194, v194, v48, v49
    v_max3_u32 v194, v194, v50, v51
    s_waitcnt vmcnt(40) lgkmcnt(4)
    v_mfma_f32_32x32x16_bf16 v[214:229], v[188:191], v[52:55], v[214:229]
    v_mfma_f32_32x32x16_bf16 v[196:211], v[252:255], v[52:55], v[196:211]
    ds_read_b64_tr_b16 v[188:189], v247 offset:10368
    ds_read_b64_tr_b16 v[190:191], v247 offset:10880
    ds_read_b64_tr_b16 v[252:253], v250 offset:10368
    ds_read_b64_tr_b16 v[254:255], v250 offset:10880
    v_max3_u32 v194, v194, v52, v53
    v_max3_u32 v194, v194, v54, v55
    s_waitcnt vmcnt(39) lgkmcnt(4)
    v_mfma_f32_32x32x16_bf16 v[214:229], v[168:171], v[56:59], v[214:229]
    v_mfma_f32_32x32x16_bf16 v[196:211], v[240:243], v[56:59], v[196:211]
    ds_read_b64_tr_b16 v[168:169], v247 offset:11520
    ds_read_b64_tr_b16 v[170:171], v247 offset:12032
    ds_read_b64_tr_b16 v[240:241], v250 offset:11520
    ds_read_b64_tr_b16 v[242:243], v250 offset:12032
    v_max3_u32 v194, v194, v56, v57
    v_max3_u32 v194, v194, v58, v59
    s_waitcnt vmcnt(38) lgkmcnt(4)
    v_mfma_f32_32x32x16_bf16 v[214:229], v[188:191], v[60:63], v[214:229]
    v_mfma_f32_32x32x16_bf16 v[196:211], v[252:255], v[60:63], v[196:211]
    ds_read_b64_tr_b16 v[188:189], v247 offset:12672
    ds_read_b64_tr_b16 v[190:191], v247 offset:13184
    ds_read_b64_tr_b16 v[252:253], v250 offset:12672
    ds_read_b64_tr_b16 v[254:255], v250 offset:13184
    v_max3_u32 v194, v194, v60, v61
    v_max3_u32 v194, v194, v62, v63
    s_waitcnt vmcnt(37) lgkmcnt(4)
    v_mfma_f32_32x32x16_bf16 v[214:229], v[168:171], v[64:67], v[214:229]
    v_mfma_f32_32x32x16_bf16 v[196:211], v[240:243], v[64:67], v[196:211]
    ds_read_b64_tr_b16 v[168:169], v247 offset:13824
    ds_read_b64_tr_b16 v[170:171], v247 offset:14336
    ds_read_b64_tr_b16 v[240:241], v250 offset:13824
    ds_read_b64_tr_b16 v[242:243], v250 offset:14336
    v_max3_u32 v194, v194, v64, v65
    v_max3_u32 v194, v194, v66, v67
    s_waitcnt vmcnt(36) lgkmcnt(4)
    v_mfma_f32_32x32x16_bf16 v[214:229], v[188:191], v[68:71], v[214:229]
    v_mfma_f32_32x32x16_bf16 v[196:211], v[252:255], v[68:71], v[196:211]
    ds_read_b64_tr_b16 v[188:189], v247 offset:14976
    ds_read_b64_tr_b16 v[190:191], v247 offset:15488
    ds_read_b64_tr_b16 v[252:253], v250 offset:14976
    ds_read_b64_tr_b16 v[254:255], v250 offset:15488
    v_max3_u32 v194, v194, v68, v69
    v_max3_u32 v194, v194, v70, v71
    s_waitcnt vmcnt(35) lgkmcnt(4)
    v_mfma_f32_32x32x16_bf16 v[214:229], v[168:171], v[72:75], v[214:229]
    v_mfma_f32_32x32x16_bf16 v[196:211], v[240:243], v[72:75], v[196:211]
    ds_read_b64_tr_b16 v[168:169], v247 offset:16128
    ds_read_b64_tr_b16 v[170:171], v247 offset:16640
    ds_read_b64_tr_b16 v[240:241], v250 offset:16128
    ds_read_b64_tr_b16 v[242:243], v250 offset:16640
    v_max3_u32 v194, v194, v72, v73
    v_max3_u32 v194, v194, v74, v75
    s_waitcnt vmcnt(34) lgkmcnt(4)
    v_mfma_f32_32x32x16_bf16 v[214:229], v[188:191], v[76:79], v[214:229]
    v_mfma_f32_32x32x16_bf16 v[196:211], v[252:255], v[76:79], v[196:211]
    ds_read_b64_tr_b16 v[188:189], v247 offset:17280
    ds_read_b64_tr_b16 v[190:191], v247 offset:17792
    ds_read_b64_tr_b16 v[252:253], v250 offset:17280
    ds_read_b64_tr_b16 v[254:255], v250 offset:17792
    v_max3_u32 v194, v194, v76, v77
    v_max3_u32 v194, v194, v78, v79
    s_waitcnt vmcnt(33) lgkmcnt(4)
    v_mfma_f32_32x32x16_bf16 v[214:229], v[168:171], v[80:83], v[214:229]
    v_mfma_f32_32x32x16_bf16 v[196:211], v[240:243], v[80:83], v[196:211]
    ds_read_b64_tr_b16 v[168:169], v247 offset:18432
    ds_read_b64_tr_b16 v[170:171], v247 offset:18944
    ds_read_b64_tr_b16 v[240:241], v250 offset:18432
    ds_read_b64_tr_b16 v[242:243], v250 offset:18944
    v_max3_u32 v194, v194, v80, v81
    v_max3_u32 v194, v194, v82, v83
    s_waitcnt vmcnt(32) lgkmcnt(4)
    v_mfma_f32_32x32x16_bf16 v[214:229], v[188:191], v[84:87], v[214:229]
    v_mfma_f32_32x32x16_bf16 v[196:211], v[252:255], v[84:87], v[196:211]
    ds_read_b64_tr_b16 v[188:189], v247 offset:19584
    ds_read_b64_tr_b16 v[190:191], v247 offset:20096
    ds_read_b64_tr_b16 v[252:253], v250 offset:19584
    ds_read_b64_tr_b16 v[254:255], v250 offset:20096
    v_max3_u32 v194, v194, v84, v85
    v_max3_u32 v194, v194, v86, v87
    s_waitcnt vmcnt(31) lgkmcnt(4)
    v_mfma_f32_32x32x16_bf16 v[214:229], v[168:171], v[88:91], v[214:229]
    v_mfma_f32_32x32x16_bf16 v[196:211], v[240:243], v[88:91], v[196:211]
    ds_read_b64_tr_b16 v[168:169], v247 offset:20736
    ds_read_b64_tr_b16 v[170:171], v247 offset:21248
    ds_read_b64_tr_b16 v[240:241], v250 offset:20736
    ds_read_b64_tr_b16 v[242:243], v250 offset:21248
    v_max3_u32 v194, v194, v88, v89
    v_max3_u32 v194, v194, v90, v91
    s_waitcnt vmcnt(30) lgkmcnt(4)
    v_mfma_f32_32x32x16_bf16 v[214:229], v[188:191], v[92:95], v[214:229]
    v_mfma_f32_32x32x16_bf16 v[196:211], v[252:255], v[92:95], v[196:211]
    ds_read_b64_tr_b16 v[188:189], v247 offset:21888
    ds_read_b64_tr_b16 v[190:191], v247 offset:22400
    ds_read_b64_tr_b16 v[252:253], v250 offset:21888
    ds_read_b64_tr_b16 v[254:255], v250 offset:22400
    v_max3_u32 v194, v194, v92, v93
    v_max3_u32 v194, v194, v94, v95
    s_waitcnt vmcnt(29) lgkmcnt(4)
    v_mfma_f32_32x32x16_bf16 v[214:229], v[168:171], v[96:99], v[214:229]
    v_mfma_f32_32x32x16_bf16 v[196:211], v[240:243], v[96:99], v[196:211]
    ds_read_b64_tr_b16 v[168:169], v247 offset:23040
    ds_read_b64_tr_b16 v[170:171], v247 offset:23552
    ds_read_b64_tr_b16 v[240:241], v250 offset:23040
    ds_read_b64_tr_b16 v[242:243], v250 offset:23552
    v_max3_u32 v194, v194, v96, v97
    v_max3_u32 v194, v194, v98, v99
    s_waitcnt vmcnt(28) lgkmcnt(4)
    v_mfma_f32_32x32x16_bf16 v[214:229], v[188:191], v[100:103], v[214:229]
    v_mfma_f32_32x32x16_bf16 v[196:211], v[252:255], v[100:103], v[196:211]
    ds_read_b64_tr_b16 v[188:189], v247 offset:24192
    ds_read_b64_tr_b16 v[190:191], v247 offset:24704
    ds_read_b64_tr_b16 v[252:253], v250 offset:24192
    ds_read_b64_tr_b16 v[254:255], v250 offset:24704
    v_max3_u32 v194, v194, v100, v101
    v_max3_u32 v194, v194, v102, v103
    s_waitcnt vmcnt(27) lgkmcnt(4)
    v_mfma_f32_32x32x16_bf16 v[214:229], v[168:171], v[104:107], v[214:229]
    v_mfma_f32_32x32x16_bf16 v[196:211], v[240:243], v[104:107], v[196:211]
    ds_read_b64_tr_b16 v[168:169], v247 offset:25344
    ds_read_b64_tr_b16 v[170:171], v247 offset:25856
    ds_read_b64_tr_b16 v[240:241], v250 offset:25344
    ds_read_b64_tr_b16 v[242:243], v250 offset:25856
    v_max3_u32 v194, v194, v104, v105
    v_max3_u32 v194, v194, v106, v107
    s_waitcnt vmcnt(26) lgkmcnt(4)
    v_mfma_f32_32x32x16_bf16 v[214:229], v[188:191], v[108:111], v[214:229]
    v_mfma_f32_32x32x16_bf16 v[196:211], v[252:255], v[108:111], v[196:211]
    ds_read_b64_tr_b16 v[188:189], v247 offset:26496
    ds_read_b64_tr_b16 v[190:191], v247 offset:27008
    ds_read_b64_tr_b16 v[252:253], v250 offset:26496
    ds_read_b64_tr_b16 v[254:255], v250 offset:27008
    v_max3_u32 v194, v194, v108, v109
    v_max3_u32 v194, v194, v110, v111
    s_waitcnt vmcnt(25) lgkmcnt(4)
    v_mfma_f32_32x32x16_bf16 v[214:229], v[168:171], v[112:115], v[214:229]
    v_mfma_f32_32x32x16_bf16 v[196:211], v[240:243], v[112:115], v[196:211]
    ds_read_b64_tr_b16 v[168:169], v247 offset:27648
    ds_read_b64_tr_b16 v[170:171], v247 offset:28160
    ds_read_b64_tr_b16 v[240:241], v250 offset:27648
    ds_read_b64_tr_b16 v[242:243], v250 offset:28160
    v_max3_u32 v194, v194, v112, v113
    v_max3_u32 v194, v194, v114, v115
    s_waitcnt vmcnt(24) lgkmcnt(4)
    v_mfma_f32_32x32x16_bf16 v[214:229], v[188:191], v[116:119], v[214:229]
    v_mfma_f32_32x32x16_bf16 v[196:211], v[252:255], v[116:119], v[196:211]
    ds_read_b64_tr_b16 v[188:189], v247 offset:28800
    ds_read_b64_tr_b16 v[190:191], v247 offset:29312
    ds_read_b64_tr_b16 v[252:253], v250 offset:28800
    ds_read_b64_tr_b16 v[254:255], v250 offset:29312
    v_max3_u32 v194, v194, v116, v117
    v_max3_u32 v194, v194, v118, v119
    s_waitcnt vmcnt(23) lgkmcnt(4)
    v_mfma_f32_32x32x16_bf16 v[214:229], v[168:171], v[120:123], v[214:229]
    v_mfma_f32_32x32x16_bf16 v[196:211], v[240:243], v[120:123], v[196:211]
    ds_read_b64_tr_b16 v[168:169], v247 offset:29952
    ds_read_b64_tr_b16 v[170:171], v247 offset:30464
    ds_read_b64_tr_b16 v[240:241], v250 offset:29952
    ds_read_b64_tr_b16 v[242:243], v250 offset:30464
    v_max3_u32 v194, v194, v120, v121
    v_max3_u32 v194, v194, v122, v123
    s_waitcnt vmcnt(22) lgkmcnt(4)
    v_mfma_f32_32x32x16_bf16 v[214:229], v[188:191], v[124:127], v[214:229]
    v_mfma_f32_32x32x16_bf16 v[196:211], v[252:255], v[124:127], v[196:211]
    ds_read_b64_tr_b16 v[188:189], v247 offset:31104
    ds_read_b64_tr_b16 v[190:191], v247 offset:31616
    ds_read_b64_tr_b16 v[252:253], v250 offset:31104
    ds_read_b64_tr_b16 v[254:255], v250 offset:31616
    v_max3_u32 v194, v194, v124, v125
    v_max3_u32 v194, v194, v126, v127
    s_waitcnt vmcnt(21) lgkmcnt(4)
    v_mfma_f32_32x32x16_bf16 v[214:229], v[168:171], v[128:131], v[214:229]
    v_mfma_f32_32x32x16_bf16 v[196:211], v[240:243], v[128:131], v[196:211]
    ds_read_b64_tr_b16 v[168:169], v247 offset:32256
    ds_read_b64_tr_b16 v[170:171], v247 offset:32768
    ds_read_b64_tr_b16 v[240:241], v250 offset:32256
    ds_read_b64_tr_b16 v[242:243], v250 offset:32768
    v_max3_u32 v194, v194, v128, v129
    v_max3_u32 v194, v194, v130, v131
    s_waitcnt vmcnt(20) lgkmcnt(4)
    v_mfma_f32_32x32x16_bf16 v[214:229], v[188:191], v[132:135], v[214:229]
    v_mfma_f32_32x32x16_bf16 v[196:211], v[252:255], v[132:135], v[196:211]
    ds_read_b64_tr_b16 v[188:189], v247 offset:33408
    ds_read_b64_tr_b16 v[190:191], v247 offset:33920
    ds_read_b64_tr_b16 v[252:253], v250 offset:33408
    ds_read_b64_tr_b16 v[254:255], v250 offset:33920
    v_max3_u32 v194, v194, v132, v133
    v_max3_u32 v194, v194, v134, v135
    s_waitcnt vmcnt(19) lgkmcnt(4)
    v_mfma_f32_32x32x16_bf16 v[214:229], v[168:171], v[136:139], v[214:229]
    v_mfma_f32_32x32x16_bf16 v[196:211], v[240:243], v[136:139], v[196:211]
    ds_read_b64_tr_b16 v[168:169], v247 offset:34560
    ds_read_b64_tr_b16 v[170:171], v247 offset:35072
    ds_read_b64_tr_b16 v[240:241], v250 offset:34560
    ds_read_b64_tr_b16 v[242:243], v250 offset:35072
    v_max3_u32 v194, v194, v136, v137
    v_max3_u32 v194, v194, v138, v139
    s_waitcnt vmcnt(18) lgkmcnt(4)
    v_mfma_f32_32x32x16_bf16 v[214:229], v[188:191], v[140:143], v[214:229]
    v_mfma_f32_32x32x16_bf16 v[196:211], v[252:255], v[140:143], v[196:211]
    ds_read_b64_tr_b16 v[188:189], v247 offset:35712
    ds_read_b64_tr_b16 v[190:191], v247 offset:36224
    ds_read_b64_tr_b16 v[252:253], v250 offset:35712
    ds_read_b64_tr_b16 v[254:255], v250 offset:36224
    v_max3_u32 v194, v194, v140, v141
    v_max3_u32 v194, v194, v142, v143
    s_waitcnt vmcnt(17) lgkmcnt(4)
    v_mfma_f32_32x32x16_bf16 v[214:229], v[168:171], v[144:147], v[214:229]
    v_mfma_f32_32x32x16_bf16 v[196:211], v[240:243], v[144:147], v[196:211]
    ds_read_b64_tr_b16 v[168:169], v249 offset:0
    ds_read_b64_tr_b16 v[170:171], v249 offset:2304
    ds_read_b64_tr_b16 v[240:241], v192 offset:0
    ds_read_b64_tr_b16 v[242:243], v192 offset:2304
    v_max3_u32 v194, v194, v144, v145
    v_max3_u32 v194, v194, v146, v147
    s_waitcnt vmcnt(16) lgkmcnt(4)
    v_mfma_f32_32x32x16_bf16 v[214:229], v[188:191], v[148:151], v[214:229]
    v_mfma_f32_32x32x16_bf16 v[196:211], v[252:255], v[148:151], v[196:211]
    ds_read_b64_tr_b16 v[188:189], v249 offset:9216
    ds_read_b64_tr_b16 v[190:191], v249 offset:11520
    ds_read_b64_tr_b16 v[252:253], v192 offset:9216
    ds_read_b64_tr_b16 v[254:255], v192 offset:11520
    v_max3_u32 v194, v194, v148, v149
    v_max3_u32 v194, v194, v150, v151
    s_waitcnt vmcnt(12) lgkmcnt(4)
    v_mfma_f32_32x32x16_bf16 v[214:229], v[168:171], v[152:155], v[214:229]
    v_mfma_f32_32x32x16_bf16 v[196:211], v[240:243], v[152:155], v[196:211]
    ds_read_b64_tr_b16 v[168:169], v249 offset:18432
    ds_read_b64_tr_b16 v[170:171], v249 offset:20736
    ds_read_b64_tr_b16 v[240:241], v192 offset:18432
    ds_read_b64_tr_b16 v[242:243], v192 offset:20736
    v_max3_u32 v194, v194, v152, v153
    v_max3_u32 v194, v194, v154, v155
    s_waitcnt vmcnt(8) lgkmcnt(4)
    v_mfma_f32_32x32x16_bf16 v[214:229], v[188:191], v[156:159], v[214:229]
    v_mfma_f32_32x32x16_bf16 v[196:211], v[252:255], v[156:159], v[196:211]
    ds_read_b64_tr_b16 v[188:189], v249 offset:27648
    ds_read_b64_tr_b16 v[190:191], v249 offset:29952
    ds_read_b64_tr_b16 v[252:253], v192 offset:27648
    ds_read_b64_tr_b16 v[254:255], v192 offset:29952
    v_max3_u32 v194, v194, v156, v157
    v_max3_u32 v194, v194, v158, v159
    s_waitcnt vmcnt(4) lgkmcnt(4)
    v_mfma_f32_32x32x16_bf16 v[214:229], v[168:171], v[160:163], v[214:229]
    v_mfma_f32_32x32x16_bf16 v[196:211], v[240:243], v[160:163], v[196:211]
    v_max3_u32 v194, v194, v160, v161
    v_max3_u32 v194, v194, v162, v163
    s_waitcnt vmcnt(0) lgkmcnt(0)
    v_mfma_f32_32x32x16_bf16 v[214:229], v[188:191], v[164:167], v[214:229]
    v_mfma_f32_32x32x16_bf16 v[196:211], v[252:255], v[164:167], v[196:211]
    v_max3_u32 v194, v194, v164, v165
    v_max3_u32 v194, v194, v166, v167
    v_cmp_eq_u32 vcc, -1, v194
    s_cmp_lt_i32 s63, 1
    s_cselect_b64 vcc, 0, vcc
    s_cbranch_vccnz POLL4_1
    v_lshlrev_b32 v24, 16, v0
    v_and_b32 v25, 0xffff0000, v0
    v_lshlrev_b32 v26, 16, v1
    v_and_b32 v27, 0xffff0000, v1
    v_lshlrev_b32 v28, 16, v2
    v_and_b32 v29, 0xffff0000, v2
    v_lshlrev_b32 v30, 16, v3
    v_and_b32 v31, 0xffff0000, v3
    v_lshlrev_b32 v32, 16, v4
    v_and_b32 v33, 0xffff0000, v4
    v_lshlrev_b32 v34, 16, v5
    v_and_b32 v35, 0xffff0000, v5
    v_lshlrev_b32 v36, 16, v6
    v_and_b32 v37, 0xffff0000, v6
    v_lshlrev_b32 v38, 16, v7
    v_and_b32 v39, 0xffff0000, v7
    v_fma_f32 v8, v8, v214, v24
    v_fma_f32 v9, v9, v215, v25
    v_fma_f32 v10, v10, v216, v26
    v_fma_f32 v11, v11, v217, v27
    v_fma_f32 v12, v12, v218, v28
    v_fma_f32 v13, v13, v219, v29
    v_fma_f32 v14, v14, v220, v30
    v_fma_f32 v15, v15, v221, v31
    v_fma_f32 v16, v16, v222, v32
    v_fma_f32 v17, v17, v223, v33
    v_fma_f32 v18, v18, v224, v34
    v_fma_f32 v19, v19, v225, v35
    v_fma_f32 v20, v20, v226, v36
    v_fma_f32 v21, v21, v227, v37
    v_fma_f32 v22, v22, v228, v38
    v_fma_f32 v23, v23, v229, v39
    v_cvt_pk_bf16_f32 v0, v8, v9
    v_cvt_pk_bf16_f32 v1, v10, v11
    v_cvt_pk_bf16_f32 v2, v12, v13
    v_cvt_pk_bf16_f32 v3, v14, v15
    v_cvt_pk_bf16_f32 v4, v16, v17
    v_cvt_pk_bf16_f32 v5, v18, v19
    v_cvt_pk_bf16_f32 v6, v20, v21
    v_cvt_pk_bf16_f32 v7, v22, v23
    buffer_store_dwordx4 v[0:3], v246, s[56:59], s8 offen offset:0
    buffer_store_dwordx4 v[4:7], v246, s[56:59], s8 offen offset:16
    v_lshlrev_b32 v24, 16, v230
    v_and_b32 v25, 0xffff0000, v230
    v_lshlrev_b32 v26, 16, v231
    v_and_b32 v27, 0xffff0000, v231
    v_lshlrev_b32 v28, 16, v232
    v_and_b32 v29, 0xffff0000, v232
    v_lshlrev_b32 v30, 16, v233
    v_and_b32 v31, 0xffff0000, v233
    v_lshlrev_b32 v32, 16, v234
    v_and_b32 v33, 0xffff0000, v234
    v_lshlrev_b32 v34, 16, v235
    v_and_b32 v35, 0xffff0000, v235
    v_lshlrev_b32 v36, 16, v236
    v_and_b32 v37, 0xffff0000, v236
    v_lshlrev_b32 v38, 16, v237
    v_and_b32 v39, 0xffff0000, v237
    v_fma_f32 v172, v172, v196, v24
    v_fma_f32 v173, v173, v197, v25
    v_fma_f32 v174, v174, v198, v26
    v_fma_f32 v175, v175, v199, v27
    v_fma_f32 v176, v176, v200, v28
    v_fma_f32 v177, v177, v201, v29
    v_fma_f32 v178, v178, v202, v30
    v_fma_f32 v179, v179, v203, v31
    v_fma_f32 v180, v180, v204, v32
    v_fma_f32 v181, v181, v205, v33
    v_fma_f32 v182, v182, v206, v34
    v_fma_f32 v183, v183, v207, v35
    v_fma_f32 v184, v184, v208, v36
    v_fma_f32 v185, v185, v209, v37
    v_fma_f32 v186, v186, v210, v38
    v_fma_f32 v187, v187, v211, v39
    v_cvt_pk_bf16_f32 v230, v172, v173
    v_cvt_pk_bf16_f32 v231, v174, v175
    v_cvt_pk_bf16_f32 v232, v176, v177
    v_cvt_pk_bf16_f32 v233, v178, v179
    v_cvt_pk_bf16_f32 v234, v180, v181
    v_cvt_pk_bf16_f32 v235, v182, v183
    v_cvt_pk_bf16_f32 v236, v184, v185
    v_cvt_pk_bf16_f32 v237, v186, v187
    buffer_store_dwordx4 v[230:233], v246, s[56:59], s9 offen offset:0
    buffer_store_dwordx4 v[234:237], v246, s[56:59], s9 offen offset:16
PK_end:
PK_done:
    s_endpgm
ATT_fallback:
    v_mov_b32 v1, 0xff800000
    s_mov_b32 s38, s37
    s_mov_b32 s39, 64
ATT_fb1_0:
    buffer_load_dwordx4 v[88:91], v220, s[4:7], s38 offen sc1
    buffer_load_ushort v112, v222, s[4:7], s38 offen sc1
    s_waitcnt vmcnt(0)
    v_mfma_f32_32x32x16_bf16 v[8:23], v[88:91], v[208:211], 0
    v_mfma_f32_32x32x8bf16_1k v[8:23], v[112:113], v[216:217], v[8:23]
    s_nop 7
    s_nop 7
    v_max3_f32 v1, v1, v8, v9
    v_max3_f32 v1, v1, v10, v11
    v_max3_f32 v1, v1, v12, v13
    v_max3_f32 v1, v1, v14, v15
    v_max3_f32 v1, v1, v16, v17
    v_max3_f32 v1, v1, v18, v19
    v_max3_f32 v1, v1, v20, v21
    v_max3_f32 v1, v1, v22, v23
    s_add_u32 s38, s38, 3072
    s_sub_u32 s39, s39, 1
    s_cmp_lg_u32 s39, 0
    s_cbranch_scc1 ATT_fb1_0
    v_mov_b32 v2, v1
    s_nop 1
    v_permlane32_swap_b32 v1, v2
    s_nop 1
    v_max_f32 v1, v1, v2
    v_sub_f32 v116, 0, v1
    v_mov_b32 v40, 0
    v_sub_f32 v117, 0, v1
    v_mov_b32 v41, 0
    v_sub_f32 v118, 0, v1
    v_mov_b32 v42, 0
    v_sub_f32 v119, 0, v1
    v_mov_b32 v43, 0
    v_sub_f32 v120, 0, v1
    v_mov_b32 v44, 0
    v_sub_f32 v121, 0, v1
    v_mov_b32 v45, 0
    v_sub_f32 v122, 0, v1
    v_mov_b32 v46, 0
    v_sub_f32 v123, 0, v1
    v_mov_b32 v47, 0
    v_sub_f32 v124, 0, v1
    v_mov_b32 v48, 0
    v_sub_f32 v125, 0, v1
    v_mov_b32 v49, 0
    v_sub_f32 v126, 0, v1
    v_mov_b32 v50, 0
    v_sub_f32 v127, 0, v1
    v_mov_b32 v51, 0
    v_sub_f32 v128, 0, v1
    v_mov_b32 v52, 0
    v_sub_f32 v129, 0, v1
    v_mov_b32 v53, 0
    v_sub_f32 v130, 0, v1
    v_mov_b32 v54, 0
    v_sub_f32 v131, 0, v1
    v_mov_b32 v55, 0
    s_mov_b32 s38, s37
    s_mov_b32 s39, 64
ATT_fb2_0:
    buffer_load_dwordx4 v[88:91], v220, s[4:7], s38 offen sc1
    buffer_load_ushort v112, v222, s[4:7], s38 offen sc1
    buffer_load_dwordx4 v[104:107], v221, s[4:7], s38 offen offset:1024 sc1
    buffer_load_dwordx4 v[96:99], v221, s[4:7], s38 offen offset:2048 sc1
    s_waitcnt vmcnt(0)
    v_mfma_f32_32x32x16_bf16 v[8:23], v[88:91], v[208:211], v[116:131]
    v_mfma_f32_32x32x8bf16_1k v[8:23], v[112:113], v[216:217], v[8:23]
    s_nop 7
    s_nop 7
    v_exp_f32 v8, v8
    v_exp_f32 v9, v9
    v_exp_f32 v10, v10
    v_exp_f32 v11, v11
    v_exp_f32 v12, v12
    v_exp_f32 v13, v13
    v_exp_f32 v14, v14
    v_exp_f32 v15, v15
    v_exp_f32 v16, v16
    v_exp_f32 v17, v17
    v_exp_f32 v18, v18
    v_exp_f32 v19, v19
    v_exp_f32 v20, v20
    v_exp_f32 v21, v21
    v_exp_f32 v22, v22
    v_exp_f32 v23, v23
    s_nop 0
    v_cvt_pk_bf16_f32 v72, v8, v9
    v_cvt_pk_bf16_f32 v73, v10, v11
    v_cvt_pk_bf16_f32 v74, v12, v13
    v_cvt_pk_bf16_f32 v75, v14, v15
    v_cvt_pk_bf16_f32 v76, v16, v17
    v_cvt_pk_bf16_f32 v77, v18, v19
    v_cvt_pk_bf16_f32 v78, v20, v21
    v_cvt_pk_bf16_f32 v79, v22, v23
    s_nop 1
    v_mfma_f32_32x32x16_bf16 v[40:55], v[104:107], v[72:75], v[40:55]
    v_mfma_f32_32x32x16_bf16 v[40:55], v[96:99], v[76:79], v[40:55]
    s_add_u32 s38, s38, 3072
    s_sub_u32 s39, s39, 1
    s_cmp_lg_u32 s39, 0
    s_cbranch_scc1 ATT_fb2_0
    s_nop 7
    s_nop 7
    v_mov_b32 v1, 0xff800000
    s_mov_b32 s38, s37
    s_mov_b32 s39, 64
ATT_fb1_1:
    buffer_load_dwordx4 v[88:91], v220, s[4:7], s38 offen sc1
    buffer_load_ushort v112, v222, s[4:7], s38 offen sc1
    s_waitcnt vmcnt(0)
    v_mfma_f32_32x32x16_bf16 v[8:23], v[88:91], v[212:215], 0
    v_mfma_f32_32x32x8bf16_1k v[8:23], v[112:113], v[218:219], v[8:23]
    s_nop 7
    s_nop 7
    v_max3_f32 v1, v1, v8, v9
    v_max3_f32 v1, v1, v10, v11
    v_max3_f32 v1, v1, v12, v13
    v_max3_f32 v1, v1, v14, v15
    v_max3_f32 v1, v1, v16, v17
    v_max3_f32 v1, v1, v18, v19
    v_max3_f32 v1, v1, v20, v21
    v_max3_f32 v1, v1, v22, v23
    s_add_u32 s38, s38, 3072
    s_sub_u32 s39, s39, 1
    s_cmp_lg_u32 s39, 0
    s_cbranch_scc1 ATT_fb1_1
    v_mov_b32 v2, v1
    s_nop 1
    v_permlane32_swap_b32 v1, v2
    s_nop 1
    v_max_f32 v1, v1, v2
    v_sub_f32 v116, 0, v1
    v_mov_b32 v56, 0
    v_sub_f32 v117, 0, v1
    v_mov_b32 v57, 0
    v_sub_f32 v118, 0, v1
    v_mov_b32 v58, 0
    v_sub_f32 v119, 0, v1
    v_mov_b32 v59, 0
    v_sub_f32 v120, 0, v1
    v_mov_b32 v60, 0
    v_sub_f32 v121, 0, v1
    v_mov_b32 v61, 0
    v_sub_f32 v122, 0, v1
    v_mov_b32 v62, 0
    v_sub_f32 v123, 0, v1
    v_mov_b32 v63, 0
    v_sub_f32 v124, 0, v1
    v_mov_b32 v64, 0
    v_sub_f32 v125, 0, v1
    v_mov_b32 v65, 0
    v_sub_f32 v126, 0, v1
    v_mov_b32 v66, 0
    v_sub_f32 v127, 0, v1
    v_mov_b32 v67, 0
    v_sub_f32 v128, 0, v1
    v_mov_b32 v68, 0
    v_sub_f32 v129, 0, v1
    v_mov_b32 v69, 0
    v_sub_f32 v130, 0, v1
    v_mov_b32 v70, 0
    v_sub_f32 v131, 0, v1
    v_mov_b32 v71, 0
    s_mov_b32 s38, s37
    s_mov_b32 s39, 64
ATT_fb2_1:
    buffer_load_dwordx4 v[88:91], v220, s[4:7], s38 offen sc1
    buffer_load_ushort v112, v222, s[4:7], s38 offen sc1
    buffer_load_dwordx4 v[104:107], v221, s[4:7], s38 offen offset:1024 sc1
    buffer_load_dwordx4 v[96:99], v221, s[4:7], s38 offen offset:2048 sc1
    s_waitcnt vmcnt(0)
    v_mfma_f32_32x32x16_bf16 v[8:23], v[88:91], v[212:215], v[116:131]
    v_mfma_f32_32x32x8bf16_1k v[8:23], v[112:113], v[218:219], v[8:23]
    s_nop 7
    s_nop 7
    v_exp_f32 v8, v8
    v_exp_f32 v9, v9
    v_exp_f32 v10, v10
    v_exp_f32 v11, v11
    v_exp_f32 v12, v12
    v_exp_f32 v13, v13
    v_exp_f32 v14, v14
    v_exp_f32 v15, v15
    v_exp_f32 v16, v16
    v_exp_f32 v17, v17
    v_exp_f32 v18, v18
    v_exp_f32 v19, v19
    v_exp_f32 v20, v20
    v_exp_f32 v21, v21
    v_exp_f32 v22, v22
    v_exp_f32 v23, v23
    s_nop 0
    v_cvt_pk_bf16_f32 v72, v8, v9
    v_cvt_pk_bf16_f32 v73, v10, v11
    v_cvt_pk_bf16_f32 v74, v12, v13
    v_cvt_pk_bf16_f32 v75, v14, v15
    v_cvt_pk_bf16_f32 v76, v16, v17
    v_cvt_pk_bf16_f32 v77, v18, v19
    v_cvt_pk_bf16_f32 v78, v20, v21
    v_cvt_pk_bf16_f32 v79, v22, v23
    s_nop 1
    v_mfma_f32_32x32x16_bf16 v[56:71], v[104:107], v[72:75], v[56:71]
    v_mfma_f32_32x32x16_bf16 v[56:71], v[96:99], v[76:79], v[56:71]
    s_add_u32 s38, s38, 3072
    s_sub_u32 s39, s39, 1
    s_cmp_lg_u32 s39, 0
    s_cbranch_scc1 ATT_fb2_1
    s_nop 7
    s_nop 7
    s_branch ATT_finish
CODE_END:
.section .rodata,"a"
.p2align 6
.amdhsa_kernel recurrent_scan__softmax_full_mha__glu_gated_glu__prompt_kernel
  .amdhsa_next_free_vgpr 256
  .amdhsa_next_free_sgpr 102
  .amdhsa_accum_offset 256
  .amdhsa_group_segment_fixed_size 0
  .amdhsa_kernarg_size 80
  .amdhsa_user_sgpr_count 2
  .amdhsa_user_sgpr_kernarg_segment_ptr 1
  .amdhsa_system_sgpr_workgroup_id_x 1
.end_amdhsa_kernel
```
